```python
import torch

def _softmax(x, axis=-1):
    return torch.softmax(x, dim=axis)
def _gelu(x):
    return torch.nn.functional.gelu(x, approximate="tanh")
def _silu(x):
    return torch.nn.functional.silu(x)
def _sigmoid(x):
    return torch.sigmoid(x)
def _layernorm(x, axis=-1, eps=1e-5):
    m = x.mean(dim=axis, keepdim=True)
    v = x.var(dim=axis, keepdim=True, unbiased=False)
    return (x - m) / torch.sqrt(v + eps)
def _scatter_add(tgt, idx, src, axis=0):
    return tgt.clone().index_add_(axis, idx, src)
def _segment_sum(src, seg, n):
    out = torch.zeros((n,) + src.shape[1:], dtype=src.dtype)
    return out.index_add_(0, seg, src)
def _pad(x, pw):
    flat = tuple(v for pair in reversed(pw) for v in pair)
    return torch.nn.functional.pad(x, flat)

kernel_name = 'gated_mix__compressed_kv_cla__dense_activation_gelu__prompt'

def setup_inputs():

    _w = (lambda a: (lambda t: t.to(torch.bfloat16) if t.is_floating_point() else t)(torch.as_tensor(a)))
    def _A_setup():
        B, H, Sq, Sk, D, M = 1, 32, 2048, 2048, 128, 640
        Dc = 4 * D
        return {
            "x": _w((lambda *s: torch.randn(*s, dtype=torch.bfloat16) * 0.05)(B, Sq, M)),
            "c_kv": _w((lambda *s: torch.randn(*s, dtype=torch.bfloat16) * 0.4)(B, Sk, Dc)),
            "w_q": _w((lambda *s: torch.randn(*s, dtype=torch.bfloat16) * 6.4)(M, H, D) * (M ** -0.5)),
            "w_uk": _w((lambda *s: torch.randn(*s, dtype=torch.bfloat16) * 6.4)(Dc, H, D) * (Dc ** -0.5)),
            "w_uv": _w((lambda *s: torch.randn(*s, dtype=torch.bfloat16) * 0.4)(Dc, H, D) * (Dc ** -0.5)),
            "w_o": _w((lambda *s: torch.randn(*s, dtype=torch.bfloat16) * 0.4)(H, D, M) * ((H * D) ** -0.5)),
        }
    _A_in = _A_setup()

    def _B_setup():
        B, S, D, F = 1, 2048, 640, 1728
        return {
            "x": _w((lambda *s: torch.randn(*s, dtype=torch.bfloat16) * 0.05)(B, S, D)),
            "w1": _w((lambda *s: torch.randn(*s, dtype=torch.bfloat16) * 3.2)(D, F) * (D ** -0.5)),
            "b1": _w((lambda *s: torch.randn(*s, dtype=torch.bfloat16) * 3.2)(F) * 0.01),
            "w2": _w((lambda *s: torch.randn(*s, dtype=torch.bfloat16) * 0.4)(F, D) * (F ** -0.5)),
            "b2": _w((lambda *s: torch.randn(*s, dtype=torch.bfloat16) * 0.8)(D) * 0.01),
        }
    _B_in = _B_setup()

    return {
        "A_x": _A_in["x"],
        "A_c_kv": _A_in["c_kv"],
        "A_w_q": _A_in["w_q"],
        "A_w_uk": _A_in["w_uk"],
        "A_w_uv": _A_in["w_uv"],
        "A_w_o": _A_in["w_o"],
        "B_x": _B_in["x"],
        "B_w1": _B_in["w1"],
        "B_b1": _B_in["b1"],
        "B_w2": _B_in["w2"],
        "B_b2": _B_in["b2"],
        "gate_w": _w((lambda *s: torch.randn(*s, dtype=torch.bfloat16) * 0.05)(640) * 16.0),
    }

def reference(A_x, A_c_kv, A_w_q, A_w_uk, A_w_uv, A_w_o, B_x, B_w1, B_b1, B_w2, B_b2, gate_w):
    def _A_ref(x, c_kv, w_q, w_uk, w_uv, w_o):
        B, Sq, M = x.shape[0], x.shape[1], x.shape[2]
        Sk = c_kv.shape[1]
        H, D = w_q.shape[1], w_q.shape[2]
        q = torch.einsum("bqm,mhd->bhqd", x, w_q)
        k = torch.einsum("bkc,chd->bhkd", c_kv, w_uk)
        v = torch.einsum("bkc,chd->bhkd", c_kv, w_uv)
        scores = torch.einsum("bhqd,bhkd->bhqk", q, k) * (D ** -0.5)
        off = Sk - Sq
        qi = torch.arange(Sq)[:, None]
        kj = torch.arange(Sk)[None, :]
        cmask = kj <= (qi + off)
        scores = torch.where(cmask[None, None], scores, -1e9)
        p = _softmax(scores, axis=-1)
        ctx = torch.einsum("bhqk,bhkd->bhqd", p, v)
        return torch.einsum("bhqd,hdm->bqm", ctx, w_o)

    def _B_ref(x, w1, b1, w2, b2):
        h = torch.einsum("bsd,df->bsf", x, w1) + b1
        h = _gelu(h)
        return torch.einsum("bsf,fd->bsd", h, w2) + b2

    x = A_x
    g = _sigmoid((x * gate_w).sum(-1, keepdims=True))
    a = _A_ref(x, A_c_kv, A_w_q, A_w_uk, A_w_uv, A_w_o)
    b = _B_ref(x, B_w1, B_b1, B_w2, B_b2)
    return g * a + (1 - g) * b
```

```asm
; @launch grid=(256,1,1) block=(256,1,1) lds=163840
.amdgcn_target "amdgcn-amd-amdhsa--gfx950"
.text
.globl gated_mix__compressed_kv_cla__dense_activation_gelu__prompt_kernel
.p2align 8
.type gated_mix__compressed_kv_cla__dense_activation_gelu__prompt_kernel,@function
gated_mix__compressed_kv_cla__dense_activation_gelu__prompt_kernel:
s_cmp_ge_u32 s2, 256
s_cbranch_scc1 L_exit
s_load_dwordx16 s[4:19], s[0:1], 0
s_load_dwordx8 s[20:27], s[0:1], 64
s_load_dwordx4 s[28:31], s[0:1], 96
s_load_dwordx2 s[32:33], s[0:1], 112
v_readfirstlane_b32 s76, v0
v_and_b32 v0, 63, v0
s_and_b32 s77, s2, 7
s_lshl_b32 s77, s77, 2
s_bfe_u32 s78, s2, 0x20003
s_add_u32 s77, s77, s78
s_lshr_b32 s78, s2, 5
s_lshr_b32 s76, s76, 6
v_lshrrev_b32 v22, 3, v0
v_and_b32 v23, 6, v22
v_and_b32 v24, 7, v0
v_xor_b32 v23, v23, v24
s_lshl_b32 s80, s76, 6
v_add_u32 v22, s80, v22
v_lshlrev_b32 v22, 10, v22
v_lshl_add_u32 v2, v23, 4, v22
s_lshl_b32 s86, s76, 13
s_and_b32 s80, s76, 1
s_lshl_b32 s81, s80, 3
v_lshrrev_b32 v22, 4, v0
v_lshl_or_b32 v23, v22, 1, s81
v_and_b32 v24, 15, v0
v_xor_b32 v23, v23, v24
v_add_u32 v22, s81, v22
v_lshlrev_b32 v22, 13, v22
v_lshl_add_u32 v3, v23, 4, v22
s_lshr_b32 s81, s76, 1
s_lshl_b32 s81, s81, 13
s_lshl_b32 s80, s80, 11
s_add_u32 s87, s80, s81
s_add_u32 s87, s87, 98304
s_sub_u32 s80, 14, s78
s_cmp_ge_u32 s76, 2
s_cselect_b32 s80, s80, s78
s_lshl_b32 s80, s80, 17
s_lshl_b32 s81, s77, 8
s_waitcnt lgkmcnt(0)
s_add_u32 s36, s6, s80
s_addc_u32 s37, s7, 0
s_and_b32 s37, s37, 0xffff
s_mov_b32 s38, 262144
s_mov_b32 s39, 0x20000
s_add_u32 m0, s86, 0
s_mov_b32 s84, 0
buffer_load_dwordx4 v2, s[36:39], s84 offen offset:0 lds
s_mov_b32 s84, 7168
buffer_load_dwordx4 v2, s[36:39], s84 offen offset:1024 lds
s_mov_b32 s84, 14336
buffer_load_dwordx4 v2, s[36:39], s84 offen offset:2048 lds
s_mov_b32 s84, 21504
buffer_load_dwordx4 v2, s[36:39], s84 offen offset:3072 lds
s_add_u32 m0, s86, 4096
s_mov_b32 s84, 32768
buffer_load_dwordx4 v2, s[36:39], s84 offen offset:0 lds
s_mov_b32 s84, 39936
buffer_load_dwordx4 v2, s[36:39], s84 offen offset:1024 lds
s_mov_b32 s84, 47104
buffer_load_dwordx4 v2, s[36:39], s84 offen offset:2048 lds
s_mov_b32 s84, 54272
buffer_load_dwordx4 v2, s[36:39], s84 offen offset:3072 lds
s_cmp_ge_u32 s76, 2
s_cselect_b32 s82, s12, s10
s_cselect_b32 s83, s13, s11
s_add_u32 s40, s82, s81
s_addc_u32 s41, s83, 0
s_and_b32 s41, s41, 0xffff
s_mov_b32 s42, 4186368
s_mov_b32 s43, 0x20000
s_add_u32 m0, s87, 0
s_mov_b32 s84, 0
buffer_load_dwordx4 v3, s[40:43], s84 offen offset:0 nt lds
s_mov_b32 s84, 31744
buffer_load_dwordx4 v3, s[40:43], s84 offen offset:1024 nt lds
s_add_u32 m0, s87, 4096
s_mov_b32 s84, 131072
buffer_load_dwordx4 v3, s[40:43], s84 offen offset:0 nt lds
s_mov_b32 s84, 162816
buffer_load_dwordx4 v3, s[40:43], s84 offen offset:1024 nt lds
s_add_u32 m0, s87, 16384
s_mov_b32 s84, 262144
buffer_load_dwordx4 v3, s[40:43], s84 offen offset:0 nt lds
s_mov_b32 s84, 293888
buffer_load_dwordx4 v3, s[40:43], s84 offen offset:1024 nt lds
s_add_u32 m0, s87, 20480
s_mov_b32 s84, 393216
buffer_load_dwordx4 v3, s[40:43], s84 offen offset:0 nt lds
s_mov_b32 s84, 424960
buffer_load_dwordx4 v3, s[40:43], s84 offen offset:1024 nt lds
v_and_b32 v22, 15, v0
s_and_b32 s80, s76, 1
s_lshl_b32 s80, s80, 14
v_lshlrev_b32 v22, 7, v22
v_add_u32 v22, s80, v22
v_lshrrev_b32 v23, 4, v0
v_and_b32 v24, 6, v0
v_xor_b32 v23, v23, v24
v_lshl_add_u32 v5, v23, 4, v22
v_xor_b32 v6, 64, v5
v_add_u32 v7, 65536, v5
v_add_u32 v8, 65536, v6
v_lshrrev_b32 v22, 4, v0
v_bfe_u32 v23, v0, 2, 2
v_lshl_add_u32 v24, v22, 3, v23
v_lshlrev_b32 v26, 8, v24
v_bfe_u32 v25, v0, 2, 3
v_lshl_add_u32 v26, v25, 5, v26
v_and_b32 v25, 3, v0
v_lshl_add_u32 v26, v25, 3, v26
v_add_u32 v26, 98304, v26
s_lshr_b32 s80, s76, 1
s_lshl_b32 s80, s80, 7
v_xor_b32 v13, 128, v26
v_xor_b32 v14, 160, v26
v_xor_b32 v15, 192, v26
v_xor_b32 v16, 224, v26
v_xor_b32 v9, s80, v26
v_xor_b32 v10, 32, v9
v_xor_b32 v11, 64, v9
v_xor_b32 v12, 96, v9
v_lshlrev_b32 v26, 7, v24
v_bfe_u32 v27, v0, 3, 2
v_lshl_add_u32 v26, v27, 5, v26
v_lshl_add_u32 v26, v25, 3, v26
v_add_u32 v17, 106496, v26
v_xor_b32 v18, 32, v17
v_xor_b32 v19, 64, v17
v_xor_b32 v20, 96, v17
v_lshlrev_b32 v1, 4, v0
v_lshlrev_b32 v30, 7, v0
s_getpc_b64 s[72:73]
L_pc_L_main:
s_add_u32 s72, s72, L_main-L_pc_L_main
s_addc_u32 s73, s73, 0
s_and_b32 s73, s73, 0xffff
s_mov_b32 s74, L_exit-L_main
s_mov_b32 s75, 0x20000
v_lshlrev_b32 v31, 14, v0
s_lshr_b32 s80, s2, 3
s_lshl_b32 s80, s80, 2
s_add_u32 s80, s80, s76
s_lshl_b32 s80, s80, 7
buffer_load_dword a200, v31, s[72:75], s80 offen
s_add_u32 m0, s86, 32768
s_mov_b32 s84, 128
buffer_load_dwordx4 v2, s[36:39], s84 offen offset:0 lds
s_mov_b32 s84, 7296
buffer_load_dwordx4 v2, s[36:39], s84 offen offset:1024 lds
s_mov_b32 s84, 14464
buffer_load_dwordx4 v2, s[36:39], s84 offen offset:2048 lds
s_mov_b32 s84, 21632
buffer_load_dwordx4 v2, s[36:39], s84 offen offset:3072 lds
s_add_u32 m0, s86, 36864
s_mov_b32 s84, 32896
buffer_load_dwordx4 v2, s[36:39], s84 offen offset:0 lds
s_mov_b32 s84, 40064
buffer_load_dwordx4 v2, s[36:39], s84 offen offset:1024 lds
s_mov_b32 s84, 47232
buffer_load_dwordx4 v2, s[36:39], s84 offen offset:2048 lds
s_mov_b32 s84, 54400
buffer_load_dwordx4 v2, s[36:39], s84 offen offset:3072 lds
s_add_u32 m0, s87, 32768
s_mov_b32 s84, 524288
buffer_load_dwordx4 v3, s[40:43], s84 offen offset:0 nt lds
s_mov_b32 s84, 556032
buffer_load_dwordx4 v3, s[40:43], s84 offen offset:1024 nt lds
s_add_u32 m0, s87, 36864
s_mov_b32 s84, 655360
buffer_load_dwordx4 v3, s[40:43], s84 offen offset:0 nt lds
s_mov_b32 s84, 687104
buffer_load_dwordx4 v3, s[40:43], s84 offen offset:1024 nt lds
s_mov_b64 exec, 0
s_cmp_eq_u32 s76, 0
s_cbranch_scc1 L_w0_0
s_cmp_eq_u32 s76, 1
s_cbranch_scc1 L_w0_1
s_cmp_eq_u32 s76, 2
s_cbranch_scc1 L_w0_2
s_branch L_w0_3
.p2align 12
L_main:
L_wend0:
s_mov_b64 exec, -1
s_waitcnt vmcnt(17)
s_barrier
ds_read_b128 a[0:3], v5 offset:0
ds_read_b64_tr_b16 a[32:33], v9 offset:0
ds_read_b64_tr_b16 a[34:35], v9 offset:1024
ds_read_b128 a[4:7], v5 offset:2048
ds_read_b64_tr_b16 a[36:37], v10 offset:0
ds_read_b64_tr_b16 a[38:39], v10 offset:1024
ds_read_b128 a[8:11], v5 offset:4096
ds_read_b64_tr_b16 a[40:41], v11 offset:0
ds_read_b64_tr_b16 a[42:43], v11 offset:1024
ds_read_b128 a[12:15], v5 offset:6144
ds_read_b64_tr_b16 a[44:45], v12 offset:0
ds_read_b64_tr_b16 a[46:47], v12 offset:1024
ds_read_b128 a[16:19], v5 offset:8192
ds_read_b64_tr_b16 a[48:49], v9 offset:8192
ds_read_b64_tr_b16 a[50:51], v9 offset:9216
ds_read_b128 a[20:23], v5 offset:10240
ds_read_b64_tr_b16 a[52:53], v10 offset:8192
ds_read_b64_tr_b16 a[54:55], v10 offset:9216
ds_read_b128 a[24:27], v5 offset:12288
ds_read_b64_tr_b16 a[56:57], v11 offset:8192
ds_read_b64_tr_b16 a[58:59], v11 offset:9216
ds_read_b128 a[28:31], v5 offset:14336
ds_read_b64_tr_b16 a[60:61], v12 offset:8192
ds_read_b64_tr_b16 a[62:63], v12 offset:9216
s_waitcnt lgkmcnt(0)
v_mfma_f32_16x16x32_bf16 a[128:131], a[32:35], a[0:3], 0
s_waitcnt vmcnt(13)
v_mfma_f32_16x16x32_bf16 a[144:147], a[32:35], a[4:7], 0
s_barrier
v_mfma_f32_16x16x32_bf16 v[160:163], a[32:35], a[8:11], 0
s_add_u32 m0, s87, 49152
ds_read_b128 a[64:67], v6 offset:0
v_mfma_f32_16x16x32_bf16 v[168:171], a[32:35], a[12:15], 0
s_mov_b32 s84, 786432
ds_read_b64_tr_b16 a[96:97], v9 offset:16384
v_mfma_f32_16x16x32_bf16 v[192:195], a[32:35], a[16:19], 0
buffer_load_dwordx4 v3, s[40:43], s84 offen offset:0 nt lds
v_mfma_f32_16x16x32_bf16 v[200:203], a[32:35], a[20:23], 0
s_mov_b32 s84, 818176
ds_read_b64_tr_b16 a[98:99], v9 offset:17408
v_mfma_f32_16x16x32_bf16 v[224:227], a[32:35], a[24:27], 0
buffer_load_dwordx4 v3, s[40:43], s84 offen offset:1024 nt lds
v_mfma_f32_16x16x32_bf16 v[232:235], a[32:35], a[28:31], 0
s_mov_b32 s56, s32
ds_read_b128 a[68:71], v6 offset:2048
v_mfma_f32_16x16x32_bf16 a[132:135], a[36:39], a[0:3], 0
s_and_b32 s57, s33, 0xffff
v_mfma_f32_16x16x32_bf16 a[148:151], a[36:39], a[4:7], 0
s_add_u32 m0, s87, 53248
ds_read_b64_tr_b16 a[100:101], v10 offset:16384
v_mfma_f32_16x16x32_bf16 v[48:51], a[36:39], a[8:11], 0
s_mov_b32 s84, 917504
v_mfma_f32_16x16x32_bf16 v[56:59], a[36:39], a[12:15], 0
buffer_load_dwordx4 v3, s[40:43], s84 offen offset:0 nt lds
v_mfma_f32_16x16x32_bf16 v[80:83], a[36:39], a[16:19], 0
s_mov_b32 s84, 949248
ds_read_b64_tr_b16 a[102:103], v10 offset:17408
v_mfma_f32_16x16x32_bf16 v[88:91], a[36:39], a[20:23], 0
buffer_load_dwordx4 v3, s[40:43], s84 offen offset:1024 nt lds
v_mfma_f32_16x16x32_bf16 v[112:115], a[36:39], a[24:27], 0
s_mov_b32 s58, 134217728
ds_read_b128 a[72:75], v6 offset:4096
v_mfma_f32_16x16x32_bf16 v[120:123], a[36:39], a[28:31], 0
s_mov_b32 s59, 0x20000
ds_read_b64_tr_b16 a[104:105], v11 offset:16384
v_mfma_f32_16x16x32_bf16 a[136:139], a[40:43], a[0:3], 0
s_add_u32 m0, s86, 65536
v_mfma_f32_16x16x32_bf16 a[152:155], a[40:43], a[4:7], 0
s_mov_b32 s84, 256
ds_read_b64_tr_b16 a[106:107], v11 offset:17408
v_mfma_f32_16x16x32_bf16 v[164:167], a[40:43], a[8:11], 0
buffer_load_dwordx4 v2, s[36:39], s84 offen offset:0 lds
v_mfma_f32_16x16x32_bf16 v[172:175], a[40:43], a[12:15], 0
s_mov_b32 s84, 7424
ds_read_b128 a[76:79], v6 offset:6144
v_mfma_f32_16x16x32_bf16 v[196:199], a[40:43], a[16:19], 0
buffer_load_dwordx4 v2, s[36:39], s84 offen offset:1024 lds
v_mfma_f32_16x16x32_bf16 v[204:207], a[40:43], a[20:23], 0
s_mov_b32 s68, s30
ds_read_b64_tr_b16 a[108:109], v12 offset:16384
v_mfma_f32_16x16x32_bf16 v[228:231], a[40:43], a[24:27], 0
s_and_b32 s69, s31, 0xffff
v_mfma_f32_16x16x32_bf16 v[236:239], a[40:43], a[28:31], 0
s_mov_b32 s84, 14592
ds_read_b64_tr_b16 a[110:111], v12 offset:17408
v_mfma_f32_16x16x32_bf16 a[140:143], a[44:47], a[0:3], 0
buffer_load_dwordx4 v2, s[36:39], s84 offen offset:2048 lds
v_mfma_f32_16x16x32_bf16 a[156:159], a[44:47], a[4:7], 0
s_mov_b32 s70, 256
ds_read_b128 a[80:83], v6 offset:8192
v_mfma_f32_16x16x32_bf16 v[52:55], a[44:47], a[8:11], 0
s_mov_b32 s84, 21760
v_mfma_f32_16x16x32_bf16 v[60:63], a[44:47], a[12:15], 0
buffer_load_dwordx4 v2, s[36:39], s84 offen offset:3072 lds
v_mfma_f32_16x16x32_bf16 v[84:87], a[44:47], a[16:19], 0
s_mov_b32 s71, 0x20000
ds_read_b64_tr_b16 a[112:113], v9 offset:24576
v_mfma_f32_16x16x32_bf16 v[92:95], a[44:47], a[20:23], 0
s_mov_b32 s3, 1073741824
ds_read_b64_tr_b16 a[114:115], v9 offset:25600
v_mfma_f32_16x16x32_bf16 v[116:119], a[44:47], a[24:27], 0
s_add_u32 m0, s86, 69632
v_mfma_f32_16x16x32_bf16 v[124:127], a[44:47], a[28:31], 0
s_mov_b32 s84, 33024
ds_read_b128 a[84:87], v6 offset:10240
v_mfma_f32_16x16x32_bf16 v[144:147], a[0:3], a[48:51], 0
buffer_load_dwordx4 v2, s[36:39], s84 offen offset:0 lds
v_mfma_f32_16x16x32_bf16 v[148:151], a[0:3], a[52:55], 0
s_cmp_eq_u32 s76, 0
s_cselect_b32 s3, 0, s3
ds_read_b64_tr_b16 a[116:117], v10 offset:24576
v_mfma_f32_16x16x32_bf16 v[152:155], a[0:3], a[56:59], 0
s_mov_b32 s84, 40192
v_cmp_eq_u32 vcc, 0, v0
v_mov_b32 v21, 1073741824
v_mfma_f32_16x16x32_bf16 v[156:159], a[0:3], a[60:63], 0
buffer_load_dwordx4 v2, s[36:39], s84 offen offset:1024 lds
v_mfma_f32_16x16x32_bf16 v[32:35], a[4:7], a[48:51], 0
ds_read_b64_tr_b16 a[118:119], v10 offset:25600
v_mov_b32 v24, 0
v_mfma_f32_16x16x32_bf16 v[36:39], a[4:7], a[52:55], 0
s_mov_b32 s84, 47360
ds_read_b128 a[88:91], v6 offset:12288
v_mov_b32 v25, 0
v_mfma_f32_16x16x32_bf16 v[40:43], a[4:7], a[56:59], 0
buffer_load_dwordx4 v2, s[36:39], s84 offen offset:2048 lds
v_mfma_f32_16x16x32_bf16 v[44:47], a[4:7], a[60:63], 0
ds_read_b64_tr_b16 a[120:121], v11 offset:24576
v_cndmask_b32 v21, v21, 0, vcc
v_mfma_f32_16x16x32_bf16 v[176:179], a[8:11], a[48:51], 0
v_mov_b32 v26, 0
v_mov_b32 v27, 0
v_mfma_f32_16x16x32_bf16 v[180:183], a[8:11], a[52:55], 0
s_mov_b32 s84, 54528
ds_read_b64_tr_b16 a[122:123], v11 offset:25600
v_mfma_f32_16x16x32_bf16 v[184:187], a[8:11], a[56:59], 0
buffer_load_dwordx4 v2, s[36:39], s84 offen offset:3072 lds
v_mfma_f32_16x16x32_bf16 v[188:191], a[8:11], a[60:63], 0
s_mul_i32 s80, s76, 6144
ds_read_b128 a[92:95], v6 offset:14336
v_mfma_f32_16x16x32_bf16 v[64:67], a[12:15], a[48:51], 0
s_add_u32 m0, s87, 0
v_mfma_f32_16x16x32_bf16 v[68:71], a[12:15], a[52:55], 0
s_mov_b32 s84, 1048576
ds_read_b64_tr_b16 a[124:125], v12 offset:24576
v_mfma_f32_16x16x32_bf16 v[72:75], a[12:15], a[56:59], 0
buffer_load_dwordx4 v3, s[40:43], s84 offen offset:0 nt lds
v_mfma_f32_16x16x32_bf16 v[76:79], a[12:15], a[60:63], 0
s_mov_b32 s100, 1073741824
ds_read_b64_tr_b16 a[126:127], v12 offset:25600
v_mfma_f32_16x16x32_bf16 v[208:211], a[16:19], a[48:51], 0
s_mov_b32 s84, 1080320
v_mfma_f32_16x16x32_bf16 v[212:215], a[16:19], a[52:55], 0
buffer_load_dwordx4 v3, s[40:43], s84 offen offset:1024 nt lds
v_mfma_f32_16x16x32_bf16 v[216:219], a[16:19], a[56:59], 0
s_cmp_eq_u32 s2, 0
s_cselect_b32 s80, s80, s100
s_cselect_b32 s100, s3, s100
v_mfma_f32_16x16x32_bf16 v[220:223], a[16:19], a[60:63], 0
s_add_u32 m0, s87, 4096
v_mfma_f32_16x16x32_bf16 v[96:99], a[20:23], a[48:51], 0
s_mov_b32 s84, 1179648
v_mfma_f32_16x16x32_bf16 v[100:103], a[20:23], a[52:55], 0
buffer_load_dwordx4 v3, s[40:43], s84 offen offset:0 nt lds
v_mfma_f32_16x16x32_bf16 v[104:107], a[20:23], a[56:59], 0
s_add_u32 s80, s80, 68222976
v_mfma_f32_16x16x32_bf16 v[108:111], a[20:23], a[60:63], 0
s_mov_b32 s84, 1211392
v_mfma_f32_16x16x32_bf16 v[240:243], a[24:27], a[48:51], 0
buffer_load_dwordx4 v3, s[40:43], s84 offen offset:1024 nt lds
v_mfma_f32_16x16x32_bf16 v[244:247], a[24:27], a[52:55], 0
s_add_u32 s81, s80, 3072
v_mfma_f32_16x16x32_bf16 v[248:251], a[24:27], a[56:59], 0
s_cmp_lg_u32 s2, 0
s_cbranch_scc0 L_clr
L_clr_ret:
v_mfma_f32_16x16x32_bf16 v[252:255], a[24:27], a[60:63], 0
s_mov_b32 s44, s4
v_mfma_f32_16x16x32_bf16 v[128:131], a[28:31], a[48:51], 0
s_and_b32 s45, s5, 0xffff
v_mfma_f32_16x16x32_bf16 v[132:135], a[28:31], a[52:55], 0
s_mov_b32 s46, 2621440
v_mfma_f32_16x16x32_bf16 v[136:139], a[28:31], a[56:59], 0
s_mov_b32 s47, 0x20000
v_mfma_f32_16x16x32_bf16 v[140:143], a[28:31], a[60:63], 0
s_mov_b32 s72, s26
s_and_b32 s73, s27, 0xffff
s_mov_b32 s74, 1280
s_mov_b32 s75, 0x20000
s_waitcnt lgkmcnt(0)
v_mfma_f32_16x16x32_bf16 a[128:131], a[96:99], a[64:67], a[128:131]
s_waitcnt vmcnt(16)
v_mfma_f32_16x16x32_bf16 a[144:147], a[96:99], a[68:71], a[144:147]
s_barrier
v_mfma_f32_16x16x32_bf16 v[160:163], a[96:99], a[72:75], v[160:163]
s_add_u32 m0, s87, 16384
ds_read_b128 a[0:3], v5 offset:32768
v_mfma_f32_16x16x32_bf16 v[168:171], a[96:99], a[76:79], v[168:171]
s_mov_b32 s84, 1310720
ds_read_b64_tr_b16 a[32:33], v9 offset:32768
v_mfma_f32_16x16x32_bf16 v[192:195], a[96:99], a[80:83], v[192:195]
buffer_load_dwordx4 v3, s[40:43], s84 offen offset:0 nt lds
v_mfma_f32_16x16x32_bf16 v[200:203], a[96:99], a[84:87], v[200:203]
s_sub_u32 s80, 14, s78
ds_read_b64_tr_b16 a[34:35], v9 offset:33792
v_mfma_f32_16x16x32_bf16 v[224:227], a[96:99], a[88:91], v[224:227]
s_cmp_lt_u32 s77, 16
s_cselect_b32 s80, s78, s80
v_mfma_f32_16x16x32_bf16 v[232:235], a[96:99], a[92:95], v[232:235]
s_lshl_b32 s80, s80, 4
ds_read_b128 a[4:7], v5 offset:34816
v_mfma_f32_16x16x32_bf16 a[132:135], a[100:103], a[64:67], a[132:135]
s_add_u32 s80, s80, s77
v_mfma_f32_16x16x32_bf16 a[148:151], a[100:103], a[68:71], a[148:151]
s_mov_b32 s84, 1342464
ds_read_b64_tr_b16 a[36:37], v10 offset:32768
v_mfma_f32_16x16x32_bf16 v[48:51], a[100:103], a[72:75], v[48:51]
buffer_load_dwordx4 v3, s[40:43], s84 offen offset:1024 nt lds
v_mfma_f32_16x16x32_bf16 v[56:59], a[100:103], a[76:79], v[56:59]
s_lshl_b32 s80, s80, 2
ds_read_b64_tr_b16 a[38:39], v10 offset:33792
v_mfma_f32_16x16x32_bf16 v[80:83], a[100:103], a[80:83], v[80:83]
s_add_u32 s80, s80, s76
v_mfma_f32_16x16x32_bf16 v[88:91], a[100:103], a[84:87], v[88:91]
s_mul_i32 s35, s80, 2560
ds_read_b128 a[8:11], v5 offset:36864
v_mfma_f32_16x16x32_bf16 v[112:115], a[100:103], a[88:91], v[112:115]
s_lshl_b32 s34, s80, 3
v_mfma_f32_16x16x32_bf16 v[120:123], a[100:103], a[92:95], v[120:123]
s_add_u32 s34, s34, 68157440
ds_read_b64_tr_b16 a[40:41], v11 offset:32768
v_mfma_f32_16x16x32_bf16 a[136:139], a[104:107], a[64:67], a[136:139]
s_add_u32 m0, s87, 20480
v_mfma_f32_16x16x32_bf16 a[152:155], a[104:107], a[68:71], a[152:155]
s_mov_b32 s84, 1441792
ds_read_b64_tr_b16 a[42:43], v11 offset:33792
v_mfma_f32_16x16x32_bf16 v[164:167], a[104:107], a[72:75], v[164:167]
buffer_load_dwordx4 v3, s[40:43], s84 offen offset:0 nt lds
v_mfma_f32_16x16x32_bf16 v[172:175], a[104:107], a[76:79], v[172:175]
s_lshl_b32 s80, s77, 8
ds_read_b128 a[12:15], v5 offset:38912
v_mfma_f32_16x16x32_bf16 v[196:199], a[104:107], a[80:83], v[196:199]
s_add_u32 s48, s8, s80
s_addc_u32 s49, s9, 0
v_mfma_f32_16x16x32_bf16 v[204:207], a[104:107], a[84:87], v[204:207]
s_and_b32 s49, s49, 0xffff
ds_read_b64_tr_b16 a[44:45], v12 offset:32768
v_mfma_f32_16x16x32_bf16 v[228:231], a[104:107], a[88:91], v[228:231]
s_mov_b32 s50, 5234944
v_mfma_f32_16x16x32_bf16 v[236:239], a[104:107], a[92:95], v[236:239]
s_mov_b32 s84, 1473536
ds_read_b64_tr_b16 a[46:47], v12 offset:33792
v_mfma_f32_16x16x32_bf16 a[140:143], a[108:111], a[64:67], a[140:143]
buffer_load_dwordx4 v3, s[40:43], s84 offen offset:1024 nt lds
v_mfma_f32_16x16x32_bf16 a[156:159], a[108:111], a[68:71], a[156:159]
s_mov_b32 s51, 0x20000
ds_read_b128 a[16:19], v5 offset:40960
v_mfma_f32_16x16x32_bf16 v[52:55], a[108:111], a[72:75], v[52:55]
s_and_b32 s17, s2, 31
v_mfma_f32_16x16x32_bf16 v[60:63], a[108:111], a[76:79], v[60:63]
s_lshr_b32 s80, s17, 1
ds_read_b64_tr_b16 a[48:49], v9 offset:40960
v_mfma_f32_16x16x32_bf16 v[84:87], a[108:111], a[80:83], v[84:87]
s_add_u32 s80, s80, 11
v_mfma_f32_16x16x32_bf16 v[92:95], a[108:111], a[84:87], v[92:95]
s_mov_b32 s81, 0x54000000
ds_read_b64_tr_b16 a[50:51], v9 offset:41984
v_mfma_f32_16x16x32_bf16 v[116:119], a[108:111], a[88:91], v[116:119]
s_add_u32 m0, s86, 0
v_mfma_f32_16x16x32_bf16 v[124:127], a[108:111], a[92:95], v[124:127]
s_mov_b32 s84, 384
ds_read_b128 a[20:23], v5 offset:43008
v_mfma_f32_16x16x32_bf16 v[144:147], a[64:67], a[112:115], v[144:147]
buffer_load_dwordx4 v2, s[36:39], s84 offen offset:0 lds
v_mfma_f32_16x16x32_bf16 v[148:151], a[64:67], a[116:119], v[148:151]
s_bitcmp1_b32 s81, s17
s_cselect_b32 s80, s80, 31
ds_read_b64_tr_b16 a[52:53], v10 offset:40960
v_mfma_f32_16x16x32_bf16 v[152:155], a[64:67], a[120:123], v[152:155]
s_cmp_lt_u32 s17, 24
s_cselect_b32 s17, s17, s80
v_mfma_f32_16x16x32_bf16 v[156:159], a[64:67], a[124:127], v[156:159]
s_lshl_b32 s80, s17, 7
ds_read_b64_tr_b16 a[54:55], v10 offset:41984
v_mfma_f32_16x16x32_bf16 v[32:35], a[68:71], a[112:115], v[32:35]
s_add_u32 s52, s18, s80
s_addc_u32 s53, s19, 0
v_mfma_f32_16x16x32_bf16 v[36:39], a[68:71], a[116:119], v[36:39]
s_mov_b32 s84, 7552
ds_read_b128 a[24:27], v5 offset:45056
v_mfma_f32_16x16x32_bf16 v[40:43], a[68:71], a[120:123], v[40:43]
buffer_load_dwordx4 v2, s[36:39], s84 offen offset:1024 lds
v_mfma_f32_16x16x32_bf16 v[44:47], a[68:71], a[124:127], v[44:47]
s_and_b32 s53, s53, 0xffff
ds_read_b64_tr_b16 a[56:57], v11 offset:40960
v_mfma_f32_16x16x32_bf16 v[176:179], a[72:75], a[112:115], v[176:179]
s_mov_b32 s54, 2208512
v_mfma_f32_16x16x32_bf16 v[180:183], a[72:75], a[116:119], v[180:183]
s_mov_b32 s55, 0x20000
ds_read_b64_tr_b16 a[58:59], v11 offset:41984
v_mfma_f32_16x16x32_bf16 v[184:187], a[72:75], a[120:123], v[184:187]
s_add_u32 s60, s20, s80
s_addc_u32 s61, s21, 0
v_mfma_f32_16x16x32_bf16 v[188:191], a[72:75], a[124:127], v[188:191]
s_and_b32 s61, s61, 0xffff
ds_read_b128 a[28:31], v5 offset:47104
v_mfma_f32_16x16x32_bf16 v[64:67], a[76:79], a[112:115], v[64:67]
s_mov_b32 s84, 14720
v_mfma_f32_16x16x32_bf16 v[68:71], a[76:79], a[116:119], v[68:71]
buffer_load_dwordx4 v2, s[36:39], s84 offen offset:2048 lds
v_mfma_f32_16x16x32_bf16 v[72:75], a[76:79], a[120:123], v[72:75]
s_mov_b32 s62, 128
ds_read_b64_tr_b16 a[60:61], v12 offset:40960
v_mfma_f32_16x16x32_bf16 v[76:79], a[76:79], a[124:127], v[76:79]
s_mov_b32 s63, 0x20000
ds_read_b64_tr_b16 a[62:63], v12 offset:41984
v_mfma_f32_16x16x32_bf16 v[208:211], a[80:83], a[112:115], v[208:211]
s_cmp_lt_u32 s17, 27
s_cselect_b32 s54, s54, 0
s_cselect_b32 s62, s62, 0
v_mfma_f32_16x16x32_bf16 v[212:215], a[80:83], a[116:119], v[212:215]
v_mfma_f32_16x16x32_bf16 v[216:219], a[80:83], a[120:123], v[216:219]
v_mfma_f32_16x16x32_bf16 v[220:223], a[80:83], a[124:127], v[220:223]
s_mov_b32 s84, 21888
v_mfma_f32_16x16x32_bf16 v[96:99], a[84:87], a[112:115], v[96:99]
buffer_load_dwordx4 v2, s[36:39], s84 offen offset:3072 lds
v_mfma_f32_16x16x32_bf16 v[100:103], a[84:87], a[116:119], v[100:103]
v_mfma_f32_16x16x32_bf16 v[104:107], a[84:87], a[120:123], v[104:107]
v_mfma_f32_16x16x32_bf16 v[108:111], a[84:87], a[124:127], v[108:111]
v_mfma_f32_16x16x32_bf16 v[240:243], a[88:91], a[112:115], v[240:243]
v_mfma_f32_16x16x32_bf16 v[244:247], a[88:91], a[116:119], v[244:247]
v_mfma_f32_16x16x32_bf16 v[248:251], a[88:91], a[120:123], v[248:251]
v_mfma_f32_16x16x32_bf16 v[252:255], a[88:91], a[124:127], v[252:255]
v_mfma_f32_16x16x32_bf16 v[128:131], a[92:95], a[112:115], v[128:131]
v_mfma_f32_16x16x32_bf16 v[132:135], a[92:95], a[116:119], v[132:135]
v_mfma_f32_16x16x32_bf16 v[136:139], a[92:95], a[120:123], v[136:139]
v_mfma_f32_16x16x32_bf16 v[140:143], a[92:95], a[124:127], v[140:143]
s_waitcnt lgkmcnt(0)
v_mfma_f32_16x16x32_bf16 a[128:131], a[32:35], a[0:3], a[128:131]
s_waitcnt vmcnt(20)
v_mfma_f32_16x16x32_bf16 a[144:147], a[32:35], a[4:7], a[144:147]
s_barrier
v_mfma_f32_16x16x32_bf16 v[160:163], a[32:35], a[8:11], v[160:163]
s_add_u32 m0, s87, 32768
ds_read_b128 a[64:67], v6 offset:32768
v_mfma_f32_16x16x32_bf16 v[168:171], a[32:35], a[12:15], v[168:171]
s_mov_b32 s84, 1572864
ds_read_b64_tr_b16 a[96:97], v9 offset:49152
v_mfma_f32_16x16x32_bf16 v[192:195], a[32:35], a[16:19], v[192:195]
buffer_load_dwordx4 v3, s[40:43], s84 offen offset:0 nt lds
v_mfma_f32_16x16x32_bf16 v[200:203], a[32:35], a[20:23], v[200:203]
s_bfe_u32 s80, s2, 0x20003
ds_read_b64_tr_b16 a[98:99], v9 offset:50176
v_mfma_f32_16x16x32_bf16 v[224:227], a[32:35], a[24:27], v[224:227]
s_and_b32 s81, s2, 7
v_mfma_f32_16x16x32_bf16 v[232:235], a[32:35], a[28:31], v[232:235]
ds_read_b128 a[68:71], v6 offset:34816
v_mfma_f32_16x16x32_bf16 a[132:135], a[36:39], a[0:3], a[132:135]
s_cmp_eq_u32 s80, 0
s_cselect_b32 s82, s18, s8
s_cselect_b32 s83, s19, s9
v_mfma_f32_16x16x32_bf16 a[148:151], a[36:39], a[4:7], a[148:151]
s_mov_b32 s84, 1604608
ds_read_b64_tr_b16 a[100:101], v10 offset:49152
v_mfma_f32_16x16x32_bf16 v[48:51], a[36:39], a[8:11], v[48:51]
buffer_load_dwordx4 v3, s[40:43], s84 offen offset:1024 nt lds
v_mfma_f32_16x16x32_bf16 v[56:59], a[36:39], a[12:15], v[56:59]
s_mov_b32 s64, s82
ds_read_b64_tr_b16 a[102:103], v10 offset:50176
v_mfma_f32_16x16x32_bf16 v[80:83], a[36:39], a[16:19], v[80:83]
s_and_b32 s65, s83, 0xffff
v_mfma_f32_16x16x32_bf16 v[88:91], a[36:39], a[20:23], v[88:91]
s_mov_b32 s66, 5242880
ds_read_b128 a[72:75], v6 offset:36864
v_mfma_f32_16x16x32_bf16 v[112:115], a[36:39], a[24:27], v[112:115]
s_mov_b32 s67, 0x20000
v_mfma_f32_16x16x32_bf16 v[120:123], a[36:39], a[28:31], v[120:123]
s_cmp_eq_u32 s80, 1
s_cselect_b32 s66, 0, s66
ds_read_b64_tr_b16 a[104:105], v11 offset:49152
v_mfma_f32_16x16x32_bf16 a[136:139], a[40:43], a[0:3], a[136:139]
s_add_u32 m0, s87, 36864
v_mfma_f32_16x16x32_bf16 a[152:155], a[40:43], a[4:7], a[152:155]
s_mov_b32 s84, 1703936
ds_read_b64_tr_b16 a[106:107], v11 offset:50176
v_mfma_f32_16x16x32_bf16 v[164:167], a[40:43], a[8:11], v[164:167]
buffer_load_dwordx4 v3, s[40:43], s84 offen offset:0 nt lds
v_mfma_f32_16x16x32_bf16 v[172:175], a[40:43], a[12:15], v[172:175]
s_mov_b32 s101, 524288
ds_read_b128 a[76:79], v6 offset:38912
v_mfma_f32_16x16x32_bf16 v[196:199], a[40:43], a[16:19], v[196:199]
s_cmp_eq_u32 s80, 0
s_cselect_b32 s66, 2211840, s66
s_cselect_b32 s101, 221184, s101
v_mfma_f32_16x16x32_bf16 v[204:207], a[40:43], a[20:23], v[204:207]
s_lshl_b32 s82, s78, 2
ds_read_b64_tr_b16 a[108:109], v12 offset:49152
v_mfma_f32_16x16x32_bf16 v[228:231], a[40:43], a[24:27], v[228:231]
s_add_u32 s82, s82, s76
v_mfma_f32_16x16x32_bf16 v[236:239], a[40:43], a[28:31], v[236:239]
s_mov_b32 s84, 1735680
ds_read_b64_tr_b16 a[110:111], v12 offset:50176
v_mfma_f32_16x16x32_bf16 a[140:143], a[44:47], a[0:3], a[140:143]
buffer_load_dwordx4 v3, s[40:43], s84 offen offset:1024 nt lds
v_mfma_f32_16x16x32_bf16 a[156:159], a[44:47], a[4:7], a[156:159]
s_mul_i32 s83, s82, 6912
ds_read_b128 a[80:83], v6 offset:40960
v_mfma_f32_16x16x32_bf16 v[52:55], a[44:47], a[8:11], v[52:55]
s_and_b32 s79, s80, 1
v_mfma_f32_16x16x32_bf16 v[60:63], a[44:47], a[12:15], v[60:63]
s_lshl_b32 s79, s79, 5
ds_read_b64_tr_b16 a[112:113], v9 offset:57344
v_mfma_f32_16x16x32_bf16 v[84:87], a[44:47], a[16:19], v[84:87]
s_add_u32 s82, s82, s79
v_mfma_f32_16x16x32_bf16 v[92:95], a[44:47], a[20:23], v[92:95]
s_lshl_b32 s82, s82, 3
ds_read_b64_tr_b16 a[114:115], v9 offset:58368
v_mfma_f32_16x16x32_bf16 v[116:119], a[44:47], a[24:27], v[116:119]
s_add_u32 m0, s86, 4096
v_mfma_f32_16x16x32_bf16 v[124:127], a[44:47], a[28:31], v[124:127]
s_mov_b32 s84, 33152
ds_read_b128 a[84:87], v6 offset:43008
v_mfma_f32_16x16x32_bf16 v[144:147], a[0:3], a[48:51], v[144:147]
buffer_load_dwordx4 v2, s[36:39], s84 offen offset:0 lds
v_mfma_f32_16x16x32_bf16 v[148:151], a[0:3], a[52:55], v[148:151]
s_add_u32 s82, s82, s81
ds_read_b64_tr_b16 a[116:117], v10 offset:57344
v_mfma_f32_16x16x32_bf16 v[152:155], a[0:3], a[56:59], v[152:155]
s_lshl_b32 s82, s82, 10
v_mfma_f32_16x16x32_bf16 v[156:159], a[0:3], a[60:63], v[156:159]
ds_read_b64_tr_b16 a[118:119], v10 offset:58368
v_mfma_f32_16x16x32_bf16 v[32:35], a[4:7], a[48:51], v[32:35]
s_cmp_eq_u32 s80, 0
s_cselect_b32 s79, s83, s82
s_cselect_b32 s80, -1, 0
v_mfma_f32_16x16x32_bf16 v[36:39], a[4:7], a[52:55], v[36:39]
s_mov_b32 s84, 40320
ds_read_b128 a[88:91], v6 offset:45056
v_lshrrev_b32 v22, 1, v0
v_mfma_f32_16x16x32_bf16 v[40:43], a[4:7], a[56:59], v[40:43]
buffer_load_dwordx4 v2, s[36:39], s84 offen offset:1024 lds
v_mfma_f32_16x16x32_bf16 v[44:47], a[4:7], a[60:63], v[44:47]
ds_read_b64_tr_b16 a[120:121], v11 offset:57344
v_lshl_add_u32 v22, v22, 3, s81
v_mfma_f32_16x16x32_bf16 v[176:179], a[8:11], a[48:51], v[176:179]
s_lshr_b32 s81, s81, 1
v_mfma_f32_16x16x32_bf16 v[180:183], a[8:11], a[52:55], v[180:183]
s_add_u32 s81, s81, 23
ds_read_b64_tr_b16 a[122:123], v11 offset:58368
v_min_u32 v22, s81, v22
v_mfma_f32_16x16x32_bf16 v[184:187], a[8:11], a[56:59], v[184:187]
v_and_b32 v24, 1, v0
v_mul_u32_u24 v24, 27, v24
v_mfma_f32_16x16x32_bf16 v[188:191], a[8:11], a[60:63], v[188:191]
ds_read_b128 a[92:95], v6 offset:47104
v_add_u32 v22, v22, v24
v_mfma_f32_16x16x32_bf16 v[64:67], a[12:15], a[48:51], v[64:67]
s_mov_b32 s84, 47488
v_bfi_b32 v22, s80, v22, v0
v_lshlrev_b32 v31, 7, v22
v_mfma_f32_16x16x32_bf16 v[68:71], a[12:15], a[52:55], v[68:71]
buffer_load_dwordx4 v2, s[36:39], s84 offen offset:2048 lds
v_mfma_f32_16x16x32_bf16 v[72:75], a[12:15], a[56:59], v[72:75]
ds_read_b64_tr_b16 a[124:125], v12 offset:57344
v_sub_u32 v29, 7, v0
v_mfma_f32_16x16x32_bf16 v[76:79], a[12:15], a[60:63], v[76:79]
ds_read_b64_tr_b16 a[126:127], v12 offset:58368
v_and_b32 v29, 1073741824, v29
v_mfma_f32_16x16x32_bf16 v[208:211], a[16:19], a[48:51], v[208:211]
v_or_b32 v31, v31, v29
v_mfma_f32_16x16x32_bf16 v[212:215], a[16:19], a[52:55], v[212:215]
v_mfma_f32_16x16x32_bf16 v[216:219], a[16:19], a[56:59], v[216:219]
v_mfma_f32_16x16x32_bf16 v[220:223], a[16:19], a[60:63], v[220:223]
s_mov_b32 s84, 54656
v_mfma_f32_16x16x32_bf16 v[96:99], a[20:23], a[48:51], v[96:99]
buffer_load_dwordx4 v2, s[36:39], s84 offen offset:3072 lds
v_mfma_f32_16x16x32_bf16 v[100:103], a[20:23], a[52:55], v[100:103]
v_mfma_f32_16x16x32_bf16 v[104:107], a[20:23], a[56:59], v[104:107]
v_mfma_f32_16x16x32_bf16 v[108:111], a[20:23], a[60:63], v[108:111]
v_mfma_f32_16x16x32_bf16 v[240:243], a[24:27], a[48:51], v[240:243]
v_mfma_f32_16x16x32_bf16 v[244:247], a[24:27], a[52:55], v[244:247]
v_mfma_f32_16x16x32_bf16 v[248:251], a[24:27], a[56:59], v[248:251]
v_mfma_f32_16x16x32_bf16 v[252:255], a[24:27], a[60:63], v[252:255]
v_mfma_f32_16x16x32_bf16 v[128:131], a[28:31], a[48:51], v[128:131]
v_mfma_f32_16x16x32_bf16 v[132:135], a[28:31], a[52:55], v[132:135]
v_mfma_f32_16x16x32_bf16 v[136:139], a[28:31], a[56:59], v[136:139]
v_mfma_f32_16x16x32_bf16 v[140:143], a[28:31], a[60:63], v[140:143]
s_waitcnt lgkmcnt(0)
v_mfma_f32_16x16x32_bf16 a[128:131], a[96:99], a[64:67], a[128:131]
s_waitcnt vmcnt(16)
v_mfma_f32_16x16x32_bf16 a[144:147], a[96:99], a[68:71], a[144:147]
s_barrier
v_mfma_f32_16x16x32_bf16 v[160:163], a[96:99], a[72:75], v[160:163]
s_add_u32 m0, s87, 49152
ds_read_b128 a[0:3], v7 offset:0
v_lshrrev_b32 v22, 5, v0
v_mfma_f32_16x16x32_bf16 v[168:171], a[96:99], a[76:79], v[168:171]
s_mov_b32 s84, 1835008
ds_read_b64_tr_b16 a[32:33], v9 offset:0
v_mul_u32_u24 v22, 1280, v22
v_mfma_f32_16x16x32_bf16 v[192:195], a[96:99], a[80:83], v[192:195]
buffer_load_dwordx4 v3, s[40:43], s84 offen offset:0 nt lds
v_mfma_f32_16x16x32_bf16 v[200:203], a[96:99], a[84:87], v[200:203]
ds_read_b64_tr_b16 a[34:35], v9 offset:1024
v_and_b32 v27, 0x1f0, v1
v_mfma_f32_16x16x32_bf16 v[224:227], a[96:99], a[88:91], v[224:227]
v_add_u32 v22, v22, v27
v_mfma_f32_16x16x32_bf16 v[232:235], a[96:99], a[92:95], v[232:235]
ds_read_b128 a[4:7], v7 offset:2048
v_mfma_f32_16x16x32_bf16 a[132:135], a[100:103], a[64:67], a[132:135]
buffer_load_dwordx4 a[168:171], v22, s[44:47], s35 offen offset:0
v_mfma_f32_16x16x32_bf16 a[148:151], a[100:103], a[68:71], a[148:151]
s_mov_b32 s84, 1866752
ds_read_b64_tr_b16 a[36:37], v10 offset:0
v_mfma_f32_16x16x32_bf16 v[48:51], a[100:103], a[72:75], v[48:51]
buffer_load_dwordx4 v3, s[40:43], s84 offen offset:1024 nt lds
v_mfma_f32_16x16x32_bf16 v[56:59], a[100:103], a[76:79], v[56:59]
ds_read_b64_tr_b16 a[38:39], v10 offset:1024
v_mfma_f32_16x16x32_bf16 v[80:83], a[100:103], a[80:83], v[80:83]
buffer_load_dwordx4 a[180:183], v27, s[72:75], 0 offen offset:0
v_mfma_f32_16x16x32_bf16 v[88:91], a[100:103], a[84:87], v[88:91]
s_lshl_b32 s80, s78, 3
ds_read_b128 a[8:11], v7 offset:4096
v_mfma_f32_16x16x32_bf16 v[112:115], a[100:103], a[88:91], v[112:115]
s_sub_u32 s81, 120, s80
v_mfma_f32_16x16x32_bf16 v[120:123], a[100:103], a[92:95], v[120:123]
s_sub_u32 s82, 7, s76
ds_read_b64_tr_b16 a[40:41], v11 offset:0
v_mfma_f32_16x16x32_bf16 a[136:139], a[104:107], a[64:67], a[136:139]
s_add_u32 m0, s87, 53248
v_mfma_f32_16x16x32_bf16 a[152:155], a[104:107], a[68:71], a[152:155]
s_mov_b32 s84, 1966080
ds_read_b64_tr_b16 a[42:43], v11 offset:1024
v_mfma_f32_16x16x32_bf16 v[164:167], a[104:107], a[72:75], v[164:167]
buffer_load_dwordx4 v3, s[40:43], s84 offen offset:0 nt lds
v_mfma_f32_16x16x32_bf16 v[172:175], a[104:107], a[76:79], v[172:175]
s_add_u32 s90, s80, s76
ds_read_b128 a[12:15], v7 offset:6144
v_mfma_f32_16x16x32_bf16 v[196:199], a[104:107], a[80:83], v[196:199]
s_add_u32 s91, s80, s82
v_mfma_f32_16x16x32_bf16 v[204:207], a[104:107], a[84:87], v[204:207]
s_add_u32 s92, s81, s76
ds_read_b64_tr_b16 a[44:45], v12 offset:0
v_mfma_f32_16x16x32_bf16 v[228:231], a[104:107], a[88:91], v[228:231]
s_add_u32 s93, s81, s82
v_mfma_f32_16x16x32_bf16 v[236:239], a[104:107], a[92:95], v[236:239]
s_mov_b32 s84, 1997824
ds_read_b64_tr_b16 a[46:47], v12 offset:1024
v_mfma_f32_16x16x32_bf16 a[140:143], a[108:111], a[64:67], a[140:143]
buffer_load_dwordx4 v3, s[40:43], s84 offen offset:1024 nt lds
v_mfma_f32_16x16x32_bf16 a[156:159], a[108:111], a[68:71], a[156:159]
s_mul_i32 s94, s90, 20480
ds_read_b128 a[16:19], v7 offset:8192
v_mfma_f32_16x16x32_bf16 v[52:55], a[108:111], a[72:75], v[52:55]
s_mul_i32 s95, s91, 20480
v_mfma_f32_16x16x32_bf16 v[60:63], a[108:111], a[76:79], v[60:63]
s_mul_i32 s96, s92, 20480
ds_read_b64_tr_b16 a[48:49], v9 offset:8192
v_mfma_f32_16x16x32_bf16 v[84:87], a[108:111], a[80:83], v[84:87]
s_mul_i32 s97, s93, 20480
v_mfma_f32_16x16x32_bf16 v[92:95], a[108:111], a[84:87], v[92:95]
s_lshl_b32 s89, s76, 10
ds_read_b64_tr_b16 a[50:51], v9 offset:9216
v_mfma_f32_16x16x32_bf16 v[116:119], a[108:111], a[88:91], v[116:119]
s_add_u32 m0, s86, 32768
v_mfma_f32_16x16x32_bf16 v[124:127], a[108:111], a[92:95], v[124:127]
L_w0_0:
s_cbranch_execz L_wend0
s_mov_b32 s84, 512
ds_read_b128 a[20:23], v7 offset:10240
v_mfma_f32_16x16x32_bf16 v[144:147], a[64:67], a[112:115], v[144:147]
buffer_load_dwordx4 v2, s[36:39], s84 offen offset:0 lds
v_mfma_f32_16x16x32_bf16 v[148:151], a[64:67], a[116:119], v[148:151]
s_add_u32 s89, s89, 106496
ds_read_b64_tr_b16 a[52:53], v10 offset:8192
v_mfma_f32_16x16x32_bf16 v[152:155], a[64:67], a[120:123], v[152:155]
s_lshl_b32 s88, s76, 11
v_mfma_f32_16x16x32_bf16 v[156:159], a[64:67], a[124:127], v[156:159]
s_add_u32 s88, s88, 98304
ds_read_b64_tr_b16 a[54:55], v10 offset:9216
v_mfma_f32_16x16x32_bf16 v[32:35], a[68:71], a[112:115], v[32:35]
v_mfma_f32_16x16x32_bf16 v[36:39], a[68:71], a[116:119], v[36:39]
s_mov_b32 s84, 7680
ds_read_b128 a[24:27], v7 offset:12288
v_mfma_f32_16x16x32_bf16 v[40:43], a[68:71], a[120:123], v[40:43]
buffer_load_dwordx4 v2, s[36:39], s84 offen offset:1024 lds
v_mfma_f32_16x16x32_bf16 v[44:47], a[68:71], a[124:127], v[44:47]
ds_read_b64_tr_b16 a[56:57], v11 offset:8192
v_mfma_f32_16x16x32_bf16 v[176:179], a[72:75], a[112:115], v[176:179]
v_mfma_f32_16x16x32_bf16 v[180:183], a[72:75], a[116:119], v[180:183]
ds_read_b64_tr_b16 a[58:59], v11 offset:9216
v_mfma_f32_16x16x32_bf16 v[184:187], a[72:75], a[120:123], v[184:187]
v_mfma_f32_16x16x32_bf16 v[188:191], a[72:75], a[124:127], v[188:191]
ds_read_b128 a[28:31], v7 offset:14336
v_mfma_f32_16x16x32_bf16 v[64:67], a[76:79], a[112:115], v[64:67]
s_mov_b32 s84, 14848
v_mfma_f32_16x16x32_bf16 v[68:71], a[76:79], a[116:119], v[68:71]
buffer_load_dwordx4 v2, s[36:39], s84 offen offset:2048 lds
v_mfma_f32_16x16x32_bf16 v[72:75], a[76:79], a[120:123], v[72:75]
ds_read_b64_tr_b16 a[60:61], v12 offset:8192
v_mfma_f32_16x16x32_bf16 v[76:79], a[76:79], a[124:127], v[76:79]
ds_read_b64_tr_b16 a[62:63], v12 offset:9216
v_mfma_f32_16x16x32_bf16 v[208:211], a[80:83], a[112:115], v[208:211]
v_mfma_f32_16x16x32_bf16 v[212:215], a[80:83], a[116:119], v[212:215]
v_mfma_f32_16x16x32_bf16 v[216:219], a[80:83], a[120:123], v[216:219]
v_mfma_f32_16x16x32_bf16 v[220:223], a[80:83], a[124:127], v[220:223]
s_mov_b32 s84, 22016
v_mfma_f32_16x16x32_bf16 v[96:99], a[84:87], a[112:115], v[96:99]
buffer_load_dwordx4 v2, s[36:39], s84 offen offset:3072 lds
v_mfma_f32_16x16x32_bf16 v[100:103], a[84:87], a[116:119], v[100:103]
v_mfma_f32_16x16x32_bf16 v[104:107], a[84:87], a[120:123], v[104:107]
v_mfma_f32_16x16x32_bf16 v[108:111], a[84:87], a[124:127], v[108:111]
v_mfma_f32_16x16x32_bf16 v[240:243], a[88:91], a[112:115], v[240:243]
v_mfma_f32_16x16x32_bf16 v[244:247], a[88:91], a[116:119], v[244:247]
v_mfma_f32_16x16x32_bf16 v[248:251], a[88:91], a[120:123], v[248:251]
v_mfma_f32_16x16x32_bf16 v[252:255], a[88:91], a[124:127], v[252:255]
v_mfma_f32_16x16x32_bf16 v[128:131], a[92:95], a[112:115], v[128:131]
v_mfma_f32_16x16x32_bf16 v[132:135], a[92:95], a[116:119], v[132:135]
v_mfma_f32_16x16x32_bf16 v[136:139], a[92:95], a[120:123], v[136:139]
v_mfma_f32_16x16x32_bf16 v[140:143], a[92:95], a[124:127], v[140:143]
s_waitcnt lgkmcnt(0)
v_mfma_f32_16x16x32_bf16 a[128:131], a[32:35], a[0:3], a[128:131]
s_waitcnt vmcnt(22)
v_mfma_f32_16x16x32_bf16 a[144:147], a[32:35], a[4:7], a[144:147]
s_barrier
v_mfma_f32_16x16x32_bf16 v[160:163], a[32:35], a[8:11], v[160:163]
s_add_u32 m0, s87, 0
ds_read_b128 a[64:67], v8 offset:0
v_mov_b32 v25, 1
v_mfma_f32_16x16x32_bf16 v[168:171], a[32:35], a[12:15], v[168:171]
s_mov_b32 s84, 2097152
ds_read_b64_tr_b16 a[96:97], v9 offset:16384
v_mfma_f32_16x16x32_bf16 v[192:195], a[32:35], a[16:19], v[192:195]
buffer_load_dwordx4 v3, s[40:43], s84 offen offset:0 nt lds
v_mfma_f32_16x16x32_bf16 v[200:203], a[32:35], a[20:23], v[200:203]
ds_read_b64_tr_b16 a[98:99], v9 offset:17408
v_mfma_f32_16x16x32_bf16 v[224:227], a[32:35], a[24:27], v[224:227]
buffer_store_dword v25, v21, s[68:71], s100 offen sc1
v_mfma_f32_16x16x32_bf16 v[232:235], a[32:35], a[28:31], v[232:235]
ds_read_b128 a[68:71], v8 offset:2048
v_lshrrev_b32 v22, 3, v0
v_mfma_f32_16x16x32_bf16 a[132:135], a[36:39], a[0:3], a[132:135]
s_lshl_b32 s80, s76, 3
v_add_u32 v22, s80, v22
v_mul_u32_u24 v22, 3456, v22
v_mfma_f32_16x16x32_bf16 a[148:151], a[36:39], a[4:7], a[148:151]
s_mov_b32 s84, 2128896
ds_read_b64_tr_b16 a[100:101], v10 offset:16384
v_mfma_f32_16x16x32_bf16 v[48:51], a[36:39], a[8:11], v[48:51]
buffer_load_dwordx4 v3, s[40:43], s84 offen offset:1024 nt lds
v_mfma_f32_16x16x32_bf16 v[56:59], a[36:39], a[12:15], v[56:59]
s_and_b32 s80, s76, 1
ds_read_b64_tr_b16 a[102:103], v10 offset:17408
v_mfma_f32_16x16x32_bf16 v[80:83], a[36:39], a[16:19], v[80:83]
s_lshl_b32 s81, s80, 2
v_bfe_u32 v23, v0, 4, 1
v_lshl_or_b32 v23, v23, 1, s81
v_mfma_f32_16x16x32_bf16 v[88:91], a[36:39], a[20:23], v[88:91]
ds_read_b128 a[72:75], v8 offset:4096
v_and_b32 v24, 7, v0
v_mfma_f32_16x16x32_bf16 v[112:115], a[36:39], a[24:27], v[112:115]
v_xor_b32 v23, v23, v24
v_lshl_add_u32 v4, v23, 4, v22
v_mfma_f32_16x16x32_bf16 v[120:123], a[36:39], a[28:31], v[120:123]
ds_read_b64_tr_b16 a[104:105], v11 offset:16384
v_mfma_f32_16x16x32_bf16 a[136:139], a[40:43], a[0:3], a[136:139]
s_add_u32 m0, s87, 4096
v_mfma_f32_16x16x32_bf16 a[152:155], a[40:43], a[4:7], a[152:155]
s_mov_b32 s84, 2228224
ds_read_b64_tr_b16 a[106:107], v11 offset:17408
v_mfma_f32_16x16x32_bf16 v[164:167], a[40:43], a[8:11], v[164:167]
buffer_load_dwordx4 v3, s[40:43], s84 offen offset:0 nt lds
v_mfma_f32_16x16x32_bf16 v[172:175], a[40:43], a[12:15], v[172:175]
ds_read_b128 a[76:79], v8 offset:6144
v_mfma_f32_16x16x32_bf16 v[196:199], a[40:43], a[16:19], v[196:199]
v_mfma_f32_16x16x32_bf16 v[204:207], a[40:43], a[20:23], v[204:207]
ds_read_b64_tr_b16 a[108:109], v12 offset:16384
v_mfma_f32_16x16x32_bf16 v[228:231], a[40:43], a[24:27], v[228:231]
v_mfma_f32_16x16x32_bf16 v[236:239], a[40:43], a[28:31], v[236:239]
s_mov_b32 s84, 2259968
ds_read_b64_tr_b16 a[110:111], v12 offset:17408
v_mfma_f32_16x16x32_bf16 a[140:143], a[44:47], a[0:3], a[140:143]
buffer_load_dwordx4 v3, s[40:43], s84 offen offset:1024 nt lds
v_mfma_f32_16x16x32_bf16 a[156:159], a[44:47], a[4:7], a[156:159]
ds_read_b128 a[80:83], v8 offset:8192
v_mfma_f32_16x16x32_bf16 v[52:55], a[44:47], a[8:11], v[52:55]
v_mfma_f32_16x16x32_bf16 v[60:63], a[44:47], a[12:15], v[60:63]
ds_read_b64_tr_b16 a[112:113], v9 offset:24576
v_mfma_f32_16x16x32_bf16 v[84:87], a[44:47], a[16:19], v[84:87]
v_mfma_f32_16x16x32_bf16 v[92:95], a[44:47], a[20:23], v[92:95]
ds_read_b64_tr_b16 a[114:115], v9 offset:25600
v_mfma_f32_16x16x32_bf16 v[116:119], a[44:47], a[24:27], v[116:119]
s_add_u32 m0, s86, 36864
v_mfma_f32_16x16x32_bf16 v[124:127], a[44:47], a[28:31], v[124:127]
s_mov_b32 s84, 33280
ds_read_b128 a[84:87], v8 offset:10240
v_mfma_f32_16x16x32_bf16 v[144:147], a[0:3], a[48:51], v[144:147]
buffer_load_dwordx4 v2, s[36:39], s84 offen offset:0 lds
v_mfma_f32_16x16x32_bf16 v[148:151], a[0:3], a[52:55], v[148:151]
buffer_load_dword a200, v31, s[64:67], s79 offen
v_mfma_f32_16x16x32_bf16 v[152:155], a[0:3], a[56:59], v[152:155]
s_add_u32 s79, s79, s101
ds_read_b64_tr_b16 a[116:117], v10 offset:24576
v_mfma_f32_16x16x32_bf16 v[156:159], a[0:3], a[60:63], v[156:159]
ds_read_b64_tr_b16 a[118:119], v10 offset:25600
v_mfma_f32_16x16x32_bf16 v[32:35], a[4:7], a[48:51], v[32:35]
v_mfma_f32_16x16x32_bf16 v[36:39], a[4:7], a[52:55], v[36:39]
s_mov_b32 s84, 40448
ds_read_b128 a[88:91], v8 offset:12288
v_mfma_f32_16x16x32_bf16 v[40:43], a[4:7], a[56:59], v[40:43]
buffer_load_dwordx4 v2, s[36:39], s84 offen offset:1024 lds
v_mfma_f32_16x16x32_bf16 v[44:47], a[4:7], a[60:63], v[44:47]
ds_read_b64_tr_b16 a[120:121], v11 offset:24576
v_mfma_f32_16x16x32_bf16 v[176:179], a[8:11], a[48:51], v[176:179]
v_mfma_f32_16x16x32_bf16 v[180:183], a[8:11], a[52:55], v[180:183]
ds_read_b64_tr_b16 a[122:123], v11 offset:25600
v_mfma_f32_16x16x32_bf16 v[184:187], a[8:11], a[56:59], v[184:187]
v_mfma_f32_16x16x32_bf16 v[188:191], a[8:11], a[60:63], v[188:191]
ds_read_b128 a[92:95], v8 offset:14336
v_mfma_f32_16x16x32_bf16 v[64:67], a[12:15], a[48:51], v[64:67]
s_mov_b32 s84, 47616
v_mfma_f32_16x16x32_bf16 v[68:71], a[12:15], a[52:55], v[68:71]
buffer_load_dwordx4 v2, s[36:39], s84 offen offset:2048 lds
v_mfma_f32_16x16x32_bf16 v[72:75], a[12:15], a[56:59], v[72:75]
ds_read_b64_tr_b16 a[124:125], v12 offset:24576
v_mfma_f32_16x16x32_bf16 v[76:79], a[12:15], a[60:63], v[76:79]
ds_read_b64_tr_b16 a[126:127], v12 offset:25600
v_mfma_f32_16x16x32_bf16 v[208:211], a[16:19], a[48:51], v[208:211]
v_mfma_f32_16x16x32_bf16 v[212:215], a[16:19], a[52:55], v[212:215]
v_mfma_f32_16x16x32_bf16 v[216:219], a[16:19], a[56:59], v[216:219]
v_mfma_f32_16x16x32_bf16 v[220:223], a[16:19], a[60:63], v[220:223]
s_mov_b32 s84, 54784
v_mfma_f32_16x16x32_bf16 v[96:99], a[20:23], a[48:51], v[96:99]
buffer_load_dwordx4 v2, s[36:39], s84 offen offset:3072 lds
v_mfma_f32_16x16x32_bf16 v[100:103], a[20:23], a[52:55], v[100:103]
v_mfma_f32_16x16x32_bf16 v[104:107], a[20:23], a[56:59], v[104:107]
v_mfma_f32_16x16x32_bf16 v[108:111], a[20:23], a[60:63], v[108:111]
v_mfma_f32_16x16x32_bf16 v[240:243], a[24:27], a[48:51], v[240:243]
v_mfma_f32_16x16x32_bf16 v[244:247], a[24:27], a[52:55], v[244:247]
v_mfma_f32_16x16x32_bf16 v[248:251], a[24:27], a[56:59], v[248:251]
v_mfma_f32_16x16x32_bf16 v[252:255], a[24:27], a[60:63], v[252:255]
v_mfma_f32_16x16x32_bf16 v[128:131], a[28:31], a[48:51], v[128:131]
v_mfma_f32_16x16x32_bf16 v[132:135], a[28:31], a[52:55], v[132:135]
v_mfma_f32_16x16x32_bf16 v[136:139], a[28:31], a[56:59], v[136:139]
v_mfma_f32_16x16x32_bf16 v[140:143], a[28:31], a[60:63], v[140:143]
s_waitcnt lgkmcnt(0)
v_mfma_f32_16x16x32_bf16 a[128:131], a[96:99], a[64:67], a[128:131]
s_waitcnt vmcnt(20)
v_mfma_f32_16x16x32_bf16 a[144:147], a[96:99], a[68:71], a[144:147]
s_barrier
v_mfma_f32_16x16x32_bf16 v[160:163], a[96:99], a[72:75], v[160:163]
s_add_u32 m0, s87, 16384
ds_read_b128 a[0:3], v5 offset:0
v_lshrrev_b32 v22, 5, v0
v_mfma_f32_16x16x32_bf16 v[168:171], a[96:99], a[76:79], v[168:171]
s_mov_b32 s84, 2359296
ds_read_b64_tr_b16 a[32:33], v9 offset:32768
v_mul_u32_u24 v22, 1280, v22
v_mfma_f32_16x16x32_bf16 v[192:195], a[96:99], a[80:83], v[192:195]
buffer_load_dwordx4 v3, s[40:43], s84 offen offset:0 nt lds
v_mfma_f32_16x16x32_bf16 v[200:203], a[96:99], a[84:87], v[200:203]
ds_read_b64_tr_b16 a[34:35], v9 offset:33792
v_and_b32 v27, 0x1f0, v1
v_mfma_f32_16x16x32_bf16 v[224:227], a[96:99], a[88:91], v[224:227]
v_add_u32 v22, v22, v27
v_mfma_f32_16x16x32_bf16 v[232:235], a[96:99], a[92:95], v[232:235]
ds_read_b128 a[4:7], v5 offset:2048
v_mfma_f32_16x16x32_bf16 a[132:135], a[100:103], a[64:67], a[132:135]
buffer_load_dwordx4 a[172:175], v22, s[44:47], s35 offen offset:512
v_mfma_f32_16x16x32_bf16 a[148:151], a[100:103], a[68:71], a[148:151]
s_mov_b32 s84, 2391040
ds_read_b64_tr_b16 a[36:37], v10 offset:32768
v_mfma_f32_16x16x32_bf16 v[48:51], a[100:103], a[72:75], v[48:51]
buffer_load_dwordx4 v3, s[40:43], s84 offen offset:1024 nt lds
v_mfma_f32_16x16x32_bf16 v[56:59], a[100:103], a[76:79], v[56:59]
ds_read_b64_tr_b16 a[38:39], v10 offset:33792
v_mfma_f32_16x16x32_bf16 v[80:83], a[100:103], a[80:83], v[80:83]
buffer_load_dwordx4 a[184:187], v27, s[72:75], 0 offen offset:512
v_mfma_f32_16x16x32_bf16 v[88:91], a[100:103], a[84:87], v[88:91]
ds_read_b128 a[8:11], v5 offset:4096
v_accvgpr_write_b32 a224, 0
v_mfma_f32_16x16x32_bf16 v[112:115], a[100:103], a[88:91], v[112:115]
v_accvgpr_write_b32 a225, 0
v_accvgpr_write_b32 a226, 0
v_mfma_f32_16x16x32_bf16 v[120:123], a[100:103], a[92:95], v[120:123]
ds_read_b64_tr_b16 a[40:41], v11 offset:32768
v_accvgpr_write_b32 a227, 0
v_mfma_f32_16x16x32_bf16 a[136:139], a[104:107], a[64:67], a[136:139]
s_add_u32 m0, s87, 20480
v_accvgpr_write_b32 a228, 0
v_accvgpr_write_b32 a229, 0
v_mfma_f32_16x16x32_bf16 a[152:155], a[104:107], a[68:71], a[152:155]
s_mov_b32 s84, 2490368
ds_read_b64_tr_b16 a[42:43], v11 offset:33792
v_accvgpr_write_b32 a230, 0
v_mfma_f32_16x16x32_bf16 v[164:167], a[104:107], a[72:75], v[164:167]
buffer_load_dwordx4 v3, s[40:43], s84 offen offset:0 nt lds
v_mfma_f32_16x16x32_bf16 v[172:175], a[104:107], a[76:79], v[172:175]
ds_read_b128 a[12:15], v5 offset:6144
v_accvgpr_write_b32 a231, 0
v_mfma_f32_16x16x32_bf16 v[196:199], a[104:107], a[80:83], v[196:199]
v_bfe_u32 v22, v0, 1, 1
v_lshrrev_b32 v23, 5, v0
v_mfma_f32_16x16x32_bf16 v[204:207], a[104:107], a[84:87], v[204:207]
ds_read_b64_tr_b16 a[44:45], v12 offset:32768
v_mov_b32 v24, 0x3f803f80
v_mfma_f32_16x16x32_bf16 v[228:231], a[104:107], a[88:91], v[228:231]
v_cmp_eq_u32 vcc, v22, v23
v_and_b32 v26, v22, v23
v_mfma_f32_16x16x32_bf16 v[236:239], a[104:107], a[92:95], v[236:239]
s_mov_b32 s84, 2522112
ds_read_b64_tr_b16 a[46:47], v12 offset:33792
v_mfma_f32_16x16x32_bf16 a[140:143], a[108:111], a[64:67], a[140:143]
buffer_load_dwordx4 v3, s[40:43], s84 offen offset:1024 nt lds
v_mfma_f32_16x16x32_bf16 a[156:159], a[108:111], a[68:71], a[156:159]
s_nop 0
ds_read_b128 a[16:19], v5 offset:8192
v_cndmask_b32 v25, 0, v24, vcc
v_mfma_f32_16x16x32_bf16 v[52:55], a[108:111], a[72:75], v[52:55]
v_cmp_eq_u32 vcc, 1, v26
v_accvgpr_write_b32 a232, v25
v_mfma_f32_16x16x32_bf16 v[60:63], a[108:111], a[76:79], v[60:63]
ds_read_b64_tr_b16 a[48:49], v9 offset:40960
v_accvgpr_write_b32 a233, v25
v_mfma_f32_16x16x32_bf16 v[84:87], a[108:111], a[80:83], v[84:87]
v_accvgpr_write_b32 a234, v25
v_accvgpr_write_b32 a235, v25
v_mfma_f32_16x16x32_bf16 v[92:95], a[108:111], a[84:87], v[92:95]
ds_read_b64_tr_b16 a[50:51], v9 offset:41984
v_cndmask_b32 v25, 0, v24, vcc
v_mfma_f32_16x16x32_bf16 v[116:119], a[108:111], a[88:91], v[116:119]
s_add_u32 m0, s86, 65536
v_accvgpr_write_b32 a236, v25
v_accvgpr_write_b32 a237, v25
v_mfma_f32_16x16x32_bf16 v[124:127], a[108:111], a[92:95], v[124:127]
s_mov_b32 s84, 640
ds_read_b128 a[20:23], v5 offset:10240
v_accvgpr_write_b32 a238, v25
v_mfma_f32_16x16x32_bf16 v[144:147], a[64:67], a[112:115], v[144:147]
buffer_load_dwordx4 v2, s[36:39], s84 offen offset:0 lds
v_mfma_f32_16x16x32_bf16 v[148:151], a[64:67], a[116:119], v[148:151]
ds_read_b64_tr_b16 a[52:53], v10 offset:40960
v_accvgpr_write_b32 a239, v25
v_mfma_f32_16x16x32_bf16 v[152:155], a[64:67], a[120:123], v[152:155]
v_lshrrev_b32 v22, 4, v0
v_lshlrev_b32 v22, 2, v22
v_mfma_f32_16x16x32_bf16 v[156:159], a[64:67], a[124:127], v[156:159]
ds_read_b64_tr_b16 a[54:55], v10 offset:41984
v_and_b32 v23, 15, v0
v_mfma_f32_16x16x32_bf16 v[32:35], a[68:71], a[112:115], v[32:35]
v_sub_u32 v22, v23, v22
v_mfma_f32_16x16x32_bf16 v[36:39], a[68:71], a[116:119], v[36:39]
s_mov_b32 s84, 7808
ds_read_b128 a[24:27], v5 offset:12288
v_mfma_f32_16x16x32_bf16 v[40:43], a[68:71], a[120:123], v[40:43]
buffer_load_dwordx4 v2, s[36:39], s84 offen offset:1024 lds
v_mfma_f32_16x16x32_bf16 v[44:47], a[68:71], a[124:127], v[44:47]
s_and_b32 s80, s76, 1
ds_read_b64_tr_b16 a[56:57], v11 offset:40960
v_mfma_f32_16x16x32_bf16 v[176:179], a[72:75], a[112:115], v[176:179]
s_lshl_b32 s80, s80, 4
v_mfma_f32_16x16x32_bf16 v[180:183], a[72:75], a[116:119], v[180:183]
s_sub_u32 s81, 16, s80
ds_read_b64_tr_b16 a[58:59], v11 offset:41984
v_add_u32 v23, s80, v22
v_mfma_f32_16x16x32_bf16 v[184:187], a[72:75], a[120:123], v[184:187]
v_subrev_u32 v25, 0, v23
v_ashrrev_i32 v25, 31, v25
v_mfma_f32_16x16x32_bf16 v[188:191], a[72:75], a[124:127], v[188:191]
ds_read_b128 a[28:31], v5 offset:14336
v_and_b32 v25, 0xff800000, v25
v_mfma_f32_16x16x32_bf16 v[64:67], a[76:79], a[112:115], v[64:67]
s_mov_b32 s84, 14976
v_accvgpr_write_b32 a240, v25
v_subrev_u32 v25, 1, v23
v_mfma_f32_16x16x32_bf16 v[68:71], a[76:79], a[116:119], v[68:71]
buffer_load_dwordx4 v2, s[36:39], s84 offen offset:2048 lds
v_mfma_f32_16x16x32_bf16 v[72:75], a[76:79], a[120:123], v[72:75]
ds_read_b64_tr_b16 a[60:61], v12 offset:40960
v_ashrrev_i32 v25, 31, v25
v_mfma_f32_16x16x32_bf16 v[76:79], a[76:79], a[124:127], v[76:79]
ds_read_b64_tr_b16 a[62:63], v12 offset:41984
v_and_b32 v25, 0xff800000, v25
v_mfma_f32_16x16x32_bf16 v[208:211], a[80:83], a[112:115], v[208:211]
v_mfma_f32_16x16x32_bf16 v[212:215], a[80:83], a[116:119], v[212:215]
v_mfma_f32_16x16x32_bf16 v[216:219], a[80:83], a[120:123], v[216:219]
v_mfma_f32_16x16x32_bf16 v[220:223], a[80:83], a[124:127], v[220:223]
s_mov_b32 s84, 22144
v_mfma_f32_16x16x32_bf16 v[96:99], a[84:87], a[112:115], v[96:99]
buffer_load_dwordx4 v2, s[36:39], s84 offen offset:3072 lds
v_mfma_f32_16x16x32_bf16 v[100:103], a[84:87], a[116:119], v[100:103]
v_mfma_f32_16x16x32_bf16 v[104:107], a[84:87], a[120:123], v[104:107]
v_mfma_f32_16x16x32_bf16 v[108:111], a[84:87], a[124:127], v[108:111]
v_mfma_f32_16x16x32_bf16 v[240:243], a[88:91], a[112:115], v[240:243]
v_mfma_f32_16x16x32_bf16 v[244:247], a[88:91], a[116:119], v[244:247]
v_mfma_f32_16x16x32_bf16 v[248:251], a[88:91], a[120:123], v[248:251]
v_mfma_f32_16x16x32_bf16 v[252:255], a[88:91], a[124:127], v[252:255]
v_mfma_f32_16x16x32_bf16 v[128:131], a[92:95], a[112:115], v[128:131]
v_mfma_f32_16x16x32_bf16 v[132:135], a[92:95], a[116:119], v[132:135]
v_mfma_f32_16x16x32_bf16 v[136:139], a[92:95], a[120:123], v[136:139]
v_mfma_f32_16x16x32_bf16 v[140:143], a[92:95], a[124:127], v[140:143]
s_waitcnt lgkmcnt(0)
v_mfma_f32_16x16x32_bf16 a[128:131], a[32:35], a[0:3], a[128:131]
s_waitcnt vmcnt(24)
v_mfma_f32_16x16x32_bf16 a[144:147], a[32:35], a[4:7], a[144:147]
s_barrier
v_mfma_f32_16x16x32_bf16 v[160:163], a[32:35], a[8:11], v[160:163]
s_add_u32 m0, s87, 32768
ds_read_b128 a[64:67], v6 offset:0
v_accvgpr_write_b32 a241, v25
v_mfma_f32_16x16x32_bf16 v[168:171], a[32:35], a[12:15], v[168:171]
s_mov_b32 s84, 2621440
ds_read_b64_tr_b16 a[96:97], v9 offset:49152
v_subrev_u32 v25, 2, v23
v_mfma_f32_16x16x32_bf16 v[192:195], a[32:35], a[16:19], v[192:195]
buffer_load_dwordx4 v3, s[40:43], s84 offen offset:0 nt lds
v_mfma_f32_16x16x32_bf16 v[200:203], a[32:35], a[20:23], v[200:203]
ds_read_b64_tr_b16 a[98:99], v9 offset:50176
v_ashrrev_i32 v25, 31, v25
v_mfma_f32_16x16x32_bf16 v[224:227], a[32:35], a[24:27], v[224:227]
v_and_b32 v25, 0xff800000, v25
v_accvgpr_write_b32 a242, v25
v_mfma_f32_16x16x32_bf16 v[232:235], a[32:35], a[28:31], v[232:235]
ds_read_b128 a[68:71], v6 offset:2048
v_subrev_u32 v25, 3, v23
v_mfma_f32_16x16x32_bf16 a[132:135], a[36:39], a[0:3], a[132:135]
v_ashrrev_i32 v25, 31, v25
v_and_b32 v25, 0xff800000, v25
v_mfma_f32_16x16x32_bf16 a[148:151], a[36:39], a[4:7], a[148:151]
s_mov_b32 s84, 2653184
ds_read_b64_tr_b16 a[100:101], v10 offset:49152
v_accvgpr_write_b32 a243, v25
v_mfma_f32_16x16x32_bf16 v[48:51], a[36:39], a[8:11], v[48:51]
buffer_load_dwordx4 v3, s[40:43], s84 offen offset:1024 nt lds
v_mfma_f32_16x16x32_bf16 v[56:59], a[36:39], a[12:15], v[56:59]
ds_read_b64_tr_b16 a[102:103], v10 offset:50176
v_subrev_u32 v25, 16, v23
v_mfma_f32_16x16x32_bf16 v[80:83], a[36:39], a[16:19], v[80:83]
v_ashrrev_i32 v25, 31, v25
v_and_b32 v25, 0xff800000, v25
v_mfma_f32_16x16x32_bf16 v[88:91], a[36:39], a[20:23], v[88:91]
ds_read_b128 a[72:75], v6 offset:4096
v_accvgpr_write_b32 a244, v25
v_mfma_f32_16x16x32_bf16 v[112:115], a[36:39], a[24:27], v[112:115]
v_subrev_u32 v25, 17, v23
v_ashrrev_i32 v25, 31, v25
v_mfma_f32_16x16x32_bf16 v[120:123], a[36:39], a[28:31], v[120:123]
ds_read_b64_tr_b16 a[104:105], v11 offset:49152
v_and_b32 v25, 0xff800000, v25
v_mfma_f32_16x16x32_bf16 a[136:139], a[40:43], a[0:3], a[136:139]
s_add_u32 m0, s87, 36864
v_accvgpr_write_b32 a245, v25
v_subrev_u32 v25, 18, v23
v_mfma_f32_16x16x32_bf16 a[152:155], a[40:43], a[4:7], a[152:155]
s_mov_b32 s84, 2752512
ds_read_b64_tr_b16 a[106:107], v11 offset:50176
v_ashrrev_i32 v25, 31, v25
v_mfma_f32_16x16x32_bf16 v[164:167], a[40:43], a[8:11], v[164:167]
buffer_load_dwordx4 v3, s[40:43], s84 offen offset:0 nt lds
v_mfma_f32_16x16x32_bf16 v[172:175], a[40:43], a[12:15], v[172:175]
ds_read_b128 a[76:79], v6 offset:6144
v_and_b32 v25, 0xff800000, v25
v_mfma_f32_16x16x32_bf16 v[196:199], a[40:43], a[16:19], v[196:199]
v_accvgpr_write_b32 a246, v25
v_subrev_u32 v25, 19, v23
v_mfma_f32_16x16x32_bf16 v[204:207], a[40:43], a[20:23], v[204:207]
ds_read_b64_tr_b16 a[108:109], v12 offset:49152
v_ashrrev_i32 v25, 31, v25
v_mfma_f32_16x16x32_bf16 v[228:231], a[40:43], a[24:27], v[228:231]
v_and_b32 v25, 0xff800000, v25
v_accvgpr_write_b32 a247, v25
v_mfma_f32_16x16x32_bf16 v[236:239], a[40:43], a[28:31], v[236:239]
s_mov_b32 s84, 2784256
ds_read_b64_tr_b16 a[110:111], v12 offset:50176
v_add_u32 v23, s81, v22
v_mfma_f32_16x16x32_bf16 a[140:143], a[44:47], a[0:3], a[140:143]
buffer_load_dwordx4 v3, s[40:43], s84 offen offset:1024 nt lds
v_mfma_f32_16x16x32_bf16 a[156:159], a[44:47], a[4:7], a[156:159]
ds_read_b128 a[80:83], v6 offset:8192
v_subrev_u32 v25, 0, v23
v_mfma_f32_16x16x32_bf16 v[52:55], a[44:47], a[8:11], v[52:55]
v_ashrrev_i32 v25, 31, v25
v_and_b32 v25, 0xff800000, v25
v_mfma_f32_16x16x32_bf16 v[60:63], a[44:47], a[12:15], v[60:63]
ds_read_b64_tr_b16 a[112:113], v9 offset:57344
v_accvgpr_write_b32 a248, v25
v_mfma_f32_16x16x32_bf16 v[84:87], a[44:47], a[16:19], v[84:87]
v_subrev_u32 v25, 1, v23
v_ashrrev_i32 v25, 31, v25
v_mfma_f32_16x16x32_bf16 v[92:95], a[44:47], a[20:23], v[92:95]
ds_read_b64_tr_b16 a[114:115], v9 offset:58368
v_and_b32 v25, 0xff800000, v25
v_mfma_f32_16x16x32_bf16 v[116:119], a[44:47], a[24:27], v[116:119]
s_add_u32 m0, s86, 69632
v_accvgpr_write_b32 a249, v25
v_subrev_u32 v25, 2, v23
v_mfma_f32_16x16x32_bf16 v[124:127], a[44:47], a[28:31], v[124:127]
s_mov_b32 s84, 33408
ds_read_b128 a[84:87], v6 offset:10240
v_ashrrev_i32 v25, 31, v25
v_mfma_f32_16x16x32_bf16 v[144:147], a[0:3], a[48:51], v[144:147]
buffer_load_dwordx4 v2, s[36:39], s84 offen offset:0 lds
v_mfma_f32_16x16x32_bf16 v[148:151], a[0:3], a[52:55], v[148:151]
buffer_load_dword a200, v31, s[64:67], s79 offen
v_mfma_f32_16x16x32_bf16 v[152:155], a[0:3], a[56:59], v[152:155]
s_add_u32 s79, s79, s101
ds_read_b64_tr_b16 a[116:117], v10 offset:57344
v_and_b32 v25, 0xff800000, v25
v_mfma_f32_16x16x32_bf16 v[156:159], a[0:3], a[60:63], v[156:159]
ds_read_b64_tr_b16 a[118:119], v10 offset:58368
v_accvgpr_write_b32 a250, v25
v_mfma_f32_16x16x32_bf16 v[32:35], a[4:7], a[48:51], v[32:35]
v_subrev_u32 v25, 3, v23
v_ashrrev_i32 v25, 31, v25
v_mfma_f32_16x16x32_bf16 v[36:39], a[4:7], a[52:55], v[36:39]
s_mov_b32 s84, 40576
ds_read_b128 a[88:91], v6 offset:12288
v_and_b32 v25, 0xff800000, v25
v_mfma_f32_16x16x32_bf16 v[40:43], a[4:7], a[56:59], v[40:43]
buffer_load_dwordx4 v2, s[36:39], s84 offen offset:1024 lds
v_mfma_f32_16x16x32_bf16 v[44:47], a[4:7], a[60:63], v[44:47]
ds_read_b64_tr_b16 a[120:121], v11 offset:57344
v_accvgpr_write_b32 a251, v25
v_mfma_f32_16x16x32_bf16 v[176:179], a[8:11], a[48:51], v[176:179]
v_subrev_u32 v25, 16, v23
v_ashrrev_i32 v25, 31, v25
v_mfma_f32_16x16x32_bf16 v[180:183], a[8:11], a[52:55], v[180:183]
ds_read_b64_tr_b16 a[122:123], v11 offset:58368
v_and_b32 v25, 0xff800000, v25
v_mfma_f32_16x16x32_bf16 v[184:187], a[8:11], a[56:59], v[184:187]
v_accvgpr_write_b32 a252, v25
v_subrev_u32 v25, 17, v23
v_mfma_f32_16x16x32_bf16 v[188:191], a[8:11], a[60:63], v[188:191]
ds_read_b128 a[92:95], v6 offset:14336
v_ashrrev_i32 v25, 31, v25
v_mfma_f32_16x16x32_bf16 v[64:67], a[12:15], a[48:51], v[64:67]
s_mov_b32 s84, 47744
v_and_b32 v25, 0xff800000, v25
v_accvgpr_write_b32 a253, v25
v_mfma_f32_16x16x32_bf16 v[68:71], a[12:15], a[52:55], v[68:71]
buffer_load_dwordx4 v2, s[36:39], s84 offen offset:2048 lds
v_mfma_f32_16x16x32_bf16 v[72:75], a[12:15], a[56:59], v[72:75]
ds_read_b64_tr_b16 a[124:125], v12 offset:57344
v_subrev_u32 v25, 18, v23
v_mfma_f32_16x16x32_bf16 v[76:79], a[12:15], a[60:63], v[76:79]
ds_read_b64_tr_b16 a[126:127], v12 offset:58368
v_ashrrev_i32 v25, 31, v25
v_mfma_f32_16x16x32_bf16 v[208:211], a[16:19], a[48:51], v[208:211]
v_and_b32 v25, 0xff800000, v25
v_accvgpr_write_b32 a254, v25
v_mfma_f32_16x16x32_bf16 v[212:215], a[16:19], a[52:55], v[212:215]
v_subrev_u32 v25, 19, v23
v_ashrrev_i32 v25, 31, v25
v_mfma_f32_16x16x32_bf16 v[216:219], a[16:19], a[56:59], v[216:219]
v_and_b32 v25, 0xff800000, v25
v_accvgpr_write_b32 a255, v25
v_mfma_f32_16x16x32_bf16 v[220:223], a[16:19], a[60:63], v[220:223]
s_mov_b32 s84, 54912
v_mfma_f32_16x16x32_bf16 v[96:99], a[20:23], a[48:51], v[96:99]
buffer_load_dwordx4 v2, s[36:39], s84 offen offset:3072 lds
v_mfma_f32_16x16x32_bf16 v[100:103], a[20:23], a[52:55], v[100:103]
v_mfma_f32_16x16x32_bf16 v[104:107], a[20:23], a[56:59], v[104:107]
v_mfma_f32_16x16x32_bf16 v[108:111], a[20:23], a[60:63], v[108:111]
v_mfma_f32_16x16x32_bf16 v[240:243], a[24:27], a[48:51], v[240:243]
v_mfma_f32_16x16x32_bf16 v[244:247], a[24:27], a[52:55], v[244:247]
v_mfma_f32_16x16x32_bf16 v[248:251], a[24:27], a[56:59], v[248:251]
v_mfma_f32_16x16x32_bf16 v[252:255], a[24:27], a[60:63], v[252:255]
v_mfma_f32_16x16x32_bf16 v[128:131], a[28:31], a[48:51], v[128:131]
v_mfma_f32_16x16x32_bf16 v[132:135], a[28:31], a[52:55], v[132:135]
v_mfma_f32_16x16x32_bf16 v[136:139], a[28:31], a[56:59], v[136:139]
v_mfma_f32_16x16x32_bf16 v[140:143], a[28:31], a[60:63], v[140:143]
s_waitcnt lgkmcnt(0)
v_mfma_f32_16x16x32_bf16 a[128:131], a[96:99], a[64:67], a[128:131]
s_waitcnt vmcnt(19)
v_mfma_f32_16x16x32_bf16 a[144:147], a[96:99], a[68:71], a[144:147]
s_barrier
v_mfma_f32_16x16x32_bf16 v[160:163], a[96:99], a[72:75], v[160:163]
s_add_u32 m0, s87, 49152
ds_read_b128 a[0:3], v5 offset:32768
v_lshrrev_b32 v22, 5, v0
v_mfma_f32_16x16x32_bf16 v[168:171], a[96:99], a[76:79], v[168:171]
s_mov_b32 s84, 2883584
ds_read_b64_tr_b16 a[32:33], v9 offset:0
v_mul_u32_u24 v22, 1280, v22
v_mfma_f32_16x16x32_bf16 v[192:195], a[96:99], a[80:83], v[192:195]
buffer_load_dwordx4 v3, s[40:43], s84 offen offset:0 nt lds
v_mfma_f32_16x16x32_bf16 v[200:203], a[96:99], a[84:87], v[200:203]
ds_read_b64_tr_b16 a[34:35], v9 offset:1024
v_and_b32 v27, 0x1f0, v1
v_mfma_f32_16x16x32_bf16 v[224:227], a[96:99], a[88:91], v[224:227]
v_add_u32 v22, v22, v27
v_mfma_f32_16x16x32_bf16 v[232:235], a[96:99], a[92:95], v[232:235]
ds_read_b128 a[4:7], v5 offset:34816
v_mfma_f32_16x16x32_bf16 a[132:135], a[100:103], a[64:67], a[132:135]
buffer_load_dwordx4 a[176:179], v22, s[44:47], s35 offen offset:1024
v_mfma_f32_16x16x32_bf16 a[148:151], a[100:103], a[68:71], a[148:151]
s_mov_b32 s84, 2915328
ds_read_b64_tr_b16 a[36:37], v10 offset:0
v_mfma_f32_16x16x32_bf16 v[48:51], a[100:103], a[72:75], v[48:51]
buffer_load_dwordx4 v3, s[40:43], s84 offen offset:1024 nt lds
v_mfma_f32_16x16x32_bf16 v[56:59], a[100:103], a[76:79], v[56:59]
ds_read_b64_tr_b16 a[38:39], v10 offset:1024
v_mfma_f32_16x16x32_bf16 v[80:83], a[100:103], a[80:83], v[80:83]
buffer_load_dwordx4 a[188:191], v27, s[72:75], 0 offen offset:1024
v_mfma_f32_16x16x32_bf16 v[88:91], a[100:103], a[84:87], v[88:91]
ds_read_b128 a[8:11], v5 offset:36864
v_mfma_f32_16x16x32_bf16 v[112:115], a[100:103], a[88:91], v[112:115]
v_mfma_f32_16x16x32_bf16 v[120:123], a[100:103], a[92:95], v[120:123]
ds_read_b64_tr_b16 a[40:41], v11 offset:0
v_mfma_f32_16x16x32_bf16 a[136:139], a[104:107], a[64:67], a[136:139]
s_add_u32 m0, s87, 53248
v_mfma_f32_16x16x32_bf16 a[152:155], a[104:107], a[68:71], a[152:155]
s_mov_b32 s84, 3014656
ds_read_b64_tr_b16 a[42:43], v11 offset:1024
v_mfma_f32_16x16x32_bf16 v[164:167], a[104:107], a[72:75], v[164:167]
buffer_load_dwordx4 v3, s[40:43], s84 offen offset:0 nt lds
v_mfma_f32_16x16x32_bf16 v[172:175], a[104:107], a[76:79], v[172:175]
L_w0_1:
s_cbranch_execz L_wend0
ds_read_b128 a[12:15], v5 offset:38912
v_mfma_f32_16x16x32_bf16 v[196:199], a[104:107], a[80:83], v[196:199]
v_mfma_f32_16x16x32_bf16 v[204:207], a[104:107], a[84:87], v[204:207]
ds_read_b64_tr_b16 a[44:45], v12 offset:0
v_mfma_f32_16x16x32_bf16 v[228:231], a[104:107], a[88:91], v[228:231]
v_mfma_f32_16x16x32_bf16 v[236:239], a[104:107], a[92:95], v[236:239]
s_mov_b32 s84, 3046400
ds_read_b64_tr_b16 a[46:47], v12 offset:1024
v_mfma_f32_16x16x32_bf16 a[140:143], a[108:111], a[64:67], a[140:143]
buffer_load_dwordx4 v3, s[40:43], s84 offen offset:1024 nt lds
v_mfma_f32_16x16x32_bf16 a[156:159], a[108:111], a[68:71], a[156:159]
ds_read_b128 a[16:19], v5 offset:40960
v_mfma_f32_16x16x32_bf16 v[52:55], a[108:111], a[72:75], v[52:55]
v_mfma_f32_16x16x32_bf16 v[60:63], a[108:111], a[76:79], v[60:63]
ds_read_b64_tr_b16 a[48:49], v9 offset:8192
v_mfma_f32_16x16x32_bf16 v[84:87], a[108:111], a[80:83], v[84:87]
v_mfma_f32_16x16x32_bf16 v[92:95], a[108:111], a[84:87], v[92:95]
ds_read_b64_tr_b16 a[50:51], v9 offset:9216
v_mfma_f32_16x16x32_bf16 v[116:119], a[108:111], a[88:91], v[116:119]
s_add_u32 m0, s86, 0
v_mfma_f32_16x16x32_bf16 v[124:127], a[108:111], a[92:95], v[124:127]
s_mov_b32 s84, 768
ds_read_b128 a[20:23], v5 offset:43008
v_mfma_f32_16x16x32_bf16 v[144:147], a[64:67], a[112:115], v[144:147]
buffer_load_dwordx4 v2, s[36:39], s84 offen offset:0 lds
v_mfma_f32_16x16x32_bf16 v[148:151], a[64:67], a[116:119], v[148:151]
ds_read_b64_tr_b16 a[52:53], v10 offset:8192
v_mfma_f32_16x16x32_bf16 v[152:155], a[64:67], a[120:123], v[152:155]
v_mfma_f32_16x16x32_bf16 v[156:159], a[64:67], a[124:127], v[156:159]
ds_read_b64_tr_b16 a[54:55], v10 offset:9216
v_mfma_f32_16x16x32_bf16 v[32:35], a[68:71], a[112:115], v[32:35]
v_mfma_f32_16x16x32_bf16 v[36:39], a[68:71], a[116:119], v[36:39]
s_mov_b32 s84, 7936
ds_read_b128 a[24:27], v5 offset:45056
v_mfma_f32_16x16x32_bf16 v[40:43], a[68:71], a[120:123], v[40:43]
buffer_load_dwordx4 v2, s[36:39], s84 offen offset:1024 lds
v_mfma_f32_16x16x32_bf16 v[44:47], a[68:71], a[124:127], v[44:47]
ds_read_b64_tr_b16 a[56:57], v11 offset:8192
v_mfma_f32_16x16x32_bf16 v[176:179], a[72:75], a[112:115], v[176:179]
v_mfma_f32_16x16x32_bf16 v[180:183], a[72:75], a[116:119], v[180:183]
ds_read_b64_tr_b16 a[58:59], v11 offset:9216
v_mfma_f32_16x16x32_bf16 v[184:187], a[72:75], a[120:123], v[184:187]
v_mfma_f32_16x16x32_bf16 v[188:191], a[72:75], a[124:127], v[188:191]
ds_read_b128 a[28:31], v5 offset:47104
v_mfma_f32_16x16x32_bf16 v[64:67], a[76:79], a[112:115], v[64:67]
s_mov_b32 s84, 15104
v_mfma_f32_16x16x32_bf16 v[68:71], a[76:79], a[116:119], v[68:71]
buffer_load_dwordx4 v2, s[36:39], s84 offen offset:2048 lds
v_mfma_f32_16x16x32_bf16 v[72:75], a[76:79], a[120:123], v[72:75]
ds_read_b64_tr_b16 a[60:61], v12 offset:8192
v_mfma_f32_16x16x32_bf16 v[76:79], a[76:79], a[124:127], v[76:79]
ds_read_b64_tr_b16 a[62:63], v12 offset:9216
v_mfma_f32_16x16x32_bf16 v[208:211], a[80:83], a[112:115], v[208:211]
v_mfma_f32_16x16x32_bf16 v[212:215], a[80:83], a[116:119], v[212:215]
v_mfma_f32_16x16x32_bf16 v[216:219], a[80:83], a[120:123], v[216:219]
v_mfma_f32_16x16x32_bf16 v[220:223], a[80:83], a[124:127], v[220:223]
s_mov_b32 s84, 22272
v_mfma_f32_16x16x32_bf16 v[96:99], a[84:87], a[112:115], v[96:99]
buffer_load_dwordx4 v2, s[36:39], s84 offen offset:3072 lds
v_mfma_f32_16x16x32_bf16 v[100:103], a[84:87], a[116:119], v[100:103]
v_mfma_f32_16x16x32_bf16 v[104:107], a[84:87], a[120:123], v[104:107]
v_mfma_f32_16x16x32_bf16 v[108:111], a[84:87], a[124:127], v[108:111]
v_mfma_f32_16x16x32_bf16 v[240:243], a[88:91], a[112:115], v[240:243]
v_mfma_f32_16x16x32_bf16 v[244:247], a[88:91], a[116:119], v[244:247]
v_mfma_f32_16x16x32_bf16 v[248:251], a[88:91], a[120:123], v[248:251]
v_mfma_f32_16x16x32_bf16 v[252:255], a[88:91], a[124:127], v[252:255]
v_mfma_f32_16x16x32_bf16 v[128:131], a[92:95], a[112:115], v[128:131]
v_mfma_f32_16x16x32_bf16 v[132:135], a[92:95], a[116:119], v[132:135]
v_mfma_f32_16x16x32_bf16 v[136:139], a[92:95], a[120:123], v[136:139]
v_mfma_f32_16x16x32_bf16 v[140:143], a[92:95], a[124:127], v[140:143]
s_waitcnt lgkmcnt(0)
v_mfma_f32_16x16x32_bf16 a[128:131], a[32:35], a[0:3], a[128:131]
s_waitcnt vmcnt(23)
v_mfma_f32_16x16x32_bf16 a[144:147], a[32:35], a[4:7], a[144:147]
s_barrier
v_mfma_f32_16x16x32_bf16 v[160:163], a[32:35], a[8:11], v[160:163]
s_add_u32 m0, s87, 0
ds_read_b128 a[64:67], v6 offset:32768
v_lshrrev_b32 v22, 4, v0
v_mfma_f32_16x16x32_bf16 v[168:171], a[32:35], a[12:15], v[168:171]
s_mov_b32 s84, 3145728
ds_read_b64_tr_b16 a[96:97], v9 offset:16384
v_lshlrev_b32 v22, 3, v22
v_mfma_f32_16x16x32_bf16 v[192:195], a[32:35], a[16:19], v[192:195]
buffer_load_dwordx4 v3, s[40:43], s84 offen offset:0 nt lds
v_mfma_f32_16x16x32_bf16 v[200:203], a[32:35], a[20:23], v[200:203]
ds_read_b64_tr_b16 a[98:99], v9 offset:17408
v_mfma_f32_16x16x32_bf16 v[224:227], a[32:35], a[24:27], v[224:227]
buffer_load_dwordx2 a[160:161], v22, s[60:63], 0 offen offset:0
v_mfma_f32_16x16x32_bf16 v[232:235], a[32:35], a[28:31], v[232:235]
ds_read_b128 a[68:71], v6 offset:34816
v_mfma_f32_16x16x32_bf16 a[132:135], a[36:39], a[0:3], a[132:135]
buffer_load_dwordx2 a[162:163], v22, s[60:63], 0 offen offset:32
v_mfma_f32_16x16x32_bf16 a[148:151], a[36:39], a[4:7], a[148:151]
s_mov_b32 s84, 3177472
ds_read_b64_tr_b16 a[100:101], v10 offset:16384
v_mfma_f32_16x16x32_bf16 v[48:51], a[36:39], a[8:11], v[48:51]
buffer_load_dwordx4 v3, s[40:43], s84 offen offset:1024 nt lds
v_mfma_f32_16x16x32_bf16 v[56:59], a[36:39], a[12:15], v[56:59]
ds_read_b64_tr_b16 a[102:103], v10 offset:17408
v_mfma_f32_16x16x32_bf16 v[80:83], a[36:39], a[16:19], v[80:83]
buffer_load_dwordx2 a[164:165], v22, s[60:63], 0 offen offset:64
v_mfma_f32_16x16x32_bf16 v[88:91], a[36:39], a[20:23], v[88:91]
ds_read_b128 a[72:75], v6 offset:36864
v_mfma_f32_16x16x32_bf16 v[112:115], a[36:39], a[24:27], v[112:115]
buffer_load_dwordx2 a[166:167], v22, s[60:63], 0 offen offset:96
v_mfma_f32_16x16x32_bf16 v[120:123], a[36:39], a[28:31], v[120:123]
s_lshl_b32 s80, s77, 20
ds_read_b64_tr_b16 a[104:105], v11 offset:16384
v_mfma_f32_16x16x32_bf16 a[136:139], a[40:43], a[0:3], a[136:139]
s_add_u32 m0, s87, 4096
v_mfma_f32_16x16x32_bf16 a[152:155], a[40:43], a[4:7], a[152:155]
s_mov_b32 s84, 3276800
ds_read_b64_tr_b16 a[106:107], v11 offset:17408
v_mfma_f32_16x16x32_bf16 v[164:167], a[40:43], a[8:11], v[164:167]
buffer_load_dwordx4 v3, s[40:43], s84 offen offset:0 nt lds
v_mfma_f32_16x16x32_bf16 v[172:175], a[40:43], a[12:15], v[172:175]
s_add_u32 s60, s32, s80
s_addc_u32 s61, s33, 0
ds_read_b128 a[76:79], v6 offset:38912
v_mfma_f32_16x16x32_bf16 v[196:199], a[40:43], a[16:19], v[196:199]
s_and_b32 s61, s61, 0xffff
v_mfma_f32_16x16x32_bf16 v[204:207], a[40:43], a[20:23], v[204:207]
s_mov_b32 s62, 0
ds_read_b64_tr_b16 a[108:109], v12 offset:16384
v_mfma_f32_16x16x32_bf16 v[228:231], a[40:43], a[24:27], v[228:231]
s_mov_b32 s63, 0x20000
v_mfma_f32_16x16x32_bf16 v[236:239], a[40:43], a[28:31], v[236:239]
s_mov_b32 s84, 3308544
ds_read_b64_tr_b16 a[110:111], v12 offset:17408
v_mfma_f32_16x16x32_bf16 a[140:143], a[44:47], a[0:3], a[140:143]
buffer_load_dwordx4 v3, s[40:43], s84 offen offset:1024 nt lds
v_mfma_f32_16x16x32_bf16 a[156:159], a[44:47], a[4:7], a[156:159]
s_sub_u32 s81, 16, s78
ds_read_b128 a[80:83], v6 offset:40960
v_mfma_f32_16x16x32_bf16 v[52:55], a[44:47], a[8:11], v[52:55]
s_lshl_b32 s62, s81, 16
v_mfma_f32_16x16x32_bf16 v[60:63], a[44:47], a[12:15], v[60:63]
s_sub_u32 s81, 15, s78
ds_read_b64_tr_b16 a[112:113], v9 offset:24576
v_mfma_f32_16x16x32_bf16 v[84:87], a[44:47], a[16:19], v[84:87]
s_bitcmp1_b32 s76, 0
s_cselect_b32 s81, s81, s78
v_mfma_f32_16x16x32_bf16 v[92:95], a[44:47], a[20:23], v[92:95]
s_lshl_b32 s81, s81, 16
ds_read_b64_tr_b16 a[114:115], v9 offset:25600
v_mfma_f32_16x16x32_bf16 v[116:119], a[44:47], a[24:27], v[116:119]
s_add_u32 m0, s86, 4096
v_mfma_f32_16x16x32_bf16 v[124:127], a[44:47], a[28:31], v[124:127]
s_mov_b32 s84, 33536
ds_read_b128 a[84:87], v6 offset:43008
v_mfma_f32_16x16x32_bf16 v[144:147], a[0:3], a[48:51], v[144:147]
buffer_load_dwordx4 v2, s[36:39], s84 offen offset:0 lds
v_mfma_f32_16x16x32_bf16 v[148:151], a[0:3], a[52:55], v[148:151]
buffer_load_dword a200, v31, s[64:67], s79 offen
v_mfma_f32_16x16x32_bf16 v[152:155], a[0:3], a[56:59], v[152:155]
s_add_u32 s79, s79, s101
ds_read_b64_tr_b16 a[116:117], v10 offset:24576
v_mfma_f32_16x16x32_bf16 v[156:159], a[0:3], a[60:63], v[156:159]
s_add_u32 s80, s80, s81
ds_read_b64_tr_b16 a[118:119], v10 offset:25600
v_mfma_f32_16x16x32_bf16 v[32:35], a[4:7], a[48:51], v[32:35]
s_lshr_b32 s81, s76, 1
v_mfma_f32_16x16x32_bf16 v[36:39], a[4:7], a[52:55], v[36:39]
s_mov_b32 s84, 40704
ds_read_b128 a[88:91], v6 offset:45056
v_mfma_f32_16x16x32_bf16 v[40:43], a[4:7], a[56:59], v[40:43]
buffer_load_dwordx4 v2, s[36:39], s84 offen offset:1024 lds
v_mfma_f32_16x16x32_bf16 v[44:47], a[4:7], a[60:63], v[44:47]
s_lshl_b32 s81, s81, 11
ds_read_b64_tr_b16 a[120:121], v11 offset:24576
v_mfma_f32_16x16x32_bf16 v[176:179], a[8:11], a[48:51], v[176:179]
s_add_u32 s98, s80, s81
v_mfma_f32_16x16x32_bf16 v[180:183], a[8:11], a[52:55], v[180:183]
s_add_u32 s99, s98, s81
ds_read_b64_tr_b16 a[122:123], v11 offset:25600
v_mfma_f32_16x16x32_bf16 v[184:187], a[8:11], a[56:59], v[184:187]
s_add_u32 s99, s99, 8192
v_mfma_f32_16x16x32_bf16 v[188:191], a[8:11], a[60:63], v[188:191]
ds_read_b128 a[92:95], v6 offset:47104
v_mfma_f32_16x16x32_bf16 v[64:67], a[12:15], a[48:51], v[64:67]
s_mov_b32 s84, 47872
v_mfma_f32_16x16x32_bf16 v[68:71], a[12:15], a[52:55], v[68:71]
buffer_load_dwordx4 v2, s[36:39], s84 offen offset:2048 lds
v_mfma_f32_16x16x32_bf16 v[72:75], a[12:15], a[56:59], v[72:75]
ds_read_b64_tr_b16 a[124:125], v12 offset:24576
v_mfma_f32_16x16x32_bf16 v[76:79], a[12:15], a[60:63], v[76:79]
ds_read_b64_tr_b16 a[126:127], v12 offset:25600
v_mfma_f32_16x16x32_bf16 v[208:211], a[16:19], a[48:51], v[208:211]
v_mfma_f32_16x16x32_bf16 v[212:215], a[16:19], a[52:55], v[212:215]
v_mfma_f32_16x16x32_bf16 v[216:219], a[16:19], a[56:59], v[216:219]
v_mfma_f32_16x16x32_bf16 v[220:223], a[16:19], a[60:63], v[220:223]
s_mov_b32 s84, 55040
v_mfma_f32_16x16x32_bf16 v[96:99], a[20:23], a[48:51], v[96:99]
buffer_load_dwordx4 v2, s[36:39], s84 offen offset:3072 lds
v_mfma_f32_16x16x32_bf16 v[100:103], a[20:23], a[52:55], v[100:103]
v_mfma_f32_16x16x32_bf16 v[104:107], a[20:23], a[56:59], v[104:107]
v_mfma_f32_16x16x32_bf16 v[108:111], a[20:23], a[60:63], v[108:111]
v_mfma_f32_16x16x32_bf16 v[240:243], a[24:27], a[48:51], v[240:243]
v_mfma_f32_16x16x32_bf16 v[244:247], a[24:27], a[52:55], v[244:247]
v_mfma_f32_16x16x32_bf16 v[248:251], a[24:27], a[56:59], v[248:251]
v_mfma_f32_16x16x32_bf16 v[252:255], a[24:27], a[60:63], v[252:255]
v_mfma_f32_16x16x32_bf16 v[128:131], a[28:31], a[48:51], v[128:131]
v_mfma_f32_16x16x32_bf16 v[132:135], a[28:31], a[52:55], v[132:135]
v_mfma_f32_16x16x32_bf16 v[136:139], a[28:31], a[56:59], v[136:139]
v_mfma_f32_16x16x32_bf16 v[140:143], a[28:31], a[60:63], v[140:143]
s_waitcnt lgkmcnt(0)
v_mfma_f32_16x16x32_bf16 a[128:131], a[96:99], a[64:67], a[128:131]
s_waitcnt vmcnt(23)
v_mfma_f32_16x16x32_bf16 a[144:147], a[96:99], a[68:71], a[144:147]
s_barrier
v_mfma_f32_16x16x32_bf16 v[160:163], a[96:99], a[72:75], v[160:163]
s_add_u32 m0, s87, 16384
ds_read_b128 a[0:3], v7 offset:0
v_mfma_f32_16x16x32_bf16 v[168:171], a[96:99], a[76:79], v[168:171]
s_mov_b32 s84, 3407872
ds_read_b64_tr_b16 a[32:33], v9 offset:32768
v_mfma_f32_16x16x32_bf16 v[192:195], a[96:99], a[80:83], v[192:195]
buffer_load_dwordx4 v3, s[40:43], s84 offen offset:0 nt lds
v_mfma_f32_16x16x32_bf16 v[200:203], a[96:99], a[84:87], v[200:203]
ds_read_b64_tr_b16 a[34:35], v9 offset:33792
v_mfma_f32_16x16x32_bf16 v[224:227], a[96:99], a[88:91], v[224:227]
v_mfma_f32_16x16x32_bf16 v[232:235], a[96:99], a[92:95], v[232:235]
ds_read_b128 a[4:7], v7 offset:2048
v_mfma_f32_16x16x32_bf16 a[132:135], a[100:103], a[64:67], a[132:135]
v_mfma_f32_16x16x32_bf16 a[148:151], a[100:103], a[68:71], a[148:151]
s_mov_b32 s84, 3439616
ds_read_b64_tr_b16 a[36:37], v10 offset:32768
v_mfma_f32_16x16x32_bf16 v[48:51], a[100:103], a[72:75], v[48:51]
buffer_load_dwordx4 v3, s[40:43], s84 offen offset:1024 nt lds
v_mfma_f32_16x16x32_bf16 v[56:59], a[100:103], a[76:79], v[56:59]
ds_read_b64_tr_b16 a[38:39], v10 offset:33792
v_mfma_f32_16x16x32_bf16 v[80:83], a[100:103], a[80:83], v[80:83]
v_mfma_f32_16x16x32_bf16 v[88:91], a[100:103], a[84:87], v[88:91]
ds_read_b128 a[8:11], v7 offset:4096
v_mfma_f32_16x16x32_bf16 v[112:115], a[100:103], a[88:91], v[112:115]
v_mfma_f32_16x16x32_bf16 v[120:123], a[100:103], a[92:95], v[120:123]
ds_read_b64_tr_b16 a[40:41], v11 offset:32768
v_mfma_f32_16x16x32_bf16 a[136:139], a[104:107], a[64:67], a[136:139]
s_add_u32 m0, s87, 20480
v_mfma_f32_16x16x32_bf16 a[152:155], a[104:107], a[68:71], a[152:155]
s_mov_b32 s84, 3538944
ds_read_b64_tr_b16 a[42:43], v11 offset:33792
v_mfma_f32_16x16x32_bf16 v[164:167], a[104:107], a[72:75], v[164:167]
buffer_load_dwordx4 v3, s[40:43], s84 offen offset:0 nt lds
v_mfma_f32_16x16x32_bf16 v[172:175], a[104:107], a[76:79], v[172:175]
ds_read_b128 a[12:15], v7 offset:6144
v_mfma_f32_16x16x32_bf16 v[196:199], a[104:107], a[80:83], v[196:199]
v_mfma_f32_16x16x32_bf16 v[204:207], a[104:107], a[84:87], v[204:207]
ds_read_b64_tr_b16 a[44:45], v12 offset:32768
v_mfma_f32_16x16x32_bf16 v[228:231], a[104:107], a[88:91], v[228:231]
v_mfma_f32_16x16x32_bf16 v[236:239], a[104:107], a[92:95], v[236:239]
s_mov_b32 s84, 3570688
ds_read_b64_tr_b16 a[46:47], v12 offset:33792
v_mfma_f32_16x16x32_bf16 a[140:143], a[108:111], a[64:67], a[140:143]
buffer_load_dwordx4 v3, s[40:43], s84 offen offset:1024 nt lds
v_mfma_f32_16x16x32_bf16 a[156:159], a[108:111], a[68:71], a[156:159]
ds_read_b128 a[16:19], v7 offset:8192
v_mfma_f32_16x16x32_bf16 v[52:55], a[108:111], a[72:75], v[52:55]
v_mfma_f32_16x16x32_bf16 v[60:63], a[108:111], a[76:79], v[60:63]
ds_read_b64_tr_b16 a[48:49], v9 offset:40960
v_mfma_f32_16x16x32_bf16 v[84:87], a[108:111], a[80:83], v[84:87]
v_mfma_f32_16x16x32_bf16 v[92:95], a[108:111], a[84:87], v[92:95]
ds_read_b64_tr_b16 a[50:51], v9 offset:41984
v_mfma_f32_16x16x32_bf16 v[116:119], a[108:111], a[88:91], v[116:119]
s_add_u32 m0, s86, 32768
v_mfma_f32_16x16x32_bf16 v[124:127], a[108:111], a[92:95], v[124:127]
s_mov_b32 s84, 896
ds_read_b128 a[20:23], v7 offset:10240
v_mfma_f32_16x16x32_bf16 v[144:147], a[64:67], a[112:115], v[144:147]
buffer_load_dwordx4 v2, s[36:39], s84 offen offset:0 lds
v_mfma_f32_16x16x32_bf16 v[148:151], a[64:67], a[116:119], v[148:151]
buffer_load_dword a200, v31, s[64:67], s79 offen
v_mfma_f32_16x16x32_bf16 v[152:155], a[64:67], a[120:123], v[152:155]
s_add_u32 s79, s79, s101
ds_read_b64_tr_b16 a[52:53], v10 offset:40960
v_mfma_f32_16x16x32_bf16 v[156:159], a[64:67], a[124:127], v[156:159]
ds_read_b64_tr_b16 a[54:55], v10 offset:41984
v_mfma_f32_16x16x32_bf16 v[32:35], a[68:71], a[112:115], v[32:35]
v_mfma_f32_16x16x32_bf16 v[36:39], a[68:71], a[116:119], v[36:39]
s_mov_b32 s84, 8064
ds_read_b128 a[24:27], v7 offset:12288
v_mfma_f32_16x16x32_bf16 v[40:43], a[68:71], a[120:123], v[40:43]
buffer_load_dwordx4 v2, s[36:39], s84 offen offset:1024 lds
v_mfma_f32_16x16x32_bf16 v[44:47], a[68:71], a[124:127], v[44:47]
ds_read_b64_tr_b16 a[56:57], v11 offset:40960
v_mfma_f32_16x16x32_bf16 v[176:179], a[72:75], a[112:115], v[176:179]
v_mfma_f32_16x16x32_bf16 v[180:183], a[72:75], a[116:119], v[180:183]
ds_read_b64_tr_b16 a[58:59], v11 offset:41984
v_mfma_f32_16x16x32_bf16 v[184:187], a[72:75], a[120:123], v[184:187]
v_mfma_f32_16x16x32_bf16 v[188:191], a[72:75], a[124:127], v[188:191]
ds_read_b128 a[28:31], v7 offset:14336
v_mfma_f32_16x16x32_bf16 v[64:67], a[76:79], a[112:115], v[64:67]
s_mov_b32 s84, 15232
v_mfma_f32_16x16x32_bf16 v[68:71], a[76:79], a[116:119], v[68:71]
buffer_load_dwordx4 v2, s[36:39], s84 offen offset:2048 lds
v_mfma_f32_16x16x32_bf16 v[72:75], a[76:79], a[120:123], v[72:75]
ds_read_b64_tr_b16 a[60:61], v12 offset:40960
v_mfma_f32_16x16x32_bf16 v[76:79], a[76:79], a[124:127], v[76:79]
ds_read_b64_tr_b16 a[62:63], v12 offset:41984
v_mfma_f32_16x16x32_bf16 v[208:211], a[80:83], a[112:115], v[208:211]
v_mfma_f32_16x16x32_bf16 v[212:215], a[80:83], a[116:119], v[212:215]
v_mfma_f32_16x16x32_bf16 v[216:219], a[80:83], a[120:123], v[216:219]
v_mfma_f32_16x16x32_bf16 v[220:223], a[80:83], a[124:127], v[220:223]
s_mov_b32 s84, 22400
v_mfma_f32_16x16x32_bf16 v[96:99], a[84:87], a[112:115], v[96:99]
buffer_load_dwordx4 v2, s[36:39], s84 offen offset:3072 lds
v_mfma_f32_16x16x32_bf16 v[100:103], a[84:87], a[116:119], v[100:103]
v_mfma_f32_16x16x32_bf16 v[104:107], a[84:87], a[120:123], v[104:107]
v_mfma_f32_16x16x32_bf16 v[108:111], a[84:87], a[124:127], v[108:111]
v_mfma_f32_16x16x32_bf16 v[240:243], a[88:91], a[112:115], v[240:243]
v_mfma_f32_16x16x32_bf16 v[244:247], a[88:91], a[116:119], v[244:247]
v_mfma_f32_16x16x32_bf16 v[248:251], a[88:91], a[120:123], v[248:251]
v_mfma_f32_16x16x32_bf16 v[252:255], a[88:91], a[124:127], v[252:255]
v_mfma_f32_16x16x32_bf16 v[128:131], a[92:95], a[112:115], v[128:131]
v_mfma_f32_16x16x32_bf16 v[132:135], a[92:95], a[116:119], v[132:135]
v_mfma_f32_16x16x32_bf16 v[136:139], a[92:95], a[120:123], v[136:139]
v_mfma_f32_16x16x32_bf16 v[140:143], a[92:95], a[124:127], v[140:143]
s_waitcnt lgkmcnt(0)
v_mfma_f32_16x16x32_bf16 a[128:131], a[32:35], a[0:3], a[128:131]
s_waitcnt vmcnt(26)
v_mfma_f32_16x16x32_bf16 a[144:147], a[32:35], a[4:7], a[144:147]
s_barrier
v_mfma_f32_16x16x32_bf16 v[160:163], a[32:35], a[8:11], v[160:163]
s_add_u32 m0, s87, 32768
ds_read_b128 a[64:67], v8 offset:0
v_mov_b32 v22, 0
v_mfma_f32_16x16x32_bf16 v[168:171], a[32:35], a[12:15], v[168:171]
s_mov_b32 s84, 3670016
ds_read_b64_tr_b16 a[96:97], v9 offset:49152
v_accvgpr_read_b32 v27, a168
v_mfma_f32_16x16x32_bf16 v[192:195], a[32:35], a[16:19], v[192:195]
buffer_load_dwordx4 v3, s[40:43], s84 offen offset:0 nt lds
v_mfma_f32_16x16x32_bf16 v[200:203], a[32:35], a[20:23], v[200:203]
s_lshl_b32 s80, s76, 16
ds_read_b64_tr_b16 a[98:99], v9 offset:50176
v_accvgpr_read_b32 v24, a180
v_mfma_f32_16x16x32_bf16 v[224:227], a[32:35], a[24:27], v[224:227]
v_lshlrev_b32 v25, 16, v27
v_lshlrev_b32 v26, 16, v24
v_mfma_f32_16x16x32_bf16 v[232:235], a[32:35], a[28:31], v[232:235]
ds_read_b128 a[68:71], v8 offset:2048
v_and_b32 v27, 0xffff0000, v27
v_mfma_f32_16x16x32_bf16 a[132:135], a[36:39], a[0:3], a[132:135]
v_and_b32 v24, 0xffff0000, v24
v_fmac_f32 v22, v25, v26
v_mfma_f32_16x16x32_bf16 a[148:151], a[36:39], a[4:7], a[148:151]
s_mov_b32 s84, 3701760
ds_read_b64_tr_b16 a[100:101], v10 offset:49152
v_fmac_f32 v22, v27, v24
v_mfma_f32_16x16x32_bf16 v[48:51], a[36:39], a[8:11], v[48:51]
buffer_load_dwordx4 v3, s[40:43], s84 offen offset:1024 nt lds
v_mfma_f32_16x16x32_bf16 v[56:59], a[36:39], a[12:15], v[56:59]
ds_read_b64_tr_b16 a[102:103], v10 offset:50176
v_accvgpr_read_b32 v27, a169
v_mfma_f32_16x16x32_bf16 v[80:83], a[36:39], a[16:19], v[80:83]
v_accvgpr_read_b32 v24, a181
v_lshlrev_b32 v25, 16, v27
v_mfma_f32_16x16x32_bf16 v[88:91], a[36:39], a[20:23], v[88:91]
ds_read_b128 a[72:75], v8 offset:4096
v_lshlrev_b32 v26, 16, v24
v_mfma_f32_16x16x32_bf16 v[112:115], a[36:39], a[24:27], v[112:115]
v_and_b32 v27, 0xffff0000, v27
v_and_b32 v24, 0xffff0000, v24
v_mfma_f32_16x16x32_bf16 v[120:123], a[36:39], a[28:31], v[120:123]
ds_read_b64_tr_b16 a[104:105], v11 offset:49152
v_fmac_f32 v22, v25, v26
v_mfma_f32_16x16x32_bf16 a[136:139], a[40:43], a[0:3], a[136:139]
s_add_u32 m0, s87, 36864
v_fmac_f32 v22, v27, v24
v_accvgpr_read_b32 v27, a170
v_mfma_f32_16x16x32_bf16 a[152:155], a[40:43], a[4:7], a[152:155]
s_mov_b32 s84, 3801088
ds_read_b64_tr_b16 a[106:107], v11 offset:50176
v_accvgpr_read_b32 v24, a182
v_mfma_f32_16x16x32_bf16 v[164:167], a[40:43], a[8:11], v[164:167]
buffer_load_dwordx4 v3, s[40:43], s84 offen offset:0 nt lds
v_mfma_f32_16x16x32_bf16 v[172:175], a[40:43], a[12:15], v[172:175]
ds_read_b128 a[76:79], v8 offset:6144
v_lshlrev_b32 v25, 16, v27
v_mfma_f32_16x16x32_bf16 v[196:199], a[40:43], a[16:19], v[196:199]
v_lshlrev_b32 v26, 16, v24
v_and_b32 v27, 0xffff0000, v27
v_mfma_f32_16x16x32_bf16 v[204:207], a[40:43], a[20:23], v[204:207]
ds_read_b64_tr_b16 a[108:109], v12 offset:49152
v_and_b32 v24, 0xffff0000, v24
v_mfma_f32_16x16x32_bf16 v[228:231], a[40:43], a[24:27], v[228:231]
v_fmac_f32 v22, v25, v26
v_fmac_f32 v22, v27, v24
v_mfma_f32_16x16x32_bf16 v[236:239], a[40:43], a[28:31], v[236:239]
s_mov_b32 s84, 3832832
ds_read_b64_tr_b16 a[110:111], v12 offset:50176
v_accvgpr_read_b32 v27, a171
v_mfma_f32_16x16x32_bf16 a[140:143], a[44:47], a[0:3], a[140:143]
buffer_load_dwordx4 v3, s[40:43], s84 offen offset:1024 nt lds
v_mfma_f32_16x16x32_bf16 a[156:159], a[44:47], a[4:7], a[156:159]
ds_read_b128 a[80:83], v8 offset:8192
v_accvgpr_read_b32 v24, a183
v_mfma_f32_16x16x32_bf16 v[52:55], a[44:47], a[8:11], v[52:55]
v_lshlrev_b32 v25, 16, v27
v_lshlrev_b32 v26, 16, v24
v_mfma_f32_16x16x32_bf16 v[60:63], a[44:47], a[12:15], v[60:63]
ds_read_b64_tr_b16 a[112:113], v9 offset:57344
v_and_b32 v27, 0xffff0000, v27
v_mfma_f32_16x16x32_bf16 v[84:87], a[44:47], a[16:19], v[84:87]
v_and_b32 v24, 0xffff0000, v24
v_fmac_f32 v22, v25, v26
v_mfma_f32_16x16x32_bf16 v[92:95], a[44:47], a[20:23], v[92:95]
ds_read_b64_tr_b16 a[114:115], v9 offset:58368
v_fmac_f32 v22, v27, v24
v_mfma_f32_16x16x32_bf16 v[116:119], a[44:47], a[24:27], v[116:119]
s_add_u32 m0, s86, 36864
v_accvgpr_read_b32 v27, a172
v_accvgpr_read_b32 v24, a184
v_mfma_f32_16x16x32_bf16 v[124:127], a[44:47], a[28:31], v[124:127]
s_mov_b32 s84, 33664
ds_read_b128 a[84:87], v8 offset:10240
v_lshlrev_b32 v25, 16, v27
v_mfma_f32_16x16x32_bf16 v[144:147], a[0:3], a[48:51], v[144:147]
buffer_load_dwordx4 v2, s[36:39], s84 offen offset:0 lds
v_mfma_f32_16x16x32_bf16 v[148:151], a[0:3], a[52:55], v[148:151]
buffer_load_dword a200, v31, s[64:67], s79 offen
v_mfma_f32_16x16x32_bf16 v[152:155], a[0:3], a[56:59], v[152:155]
s_add_u32 s79, s79, s101
ds_read_b64_tr_b16 a[116:117], v10 offset:57344
v_lshlrev_b32 v26, 16, v24
v_mfma_f32_16x16x32_bf16 v[156:159], a[0:3], a[60:63], v[156:159]
ds_read_b64_tr_b16 a[118:119], v10 offset:58368
v_and_b32 v27, 0xffff0000, v27
v_mfma_f32_16x16x32_bf16 v[32:35], a[4:7], a[48:51], v[32:35]
v_and_b32 v24, 0xffff0000, v24
v_fmac_f32 v22, v25, v26
v_mfma_f32_16x16x32_bf16 v[36:39], a[4:7], a[52:55], v[36:39]
s_mov_b32 s84, 40832
ds_read_b128 a[88:91], v8 offset:12288
v_fmac_f32 v22, v27, v24
v_mfma_f32_16x16x32_bf16 v[40:43], a[4:7], a[56:59], v[40:43]
buffer_load_dwordx4 v2, s[36:39], s84 offen offset:1024 lds
v_mfma_f32_16x16x32_bf16 v[44:47], a[4:7], a[60:63], v[44:47]
ds_read_b64_tr_b16 a[120:121], v11 offset:57344
v_accvgpr_read_b32 v27, a173
v_mfma_f32_16x16x32_bf16 v[176:179], a[8:11], a[48:51], v[176:179]
v_accvgpr_read_b32 v24, a185
v_lshlrev_b32 v25, 16, v27
v_mfma_f32_16x16x32_bf16 v[180:183], a[8:11], a[52:55], v[180:183]
ds_read_b64_tr_b16 a[122:123], v11 offset:58368
v_lshlrev_b32 v26, 16, v24
v_mfma_f32_16x16x32_bf16 v[184:187], a[8:11], a[56:59], v[184:187]
v_and_b32 v27, 0xffff0000, v27
v_and_b32 v24, 0xffff0000, v24
v_mfma_f32_16x16x32_bf16 v[188:191], a[8:11], a[60:63], v[188:191]
ds_read_b128 a[92:95], v8 offset:14336
v_fmac_f32 v22, v25, v26
v_mfma_f32_16x16x32_bf16 v[64:67], a[12:15], a[48:51], v[64:67]
s_mov_b32 s84, 48000
v_fmac_f32 v22, v27, v24
v_lshrrev_b32 v30, 3, v0
v_mfma_f32_16x16x32_bf16 v[68:71], a[12:15], a[52:55], v[68:71]
buffer_load_dwordx4 v2, s[36:39], s84 offen offset:2048 lds
v_mfma_f32_16x16x32_bf16 v[72:75], a[12:15], a[56:59], v[72:75]
ds_read_b64_tr_b16 a[124:125], v12 offset:57344
v_lshlrev_b32 v30, 8, v30
v_mfma_f32_16x16x32_bf16 v[76:79], a[12:15], a[60:63], v[76:79]
ds_read_b64_tr_b16 a[126:127], v12 offset:58368
v_subrev_u32 v30, s80, v30
v_mfma_f32_16x16x32_bf16 v[208:211], a[16:19], a[48:51], v[208:211]
v_mfma_f32_16x16x32_bf16 v[212:215], a[16:19], a[52:55], v[212:215]
v_mfma_f32_16x16x32_bf16 v[216:219], a[16:19], a[56:59], v[216:219]
v_mfma_f32_16x16x32_bf16 v[220:223], a[16:19], a[60:63], v[220:223]
s_mov_b32 s84, 55168
v_mfma_f32_16x16x32_bf16 v[96:99], a[20:23], a[48:51], v[96:99]
buffer_load_dwordx4 v2, s[36:39], s84 offen offset:3072 lds
v_mfma_f32_16x16x32_bf16 v[100:103], a[20:23], a[52:55], v[100:103]
v_add_u32 v2, v2, v30
v_mfma_f32_16x16x32_bf16 v[104:107], a[20:23], a[56:59], v[104:107]
v_mfma_f32_16x16x32_bf16 v[108:111], a[20:23], a[60:63], v[108:111]
v_mfma_f32_16x16x32_bf16 v[240:243], a[24:27], a[48:51], v[240:243]
v_mfma_f32_16x16x32_bf16 v[244:247], a[24:27], a[52:55], v[244:247]
v_mfma_f32_16x16x32_bf16 v[248:251], a[24:27], a[56:59], v[248:251]
v_mfma_f32_16x16x32_bf16 v[252:255], a[24:27], a[60:63], v[252:255]
v_mfma_f32_16x16x32_bf16 v[128:131], a[28:31], a[48:51], v[128:131]
v_mfma_f32_16x16x32_bf16 v[132:135], a[28:31], a[52:55], v[132:135]
v_mfma_f32_16x16x32_bf16 v[136:139], a[28:31], a[56:59], v[136:139]
v_mfma_f32_16x16x32_bf16 v[140:143], a[28:31], a[60:63], v[140:143]
s_waitcnt lgkmcnt(0)
v_mfma_f32_16x16x32_bf16 a[128:131], a[96:99], a[64:67], a[128:131]
s_waitcnt vmcnt(18)
v_mfma_f32_16x16x32_bf16 a[144:147], a[96:99], a[68:71], a[144:147]
s_barrier
v_mfma_f32_16x16x32_bf16 v[160:163], a[96:99], a[72:75], v[160:163]
s_add_u32 m0, s87, 49152
ds_read_b128 a[0:3], v5 offset:0
v_accvgpr_read_b32 v27, a174
v_mfma_f32_16x16x32_bf16 v[168:171], a[96:99], a[76:79], v[168:171]
s_mov_b32 s84, 3932160
ds_read_b64_tr_b16 a[32:33], v9 offset:0
v_accvgpr_read_b32 v24, a186
v_mfma_f32_16x16x32_bf16 v[192:195], a[96:99], a[80:83], v[192:195]
buffer_load_dwordx4 v3, s[40:43], s84 offen offset:0 nt lds
v_mfma_f32_16x16x32_bf16 v[200:203], a[96:99], a[84:87], v[200:203]
s_lshr_b32 s80, s76, 1
ds_read_b64_tr_b16 a[34:35], v9 offset:1024
v_lshlrev_b32 v25, 16, v27
v_mfma_f32_16x16x32_bf16 v[224:227], a[96:99], a[88:91], v[224:227]
s_lshl_b32 s80, s80, 17
v_lshlrev_b32 v26, 16, v24
v_and_b32 v27, 0xffff0000, v27
v_mfma_f32_16x16x32_bf16 v[232:235], a[96:99], a[92:95], v[232:235]
ds_read_b128 a[4:7], v5 offset:2048
v_and_b32 v24, 0xffff0000, v24
v_mfma_f32_16x16x32_bf16 a[132:135], a[100:103], a[64:67], a[132:135]
v_fmac_f32 v22, v25, v26
v_fmac_f32 v22, v27, v24
v_mfma_f32_16x16x32_bf16 a[148:151], a[100:103], a[68:71], a[148:151]
s_mov_b32 s84, 3963904
ds_read_b64_tr_b16 a[36:37], v10 offset:0
v_accvgpr_read_b32 v27, a175
v_mfma_f32_16x16x32_bf16 v[48:51], a[100:103], a[72:75], v[48:51]
buffer_load_dwordx4 v3, s[40:43], s84 offen offset:1024 nt lds
v_mfma_f32_16x16x32_bf16 v[56:59], a[100:103], a[76:79], v[56:59]
ds_read_b64_tr_b16 a[38:39], v10 offset:1024
v_accvgpr_read_b32 v24, a187
v_mfma_f32_16x16x32_bf16 v[80:83], a[100:103], a[80:83], v[80:83]
v_lshlrev_b32 v25, 16, v27
v_lshlrev_b32 v26, 16, v24
v_mfma_f32_16x16x32_bf16 v[88:91], a[100:103], a[84:87], v[88:91]
ds_read_b128 a[8:11], v5 offset:4096
v_and_b32 v27, 0xffff0000, v27
v_mfma_f32_16x16x32_bf16 v[112:115], a[100:103], a[88:91], v[112:115]
v_and_b32 v24, 0xffff0000, v24
v_fmac_f32 v22, v25, v26
v_mfma_f32_16x16x32_bf16 v[120:123], a[100:103], a[92:95], v[120:123]
ds_read_b64_tr_b16 a[40:41], v11 offset:0
v_fmac_f32 v22, v27, v24
v_mfma_f32_16x16x32_bf16 a[136:139], a[104:107], a[64:67], a[136:139]
s_add_u32 m0, s87, 53248
v_accvgpr_read_b32 v27, a176
v_accvgpr_read_b32 v24, a188
v_mfma_f32_16x16x32_bf16 a[152:155], a[104:107], a[68:71], a[152:155]
s_mov_b32 s84, 4063232
ds_read_b64_tr_b16 a[42:43], v11 offset:1024
v_lshlrev_b32 v25, 16, v27
v_mfma_f32_16x16x32_bf16 v[164:167], a[104:107], a[72:75], v[164:167]
buffer_load_dwordx4 v3, s[40:43], s84 offen offset:0 nt lds
v_mfma_f32_16x16x32_bf16 v[172:175], a[104:107], a[76:79], v[172:175]
L_w0_2:
s_cbranch_execz L_wend0
ds_read_b128 a[12:15], v5 offset:6144
v_lshlrev_b32 v26, 16, v24
v_mfma_f32_16x16x32_bf16 v[196:199], a[104:107], a[80:83], v[196:199]
v_and_b32 v27, 0xffff0000, v27
v_and_b32 v24, 0xffff0000, v24
v_mfma_f32_16x16x32_bf16 v[204:207], a[104:107], a[84:87], v[204:207]
ds_read_b64_tr_b16 a[44:45], v12 offset:0
v_fmac_f32 v22, v25, v26
v_mfma_f32_16x16x32_bf16 v[228:231], a[104:107], a[88:91], v[228:231]
v_fmac_f32 v22, v27, v24
v_accvgpr_read_b32 v27, a177
v_mfma_f32_16x16x32_bf16 v[236:239], a[104:107], a[92:95], v[236:239]
s_mov_b32 s84, 4094976
ds_read_b64_tr_b16 a[46:47], v12 offset:1024
v_accvgpr_read_b32 v24, a189
v_mfma_f32_16x16x32_bf16 a[140:143], a[108:111], a[64:67], a[140:143]
buffer_load_dwordx4 v3, s[40:43], s84 offen offset:1024 nt lds
v_mfma_f32_16x16x32_bf16 a[156:159], a[108:111], a[68:71], a[156:159]
ds_read_b128 a[16:19], v5 offset:8192
v_lshlrev_b32 v25, 16, v27
v_mfma_f32_16x16x32_bf16 v[52:55], a[108:111], a[72:75], v[52:55]
v_lshlrev_b32 v26, 16, v24
v_and_b32 v27, 0xffff0000, v27
v_mfma_f32_16x16x32_bf16 v[60:63], a[108:111], a[76:79], v[60:63]
ds_read_b64_tr_b16 a[48:49], v9 offset:8192
v_and_b32 v24, 0xffff0000, v24
v_mfma_f32_16x16x32_bf16 v[84:87], a[108:111], a[80:83], v[84:87]
v_fmac_f32 v22, v25, v26
v_fmac_f32 v22, v27, v24
v_mfma_f32_16x16x32_bf16 v[92:95], a[108:111], a[84:87], v[92:95]
ds_read_b64_tr_b16 a[50:51], v9 offset:9216
v_accvgpr_read_b32 v27, a178
v_mfma_f32_16x16x32_bf16 v[116:119], a[108:111], a[88:91], v[116:119]
s_add_u32 m0, s86, 65536
v_accvgpr_read_b32 v24, a190
v_lshlrev_b32 v25, 16, v27
v_mfma_f32_16x16x32_bf16 v[124:127], a[108:111], a[92:95], v[124:127]
s_add_u32 s84, s94, 0
ds_read_b128 a[20:23], v5 offset:10240
v_lshlrev_b32 v26, 16, v24
v_mfma_f32_16x16x32_bf16 v[144:147], a[64:67], a[112:115], v[144:147]
buffer_load_dwordx4 v2, s[44:47], s84 offen offset:0 lds
v_mfma_f32_16x16x32_bf16 v[148:151], a[64:67], a[116:119], v[148:151]
buffer_load_dword v23, v31, s[64:67], s79 offen
v_mfma_f32_16x16x32_bf16 v[152:155], a[64:67], a[120:123], v[152:155]
s_add_u32 s79, s79, s101
ds_read_b64_tr_b16 a[52:53], v10 offset:8192
v_and_b32 v27, 0xffff0000, v27
v_mfma_f32_16x16x32_bf16 v[156:159], a[64:67], a[124:127], v[156:159]
ds_read_b64_tr_b16 a[54:55], v10 offset:9216
v_and_b32 v24, 0xffff0000, v24
v_mfma_f32_16x16x32_bf16 v[32:35], a[68:71], a[112:115], v[32:35]
v_fmac_f32 v22, v25, v26
v_fmac_f32 v22, v27, v24
v_mfma_f32_16x16x32_bf16 v[36:39], a[68:71], a[116:119], v[36:39]
s_add_u32 s84, s94, 9216
ds_read_b128 a[24:27], v5 offset:12288
v_accvgpr_read_b32 v27, a179
v_mfma_f32_16x16x32_bf16 v[40:43], a[68:71], a[120:123], v[40:43]
buffer_load_dwordx4 v2, s[44:47], s84 offen offset:1024 lds
v_mfma_f32_16x16x32_bf16 v[44:47], a[68:71], a[124:127], v[44:47]
ds_read_b64_tr_b16 a[56:57], v11 offset:8192
v_accvgpr_read_b32 v24, a191
v_mfma_f32_16x16x32_bf16 v[176:179], a[72:75], a[112:115], v[176:179]
v_lshlrev_b32 v25, 16, v27
v_lshlrev_b32 v26, 16, v24
v_mfma_f32_16x16x32_bf16 v[180:183], a[72:75], a[116:119], v[180:183]
ds_read_b64_tr_b16 a[58:59], v11 offset:9216
v_and_b32 v27, 0xffff0000, v27
v_mfma_f32_16x16x32_bf16 v[184:187], a[72:75], a[120:123], v[184:187]
v_and_b32 v24, 0xffff0000, v24
v_fmac_f32 v22, v25, v26
v_mfma_f32_16x16x32_bf16 v[188:191], a[72:75], a[124:127], v[188:191]
ds_read_b128 a[28:31], v5 offset:14336
v_fmac_f32 v22, v27, v24
v_mfma_f32_16x16x32_bf16 v[64:67], a[76:79], a[112:115], v[64:67]
s_add_u32 s84, s95, 4294965248
buffer_load_dword v28, v21, s[68:71], 0 offen sc1
v_mfma_f32_16x16x32_bf16 v[68:71], a[76:79], a[116:119], v[68:71]
buffer_load_dwordx4 v2, s[44:47], s84 offen offset:2048 lds
v_mfma_f32_16x16x32_bf16 v[72:75], a[76:79], a[120:123], v[72:75]
ds_read_b64_tr_b16 a[60:61], v12 offset:8192
v_mfma_f32_16x16x32_bf16 v[76:79], a[76:79], a[124:127], v[76:79]
ds_read_b64_tr_b16 a[62:63], v12 offset:9216
v_mfma_f32_16x16x32_bf16 v[208:211], a[80:83], a[112:115], v[208:211]
v_mfma_f32_16x16x32_bf16 v[212:215], a[80:83], a[116:119], v[212:215]
v_mfma_f32_16x16x32_bf16 v[216:219], a[80:83], a[120:123], v[216:219]
v_mfma_f32_16x16x32_bf16 v[220:223], a[80:83], a[124:127], v[220:223]
s_add_u32 s84, s95, 7168
v_mfma_f32_16x16x32_bf16 v[96:99], a[84:87], a[112:115], v[96:99]
buffer_load_dwordx4 v2, s[44:47], s84 offen offset:3072 lds
v_mfma_f32_16x16x32_bf16 v[100:103], a[84:87], a[116:119], v[100:103]
v_add_u32 v3, s80, v3
v_mfma_f32_16x16x32_bf16 v[104:107], a[84:87], a[120:123], v[104:107]
v_mfma_f32_16x16x32_bf16 v[108:111], a[84:87], a[124:127], v[108:111]
v_mfma_f32_16x16x32_bf16 v[240:243], a[88:91], a[112:115], v[240:243]
v_mfma_f32_16x16x32_bf16 v[244:247], a[88:91], a[116:119], v[244:247]
v_mfma_f32_16x16x32_bf16 v[248:251], a[88:91], a[120:123], v[248:251]
v_mfma_f32_16x16x32_bf16 v[252:255], a[88:91], a[124:127], v[252:255]
v_mfma_f32_16x16x32_bf16 v[128:131], a[92:95], a[112:115], v[128:131]
v_mfma_f32_16x16x32_bf16 v[132:135], a[92:95], a[116:119], v[132:135]
v_mfma_f32_16x16x32_bf16 v[136:139], a[92:95], a[120:123], v[136:139]
v_mfma_f32_16x16x32_bf16 v[140:143], a[92:95], a[124:127], v[140:143]
s_waitcnt lgkmcnt(0)
v_mfma_f32_16x16x32_bf16 a[128:131], a[32:35], a[0:3], a[128:131]
s_waitcnt vmcnt(24)
v_mfma_f32_16x16x32_bf16 a[144:147], a[32:35], a[4:7], a[144:147]
s_barrier
v_mfma_f32_16x16x32_bf16 v[160:163], a[32:35], a[8:11], v[160:163]
s_add_u32 m0, s88, 0
ds_read_b128 a[64:67], v6 offset:0
v_add_f32_dpp v22, v22, v22 quad_perm:[1,0,3,2] row_mask:0xf bank_mask:0xf
v_mfma_f32_16x16x32_bf16 v[168:171], a[32:35], a[12:15], v[168:171]
s_mov_b32 s84, 0
ds_read_b64_tr_b16 a[96:97], v9 offset:16384
v_mfma_f32_16x16x32_bf16 v[192:195], a[32:35], a[16:19], v[192:195]
buffer_load_dwordx4 v3, s[48:51], s84 offen offset:0 lds
v_mfma_f32_16x16x32_bf16 v[200:203], a[32:35], a[20:23], v[200:203]
buffer_load_dword v23, v31, s[64:67], s79 offen
v_mfma_f32_16x16x32_bf16 v[224:227], a[32:35], a[24:27], v[224:227]
s_add_u32 s79, s79, s101
ds_read_b64_tr_b16 a[98:99], v9 offset:17408
v_add_f32_dpp v22, v22, v22 quad_perm:[2,3,0,1] row_mask:0xf bank_mask:0xf
v_mfma_f32_16x16x32_bf16 v[232:235], a[32:35], a[28:31], v[232:235]
ds_read_b128 a[68:71], v6 offset:2048
v_mfma_f32_16x16x32_bf16 a[132:135], a[36:39], a[0:3], a[132:135]
v_add_f32_dpp v22, v22, v22 row_half_mirror row_mask:0xf bank_mask:0xf
v_mfma_f32_16x16x32_bf16 a[148:151], a[36:39], a[4:7], a[148:151]
ds_read_b64_tr_b16 a[100:101], v10 offset:16384
v_mfma_f32_16x16x32_bf16 v[48:51], a[36:39], a[8:11], v[48:51]
s_mov_b32 s84, 31744
v_add_f32_dpp v22, v22, v22 row_mirror row_mask:0xf bank_mask:0xf
v_mfma_f32_16x16x32_bf16 v[56:59], a[36:39], a[12:15], v[56:59]
buffer_load_dwordx4 v3, s[48:51], s84 offen offset:1024 lds
v_mfma_f32_16x16x32_bf16 v[80:83], a[36:39], a[16:19], v[80:83]
ds_read_b64_tr_b16 a[102:103], v10 offset:17408
v_add_f32_dpp v22, v22, v22 row_bcast:15 row_mask:0xa bank_mask:0xf
v_mfma_f32_16x16x32_bf16 v[88:91], a[36:39], a[20:23], v[88:91]
ds_read_b128 a[72:75], v6 offset:4096
v_mfma_f32_16x16x32_bf16 v[112:115], a[36:39], a[24:27], v[112:115]
v_mul_f32 v22, 0xbfb8aa3b, v22
v_mfma_f32_16x16x32_bf16 v[120:123], a[36:39], a[28:31], v[120:123]
ds_read_b64_tr_b16 a[104:105], v11 offset:16384
v_mfma_f32_16x16x32_bf16 a[136:139], a[40:43], a[0:3], a[136:139]
v_exp_f32 v22, v22
v_mfma_f32_16x16x32_bf16 a[152:155], a[40:43], a[4:7], a[152:155]
ds_read_b64_tr_b16 a[106:107], v11 offset:17408
v_mfma_f32_16x16x32_bf16 v[164:167], a[40:43], a[8:11], v[164:167]
s_add_u32 m0, s89, 0
v_add_f32 v22, 1.0, v22
v_mfma_f32_16x16x32_bf16 v[172:175], a[40:43], a[12:15], v[172:175]
s_mov_b32 s84, 0
ds_read_b128 a[76:79], v6 offset:6144
v_mfma_f32_16x16x32_bf16 v[196:199], a[40:43], a[16:19], v[196:199]
buffer_load_dwordx4 v4, s[52:55], s84 offen lds
v_mfma_f32_16x16x32_bf16 v[204:207], a[40:43], a[20:23], v[204:207]
ds_read_b64_tr_b16 a[108:109], v12 offset:16384
v_mfma_f32_16x16x32_bf16 v[228:231], a[40:43], a[24:27], v[228:231]
v_rcp_f32 v22, v22
v_mfma_f32_16x16x32_bf16 v[236:239], a[40:43], a[28:31], v[236:239]
ds_read_b64_tr_b16 a[110:111], v12 offset:17408
v_mfma_f32_16x16x32_bf16 a[140:143], a[44:47], a[0:3], a[140:143]
buffer_load_dword v23, v31, s[64:67], s79 offen
v_mfma_f32_16x16x32_bf16 a[156:159], a[44:47], a[4:7], a[156:159]
s_add_u32 s79, s79, s101
ds_read_b128 a[80:83], v6 offset:8192
v_add_u32 v27, 1, v0
v_mfma_f32_16x16x32_bf16 v[52:55], a[44:47], a[8:11], v[52:55]
s_add_u32 m0, s86, 69632
v_lshlrev_b32 v27, 27, v27
v_lshrrev_b32 v27, 1, v27
v_mfma_f32_16x16x32_bf16 v[60:63], a[44:47], a[12:15], v[60:63]
s_add_u32 s84, s96, 0
ds_read_b64_tr_b16 a[112:113], v9 offset:24576
v_lshrrev_b32 v24, 5, v0
v_mfma_f32_16x16x32_bf16 v[84:87], a[44:47], a[16:19], v[84:87]
buffer_load_dwordx4 v2, s[44:47], s84 offen offset:0 lds
v_mfma_f32_16x16x32_bf16 v[92:95], a[44:47], a[20:23], v[92:95]
ds_read_b64_tr_b16 a[114:115], v9 offset:25600
v_lshl_add_u32 v27, v24, 2, v27
v_mfma_f32_16x16x32_bf16 v[116:119], a[44:47], a[24:27], v[116:119]
buffer_store_dword v22, v27, s[56:59], s34 offen sc1
v_mfma_f32_16x16x32_bf16 v[124:127], a[44:47], a[28:31], v[124:127]
ds_read_b128 a[84:87], v6 offset:10240
v_mfma_f32_16x16x32_bf16 v[144:147], a[0:3], a[48:51], v[144:147]
v_mfma_f32_16x16x32_bf16 v[148:151], a[0:3], a[52:55], v[148:151]
ds_read_b64_tr_b16 a[116:117], v10 offset:24576
v_mfma_f32_16x16x32_bf16 v[152:155], a[0:3], a[56:59], v[152:155]
s_add_u32 s84, s96, 9216
v_mfma_f32_16x16x32_bf16 v[156:159], a[0:3], a[60:63], v[156:159]
buffer_load_dwordx4 v2, s[44:47], s84 offen offset:1024 lds
v_mfma_f32_16x16x32_bf16 v[32:35], a[4:7], a[48:51], v[32:35]
ds_read_b64_tr_b16 a[118:119], v10 offset:25600
v_mfma_f32_16x16x32_bf16 v[36:39], a[4:7], a[52:55], v[36:39]
ds_read_b128 a[88:91], v6 offset:12288
v_mfma_f32_16x16x32_bf16 v[40:43], a[4:7], a[56:59], v[40:43]
v_mfma_f32_16x16x32_bf16 v[44:47], a[4:7], a[60:63], v[44:47]
ds_read_b64_tr_b16 a[120:121], v11 offset:24576
v_mfma_f32_16x16x32_bf16 v[176:179], a[8:11], a[48:51], v[176:179]
v_mfma_f32_16x16x32_bf16 v[180:183], a[8:11], a[52:55], v[180:183]
ds_read_b64_tr_b16 a[122:123], v11 offset:25600
v_mfma_f32_16x16x32_bf16 v[184:187], a[8:11], a[56:59], v[184:187]
s_add_u32 s84, s97, 4294965248
v_mfma_f32_16x16x32_bf16 v[188:191], a[8:11], a[60:63], v[188:191]
buffer_load_dwordx4 v2, s[44:47], s84 offen offset:2048 lds
v_mfma_f32_16x16x32_bf16 v[64:67], a[12:15], a[48:51], v[64:67]
buffer_load_dword v23, v31, s[64:67], s79 offen
v_mfma_f32_16x16x32_bf16 v[68:71], a[12:15], a[52:55], v[68:71]
s_add_u32 s79, s79, s101
ds_read_b128 a[92:95], v6 offset:14336
v_mfma_f32_16x16x32_bf16 v[72:75], a[12:15], a[56:59], v[72:75]
ds_read_b64_tr_b16 a[124:125], v12 offset:24576
v_mfma_f32_16x16x32_bf16 v[76:79], a[12:15], a[60:63], v[76:79]
ds_read_b64_tr_b16 a[126:127], v12 offset:25600
v_mfma_f32_16x16x32_bf16 v[208:211], a[16:19], a[48:51], v[208:211]
v_mfma_f32_16x16x32_bf16 v[212:215], a[16:19], a[52:55], v[212:215]
v_mfma_f32_16x16x32_bf16 v[216:219], a[16:19], a[56:59], v[216:219]
s_add_u32 s84, s97, 7168
v_mfma_f32_16x16x32_bf16 v[220:223], a[16:19], a[60:63], v[220:223]
buffer_load_dwordx4 v2, s[44:47], s84 offen offset:3072 lds
v_mfma_f32_16x16x32_bf16 v[96:99], a[20:23], a[48:51], v[96:99]
v_mfma_f32_16x16x32_bf16 v[100:103], a[20:23], a[52:55], v[100:103]
v_mfma_f32_16x16x32_bf16 v[104:107], a[20:23], a[56:59], v[104:107]
v_mfma_f32_16x16x32_bf16 v[108:111], a[20:23], a[60:63], v[108:111]
v_mfma_f32_16x16x32_bf16 v[240:243], a[24:27], a[48:51], v[240:243]
v_mfma_f32_16x16x32_bf16 v[244:247], a[24:27], a[52:55], v[244:247]
v_mfma_f32_16x16x32_bf16 v[248:251], a[24:27], a[56:59], v[248:251]
v_mfma_f32_16x16x32_bf16 v[252:255], a[24:27], a[60:63], v[252:255]
v_mfma_f32_16x16x32_bf16 v[128:131], a[28:31], a[48:51], v[128:131]
v_mfma_f32_16x16x32_bf16 v[132:135], a[28:31], a[52:55], v[132:135]
v_mfma_f32_16x16x32_bf16 v[136:139], a[28:31], a[56:59], v[136:139]
v_mfma_f32_16x16x32_bf16 v[140:143], a[28:31], a[60:63], v[140:143]
s_waitcnt lgkmcnt(0)
v_mfma_f32_16x16x32_bf16 a[128:131], a[96:99], a[64:67], a[128:131]
s_waitcnt vmcnt(21)
v_mfma_f32_16x16x32_bf16 a[144:147], a[96:99], a[68:71], a[144:147]
s_barrier
v_mfma_f32_16x16x32_bf16 v[160:163], a[96:99], a[72:75], v[160:163]
s_add_u32 m0, s88, 16384
ds_read_b128 a[0:3], v5 offset:32768
v_accvgpr_read_b32 v26, a160
v_mfma_f32_16x16x32_bf16 v[168:171], a[96:99], a[76:79], v[168:171]
s_mov_b32 s84, 262144
ds_read_b64_tr_b16 a[32:33], v9 offset:32768
v_lshlrev_b32 v27, 16, v26
v_mfma_f32_16x16x32_bf16 v[192:195], a[96:99], a[80:83], v[192:195]
buffer_load_dwordx4 v3, s[48:51], s84 offen offset:0 lds
v_mfma_f32_16x16x32_bf16 v[200:203], a[96:99], a[84:87], v[200:203]
buffer_load_dword v23, v31, s[64:67], s79 offen
v_mfma_f32_16x16x32_bf16 v[224:227], a[96:99], a[88:91], v[224:227]
s_add_u32 s79, s79, s101
ds_read_b64_tr_b16 a[34:35], v9 offset:33792
v_and_b32 v26, 0xffff0000, v26
v_mfma_f32_16x16x32_bf16 v[232:235], a[96:99], a[92:95], v[232:235]
ds_read_b128 a[4:7], v5 offset:34816
v_accvgpr_write_b32 a208, v27
v_mfma_f32_16x16x32_bf16 a[132:135], a[100:103], a[64:67], a[132:135]
v_accvgpr_write_b32 a209, v26
v_accvgpr_read_b32 v26, a161
v_mfma_f32_16x16x32_bf16 a[148:151], a[100:103], a[68:71], a[148:151]
ds_read_b64_tr_b16 a[36:37], v10 offset:32768
v_lshlrev_b32 v27, 16, v26
v_mfma_f32_16x16x32_bf16 v[48:51], a[100:103], a[72:75], v[48:51]
s_mov_b32 s84, 293888
v_and_b32 v26, 0xffff0000, v26
v_accvgpr_write_b32 a210, v27
v_mfma_f32_16x16x32_bf16 v[56:59], a[100:103], a[76:79], v[56:59]
buffer_load_dwordx4 v3, s[48:51], s84 offen offset:1024 lds
v_mfma_f32_16x16x32_bf16 v[80:83], a[100:103], a[80:83], v[80:83]
ds_read_b64_tr_b16 a[38:39], v10 offset:33792
v_accvgpr_write_b32 a211, v26
v_mfma_f32_16x16x32_bf16 v[88:91], a[100:103], a[84:87], v[88:91]
ds_read_b128 a[8:11], v5 offset:36864
v_accvgpr_read_b32 v26, a162
v_mfma_f32_16x16x32_bf16 v[112:115], a[100:103], a[88:91], v[112:115]
v_lshlrev_b32 v27, 16, v26
v_and_b32 v26, 0xffff0000, v26
v_mfma_f32_16x16x32_bf16 v[120:123], a[100:103], a[92:95], v[120:123]
ds_read_b64_tr_b16 a[40:41], v11 offset:32768
v_accvgpr_write_b32 a212, v27
v_mfma_f32_16x16x32_bf16 a[136:139], a[104:107], a[64:67], a[136:139]
v_accvgpr_write_b32 a213, v26
v_accvgpr_read_b32 v26, a163
v_mfma_f32_16x16x32_bf16 a[152:155], a[104:107], a[68:71], a[152:155]
ds_read_b64_tr_b16 a[42:43], v11 offset:33792
v_lshlrev_b32 v27, 16, v26
v_mfma_f32_16x16x32_bf16 v[164:167], a[104:107], a[72:75], v[164:167]
s_add_u32 m0, s89, 16384
v_and_b32 v26, 0xffff0000, v26
v_accvgpr_write_b32 a214, v27
v_mfma_f32_16x16x32_bf16 v[172:175], a[104:107], a[76:79], v[172:175]
s_mov_b32 s84, 110592
ds_read_b128 a[12:15], v5 offset:38912
v_accvgpr_write_b32 a215, v26
v_mfma_f32_16x16x32_bf16 v[196:199], a[104:107], a[80:83], v[196:199]
buffer_load_dwordx4 v4, s[52:55], s84 offen lds
v_mfma_f32_16x16x32_bf16 v[204:207], a[104:107], a[84:87], v[204:207]
ds_read_b64_tr_b16 a[44:45], v12 offset:32768
v_accvgpr_read_b32 v26, a164
v_mfma_f32_16x16x32_bf16 v[228:231], a[104:107], a[88:91], v[228:231]
v_lshlrev_b32 v27, 16, v26
v_and_b32 v26, 0xffff0000, v26
v_mfma_f32_16x16x32_bf16 v[236:239], a[104:107], a[92:95], v[236:239]
ds_read_b64_tr_b16 a[46:47], v12 offset:33792
v_accvgpr_write_b32 a216, v27
v_mfma_f32_16x16x32_bf16 a[140:143], a[108:111], a[64:67], a[140:143]
v_accvgpr_write_b32 a217, v26
v_accvgpr_read_b32 v26, a165
v_mfma_f32_16x16x32_bf16 a[156:159], a[108:111], a[68:71], a[156:159]
ds_read_b128 a[16:19], v5 offset:40960
v_lshlrev_b32 v27, 16, v26
v_mfma_f32_16x16x32_bf16 v[52:55], a[108:111], a[72:75], v[52:55]
s_add_u32 m0, s86, 0
v_and_b32 v26, 0xffff0000, v26
v_accvgpr_write_b32 a218, v27
v_mfma_f32_16x16x32_bf16 v[60:63], a[108:111], a[76:79], v[60:63]
s_add_u32 s84, s94, 128
ds_read_b64_tr_b16 a[48:49], v9 offset:40960
v_accvgpr_write_b32 a219, v26
v_mfma_f32_16x16x32_bf16 v[84:87], a[108:111], a[80:83], v[84:87]
buffer_load_dwordx4 v2, s[44:47], s84 offen offset:0 lds
v_mfma_f32_16x16x32_bf16 v[92:95], a[108:111], a[84:87], v[92:95]
ds_read_b64_tr_b16 a[50:51], v9 offset:41984
v_accvgpr_read_b32 v26, a166
v_mfma_f32_16x16x32_bf16 v[116:119], a[108:111], a[88:91], v[116:119]
v_lshlrev_b32 v27, 16, v26
v_and_b32 v26, 0xffff0000, v26
v_mfma_f32_16x16x32_bf16 v[124:127], a[108:111], a[92:95], v[124:127]
ds_read_b128 a[20:23], v5 offset:43008
v_accvgpr_write_b32 a220, v27
v_mfma_f32_16x16x32_bf16 v[144:147], a[64:67], a[112:115], v[144:147]
v_accvgpr_write_b32 a221, v26
v_accvgpr_read_b32 v26, a167
v_mfma_f32_16x16x32_bf16 v[148:151], a[64:67], a[116:119], v[148:151]
ds_read_b64_tr_b16 a[52:53], v10 offset:40960
v_lshlrev_b32 v27, 16, v26
v_mfma_f32_16x16x32_bf16 v[152:155], a[64:67], a[120:123], v[152:155]
s_add_u32 s84, s94, 9344
v_and_b32 v26, 0xffff0000, v26
v_accvgpr_write_b32 a222, v27
v_mfma_f32_16x16x32_bf16 v[156:159], a[64:67], a[124:127], v[156:159]
buffer_load_dwordx4 v2, s[44:47], s84 offen offset:1024 lds
v_mfma_f32_16x16x32_bf16 v[32:35], a[68:71], a[112:115], v[32:35]
ds_read_b64_tr_b16 a[54:55], v10 offset:41984
v_accvgpr_write_b32 a223, v26
v_mfma_f32_16x16x32_bf16 v[36:39], a[68:71], a[116:119], v[36:39]
ds_read_b128 a[24:27], v5 offset:45056
v_mfma_f32_16x16x32_bf16 v[40:43], a[68:71], a[120:123], v[40:43]
v_mfma_f32_16x16x32_bf16 v[44:47], a[68:71], a[124:127], v[44:47]
ds_read_b64_tr_b16 a[56:57], v11 offset:40960
v_mfma_f32_16x16x32_bf16 v[176:179], a[72:75], a[112:115], v[176:179]
v_mfma_f32_16x16x32_bf16 v[180:183], a[72:75], a[116:119], v[180:183]
ds_read_b64_tr_b16 a[58:59], v11 offset:41984
v_mfma_f32_16x16x32_bf16 v[184:187], a[72:75], a[120:123], v[184:187]
s_add_u32 s84, s95, 4294965376
v_mfma_f32_16x16x32_bf16 v[188:191], a[72:75], a[124:127], v[188:191]
buffer_load_dwordx4 v2, s[44:47], s84 offen offset:2048 lds
v_mfma_f32_16x16x32_bf16 v[64:67], a[76:79], a[112:115], v[64:67]
ds_read_b128 a[28:31], v5 offset:47104
v_mfma_f32_16x16x32_bf16 v[68:71], a[76:79], a[116:119], v[68:71]
ds_read_b64_tr_b16 a[60:61], v12 offset:40960
v_mfma_f32_16x16x32_bf16 v[72:75], a[76:79], a[120:123], v[72:75]
v_mfma_f32_16x16x32_bf16 v[76:79], a[76:79], a[124:127], v[76:79]
ds_read_b64_tr_b16 a[62:63], v12 offset:41984
v_mfma_f32_16x16x32_bf16 v[208:211], a[80:83], a[112:115], v[208:211]
v_mfma_f32_16x16x32_bf16 v[212:215], a[80:83], a[116:119], v[212:215]
v_mfma_f32_16x16x32_bf16 v[216:219], a[80:83], a[120:123], v[216:219]
s_add_u32 s84, s95, 7296
v_mfma_f32_16x16x32_bf16 v[220:223], a[80:83], a[124:127], v[220:223]
buffer_load_dwordx4 v2, s[44:47], s84 offen offset:3072 lds
v_mfma_f32_16x16x32_bf16 v[96:99], a[84:87], a[112:115], v[96:99]
v_mfma_f32_16x16x32_bf16 v[100:103], a[84:87], a[116:119], v[100:103]
v_mfma_f32_16x16x32_bf16 v[104:107], a[84:87], a[120:123], v[104:107]
v_mfma_f32_16x16x32_bf16 v[108:111], a[84:87], a[124:127], v[108:111]
v_mfma_f32_16x16x32_bf16 v[240:243], a[88:91], a[112:115], v[240:243]
v_mfma_f32_16x16x32_bf16 v[244:247], a[88:91], a[116:119], v[244:247]
v_mfma_f32_16x16x32_bf16 v[248:251], a[88:91], a[120:123], v[248:251]
v_mfma_f32_16x16x32_bf16 v[252:255], a[88:91], a[124:127], v[252:255]
v_mfma_f32_16x16x32_bf16 v[128:131], a[92:95], a[112:115], v[128:131]
v_mfma_f32_16x16x32_bf16 v[132:135], a[92:95], a[116:119], v[132:135]
v_mfma_f32_16x16x32_bf16 v[136:139], a[92:95], a[120:123], v[136:139]
v_mfma_f32_16x16x32_bf16 v[140:143], a[92:95], a[124:127], v[140:143]
s_waitcnt vmcnt(21)
v_readfirstlane_b32 s80, v28
s_cmp_eq_u32 s80, 1
s_cbranch_scc0 L_init_spin0
L_init_ok:
s_waitcnt lgkmcnt(0)
v_mfma_f32_16x16x32_bf16 a[128:131], a[32:35], a[0:3], a[128:131]
s_waitcnt vmcnt(25)
v_mfma_f32_16x16x32_bf16 a[144:147], a[32:35], a[4:7], a[144:147]
s_barrier
v_mfma_f32_16x16x32_bf16 v[160:163], a[32:35], a[8:11], v[160:163]
s_add_u32 m0, s88, 32768
ds_read_b128 a[64:67], v6 offset:32768
v_mfma_f32_16x16x32_bf16 v[168:171], a[32:35], a[12:15], v[168:171]
s_mov_b32 s84, 524288
ds_read_b64_tr_b16 a[96:97], v9 offset:49152
v_mfma_f32_16x16x32_bf16 v[192:195], a[32:35], a[16:19], v[192:195]
buffer_load_dwordx4 v3, s[48:51], s84 offen offset:0 lds
v_mfma_f32_16x16x32_bf16 v[200:203], a[32:35], a[20:23], v[200:203]
s_and_b32 s80, s76, 1
ds_read_b64_tr_b16 a[98:99], v9 offset:50176
v_mfma_f32_16x16x32_bf16 v[224:227], a[32:35], a[24:27], v[224:227]
s_lshl_b32 s80, s80, 14
v_mfma_f32_16x16x32_bf16 v[232:235], a[32:35], a[28:31], v[232:235]
s_sub_u32 s80, s86, s80
ds_read_b128 a[68:71], v6 offset:34816
v_mfma_f32_16x16x32_bf16 a[132:135], a[36:39], a[0:3], a[132:135]
v_mfma_f32_16x16x32_bf16 a[148:151], a[36:39], a[4:7], a[148:151]
ds_read_b64_tr_b16 a[100:101], v10 offset:49152
v_mfma_f32_16x16x32_bf16 v[48:51], a[36:39], a[8:11], v[48:51]
s_mov_b32 s84, 556032
v_mfma_f32_16x16x32_bf16 v[56:59], a[36:39], a[12:15], v[56:59]
buffer_load_dwordx4 v3, s[48:51], s84 offen offset:1024 lds
v_mfma_f32_16x16x32_bf16 v[80:83], a[36:39], a[16:19], v[80:83]
ds_read_b64_tr_b16 a[102:103], v10 offset:50176
v_mfma_f32_16x16x32_bf16 v[88:91], a[36:39], a[20:23], v[88:91]
ds_read_b128 a[72:75], v6 offset:36864
v_mfma_f32_16x16x32_bf16 v[112:115], a[36:39], a[24:27], v[112:115]
v_mfma_f32_16x16x32_bf16 v[120:123], a[36:39], a[28:31], v[120:123]
ds_read_b64_tr_b16 a[104:105], v11 offset:49152
v_mfma_f32_16x16x32_bf16 a[136:139], a[40:43], a[0:3], a[136:139]
v_mfma_f32_16x16x32_bf16 a[152:155], a[40:43], a[4:7], a[152:155]
ds_read_b64_tr_b16 a[106:107], v11 offset:50176
v_mfma_f32_16x16x32_bf16 v[164:167], a[40:43], a[8:11], v[164:167]
s_add_u32 m0, s89, 32768
v_mfma_f32_16x16x32_bf16 v[172:175], a[40:43], a[12:15], v[172:175]
s_mov_b32 s84, 221184
ds_read_b128 a[76:79], v6 offset:38912
v_mfma_f32_16x16x32_bf16 v[196:199], a[40:43], a[16:19], v[196:199]
buffer_load_dwordx4 v4, s[52:55], s84 offen lds
v_mfma_f32_16x16x32_bf16 v[204:207], a[40:43], a[20:23], v[204:207]
ds_read_b64_tr_b16 a[108:109], v12 offset:49152
v_mfma_f32_16x16x32_bf16 v[228:231], a[40:43], a[24:27], v[228:231]
v_mfma_f32_16x16x32_bf16 v[236:239], a[40:43], a[28:31], v[236:239]
ds_read_b64_tr_b16 a[110:111], v12 offset:50176
v_mfma_f32_16x16x32_bf16 a[140:143], a[44:47], a[0:3], a[140:143]
v_mfma_f32_16x16x32_bf16 a[156:159], a[44:47], a[4:7], a[156:159]
ds_read_b128 a[80:83], v6 offset:40960
v_mfma_f32_16x16x32_bf16 v[52:55], a[44:47], a[8:11], v[52:55]
s_add_u32 m0, s86, 4096
v_mfma_f32_16x16x32_bf16 v[60:63], a[44:47], a[12:15], v[60:63]
s_add_u32 s84, s96, 128
ds_read_b64_tr_b16 a[112:113], v9 offset:57344
v_mfma_f32_16x16x32_bf16 v[84:87], a[44:47], a[16:19], v[84:87]
buffer_load_dwordx4 v2, s[44:47], s84 offen offset:0 lds
v_mfma_f32_16x16x32_bf16 v[92:95], a[44:47], a[20:23], v[92:95]
ds_read_b64_tr_b16 a[114:115], v9 offset:58368
v_mfma_f32_16x16x32_bf16 v[116:119], a[44:47], a[24:27], v[116:119]
v_mfma_f32_16x16x32_bf16 v[124:127], a[44:47], a[28:31], v[124:127]
ds_read_b128 a[84:87], v6 offset:43008
v_mfma_f32_16x16x32_bf16 v[144:147], a[0:3], a[48:51], v[144:147]
v_mfma_f32_16x16x32_bf16 v[148:151], a[0:3], a[52:55], v[148:151]
ds_read_b64_tr_b16 a[116:117], v10 offset:57344
v_mfma_f32_16x16x32_bf16 v[152:155], a[0:3], a[56:59], v[152:155]
s_add_u32 s84, s96, 9344
v_mfma_f32_16x16x32_bf16 v[156:159], a[0:3], a[60:63], v[156:159]
buffer_load_dwordx4 v2, s[44:47], s84 offen offset:1024 lds
v_mfma_f32_16x16x32_bf16 v[32:35], a[4:7], a[48:51], v[32:35]
ds_read_b64_tr_b16 a[118:119], v10 offset:58368
v_mfma_f32_16x16x32_bf16 v[36:39], a[4:7], a[52:55], v[36:39]
ds_read_b128 a[88:91], v6 offset:45056
v_mfma_f32_16x16x32_bf16 v[40:43], a[4:7], a[56:59], v[40:43]
v_mfma_f32_16x16x32_bf16 v[44:47], a[4:7], a[60:63], v[44:47]
ds_read_b64_tr_b16 a[120:121], v11 offset:57344
v_mfma_f32_16x16x32_bf16 v[176:179], a[8:11], a[48:51], v[176:179]
v_mfma_f32_16x16x32_bf16 v[180:183], a[8:11], a[52:55], v[180:183]
ds_read_b64_tr_b16 a[122:123], v11 offset:58368
v_mfma_f32_16x16x32_bf16 v[184:187], a[8:11], a[56:59], v[184:187]
s_add_u32 s84, s97, 4294965376
v_mfma_f32_16x16x32_bf16 v[188:191], a[8:11], a[60:63], v[188:191]
buffer_load_dwordx4 v2, s[44:47], s84 offen offset:2048 lds
v_mfma_f32_16x16x32_bf16 v[64:67], a[12:15], a[48:51], v[64:67]
ds_read_b128 a[92:95], v6 offset:47104
v_mfma_f32_16x16x32_bf16 v[68:71], a[12:15], a[52:55], v[68:71]
ds_read_b64_tr_b16 a[124:125], v12 offset:57344
v_mfma_f32_16x16x32_bf16 v[72:75], a[12:15], a[56:59], v[72:75]
v_mfma_f32_16x16x32_bf16 v[76:79], a[12:15], a[60:63], v[76:79]
ds_read_b64_tr_b16 a[126:127], v12 offset:58368
v_add_u32 v5, s80, v5
v_mfma_f32_16x16x32_bf16 v[208:211], a[16:19], a[48:51], v[208:211]
v_add_u32 v6, s80, v6
v_add_u32 v7, s80, v7
v_mfma_f32_16x16x32_bf16 v[212:215], a[16:19], a[52:55], v[212:215]
v_add_u32 v8, s80, v8
v_xor_b32 v9, 128, v13
v_mfma_f32_16x16x32_bf16 v[216:219], a[16:19], a[56:59], v[216:219]
s_add_u32 s84, s97, 7296
v_xor_b32 v10, 128, v14
v_xor_b32 v11, 128, v15
v_mfma_f32_16x16x32_bf16 v[220:223], a[16:19], a[60:63], v[220:223]
buffer_load_dwordx4 v2, s[44:47], s84 offen offset:3072 lds
v_mfma_f32_16x16x32_bf16 v[96:99], a[20:23], a[48:51], v[96:99]
v_xor_b32 v12, 128, v16
v_mfma_f32_16x16x32_bf16 v[100:103], a[20:23], a[52:55], v[100:103]
v_mfma_f32_16x16x32_bf16 v[104:107], a[20:23], a[56:59], v[104:107]
v_mfma_f32_16x16x32_bf16 v[108:111], a[20:23], a[60:63], v[108:111]
v_mfma_f32_16x16x32_bf16 v[240:243], a[24:27], a[48:51], v[240:243]
v_mfma_f32_16x16x32_bf16 v[244:247], a[24:27], a[52:55], v[244:247]
v_mfma_f32_16x16x32_bf16 v[248:251], a[24:27], a[56:59], v[248:251]
v_mfma_f32_16x16x32_bf16 v[252:255], a[24:27], a[60:63], v[252:255]
v_mfma_f32_16x16x32_bf16 v[128:131], a[28:31], a[48:51], v[128:131]
v_mfma_f32_16x16x32_bf16 v[132:135], a[28:31], a[52:55], v[132:135]
v_mfma_f32_16x16x32_bf16 v[136:139], a[28:31], a[56:59], v[136:139]
v_mfma_f32_16x16x32_bf16 v[140:143], a[28:31], a[60:63], v[140:143]
s_waitcnt lgkmcnt(0)
v_mfma_f32_16x16x32_bf16 a[128:131], a[96:99], a[64:67], a[128:131]
s_waitcnt vmcnt(15)
v_mfma_f32_16x16x32_bf16 a[132:135], a[100:103], a[64:67], a[132:135]
s_barrier
v_mfma_f32_16x16x32_bf16 a[136:139], a[104:107], a[64:67], a[136:139]
s_add_u32 m0, s88, 49152
ds_read_b128 a[0:3], v7 offset:0
v_mfma_f32_16x16x32_bf16 a[140:143], a[108:111], a[64:67], a[140:143]
s_mov_b32 s84, 786432
ds_read_b64_tr_b16 a[16:17], v9 offset:0
v_mfma_f32_16x16x32_bf16 a[144:147], a[96:99], a[68:71], a[144:147]
buffer_load_dwordx4 v3, s[48:51], s84 offen offset:0 lds
v_mfma_f32_16x16x32_bf16 a[148:151], a[100:103], a[68:71], a[148:151]
ds_read_b64_tr_b16 a[18:19], v9 offset:1024
v_accvgpr_read_b32 v24, a128
v_accvgpr_read_b32 v25, a129
v_mfma_f32_16x16x32_bf16 a[152:155], a[104:107], a[68:71], a[152:155]
v_accvgpr_read_b32 v26, a130
v_accvgpr_read_b32 v27, a131
v_accvgpr_read_b32 v28, a132
v_mfma_f32_16x16x32_bf16 a[156:159], a[108:111], a[68:71], a[156:159]
ds_read_b64_tr_b16 a[20:21], v10 offset:0
v_accvgpr_read_b32 v29, a133
v_accvgpr_read_b32 v30, a134
v_mfma_f32_16x16x32_bf16 v[144:147], a[64:67], a[112:115], v[144:147]
ds_read_b64_tr_b16 a[22:23], v10 offset:1024
v_accvgpr_read_b32 v31, a135
v_cvt_pk_bf16_f32 v24, v24, v25
v_mfma_f32_16x16x32_bf16 v[32:35], a[68:71], a[112:115], v[32:35]
v_cvt_pk_bf16_f32 v25, v26, v27
v_cvt_pk_bf16_f32 v26, v28, v29
v_cvt_pk_bf16_f32 v27, v30, v31
v_mfma_f32_16x16x32_bf16 v[148:151], a[64:67], a[116:119], v[148:151]
s_mov_b32 s84, 818176
ds_read_b64_tr_b16 a[24:25], v11 offset:0
v_mfma_f32_16x16x32_bf16 v[36:39], a[68:71], a[116:119], v[36:39]
buffer_load_dwordx4 v3, s[48:51], s84 offen offset:1024 lds
v_mfma_f32_16x16x32_bf16 v[152:155], a[64:67], a[120:123], v[152:155]
s_add_u32 s85, s98, 0
ds_read_b64_tr_b16 a[26:27], v11 offset:1024
v_mfma_f32_16x16x32_bf16 v[40:43], a[68:71], a[120:123], v[40:43]
L_w0_3:
s_cbranch_execz L_wend0
ds_read_b128 a[4:7], v7 offset:2048
v_cvt_pk_bf16_f32 v144, v144, v145
v_cvt_pk_bf16_f32 v145, v146, v147
v_mfma_f32_16x16x32_bf16 v[156:159], a[64:67], a[124:127], v[156:159]
buffer_store_dwordx4 v[24:27], v1, s[56:59], s85 offen sc1
v_cvt_pk_bf16_f32 v146, v32, v33
v_mfma_f32_16x16x32_bf16 v[44:47], a[68:71], a[124:127], v[44:47]
ds_read_b64_tr_b16 a[28:29], v12 offset:0
v_cvt_pk_bf16_f32 v147, v34, v35
v_cvt_pk_bf16_f32 v148, v148, v149
v_mfma_f32_16x16x32_bf16 v[160:163], a[96:99], a[72:75], v[160:163]
v_accvgpr_read_b32 v24, a136
v_accvgpr_read_b32 v25, a137
v_accvgpr_read_b32 v26, a138
v_mfma_f32_16x16x32_bf16 v[48:51], a[100:103], a[72:75], v[48:51]
ds_read_b64_tr_b16 a[30:31], v12 offset:1024
v_accvgpr_read_b32 v27, a139
v_accvgpr_read_b32 v28, a140
v_mfma_f32_16x16x32_bf16 v[164:167], a[104:107], a[72:75], v[164:167]
s_add_u32 m0, s89, 49152
ds_read_b64_tr_b16 a[32:33], v13 offset:0
v_accvgpr_read_b32 v29, a141
v_accvgpr_read_b32 v30, a142
v_mfma_f32_16x16x32_bf16 v[52:55], a[108:111], a[72:75], v[52:55]
s_mov_b32 s84, 331776
v_accvgpr_read_b32 v31, a143
v_cvt_pk_bf16_f32 v24, v24, v25
v_cvt_pk_bf16_f32 v25, v26, v27
v_mfma_f32_16x16x32_bf16 v[168:171], a[96:99], a[76:79], v[168:171]
buffer_load_dwordx4 v4, s[52:55], s84 offen lds
v_cvt_pk_bf16_f32 v26, v28, v29
v_mfma_f32_16x16x32_bf16 v[56:59], a[100:103], a[76:79], v[56:59]
ds_read_b64_tr_b16 a[34:35], v13 offset:1024
v_cvt_pk_bf16_f32 v27, v30, v31
v_cvt_pk_bf16_f32 v149, v150, v151
v_mfma_f32_16x16x32_bf16 v[172:175], a[104:107], a[76:79], v[172:175]
s_add_u32 s85, s98, 1024
ds_read_b64_tr_b16 a[36:37], v14 offset:0
v_cvt_pk_bf16_f32 v150, v36, v37
v_cvt_pk_bf16_f32 v151, v38, v39
v_mfma_f32_16x16x32_bf16 v[60:63], a[108:111], a[76:79], v[60:63]
ds_read_b64_tr_b16 a[38:39], v14 offset:1024
v_cvt_pk_bf16_f32 v152, v152, v153
v_cvt_pk_bf16_f32 v153, v154, v155
v_mfma_f32_16x16x32_bf16 v[176:179], a[72:75], a[112:115], v[176:179]
buffer_store_dwordx4 v[24:27], v1, s[56:59], s85 offen sc1
v_cvt_pk_bf16_f32 v154, v40, v41
v_mfma_f32_16x16x32_bf16 v[64:67], a[76:79], a[112:115], v[64:67]
ds_read_b128 a[8:11], v7 offset:4096
v_cvt_pk_bf16_f32 v155, v42, v43
v_cvt_pk_bf16_f32 v156, v156, v157
v_mfma_f32_16x16x32_bf16 v[180:183], a[72:75], a[116:119], v[180:183]
s_add_u32 m0, s86, 32768
v_accvgpr_read_b32 v24, a144
v_accvgpr_read_b32 v25, a145
v_accvgpr_read_b32 v26, a146
v_mfma_f32_16x16x32_bf16 v[68:71], a[76:79], a[116:119], v[68:71]
s_add_u32 s84, s94, 256
ds_read_b64_tr_b16 a[40:41], v15 offset:0
v_accvgpr_read_b32 v27, a147
v_accvgpr_read_b32 v28, a148
v_mfma_f32_16x16x32_bf16 v[184:187], a[72:75], a[120:123], v[184:187]
buffer_load_dwordx4 v2, s[44:47], s84 offen offset:0 lds
v_accvgpr_read_b32 v29, a149
v_mfma_f32_16x16x32_bf16 v[72:75], a[76:79], a[120:123], v[72:75]
ds_read_b64_tr_b16 a[42:43], v15 offset:1024
v_accvgpr_read_b32 v30, a150
v_accvgpr_read_b32 v31, a151
v_mfma_f32_16x16x32_bf16 v[188:191], a[72:75], a[124:127], v[188:191]
ds_read_b64_tr_b16 a[44:45], v16 offset:0
v_cvt_pk_bf16_f32 v24, v24, v25
v_cvt_pk_bf16_f32 v25, v26, v27
v_mfma_f32_16x16x32_bf16 v[76:79], a[76:79], a[124:127], v[76:79]
v_cvt_pk_bf16_f32 v26, v28, v29
v_cvt_pk_bf16_f32 v27, v30, v31
v_cvt_pk_bf16_f32 v157, v158, v159
v_mfma_f32_16x16x32_bf16 v[192:195], a[96:99], a[80:83], v[192:195]
s_add_u32 s85, s98, 4096
ds_read_b64_tr_b16 a[46:47], v16 offset:1024
v_cvt_pk_bf16_f32 v158, v44, v45
v_cvt_pk_bf16_f32 v159, v46, v47
v_mfma_f32_16x16x32_bf16 v[80:83], a[100:103], a[80:83], v[80:83]
ds_read_b64_tr_b16 a[48:49], v17 offset:0
v_cvt_pk_bf16_f32 v160, v160, v161
v_cvt_pk_bf16_f32 v161, v162, v163
v_mfma_f32_16x16x32_bf16 v[196:199], a[104:107], a[80:83], v[196:199]
s_add_u32 s84, s94, 9472
v_cvt_pk_bf16_f32 v162, v48, v49
v_cvt_pk_bf16_f32 v163, v50, v51
v_cvt_pk_bf16_f32 v164, v164, v165
v_mfma_f32_16x16x32_bf16 v[84:87], a[108:111], a[80:83], v[84:87]
buffer_load_dwordx4 v2, s[44:47], s84 offen offset:1024 lds
v_cvt_pk_bf16_f32 v165, v166, v167
v_mfma_f32_16x16x32_bf16 v[200:203], a[96:99], a[84:87], v[200:203]
ds_read_b64_tr_b16 a[50:51], v17 offset:512
buffer_store_dwordx4 v[24:27], v1, s[56:59], s85 offen sc1
v_mfma_f32_16x16x32_bf16 v[88:91], a[100:103], a[84:87], v[88:91]
ds_read_b128 a[12:15], v7 offset:6144
v_cvt_pk_bf16_f32 v166, v52, v53
v_cvt_pk_bf16_f32 v167, v54, v55
v_mfma_f32_16x16x32_bf16 v[204:207], a[104:107], a[84:87], v[204:207]
ds_read_b64_tr_b16 a[52:53], v18 offset:0
v_accvgpr_read_b32 v24, a152
v_accvgpr_read_b32 v25, a153
v_mfma_f32_16x16x32_bf16 v[92:95], a[108:111], a[84:87], v[92:95]
v_accvgpr_read_b32 v26, a154
v_accvgpr_read_b32 v27, a155
v_accvgpr_read_b32 v28, a156
v_mfma_f32_16x16x32_bf16 v[208:211], a[80:83], a[112:115], v[208:211]
ds_read_b64_tr_b16 a[54:55], v18 offset:512
v_accvgpr_read_b32 v29, a157
v_accvgpr_read_b32 v30, a158
v_mfma_f32_16x16x32_bf16 v[96:99], a[84:87], a[112:115], v[96:99]
v_accvgpr_read_b32 v31, a159
v_cvt_pk_bf16_f32 v24, v24, v25
v_cvt_pk_bf16_f32 v25, v26, v27
v_mfma_f32_16x16x32_bf16 v[212:215], a[80:83], a[116:119], v[212:215]
s_add_u32 s84, s95, 4294965504
ds_read_b64_tr_b16 a[56:57], v19 offset:0
v_cvt_pk_bf16_f32 v26, v28, v29
v_cvt_pk_bf16_f32 v27, v30, v31
v_mfma_f32_16x16x32_bf16 v[100:103], a[84:87], a[116:119], v[100:103]
buffer_load_dwordx4 v2, s[44:47], s84 offen offset:2048 lds
v_cvt_pk_bf16_f32 v168, v168, v169
v_mfma_f32_16x16x32_bf16 v[216:219], a[80:83], a[120:123], v[216:219]
s_add_u32 s85, s98, 5120
ds_read_b64_tr_b16 a[58:59], v19 offset:512
v_cvt_pk_bf16_f32 v169, v170, v171
v_cvt_pk_bf16_f32 v170, v56, v57
v_mfma_f32_16x16x32_bf16 v[104:107], a[84:87], a[120:123], v[104:107]
ds_read_b64_tr_b16 a[60:61], v20 offset:0
v_cvt_pk_bf16_f32 v171, v58, v59
v_cvt_pk_bf16_f32 v172, v172, v173
v_mfma_f32_16x16x32_bf16 v[220:223], a[80:83], a[124:127], v[220:223]
buffer_store_dwordx4 v[24:27], v1, s[56:59], s85 offen sc1
v_cvt_pk_bf16_f32 v173, v174, v175
v_mfma_f32_16x16x32_bf16 v[108:111], a[84:87], a[124:127], v[108:111]
ds_read_b64_tr_b16 a[62:63], v20 offset:512
v_cvt_pk_bf16_f32 v174, v60, v61
v_cvt_pk_bf16_f32 v175, v62, v63
v_mfma_f32_16x16x32_bf16 v[224:227], a[96:99], a[88:91], v[224:227]
v_cvt_pk_bf16_f32 v176, v176, v177
v_cvt_pk_bf16_f32 v177, v178, v179
v_cvt_pk_bf16_f32 v178, v64, v65
v_mfma_f32_16x16x32_bf16 v[112:115], a[100:103], a[88:91], v[112:115]
v_cvt_pk_bf16_f32 v179, v66, v67
v_cvt_pk_bf16_f32 v180, v180, v181
v_cvt_pk_bf16_f32 v181, v182, v183
v_mfma_f32_16x16x32_bf16 v[228:231], a[104:107], a[88:91], v[228:231]
s_add_u32 s84, s95, 7424
v_cvt_pk_bf16_f32 v182, v68, v69
v_cvt_pk_bf16_f32 v183, v70, v71
v_cvt_pk_bf16_f32 v184, v184, v185
v_mfma_f32_16x16x32_bf16 v[116:119], a[108:111], a[88:91], v[116:119]
buffer_load_dwordx4 v2, s[44:47], s84 offen offset:3072 lds
v_cvt_pk_bf16_f32 v185, v186, v187
v_mfma_f32_16x16x32_bf16 v[232:235], a[96:99], a[92:95], v[232:235]
v_cvt_pk_bf16_f32 v186, v72, v73
v_cvt_pk_bf16_f32 v187, v74, v75
v_cvt_pk_bf16_f32 v188, v188, v189
v_mfma_f32_16x16x32_bf16 v[120:123], a[100:103], a[92:95], v[120:123]
v_cvt_pk_bf16_f32 v189, v190, v191
v_cvt_pk_bf16_f32 v190, v76, v77
v_cvt_pk_bf16_f32 v191, v78, v79
v_mfma_f32_16x16x32_bf16 v[236:239], a[104:107], a[92:95], v[236:239]
v_cvt_pk_bf16_f32 v192, v192, v193
v_cvt_pk_bf16_f32 v193, v194, v195
v_cvt_pk_bf16_f32 v194, v80, v81
v_mfma_f32_16x16x32_bf16 v[124:127], a[108:111], a[92:95], v[124:127]
v_cvt_pk_bf16_f32 v195, v82, v83
v_cvt_pk_bf16_f32 v196, v196, v197
v_cvt_pk_bf16_f32 v197, v198, v199
v_mfma_f32_16x16x32_bf16 v[240:243], a[88:91], a[112:115], v[240:243]
v_cvt_pk_bf16_f32 v198, v84, v85
v_cvt_pk_bf16_f32 v199, v86, v87
v_cvt_pk_bf16_f32 v200, v200, v201
v_mfma_f32_16x16x32_bf16 v[128:131], a[92:95], a[112:115], v[128:131]
v_cvt_pk_bf16_f32 v201, v202, v203
v_cvt_pk_bf16_f32 v202, v88, v89
v_cvt_pk_bf16_f32 v203, v90, v91
v_mfma_f32_16x16x32_bf16 v[244:247], a[88:91], a[116:119], v[244:247]
v_cvt_pk_bf16_f32 v204, v204, v205
v_cvt_pk_bf16_f32 v205, v206, v207
v_cvt_pk_bf16_f32 v206, v92, v93
v_mfma_f32_16x16x32_bf16 v[132:135], a[92:95], a[116:119], v[132:135]
v_cvt_pk_bf16_f32 v207, v94, v95
v_cvt_pk_bf16_f32 v208, v208, v209
v_cvt_pk_bf16_f32 v209, v210, v211
v_mfma_f32_16x16x32_bf16 v[248:251], a[88:91], a[120:123], v[248:251]
v_cvt_pk_bf16_f32 v210, v96, v97
v_cvt_pk_bf16_f32 v211, v98, v99
v_cvt_pk_bf16_f32 v212, v212, v213
v_mfma_f32_16x16x32_bf16 v[136:139], a[92:95], a[120:123], v[136:139]
v_cvt_pk_bf16_f32 v213, v214, v215
v_cvt_pk_bf16_f32 v214, v100, v101
v_cvt_pk_bf16_f32 v215, v102, v103
v_mfma_f32_16x16x32_bf16 v[252:255], a[88:91], a[124:127], v[252:255]
v_cvt_pk_bf16_f32 v216, v216, v217
v_cvt_pk_bf16_f32 v217, v218, v219
v_cvt_pk_bf16_f32 v218, v104, v105
v_mfma_f32_16x16x32_bf16 v[140:143], a[92:95], a[124:127], v[140:143]
v_cvt_pk_bf16_f32 v219, v106, v107
v_cvt_pk_bf16_f32 v220, v220, v221
v_cvt_pk_bf16_f32 v221, v222, v223
s_waitcnt lgkmcnt(0)
v_mfma_f32_16x16x32_bf16 a[144:147], a[48:51], a[0:3], a[208:211]
s_waitcnt vmcnt(22)
v_cvt_pk_bf16_f32 v222, v108, v109
v_cvt_pk_bf16_f32 v223, v110, v111
v_cvt_pk_bf16_f32 v224, v224, v225
v_mfma_f32_16x16x32_bf16 a[160:163], a[48:51], a[4:7], a[208:211]
s_barrier
v_cvt_pk_bf16_f32 v225, v226, v227
v_cvt_pk_bf16_f32 v226, v112, v113
v_cvt_pk_bf16_f32 v227, v114, v115
v_mfma_f32_16x16x32_bf16 a[176:179], a[48:51], a[8:11], a[208:211]
s_add_u32 m0, s88, 0
ds_read_b128 a[64:67], v8 offset:0
v_cvt_pk_bf16_f32 v228, v228, v229
v_cvt_pk_bf16_f32 v229, v230, v231
v_mfma_f32_16x16x32_bf16 a[192:195], a[48:51], a[12:15], a[208:211]
s_mov_b32 s84, 1048576
ds_read_b64_tr_b16 a[80:81], v9 offset:16384
v_cvt_pk_bf16_f32 v230, v116, v117
v_cvt_pk_bf16_f32 v231, v118, v119
v_mfma_f32_16x16x32_bf16 a[148:151], a[52:55], a[0:3], a[212:215]
buffer_load_dwordx4 v3, s[48:51], s84 offen offset:0 lds
v_cvt_pk_bf16_f32 v232, v232, v233
v_mfma_f32_16x16x32_bf16 a[164:167], a[52:55], a[4:7], a[212:215]
ds_read_b64_tr_b16 a[82:83], v9 offset:17408
v_cvt_pk_bf16_f32 v233, v234, v235
v_cvt_pk_bf16_f32 v234, v120, v121
v_mfma_f32_16x16x32_bf16 a[180:183], a[52:55], a[8:11], a[212:215]
s_mov_b32 s84, 1080320
ds_read_b64_tr_b16 a[84:85], v10 offset:16384
v_cvt_pk_bf16_f32 v235, v122, v123
v_cvt_pk_bf16_f32 v236, v236, v237
v_mfma_f32_16x16x32_bf16 a[196:199], a[52:55], a[12:15], a[212:215]
buffer_load_dwordx4 v3, s[48:51], s84 offen offset:1024 lds
v_cvt_pk_bf16_f32 v237, v238, v239
v_mfma_f32_16x16x32_bf16 a[152:155], a[56:59], a[0:3], a[216:219]
ds_read_b64_tr_b16 a[86:87], v10 offset:17408
v_cvt_pk_bf16_f32 v238, v124, v125
v_cvt_pk_bf16_f32 v239, v126, v127
v_mfma_f32_16x16x32_bf16 a[168:171], a[56:59], a[4:7], a[216:219]
ds_read_b64_tr_b16 a[88:89], v11 offset:16384
v_cvt_pk_bf16_f32 v240, v240, v241
v_cvt_pk_bf16_f32 v241, v242, v243
v_mfma_f32_16x16x32_bf16 a[184:187], a[56:59], a[8:11], a[216:219]
ds_read_b64_tr_b16 a[90:91], v11 offset:17408
v_cvt_pk_bf16_f32 v242, v128, v129
v_cvt_pk_bf16_f32 v243, v130, v131
v_mfma_f32_16x16x32_bf16 a[200:203], a[56:59], a[12:15], a[216:219]
s_add_u32 m0, s89, 0
ds_read_b128 a[68:71], v8 offset:2048
v_cvt_pk_bf16_f32 v244, v244, v245
v_cvt_pk_bf16_f32 v245, v246, v247
v_mfma_f32_16x16x32_bf16 a[156:159], a[60:63], a[0:3], a[220:223]
s_mov_b32 s84, 442368
ds_read_b64_tr_b16 a[92:93], v12 offset:16384
v_cvt_pk_bf16_f32 v246, v132, v133
v_cvt_pk_bf16_f32 v247, v134, v135
v_mfma_f32_16x16x32_bf16 a[172:175], a[60:63], a[4:7], a[220:223]
buffer_load_dwordx4 v4, s[52:55], s84 offen lds
v_cvt_pk_bf16_f32 v248, v248, v249
v_mfma_f32_16x16x32_bf16 a[188:191], a[60:63], a[8:11], a[220:223]
ds_read_b64_tr_b16 a[94:95], v12 offset:17408
v_cvt_pk_bf16_f32 v249, v250, v251
v_cvt_pk_bf16_f32 v250, v136, v137
v_mfma_f32_16x16x32_bf16 a[204:207], a[60:63], a[12:15], a[220:223]
ds_read_b64_tr_b16 a[96:97], v13 offset:16384
v_cvt_pk_bf16_f32 v251, v138, v139
v_cvt_pk_bf16_f32 v252, v252, v253
v_mfma_f32_16x16x32_bf16 a[128:131], a[32:35], a[12:15], 0
s_add_u32 s85, s99, 0
ds_read_b64_tr_b16 a[98:99], v13 offset:17408
v_cvt_pk_bf16_f32 v253, v254, v255
v_cvt_pk_bf16_f32 v254, v140, v141
v_mfma_f32_16x16x32_bf16 a[132:135], a[36:39], a[12:15], 0
buffer_store_dwordx4 v[144:147], v1, s[56:59], s85 offen sc1
v_cvt_pk_bf16_f32 v255, v142, v143
v_mfma_f32_16x16x32_bf16 a[136:139], a[40:43], a[12:15], 0
ds_read_b64_tr_b16 a[100:101], v14 offset:16384
v_mfma_f32_16x16x32_bf16 a[140:143], a[44:47], a[12:15], 0
ds_read_b64_tr_b16 a[102:103], v14 offset:17408
v_mfma_f32_16x16x32_bf16 v[32:35], a[16:19], a[0:3], 0
ds_read_b128 a[72:75], v8 offset:4096
v_mfma_f32_16x16x32_bf16 v[36:39], a[20:23], a[0:3], 0
s_add_u32 m0, s86, 36864
ds_read_b64_tr_b16 a[104:105], v15 offset:16384
v_mfma_f32_16x16x32_bf16 v[40:43], a[24:27], a[0:3], 0
s_add_u32 s84, s96, 256
ds_read_b64_tr_b16 a[106:107], v15 offset:17408
v_mfma_f32_16x16x32_bf16 v[44:47], a[28:31], a[0:3], 0
buffer_load_dwordx4 v2, s[44:47], s84 offen offset:0 lds
v_mfma_f32_16x16x32_bf16 v[48:51], a[32:35], a[0:3], 0
ds_read_b64_tr_b16 a[108:109], v16 offset:16384
v_mfma_f32_16x16x32_bf16 v[52:55], a[36:39], a[0:3], 0
s_add_u32 s84, s96, 9472
ds_read_b64_tr_b16 a[110:111], v16 offset:17408
v_mfma_f32_16x16x32_bf16 v[56:59], a[40:43], a[0:3], 0
buffer_load_dwordx4 v2, s[44:47], s84 offen offset:1024 lds
v_mfma_f32_16x16x32_bf16 v[60:63], a[44:47], a[0:3], 0
ds_read_b64_tr_b16 a[112:113], v17 offset:16384
v_mfma_f32_16x16x32_bf16 v[64:67], a[16:19], a[4:7], 0
ds_read_b64_tr_b16 a[114:115], v17 offset:16896
v_mfma_f32_16x16x32_bf16 v[68:71], a[20:23], a[4:7], 0
ds_read_b128 a[76:79], v8 offset:6144
v_mfma_f32_16x16x32_bf16 v[72:75], a[24:27], a[4:7], 0
s_add_u32 s84, s97, 4294965504
ds_read_b64_tr_b16 a[116:117], v18 offset:16384
v_mfma_f32_16x16x32_bf16 v[76:79], a[28:31], a[4:7], 0
buffer_load_dwordx4 v2, s[44:47], s84 offen offset:2048 lds
v_mfma_f32_16x16x32_bf16 v[80:83], a[32:35], a[4:7], 0
ds_read_b64_tr_b16 a[118:119], v18 offset:16896
v_mfma_f32_16x16x32_bf16 v[84:87], a[36:39], a[4:7], 0
ds_read_b64_tr_b16 a[120:121], v19 offset:16384
v_mfma_f32_16x16x32_bf16 v[88:91], a[40:43], a[4:7], 0
ds_read_b64_tr_b16 a[122:123], v19 offset:16896
v_mfma_f32_16x16x32_bf16 v[92:95], a[44:47], a[4:7], 0
s_add_u32 s84, s97, 7424
ds_read_b64_tr_b16 a[124:125], v20 offset:16384
v_mfma_f32_16x16x32_bf16 v[96:99], a[16:19], a[8:11], 0
buffer_load_dwordx4 v2, s[44:47], s84 offen offset:3072 lds
v_mfma_f32_16x16x32_bf16 v[100:103], a[20:23], a[8:11], 0
ds_read_b64_tr_b16 a[126:127], v20 offset:16896
v_mfma_f32_16x16x32_bf16 v[104:107], a[24:27], a[8:11], 0
v_mfma_f32_16x16x32_bf16 v[108:111], a[28:31], a[8:11], 0
v_mfma_f32_16x16x32_bf16 v[112:115], a[32:35], a[8:11], 0
s_add_u32 s85, s99, 1024
v_mfma_f32_16x16x32_bf16 v[116:119], a[36:39], a[8:11], 0
buffer_store_dwordx4 v[148:151], v1, s[56:59], s85 offen sc1
v_mfma_f32_16x16x32_bf16 v[120:123], a[40:43], a[8:11], 0
v_mfma_f32_16x16x32_bf16 v[124:127], a[44:47], a[8:11], 0
v_mfma_f32_16x16x32_bf16 v[128:131], a[16:19], a[12:15], 0
v_mfma_f32_16x16x32_bf16 v[132:135], a[20:23], a[12:15], 0
v_mfma_f32_16x16x32_bf16 v[136:139], a[24:27], a[12:15], 0
v_mfma_f32_16x16x32_bf16 v[140:143], a[28:31], a[12:15], 0
s_waitcnt lgkmcnt(0)
v_mfma_f32_16x16x32_bf16 a[144:147], a[112:115], a[64:67], a[144:147]
s_waitcnt vmcnt(20)
v_mfma_f32_16x16x32_bf16 a[160:163], a[112:115], a[68:71], a[160:163]
s_barrier
v_mfma_f32_16x16x32_bf16 a[176:179], a[112:115], a[72:75], a[176:179]
s_add_u32 m0, s88, 16384
ds_read_b128 a[0:3], v5 offset:0
v_mfma_f32_16x16x32_bf16 a[192:195], a[112:115], a[76:79], a[192:195]
s_mov_b32 s84, 1310720
ds_read_b64_tr_b16 a[16:17], v9 offset:32768
v_mfma_f32_16x16x32_bf16 a[148:151], a[116:119], a[64:67], a[148:151]
buffer_load_dwordx4 v3, s[48:51], s84 offen offset:0 lds
v_mfma_f32_16x16x32_bf16 a[164:167], a[116:119], a[68:71], a[164:167]
ds_read_b64_tr_b16 a[18:19], v9 offset:33792
v_mfma_f32_16x16x32_bf16 a[180:183], a[116:119], a[72:75], a[180:183]
s_mov_b32 s84, 1342464
ds_read_b64_tr_b16 a[20:21], v10 offset:32768
v_mfma_f32_16x16x32_bf16 a[196:199], a[116:119], a[76:79], a[196:199]
buffer_load_dwordx4 v3, s[48:51], s84 offen offset:1024 lds
v_mfma_f32_16x16x32_bf16 a[152:155], a[120:123], a[64:67], a[152:155]
ds_read_b64_tr_b16 a[22:23], v10 offset:33792
v_mfma_f32_16x16x32_bf16 a[168:171], a[120:123], a[68:71], a[168:171]
ds_read_b64_tr_b16 a[24:25], v11 offset:32768
v_mfma_f32_16x16x32_bf16 a[184:187], a[120:123], a[72:75], a[184:187]
ds_read_b64_tr_b16 a[26:27], v11 offset:33792
v_mfma_f32_16x16x32_bf16 a[200:203], a[120:123], a[76:79], a[200:203]
s_add_u32 m0, s89, 16384
ds_read_b128 a[4:7], v5 offset:2048
v_mfma_f32_16x16x32_bf16 a[156:159], a[124:127], a[64:67], a[156:159]
s_mov_b32 s84, 552960
ds_read_b64_tr_b16 a[28:29], v12 offset:32768
v_mfma_f32_16x16x32_bf16 a[172:175], a[124:127], a[68:71], a[172:175]
buffer_load_dwordx4 v4, s[52:55], s84 offen lds
v_mfma_f32_16x16x32_bf16 a[188:191], a[124:127], a[72:75], a[188:191]
ds_read_b64_tr_b16 a[30:31], v12 offset:33792
v_mfma_f32_16x16x32_bf16 a[204:207], a[124:127], a[76:79], a[204:207]
ds_read_b64_tr_b16 a[32:33], v13 offset:32768
v_mfma_f32_16x16x32_bf16 v[48:51], a[96:99], a[64:67], v[48:51]
s_add_u32 s85, s99, 2048
ds_read_b64_tr_b16 a[34:35], v13 offset:33792
v_mfma_f32_16x16x32_bf16 v[80:83], a[96:99], a[68:71], v[80:83]
buffer_store_dwordx4 v[152:155], v1, s[56:59], s85 offen sc1
v_mfma_f32_16x16x32_bf16 v[112:115], a[96:99], a[72:75], v[112:115]
ds_read_b64_tr_b16 a[36:37], v14 offset:32768
v_mfma_f32_16x16x32_bf16 a[128:131], a[96:99], a[76:79], a[128:131]
ds_read_b64_tr_b16 a[38:39], v14 offset:33792
v_mfma_f32_16x16x32_bf16 v[52:55], a[100:103], a[64:67], v[52:55]
ds_read_b128 a[8:11], v5 offset:4096
v_mfma_f32_16x16x32_bf16 v[84:87], a[100:103], a[68:71], v[84:87]
s_add_u32 m0, s86, 65536
ds_read_b64_tr_b16 a[40:41], v15 offset:32768
v_mfma_f32_16x16x32_bf16 v[116:119], a[100:103], a[72:75], v[116:119]
s_add_u32 s84, s94, 384
ds_read_b64_tr_b16 a[42:43], v15 offset:33792
v_mfma_f32_16x16x32_bf16 a[132:135], a[100:103], a[76:79], a[132:135]
buffer_load_dwordx4 v2, s[44:47], s84 offen offset:0 lds
v_mfma_f32_16x16x32_bf16 v[56:59], a[104:107], a[64:67], v[56:59]
ds_read_b64_tr_b16 a[44:45], v16 offset:32768
v_mfma_f32_16x16x32_bf16 v[88:91], a[104:107], a[68:71], v[88:91]
s_add_u32 s84, s94, 9600
ds_read_b64_tr_b16 a[46:47], v16 offset:33792
v_mfma_f32_16x16x32_bf16 v[120:123], a[104:107], a[72:75], v[120:123]
buffer_load_dwordx4 v2, s[44:47], s84 offen offset:1024 lds
v_mfma_f32_16x16x32_bf16 a[136:139], a[104:107], a[76:79], a[136:139]
ds_read_b64_tr_b16 a[48:49], v17 offset:32768
v_mfma_f32_16x16x32_bf16 v[60:63], a[108:111], a[64:67], v[60:63]
ds_read_b64_tr_b16 a[50:51], v17 offset:33280
v_mfma_f32_16x16x32_bf16 v[92:95], a[108:111], a[68:71], v[92:95]
ds_read_b128 a[12:15], v5 offset:6144
v_mfma_f32_16x16x32_bf16 v[124:127], a[108:111], a[72:75], v[124:127]
s_add_u32 s84, s95, 4294965632
ds_read_b64_tr_b16 a[52:53], v18 offset:32768
v_mfma_f32_16x16x32_bf16 a[140:143], a[108:111], a[76:79], a[140:143]
buffer_load_dwordx4 v2, s[44:47], s84 offen offset:2048 lds
v_mfma_f32_16x16x32_bf16 v[32:35], a[80:83], a[64:67], v[32:35]
ds_read_b64_tr_b16 a[54:55], v18 offset:33280
v_mfma_f32_16x16x32_bf16 v[64:67], a[80:83], a[68:71], v[64:67]
ds_read_b64_tr_b16 a[56:57], v19 offset:32768
v_mfma_f32_16x16x32_bf16 v[96:99], a[80:83], a[72:75], v[96:99]
ds_read_b64_tr_b16 a[58:59], v19 offset:33280
v_mfma_f32_16x16x32_bf16 v[128:131], a[80:83], a[76:79], v[128:131]
s_add_u32 s84, s95, 7552
ds_read_b64_tr_b16 a[60:61], v20 offset:32768
v_mfma_f32_16x16x32_bf16 v[36:39], a[84:87], a[64:67], v[36:39]
buffer_load_dwordx4 v2, s[44:47], s84 offen offset:3072 lds
v_mfma_f32_16x16x32_bf16 v[68:71], a[84:87], a[68:71], v[68:71]
ds_read_b64_tr_b16 a[62:63], v20 offset:33280
v_mfma_f32_16x16x32_bf16 v[100:103], a[84:87], a[72:75], v[100:103]
s_cmp_lt_u32 s2, 160
s_cselect_b32 s82, s14, s22
s_cselect_b32 s83, s15, s23
v_mfma_f32_16x16x32_bf16 v[132:135], a[84:87], a[76:79], v[132:135]
s_mov_b32 s64, s82
v_mfma_f32_16x16x32_bf16 v[40:43], a[88:91], a[64:67], v[40:43]
s_add_u32 s85, s99, 3072
v_mfma_f32_16x16x32_bf16 v[72:75], a[88:91], a[68:71], v[72:75]
buffer_store_dwordx4 v[156:159], v1, s[56:59], s85 offen sc1
v_mfma_f32_16x16x32_bf16 v[104:107], a[88:91], a[72:75], v[104:107]
s_and_b32 s65, s83, 0xffff
v_mfma_f32_16x16x32_bf16 v[136:139], a[88:91], a[76:79], v[136:139]
s_mov_b32 s66, 5242880
v_mfma_f32_16x16x32_bf16 v[44:47], a[92:95], a[64:67], v[44:47]
s_mov_b32 s67, 0x20000
v_mfma_f32_16x16x32_bf16 v[76:79], a[92:95], a[68:71], v[76:79]
s_cmp_lt_u32 s2, 160
s_cselect_b32 s66, s66, 2211840
v_mfma_f32_16x16x32_bf16 v[108:111], a[92:95], a[72:75], v[108:111]
v_mfma_f32_16x16x32_bf16 v[140:143], a[92:95], a[76:79], v[140:143]
s_waitcnt lgkmcnt(0)
v_mfma_f32_16x16x32_bf16 a[144:147], a[48:51], a[0:3], a[144:147]
s_waitcnt vmcnt(25)
v_mfma_f32_16x16x32_bf16 a[160:163], a[48:51], a[4:7], a[160:163]
s_barrier
v_mfma_f32_16x16x32_bf16 a[176:179], a[48:51], a[8:11], a[176:179]
s_add_u32 m0, s88, 32768
ds_read_b128 a[64:67], v6 offset:0
v_mfma_f32_16x16x32_bf16 a[192:195], a[48:51], a[12:15], a[192:195]
s_mov_b32 s84, 1572864
ds_read_b64_tr_b16 a[80:81], v9 offset:49152
v_mfma_f32_16x16x32_bf16 a[148:151], a[52:55], a[0:3], a[148:151]
buffer_load_dwordx4 v3, s[48:51], s84 offen offset:0 lds
v_mfma_f32_16x16x32_bf16 a[164:167], a[52:55], a[4:7], a[164:167]
s_lshl_b32 s82, s2, 2
ds_read_b64_tr_b16 a[82:83], v9 offset:50176
v_mfma_f32_16x16x32_bf16 a[180:183], a[52:55], a[8:11], a[180:183]
s_mov_b32 s84, 1604608
ds_read_b64_tr_b16 a[84:85], v10 offset:49152
v_mfma_f32_16x16x32_bf16 a[196:199], a[52:55], a[12:15], a[196:199]
buffer_load_dwordx4 v3, s[48:51], s84 offen offset:1024 lds
v_mfma_f32_16x16x32_bf16 a[152:155], a[56:59], a[0:3], a[152:155]
s_sub_u32 s83, s82, 640
ds_read_b64_tr_b16 a[86:87], v10 offset:50176
v_mfma_f32_16x16x32_bf16 a[168:171], a[56:59], a[4:7], a[168:171]
s_cmp_lt_u32 s2, 160
s_cselect_b32 s82, s82, s83
ds_read_b64_tr_b16 a[88:89], v11 offset:49152
v_mfma_f32_16x16x32_bf16 a[184:187], a[56:59], a[8:11], a[184:187]
s_mul_i32 s83, s82, 52429
ds_read_b64_tr_b16 a[90:91], v11 offset:50176
v_mfma_f32_16x16x32_bf16 a[200:203], a[56:59], a[12:15], a[200:203]
s_add_u32 m0, s89, 32768
ds_read_b128 a[68:71], v6 offset:2048
v_mfma_f32_16x16x32_bf16 a[156:159], a[60:63], a[0:3], a[156:159]
s_mov_b32 s84, 663552
ds_read_b64_tr_b16 a[92:93], v12 offset:49152
v_mfma_f32_16x16x32_bf16 a[172:175], a[60:63], a[4:7], a[172:175]
buffer_load_dwordx4 v4, s[52:55], s84 offen lds
v_mfma_f32_16x16x32_bf16 a[188:191], a[60:63], a[8:11], a[188:191]
s_lshr_b32 s83, s83, 18
ds_read_b64_tr_b16 a[94:95], v12 offset:50176
v_mfma_f32_16x16x32_bf16 a[204:207], a[60:63], a[12:15], a[204:207]
s_mul_i32 s83, s83, 39680
ds_read_b64_tr_b16 a[96:97], v13 offset:49152
v_mfma_f32_16x16x32_bf16 v[48:51], a[32:35], a[0:3], v[48:51]
s_add_u32 s85, s98, 16384
ds_read_b64_tr_b16 a[98:99], v13 offset:50176
v_mfma_f32_16x16x32_bf16 v[80:83], a[32:35], a[4:7], v[80:83]
buffer_store_dwordx4 v[160:163], v1, s[56:59], s85 offen sc1
v_mfma_f32_16x16x32_bf16 v[112:115], a[32:35], a[8:11], v[112:115]
s_lshl_b32 s36, s82, 8
ds_read_b64_tr_b16 a[100:101], v14 offset:49152
v_mfma_f32_16x16x32_bf16 a[128:131], a[32:35], a[12:15], a[128:131]
s_add_u32 s36, s36, s83
ds_read_b64_tr_b16 a[102:103], v14 offset:50176
v_mfma_f32_16x16x32_bf16 v[52:55], a[36:39], a[0:3], v[52:55]
s_add_u32 s82, s82, 1
ds_read_b128 a[72:75], v6 offset:4096
v_mfma_f32_16x16x32_bf16 v[84:87], a[36:39], a[4:7], v[84:87]
s_add_u32 m0, s86, 69632
ds_read_b64_tr_b16 a[104:105], v15 offset:49152
v_mfma_f32_16x16x32_bf16 v[116:119], a[36:39], a[8:11], v[116:119]
s_add_u32 s84, s96, 384
ds_read_b64_tr_b16 a[106:107], v15 offset:50176
v_mfma_f32_16x16x32_bf16 a[132:135], a[36:39], a[12:15], a[132:135]
buffer_load_dwordx4 v2, s[44:47], s84 offen offset:0 lds
v_mfma_f32_16x16x32_bf16 v[56:59], a[40:43], a[0:3], v[56:59]
s_mul_i32 s83, s82, 52429
ds_read_b64_tr_b16 a[108:109], v16 offset:49152
v_mfma_f32_16x16x32_bf16 v[88:91], a[40:43], a[4:7], v[88:91]
s_add_u32 s84, s96, 9600
ds_read_b64_tr_b16 a[110:111], v16 offset:50176
v_mfma_f32_16x16x32_bf16 v[120:123], a[40:43], a[8:11], v[120:123]
buffer_load_dwordx4 v2, s[44:47], s84 offen offset:1024 lds
v_mfma_f32_16x16x32_bf16 a[136:139], a[40:43], a[12:15], a[136:139]
s_lshr_b32 s83, s83, 18
ds_read_b64_tr_b16 a[112:113], v17 offset:49152
v_mfma_f32_16x16x32_bf16 v[60:63], a[44:47], a[0:3], v[60:63]
s_mul_i32 s83, s83, 39680
ds_read_b64_tr_b16 a[114:115], v17 offset:49664
v_mfma_f32_16x16x32_bf16 v[92:95], a[44:47], a[4:7], v[92:95]
s_lshl_b32 s37, s82, 8
ds_read_b128 a[76:79], v6 offset:6144
v_mfma_f32_16x16x32_bf16 v[124:127], a[44:47], a[8:11], v[124:127]
s_add_u32 s84, s97, 4294965632
ds_read_b64_tr_b16 a[116:117], v18 offset:49152
v_mfma_f32_16x16x32_bf16 a[140:143], a[44:47], a[12:15], a[140:143]
buffer_load_dwordx4 v2, s[44:47], s84 offen offset:2048 lds
v_mfma_f32_16x16x32_bf16 v[32:35], a[16:19], a[0:3], v[32:35]
s_add_u32 s37, s37, s83
ds_read_b64_tr_b16 a[118:119], v18 offset:49664
v_mfma_f32_16x16x32_bf16 v[64:67], a[16:19], a[4:7], v[64:67]
s_add_u32 s82, s82, 1
ds_read_b64_tr_b16 a[120:121], v19 offset:49152
v_mfma_f32_16x16x32_bf16 v[96:99], a[16:19], a[8:11], v[96:99]
s_mul_i32 s83, s82, 52429
ds_read_b64_tr_b16 a[122:123], v19 offset:49664
v_mfma_f32_16x16x32_bf16 v[128:131], a[16:19], a[12:15], v[128:131]
s_add_u32 s84, s97, 7552
ds_read_b64_tr_b16 a[124:125], v20 offset:49152
v_mfma_f32_16x16x32_bf16 v[36:39], a[20:23], a[0:3], v[36:39]
buffer_load_dwordx4 v2, s[44:47], s84 offen offset:3072 lds
v_mfma_f32_16x16x32_bf16 v[68:71], a[20:23], a[4:7], v[68:71]
s_lshr_b32 s83, s83, 18
ds_read_b64_tr_b16 a[126:127], v20 offset:49664
v_mfma_f32_16x16x32_bf16 v[100:103], a[20:23], a[8:11], v[100:103]
s_mul_i32 s83, s83, 39680
v_mfma_f32_16x16x32_bf16 v[132:135], a[20:23], a[12:15], v[132:135]
s_lshl_b32 s38, s82, 8
v_mfma_f32_16x16x32_bf16 v[40:43], a[24:27], a[0:3], v[40:43]
s_add_u32 s85, s98, 17408
v_mfma_f32_16x16x32_bf16 v[72:75], a[24:27], a[4:7], v[72:75]
buffer_store_dwordx4 v[164:167], v1, s[56:59], s85 offen sc1
v_mfma_f32_16x16x32_bf16 v[104:107], a[24:27], a[8:11], v[104:107]
s_add_u32 s38, s38, s83
v_mfma_f32_16x16x32_bf16 v[136:139], a[24:27], a[12:15], v[136:139]
s_add_u32 s82, s82, 1
v_mfma_f32_16x16x32_bf16 v[44:47], a[28:31], a[0:3], v[44:47]
s_mul_i32 s83, s82, 52429
v_mfma_f32_16x16x32_bf16 v[76:79], a[28:31], a[4:7], v[76:79]
s_lshr_b32 s83, s83, 18
v_mfma_f32_16x16x32_bf16 v[108:111], a[28:31], a[8:11], v[108:111]
s_mul_i32 s83, s83, 39680
v_mfma_f32_16x16x32_bf16 v[140:143], a[28:31], a[12:15], v[140:143]
s_lshl_b32 s39, s82, 8
s_add_u32 s39, s39, s83
s_waitcnt lgkmcnt(0)
v_mfma_f32_16x16x32_bf16 a[144:147], a[112:115], a[64:67], a[144:147]
s_waitcnt vmcnt(19)
v_mfma_f32_16x16x32_bf16 a[160:163], a[112:115], a[68:71], a[160:163]
s_barrier
v_mfma_f32_16x16x32_bf16 a[176:179], a[112:115], a[72:75], a[176:179]
s_add_u32 m0, s88, 49152
ds_read_b128 a[0:3], v5 offset:32768
v_mfma_f32_16x16x32_bf16 a[192:195], a[112:115], a[76:79], a[192:195]
s_mov_b32 s84, 1835008
ds_read_b64_tr_b16 a[16:17], v9 offset:0
v_mfma_f32_16x16x32_bf16 a[148:151], a[116:119], a[64:67], a[148:151]
buffer_load_dwordx4 v3, s[48:51], s84 offen offset:0 lds
v_mfma_f32_16x16x32_bf16 a[164:167], a[116:119], a[68:71], a[164:167]
s_bfe_u32 s22, s2, 0x20001
ds_read_b64_tr_b16 a[18:19], v9 offset:1024
v_mfma_f32_16x16x32_bf16 a[180:183], a[116:119], a[72:75], a[180:183]
s_mov_b32 s84, 1866752
ds_read_b64_tr_b16 a[20:21], v10 offset:0
v_mfma_f32_16x16x32_bf16 a[196:199], a[116:119], a[76:79], a[196:199]
buffer_load_dwordx4 v3, s[48:51], s84 offen offset:1024 lds
v_mfma_f32_16x16x32_bf16 a[152:155], a[120:123], a[64:67], a[152:155]
s_and_b32 s82, s2, 1
ds_read_b64_tr_b16 a[22:23], v10 offset:1024
v_mfma_f32_16x16x32_bf16 a[168:171], a[120:123], a[68:71], a[168:171]
s_lshl_b32 s82, s82, 5
ds_read_b64_tr_b16 a[24:25], v11 offset:0
v_mfma_f32_16x16x32_bf16 a[184:187], a[120:123], a[72:75], a[184:187]
s_lshr_b32 s23, s2, 3
ds_read_b64_tr_b16 a[26:27], v11 offset:1024
v_mfma_f32_16x16x32_bf16 a[200:203], a[120:123], a[76:79], a[200:203]
s_add_u32 m0, s89, 49152
ds_read_b128 a[4:7], v5 offset:34816
v_mfma_f32_16x16x32_bf16 a[156:159], a[124:127], a[64:67], a[156:159]
s_mov_b32 s84, 774144
ds_read_b64_tr_b16 a[28:29], v12 offset:0
v_mfma_f32_16x16x32_bf16 a[172:175], a[124:127], a[68:71], a[172:175]
buffer_load_dwordx4 v4, s[52:55], s84 offen lds
v_mfma_f32_16x16x32_bf16 a[188:191], a[124:127], a[72:75], a[188:191]
s_add_u32 s23, s23, s82
ds_read_b64_tr_b16 a[30:31], v12 offset:1024
v_mfma_f32_16x16x32_bf16 a[204:207], a[124:127], a[76:79], a[204:207]
s_lshr_b32 s30, s23, 2
ds_read_b64_tr_b16 a[32:33], v13 offset:0
v_mfma_f32_16x16x32_bf16 v[48:51], a[96:99], a[64:67], v[48:51]
s_add_u32 s85, s98, 20480
ds_read_b64_tr_b16 a[34:35], v13 offset:1024
v_mfma_f32_16x16x32_bf16 v[80:83], a[96:99], a[68:71], v[80:83]
buffer_store_dwordx4 v[168:171], v1, s[56:59], s85 offen sc1
v_mfma_f32_16x16x32_bf16 v[112:115], a[96:99], a[72:75], v[112:115]
s_lshl_b32 s30, s30, 1
ds_read_b64_tr_b16 a[36:37], v14 offset:0
v_mfma_f32_16x16x32_bf16 a[128:131], a[96:99], a[76:79], a[128:131]
s_and_b32 s83, s76, 1
ds_read_b64_tr_b16 a[38:39], v14 offset:1024
v_mfma_f32_16x16x32_bf16 v[52:55], a[100:103], a[64:67], v[52:55]
s_add_u32 s30, s30, s83
ds_read_b128 a[8:11], v5 offset:36864
v_mfma_f32_16x16x32_bf16 v[84:87], a[100:103], a[68:71], v[84:87]
s_add_u32 m0, s86, 0
ds_read_b64_tr_b16 a[40:41], v15 offset:0
v_mfma_f32_16x16x32_bf16 v[116:119], a[100:103], a[72:75], v[116:119]
s_add_u32 s84, s94, 512
ds_read_b64_tr_b16 a[42:43], v15 offset:1024
v_mfma_f32_16x16x32_bf16 a[132:135], a[100:103], a[76:79], a[132:135]
buffer_load_dwordx4 v2, s[44:47], s84 offen offset:0 lds
v_mfma_f32_16x16x32_bf16 v[56:59], a[104:107], a[64:67], v[56:59]
s_and_b32 s31, s23, 3
ds_read_b64_tr_b16 a[44:45], v16 offset:0
v_mfma_f32_16x16x32_bf16 v[88:91], a[104:107], a[68:71], v[88:91]
s_add_u32 s84, s94, 9728
ds_read_b64_tr_b16 a[46:47], v16 offset:1024
v_mfma_f32_16x16x32_bf16 v[120:123], a[104:107], a[72:75], v[120:123]
buffer_load_dwordx4 v2, s[44:47], s84 offen offset:1024 lds
v_mfma_f32_16x16x32_bf16 a[136:139], a[104:107], a[76:79], a[136:139]
s_lshl_b32 s31, s31, 1
ds_read_b64_tr_b16 a[48:49], v17 offset:0
v_mfma_f32_16x16x32_bf16 v[60:63], a[108:111], a[64:67], v[60:63]
s_lshr_b32 s83, s76, 1
ds_read_b64_tr_b16 a[50:51], v17 offset:512
v_mfma_f32_16x16x32_bf16 v[92:95], a[108:111], a[68:71], v[92:95]
s_add_u32 s31, s31, s83
ds_read_b128 a[12:15], v5 offset:38912
v_mfma_f32_16x16x32_bf16 v[124:127], a[108:111], a[72:75], v[124:127]
s_add_u32 s84, s95, 4294965760
ds_read_b64_tr_b16 a[52:53], v18 offset:0
v_mfma_f32_16x16x32_bf16 a[140:143], a[108:111], a[76:79], a[140:143]
buffer_load_dwordx4 v2, s[44:47], s84 offen offset:2048 lds
v_mfma_f32_16x16x32_bf16 v[32:35], a[80:83], a[64:67], v[32:35]
ds_read_b64_tr_b16 a[54:55], v18 offset:512
v_mfma_f32_16x16x32_bf16 v[64:67], a[80:83], a[68:71], v[64:67]
ds_read_b64_tr_b16 a[56:57], v19 offset:0
v_mfma_f32_16x16x32_bf16 v[96:99], a[80:83], a[72:75], v[96:99]
ds_read_b64_tr_b16 a[58:59], v19 offset:512
v_mfma_f32_16x16x32_bf16 v[128:131], a[80:83], a[76:79], v[128:131]
s_add_u32 s84, s95, 7680
ds_read_b64_tr_b16 a[60:61], v20 offset:0
v_mfma_f32_16x16x32_bf16 v[36:39], a[84:87], a[64:67], v[36:39]
buffer_load_dwordx4 v2, s[44:47], s84 offen offset:3072 lds
v_mfma_f32_16x16x32_bf16 v[68:71], a[84:87], a[68:71], v[68:71]
ds_read_b64_tr_b16 a[62:63], v20 offset:512
v_mfma_f32_16x16x32_bf16 v[100:103], a[84:87], a[72:75], v[100:103]
v_mfma_f32_16x16x32_bf16 v[132:135], a[84:87], a[76:79], v[132:135]
v_mfma_f32_16x16x32_bf16 v[40:43], a[88:91], a[64:67], v[40:43]
s_add_u32 s85, s98, 21504
v_mfma_f32_16x16x32_bf16 v[72:75], a[88:91], a[68:71], v[72:75]
buffer_store_dwordx4 v[172:175], v1, s[56:59], s85 offen sc1
v_mfma_f32_16x16x32_bf16 v[104:107], a[88:91], a[72:75], v[104:107]
v_mfma_f32_16x16x32_bf16 v[136:139], a[88:91], a[76:79], v[136:139]
v_mfma_f32_16x16x32_bf16 v[44:47], a[92:95], a[64:67], v[44:47]
v_mfma_f32_16x16x32_bf16 v[76:79], a[92:95], a[68:71], v[76:79]
v_mfma_f32_16x16x32_bf16 v[108:111], a[92:95], a[72:75], v[108:111]
v_mfma_f32_16x16x32_bf16 v[140:143], a[92:95], a[76:79], v[140:143]
s_waitcnt lgkmcnt(0)
v_mfma_f32_16x16x32_bf16 a[144:147], a[48:51], a[0:3], a[144:147]
s_waitcnt vmcnt(24)
v_mfma_f32_16x16x32_bf16 a[160:163], a[48:51], a[4:7], a[160:163]
s_barrier
v_mfma_f32_16x16x32_bf16 a[176:179], a[48:51], a[8:11], a[176:179]
s_add_u32 m0, s88, 0
ds_read_b128 a[64:67], v6 offset:32768
v_mfma_f32_16x16x32_bf16 a[192:195], a[48:51], a[12:15], a[192:195]
s_mov_b32 s84, 2097152
ds_read_b64_tr_b16 a[80:81], v9 offset:16384
v_mfma_f32_16x16x32_bf16 a[148:151], a[52:55], a[0:3], a[148:151]
buffer_load_dwordx4 v3, s[48:51], s84 offen offset:0 lds
v_mfma_f32_16x16x32_bf16 a[164:167], a[52:55], a[4:7], a[164:167]
s_mul_i32 s82, s30, 221184
ds_read_b64_tr_b16 a[82:83], v9 offset:17408
v_mfma_f32_16x16x32_bf16 a[180:183], a[52:55], a[8:11], a[180:183]
s_mov_b32 s84, 2128896
ds_read_b64_tr_b16 a[84:85], v10 offset:16384
v_mfma_f32_16x16x32_bf16 a[196:199], a[52:55], a[12:15], a[196:199]
buffer_load_dwordx4 v3, s[48:51], s84 offen offset:1024 lds
v_mfma_f32_16x16x32_bf16 a[152:155], a[56:59], a[0:3], a[152:155]
s_add_u32 s82, s82, 50331648
ds_read_b64_tr_b16 a[86:87], v10 offset:17408
v_mfma_f32_16x16x32_bf16 a[168:171], a[56:59], a[4:7], a[168:171]
s_add_u32 s40, s32, s82
s_addc_u32 s41, s33, 0
ds_read_b64_tr_b16 a[88:89], v11 offset:16384
v_mfma_f32_16x16x32_bf16 a[184:187], a[56:59], a[8:11], a[184:187]
s_and_b32 s41, s41, 0xffff
ds_read_b64_tr_b16 a[90:91], v11 offset:17408
v_mfma_f32_16x16x32_bf16 a[200:203], a[56:59], a[12:15], a[200:203]
s_add_u32 m0, s89, 0
ds_read_b128 a[68:71], v6 offset:34816
v_mfma_f32_16x16x32_bf16 a[156:159], a[60:63], a[0:3], a[156:159]
s_mov_b32 s84, 884736
ds_read_b64_tr_b16 a[92:93], v12 offset:16384
v_mfma_f32_16x16x32_bf16 a[172:175], a[60:63], a[4:7], a[172:175]
buffer_load_dwordx4 v4, s[52:55], s84 offen lds
v_mfma_f32_16x16x32_bf16 a[188:191], a[60:63], a[8:11], a[188:191]
s_mov_b32 s42, 221184
ds_read_b64_tr_b16 a[94:95], v12 offset:17408
v_mfma_f32_16x16x32_bf16 a[204:207], a[60:63], a[12:15], a[204:207]
s_mov_b32 s43, 0x20000
ds_read_b64_tr_b16 a[96:97], v13 offset:16384
v_mfma_f32_16x16x32_bf16 v[48:51], a[32:35], a[0:3], v[48:51]
s_add_u32 s85, s99, 16384
ds_read_b64_tr_b16 a[98:99], v13 offset:17408
v_mfma_f32_16x16x32_bf16 v[80:83], a[32:35], a[4:7], v[80:83]
buffer_store_dwordx4 v[176:179], v1, s[56:59], s85 offen sc1
v_mfma_f32_16x16x32_bf16 v[112:115], a[32:35], a[8:11], v[112:115]
s_mul_i32 s82, s31, 5120
ds_read_b64_tr_b16 a[100:101], v14 offset:16384
v_mfma_f32_16x16x32_bf16 a[128:131], a[32:35], a[12:15], a[128:131]
s_add_u32 s82, s82, 63963136
ds_read_b64_tr_b16 a[102:103], v14 offset:17408
v_mfma_f32_16x16x32_bf16 v[52:55], a[36:39], a[0:3], v[52:55]
s_add_u32 s72, s32, s82
s_addc_u32 s73, s33, 0
ds_read_b128 a[72:75], v6 offset:36864
v_mfma_f32_16x16x32_bf16 v[84:87], a[36:39], a[4:7], v[84:87]
s_add_u32 m0, s86, 4096
ds_read_b64_tr_b16 a[104:105], v15 offset:16384
v_mfma_f32_16x16x32_bf16 v[116:119], a[36:39], a[8:11], v[116:119]
s_add_u32 s84, s96, 512
ds_read_b64_tr_b16 a[106:107], v15 offset:17408
v_mfma_f32_16x16x32_bf16 a[132:135], a[36:39], a[12:15], a[132:135]
buffer_load_dwordx4 v2, s[44:47], s84 offen offset:0 lds
v_mfma_f32_16x16x32_bf16 v[56:59], a[40:43], a[0:3], v[56:59]
s_and_b32 s73, s73, 0xffff
ds_read_b64_tr_b16 a[108:109], v16 offset:16384
v_mfma_f32_16x16x32_bf16 v[88:91], a[40:43], a[4:7], v[88:91]
s_add_u32 s84, s96, 9728
ds_read_b64_tr_b16 a[110:111], v16 offset:17408
v_mfma_f32_16x16x32_bf16 v[120:123], a[40:43], a[8:11], v[120:123]
buffer_load_dwordx4 v2, s[44:47], s84 offen offset:1024 lds
v_mfma_f32_16x16x32_bf16 a[136:139], a[40:43], a[12:15], a[136:139]
s_mov_b32 s74, 2176000
ds_read_b64_tr_b16 a[112:113], v17 offset:16384
v_mfma_f32_16x16x32_bf16 v[60:63], a[44:47], a[0:3], v[60:63]
s_mov_b32 s75, 0x20000
ds_read_b64_tr_b16 a[114:115], v17 offset:16896
v_mfma_f32_16x16x32_bf16 v[92:95], a[44:47], a[4:7], v[92:95]
ds_read_b128 a[76:79], v6 offset:38912
v_mfma_f32_16x16x32_bf16 v[124:127], a[44:47], a[8:11], v[124:127]
s_add_u32 s84, s97, 4294965760
ds_read_b64_tr_b16 a[116:117], v18 offset:16384
v_mfma_f32_16x16x32_bf16 a[140:143], a[44:47], a[12:15], a[140:143]
buffer_load_dwordx4 v2, s[44:47], s84 offen offset:2048 lds
v_mfma_f32_16x16x32_bf16 v[32:35], a[16:19], a[0:3], v[32:35]
ds_read_b64_tr_b16 a[118:119], v18 offset:16896
v_mfma_f32_16x16x32_bf16 v[64:67], a[16:19], a[4:7], v[64:67]
ds_read_b64_tr_b16 a[120:121], v19 offset:16384
v_mfma_f32_16x16x32_bf16 v[96:99], a[16:19], a[8:11], v[96:99]
ds_read_b64_tr_b16 a[122:123], v19 offset:16896
v_mfma_f32_16x16x32_bf16 v[128:131], a[16:19], a[12:15], v[128:131]
s_add_u32 s84, s97, 7680
ds_read_b64_tr_b16 a[124:125], v20 offset:16384
v_mfma_f32_16x16x32_bf16 v[36:39], a[20:23], a[0:3], v[36:39]
buffer_load_dwordx4 v2, s[44:47], s84 offen offset:3072 lds
v_mfma_f32_16x16x32_bf16 v[68:71], a[20:23], a[4:7], v[68:71]
ds_read_b64_tr_b16 a[126:127], v20 offset:16896
v_mfma_f32_16x16x32_bf16 v[100:103], a[20:23], a[8:11], v[100:103]
v_mfma_f32_16x16x32_bf16 v[132:135], a[20:23], a[12:15], v[132:135]
v_mfma_f32_16x16x32_bf16 v[40:43], a[24:27], a[0:3], v[40:43]
s_add_u32 s85, s99, 17408
v_mfma_f32_16x16x32_bf16 v[72:75], a[24:27], a[4:7], v[72:75]
buffer_store_dwordx4 v[180:183], v1, s[56:59], s85 offen sc1
v_mfma_f32_16x16x32_bf16 v[104:107], a[24:27], a[8:11], v[104:107]
v_mfma_f32_16x16x32_bf16 v[136:139], a[24:27], a[12:15], v[136:139]
v_mfma_f32_16x16x32_bf16 v[44:47], a[28:31], a[0:3], v[44:47]
v_mfma_f32_16x16x32_bf16 v[76:79], a[28:31], a[4:7], v[76:79]
v_mfma_f32_16x16x32_bf16 v[108:111], a[28:31], a[8:11], v[108:111]
v_mfma_f32_16x16x32_bf16 v[140:143], a[28:31], a[12:15], v[140:143]
s_waitcnt lgkmcnt(0)
v_mfma_f32_16x16x32_bf16 a[144:147], a[112:115], a[64:67], a[144:147]
s_waitcnt vmcnt(19)
v_mfma_f32_16x16x32_bf16 a[160:163], a[112:115], a[68:71], a[160:163]
s_barrier
v_mfma_f32_16x16x32_bf16 a[176:179], a[112:115], a[72:75], a[176:179]
s_add_u32 m0, s88, 16384
ds_read_b128 a[0:3], v7 offset:0
v_mfma_f32_16x16x32_bf16 a[192:195], a[112:115], a[76:79], a[192:195]
s_mov_b32 s84, 2359296
ds_read_b64_tr_b16 a[16:17], v9 offset:32768
v_mfma_f32_16x16x32_bf16 a[148:151], a[116:119], a[64:67], a[148:151]
buffer_load_dwordx4 v3, s[48:51], s84 offen offset:0 lds
v_mfma_f32_16x16x32_bf16 a[164:167], a[116:119], a[68:71], a[164:167]
ds_read_b64_tr_b16 a[18:19], v9 offset:33792
v_mfma_f32_16x16x32_bf16 a[180:183], a[116:119], a[72:75], a[180:183]
s_mov_b32 s84, 2391040
ds_read_b64_tr_b16 a[20:21], v10 offset:32768
v_mfma_f32_16x16x32_bf16 a[196:199], a[116:119], a[76:79], a[196:199]
buffer_load_dwordx4 v3, s[48:51], s84 offen offset:1024 lds
v_mfma_f32_16x16x32_bf16 a[152:155], a[120:123], a[64:67], a[152:155]
ds_read_b64_tr_b16 a[22:23], v10 offset:33792
v_mfma_f32_16x16x32_bf16 a[168:171], a[120:123], a[68:71], a[168:171]
ds_read_b64_tr_b16 a[24:25], v11 offset:32768
v_mfma_f32_16x16x32_bf16 a[184:187], a[120:123], a[72:75], a[184:187]
ds_read_b64_tr_b16 a[26:27], v11 offset:33792
v_mfma_f32_16x16x32_bf16 a[200:203], a[120:123], a[76:79], a[200:203]
s_add_u32 m0, s89, 16384
ds_read_b128 a[4:7], v7 offset:2048
v_mfma_f32_16x16x32_bf16 a[156:159], a[124:127], a[64:67], a[156:159]
s_mov_b32 s84, 995328
ds_read_b64_tr_b16 a[28:29], v12 offset:32768
v_mfma_f32_16x16x32_bf16 a[172:175], a[124:127], a[68:71], a[172:175]
buffer_load_dwordx4 v4, s[52:55], s84 offen lds
v_mfma_f32_16x16x32_bf16 a[188:191], a[124:127], a[72:75], a[188:191]
ds_read_b64_tr_b16 a[30:31], v12 offset:33792
v_mfma_f32_16x16x32_bf16 a[204:207], a[124:127], a[76:79], a[204:207]
ds_read_b64_tr_b16 a[32:33], v13 offset:32768
v_mfma_f32_16x16x32_bf16 v[48:51], a[96:99], a[64:67], v[48:51]
s_add_u32 s85, s99, 18432
ds_read_b64_tr_b16 a[34:35], v13 offset:33792
v_mfma_f32_16x16x32_bf16 v[80:83], a[96:99], a[68:71], v[80:83]
buffer_store_dwordx4 v[184:187], v1, s[56:59], s85 offen sc1
v_mfma_f32_16x16x32_bf16 v[112:115], a[96:99], a[72:75], v[112:115]
ds_read_b64_tr_b16 a[36:37], v14 offset:32768
v_mfma_f32_16x16x32_bf16 a[128:131], a[96:99], a[76:79], a[128:131]
ds_read_b64_tr_b16 a[38:39], v14 offset:33792
v_mfma_f32_16x16x32_bf16 v[52:55], a[100:103], a[64:67], v[52:55]
ds_read_b128 a[8:11], v7 offset:4096
v_mfma_f32_16x16x32_bf16 v[84:87], a[100:103], a[68:71], v[84:87]
s_add_u32 m0, s86, 32768
ds_read_b64_tr_b16 a[40:41], v15 offset:32768
v_mfma_f32_16x16x32_bf16 v[116:119], a[100:103], a[72:75], v[116:119]
s_add_u32 s84, s94, 640
ds_read_b64_tr_b16 a[42:43], v15 offset:33792
v_mfma_f32_16x16x32_bf16 a[132:135], a[100:103], a[76:79], a[132:135]
buffer_load_dwordx4 v2, s[44:47], s84 offen offset:0 lds
v_mfma_f32_16x16x32_bf16 v[56:59], a[104:107], a[64:67], v[56:59]
ds_read_b64_tr_b16 a[44:45], v16 offset:32768
v_mfma_f32_16x16x32_bf16 v[88:91], a[104:107], a[68:71], v[88:91]
s_add_u32 s84, s94, 9856
ds_read_b64_tr_b16 a[46:47], v16 offset:33792
v_mfma_f32_16x16x32_bf16 v[120:123], a[104:107], a[72:75], v[120:123]
buffer_load_dwordx4 v2, s[44:47], s84 offen offset:1024 lds
v_mfma_f32_16x16x32_bf16 a[136:139], a[104:107], a[76:79], a[136:139]
ds_read_b64_tr_b16 a[48:49], v17 offset:32768
v_mfma_f32_16x16x32_bf16 v[60:63], a[108:111], a[64:67], v[60:63]
ds_read_b64_tr_b16 a[50:51], v17 offset:33280
v_mfma_f32_16x16x32_bf16 v[92:95], a[108:111], a[68:71], v[92:95]
ds_read_b128 a[12:15], v7 offset:6144
v_mfma_f32_16x16x32_bf16 v[124:127], a[108:111], a[72:75], v[124:127]
s_add_u32 s84, s95, 4294965888
ds_read_b64_tr_b16 a[52:53], v18 offset:32768
v_mfma_f32_16x16x32_bf16 a[140:143], a[108:111], a[76:79], a[140:143]
buffer_load_dwordx4 v2, s[44:47], s84 offen offset:2048 lds
v_mfma_f32_16x16x32_bf16 v[32:35], a[80:83], a[64:67], v[32:35]
ds_read_b64_tr_b16 a[54:55], v18 offset:33280
v_mfma_f32_16x16x32_bf16 v[64:67], a[80:83], a[68:71], v[64:67]
ds_read_b64_tr_b16 a[56:57], v19 offset:32768
v_mfma_f32_16x16x32_bf16 v[96:99], a[80:83], a[72:75], v[96:99]
ds_read_b64_tr_b16 a[58:59], v19 offset:33280
v_mfma_f32_16x16x32_bf16 v[128:131], a[80:83], a[76:79], v[128:131]
s_add_u32 s84, s95, 7808
ds_read_b64_tr_b16 a[60:61], v20 offset:32768
v_mfma_f32_16x16x32_bf16 v[36:39], a[84:87], a[64:67], v[36:39]
buffer_load_dwordx4 v2, s[44:47], s84 offen offset:3072 lds
v_mfma_f32_16x16x32_bf16 v[68:71], a[84:87], a[68:71], v[68:71]
ds_read_b64_tr_b16 a[62:63], v20 offset:33280
v_mfma_f32_16x16x32_bf16 v[100:103], a[84:87], a[72:75], v[100:103]
v_mfma_f32_16x16x32_bf16 v[132:135], a[84:87], a[76:79], v[132:135]
v_mfma_f32_16x16x32_bf16 v[40:43], a[88:91], a[64:67], v[40:43]
s_add_u32 s85, s99, 19456
v_mfma_f32_16x16x32_bf16 v[72:75], a[88:91], a[68:71], v[72:75]
buffer_store_dwordx4 v[188:191], v1, s[56:59], s85 offen sc1
v_mfma_f32_16x16x32_bf16 v[104:107], a[88:91], a[72:75], v[104:107]
v_mfma_f32_16x16x32_bf16 v[136:139], a[88:91], a[76:79], v[136:139]
v_mfma_f32_16x16x32_bf16 v[44:47], a[92:95], a[64:67], v[44:47]
v_mfma_f32_16x16x32_bf16 v[76:79], a[92:95], a[68:71], v[76:79]
v_mfma_f32_16x16x32_bf16 v[108:111], a[92:95], a[72:75], v[108:111]
v_mfma_f32_16x16x32_bf16 v[140:143], a[92:95], a[76:79], v[140:143]
s_waitcnt lgkmcnt(0)
v_mfma_f32_16x16x32_bf16 a[144:147], a[48:51], a[0:3], a[144:147]
s_waitcnt vmcnt(24)
v_mfma_f32_16x16x32_bf16 a[160:163], a[48:51], a[4:7], a[160:163]
s_barrier
v_mfma_f32_16x16x32_bf16 a[176:179], a[48:51], a[8:11], a[176:179]
s_add_u32 m0, s88, 32768
ds_read_b128 a[64:67], v8 offset:0
v_mfma_f32_16x16x32_bf16 a[192:195], a[48:51], a[12:15], a[192:195]
s_mov_b32 s84, 2621440
ds_read_b64_tr_b16 a[80:81], v9 offset:49152
v_mfma_f32_16x16x32_bf16 a[148:151], a[52:55], a[0:3], a[148:151]
buffer_load_dwordx4 v3, s[48:51], s84 offen offset:0 lds
v_mfma_f32_16x16x32_bf16 a[164:167], a[52:55], a[4:7], a[164:167]
ds_read_b64_tr_b16 a[82:83], v9 offset:50176
v_mfma_f32_16x16x32_bf16 a[180:183], a[52:55], a[8:11], a[180:183]
s_mov_b32 s84, 2653184
ds_read_b64_tr_b16 a[84:85], v10 offset:49152
v_mfma_f32_16x16x32_bf16 a[196:199], a[52:55], a[12:15], a[196:199]
buffer_load_dwordx4 v3, s[48:51], s84 offen offset:1024 lds
v_mfma_f32_16x16x32_bf16 a[152:155], a[56:59], a[0:3], a[152:155]
ds_read_b64_tr_b16 a[86:87], v10 offset:50176
v_mfma_f32_16x16x32_bf16 a[168:171], a[56:59], a[4:7], a[168:171]
ds_read_b64_tr_b16 a[88:89], v11 offset:49152
v_mfma_f32_16x16x32_bf16 a[184:187], a[56:59], a[8:11], a[184:187]
ds_read_b64_tr_b16 a[90:91], v11 offset:50176
v_mfma_f32_16x16x32_bf16 a[200:203], a[56:59], a[12:15], a[200:203]
s_add_u32 m0, s89, 32768
ds_read_b128 a[68:71], v8 offset:2048
v_mfma_f32_16x16x32_bf16 a[156:159], a[60:63], a[0:3], a[156:159]
s_mov_b32 s84, 1105920
ds_read_b64_tr_b16 a[92:93], v12 offset:49152
v_mfma_f32_16x16x32_bf16 a[172:175], a[60:63], a[4:7], a[172:175]
buffer_load_dwordx4 v4, s[52:55], s84 offen lds
v_mfma_f32_16x16x32_bf16 a[188:191], a[60:63], a[8:11], a[188:191]
ds_read_b64_tr_b16 a[94:95], v12 offset:50176
v_mfma_f32_16x16x32_bf16 a[204:207], a[60:63], a[12:15], a[204:207]
ds_read_b64_tr_b16 a[96:97], v13 offset:49152
v_mfma_f32_16x16x32_bf16 v[48:51], a[32:35], a[0:3], v[48:51]
s_add_u32 s85, s98, 32768
ds_read_b64_tr_b16 a[98:99], v13 offset:50176
v_mfma_f32_16x16x32_bf16 v[80:83], a[32:35], a[4:7], v[80:83]
buffer_store_dwordx4 v[192:195], v1, s[56:59], s85 offen sc1
v_mfma_f32_16x16x32_bf16 v[112:115], a[32:35], a[8:11], v[112:115]
ds_read_b64_tr_b16 a[100:101], v14 offset:49152
v_mfma_f32_16x16x32_bf16 a[128:131], a[32:35], a[12:15], a[128:131]
ds_read_b64_tr_b16 a[102:103], v14 offset:50176
v_mfma_f32_16x16x32_bf16 v[52:55], a[36:39], a[0:3], v[52:55]
ds_read_b128 a[72:75], v8 offset:4096
v_mfma_f32_16x16x32_bf16 v[84:87], a[36:39], a[4:7], v[84:87]
s_add_u32 m0, s86, 36864
ds_read_b64_tr_b16 a[104:105], v15 offset:49152
v_mfma_f32_16x16x32_bf16 v[116:119], a[36:39], a[8:11], v[116:119]
s_add_u32 s84, s96, 640
ds_read_b64_tr_b16 a[106:107], v15 offset:50176
v_mfma_f32_16x16x32_bf16 a[132:135], a[36:39], a[12:15], a[132:135]
buffer_load_dwordx4 v2, s[44:47], s84 offen offset:0 lds
v_mfma_f32_16x16x32_bf16 v[56:59], a[40:43], a[0:3], v[56:59]
ds_read_b64_tr_b16 a[108:109], v16 offset:49152
v_mfma_f32_16x16x32_bf16 v[88:91], a[40:43], a[4:7], v[88:91]
s_add_u32 s84, s96, 9856
ds_read_b64_tr_b16 a[110:111], v16 offset:50176
v_mfma_f32_16x16x32_bf16 v[120:123], a[40:43], a[8:11], v[120:123]
buffer_load_dwordx4 v2, s[44:47], s84 offen offset:1024 lds
v_mfma_f32_16x16x32_bf16 a[136:139], a[40:43], a[12:15], a[136:139]
ds_read_b64_tr_b16 a[112:113], v17 offset:49152
v_mfma_f32_16x16x32_bf16 v[60:63], a[44:47], a[0:3], v[60:63]
ds_read_b64_tr_b16 a[114:115], v17 offset:49664
v_mfma_f32_16x16x32_bf16 v[92:95], a[44:47], a[4:7], v[92:95]
ds_read_b128 a[76:79], v8 offset:6144
v_mfma_f32_16x16x32_bf16 v[124:127], a[44:47], a[8:11], v[124:127]
s_add_u32 s84, s97, 4294965888
ds_read_b64_tr_b16 a[116:117], v18 offset:49152
v_mfma_f32_16x16x32_bf16 a[140:143], a[44:47], a[12:15], a[140:143]
buffer_load_dwordx4 v2, s[44:47], s84 offen offset:2048 lds
v_mfma_f32_16x16x32_bf16 v[32:35], a[16:19], a[0:3], v[32:35]
ds_read_b64_tr_b16 a[118:119], v18 offset:49664
v_mfma_f32_16x16x32_bf16 v[64:67], a[16:19], a[4:7], v[64:67]
ds_read_b64_tr_b16 a[120:121], v19 offset:49152
v_mfma_f32_16x16x32_bf16 v[96:99], a[16:19], a[8:11], v[96:99]
ds_read_b64_tr_b16 a[122:123], v19 offset:49664
v_mfma_f32_16x16x32_bf16 v[128:131], a[16:19], a[12:15], v[128:131]
s_add_u32 s84, s97, 7808
ds_read_b64_tr_b16 a[124:125], v20 offset:49152
v_mfma_f32_16x16x32_bf16 v[36:39], a[20:23], a[0:3], v[36:39]
buffer_load_dwordx4 v2, s[44:47], s84 offen offset:3072 lds
v_mfma_f32_16x16x32_bf16 v[68:71], a[20:23], a[4:7], v[68:71]
ds_read_b64_tr_b16 a[126:127], v20 offset:49664
v_mfma_f32_16x16x32_bf16 v[100:103], a[20:23], a[8:11], v[100:103]
v_mfma_f32_16x16x32_bf16 v[132:135], a[20:23], a[12:15], v[132:135]
v_mfma_f32_16x16x32_bf16 v[40:43], a[24:27], a[0:3], v[40:43]
s_add_u32 s85, s98, 33792
v_mfma_f32_16x16x32_bf16 v[72:75], a[24:27], a[4:7], v[72:75]
buffer_store_dwordx4 v[196:199], v1, s[56:59], s85 offen sc1
v_mfma_f32_16x16x32_bf16 v[104:107], a[24:27], a[8:11], v[104:107]
v_mfma_f32_16x16x32_bf16 v[136:139], a[24:27], a[12:15], v[136:139]
v_mfma_f32_16x16x32_bf16 v[44:47], a[28:31], a[0:3], v[44:47]
v_mfma_f32_16x16x32_bf16 v[76:79], a[28:31], a[4:7], v[76:79]
v_mfma_f32_16x16x32_bf16 v[108:111], a[28:31], a[8:11], v[108:111]
v_mfma_f32_16x16x32_bf16 v[140:143], a[28:31], a[12:15], v[140:143]
s_waitcnt lgkmcnt(0)
v_mfma_f32_16x16x32_bf16 a[144:147], a[112:115], a[64:67], a[144:147]
s_waitcnt vmcnt(19)
v_mfma_f32_16x16x32_bf16 a[160:163], a[112:115], a[68:71], a[160:163]
s_barrier
v_mfma_f32_16x16x32_bf16 a[176:179], a[112:115], a[72:75], a[176:179]
s_add_u32 m0, s88, 49152
ds_read_b128 a[0:3], v5 offset:0
v_mfma_f32_16x16x32_bf16 a[192:195], a[112:115], a[76:79], a[192:195]
s_mov_b32 s84, 2883584
ds_read_b64_tr_b16 a[16:17], v9 offset:0
v_mfma_f32_16x16x32_bf16 a[148:151], a[116:119], a[64:67], a[148:151]
buffer_load_dwordx4 v3, s[48:51], s84 offen offset:0 lds
v_mfma_f32_16x16x32_bf16 a[164:167], a[116:119], a[68:71], a[164:167]
ds_read_b64_tr_b16 a[18:19], v9 offset:1024
v_mfma_f32_16x16x32_bf16 a[180:183], a[116:119], a[72:75], a[180:183]
s_mov_b32 s84, 2915328
ds_read_b64_tr_b16 a[20:21], v10 offset:0
v_mfma_f32_16x16x32_bf16 a[196:199], a[116:119], a[76:79], a[196:199]
buffer_load_dwordx4 v3, s[48:51], s84 offen offset:1024 lds
v_mfma_f32_16x16x32_bf16 a[152:155], a[120:123], a[64:67], a[152:155]
ds_read_b64_tr_b16 a[22:23], v10 offset:1024
v_mfma_f32_16x16x32_bf16 a[168:171], a[120:123], a[68:71], a[168:171]
ds_read_b64_tr_b16 a[24:25], v11 offset:0
v_mfma_f32_16x16x32_bf16 a[184:187], a[120:123], a[72:75], a[184:187]
ds_read_b64_tr_b16 a[26:27], v11 offset:1024
v_mfma_f32_16x16x32_bf16 a[200:203], a[120:123], a[76:79], a[200:203]
s_add_u32 m0, s89, 49152
ds_read_b128 a[4:7], v5 offset:2048
v_mfma_f32_16x16x32_bf16 a[156:159], a[124:127], a[64:67], a[156:159]
s_mov_b32 s84, 1216512
ds_read_b64_tr_b16 a[28:29], v12 offset:0
v_mfma_f32_16x16x32_bf16 a[172:175], a[124:127], a[68:71], a[172:175]
buffer_load_dwordx4 v4, s[52:55], s84 offen lds
v_mfma_f32_16x16x32_bf16 a[188:191], a[124:127], a[72:75], a[188:191]
ds_read_b64_tr_b16 a[30:31], v12 offset:1024
v_mfma_f32_16x16x32_bf16 a[204:207], a[124:127], a[76:79], a[204:207]
ds_read_b64_tr_b16 a[32:33], v13 offset:0
v_mfma_f32_16x16x32_bf16 v[48:51], a[96:99], a[64:67], v[48:51]
s_add_u32 s85, s98, 36864
ds_read_b64_tr_b16 a[34:35], v13 offset:1024
v_mfma_f32_16x16x32_bf16 v[80:83], a[96:99], a[68:71], v[80:83]
buffer_store_dwordx4 v[200:203], v1, s[56:59], s85 offen sc1
v_mfma_f32_16x16x32_bf16 v[112:115], a[96:99], a[72:75], v[112:115]
ds_read_b64_tr_b16 a[36:37], v14 offset:0
v_mfma_f32_16x16x32_bf16 a[128:131], a[96:99], a[76:79], a[128:131]
ds_read_b64_tr_b16 a[38:39], v14 offset:1024
v_mfma_f32_16x16x32_bf16 v[52:55], a[100:103], a[64:67], v[52:55]
ds_read_b128 a[8:11], v5 offset:4096
v_mfma_f32_16x16x32_bf16 v[84:87], a[100:103], a[68:71], v[84:87]
s_add_u32 m0, s86, 65536
ds_read_b64_tr_b16 a[40:41], v15 offset:0
v_mfma_f32_16x16x32_bf16 v[116:119], a[100:103], a[72:75], v[116:119]
s_add_u32 s84, s94, 768
ds_read_b64_tr_b16 a[42:43], v15 offset:1024
v_mfma_f32_16x16x32_bf16 a[132:135], a[100:103], a[76:79], a[132:135]
buffer_load_dwordx4 v2, s[44:47], s84 offen offset:0 lds
v_mfma_f32_16x16x32_bf16 v[56:59], a[104:107], a[64:67], v[56:59]
ds_read_b64_tr_b16 a[44:45], v16 offset:0
v_mfma_f32_16x16x32_bf16 v[88:91], a[104:107], a[68:71], v[88:91]
s_add_u32 s84, s94, 9984
ds_read_b64_tr_b16 a[46:47], v16 offset:1024
v_mfma_f32_16x16x32_bf16 v[120:123], a[104:107], a[72:75], v[120:123]
buffer_load_dwordx4 v2, s[44:47], s84 offen offset:1024 lds
v_mfma_f32_16x16x32_bf16 a[136:139], a[104:107], a[76:79], a[136:139]
ds_read_b64_tr_b16 a[48:49], v17 offset:0
v_mfma_f32_16x16x32_bf16 v[60:63], a[108:111], a[64:67], v[60:63]
ds_read_b64_tr_b16 a[50:51], v17 offset:512
v_mfma_f32_16x16x32_bf16 v[92:95], a[108:111], a[68:71], v[92:95]
ds_read_b128 a[12:15], v5 offset:6144
v_mfma_f32_16x16x32_bf16 v[124:127], a[108:111], a[72:75], v[124:127]
s_add_u32 s84, s95, 4294966016
ds_read_b64_tr_b16 a[52:53], v18 offset:0
v_mfma_f32_16x16x32_bf16 a[140:143], a[108:111], a[76:79], a[140:143]
buffer_load_dwordx4 v2, s[44:47], s84 offen offset:2048 lds
v_mfma_f32_16x16x32_bf16 v[32:35], a[80:83], a[64:67], v[32:35]
ds_read_b64_tr_b16 a[54:55], v18 offset:512
v_mfma_f32_16x16x32_bf16 v[64:67], a[80:83], a[68:71], v[64:67]
ds_read_b64_tr_b16 a[56:57], v19 offset:0
v_mfma_f32_16x16x32_bf16 v[96:99], a[80:83], a[72:75], v[96:99]
ds_read_b64_tr_b16 a[58:59], v19 offset:512
v_mfma_f32_16x16x32_bf16 v[128:131], a[80:83], a[76:79], v[128:131]
s_add_u32 s84, s95, 7936
ds_read_b64_tr_b16 a[60:61], v20 offset:0
v_mfma_f32_16x16x32_bf16 v[36:39], a[84:87], a[64:67], v[36:39]
buffer_load_dwordx4 v2, s[44:47], s84 offen offset:3072 lds
v_mfma_f32_16x16x32_bf16 v[68:71], a[84:87], a[68:71], v[68:71]
ds_read_b64_tr_b16 a[62:63], v20 offset:512
v_mfma_f32_16x16x32_bf16 v[100:103], a[84:87], a[72:75], v[100:103]
v_mfma_f32_16x16x32_bf16 v[132:135], a[84:87], a[76:79], v[132:135]
v_mfma_f32_16x16x32_bf16 v[40:43], a[88:91], a[64:67], v[40:43]
s_add_u32 s85, s98, 37888
v_mfma_f32_16x16x32_bf16 v[72:75], a[88:91], a[68:71], v[72:75]
buffer_store_dwordx4 v[204:207], v1, s[56:59], s85 offen sc1
v_mfma_f32_16x16x32_bf16 v[104:107], a[88:91], a[72:75], v[104:107]
v_mfma_f32_16x16x32_bf16 v[136:139], a[88:91], a[76:79], v[136:139]
v_mfma_f32_16x16x32_bf16 v[44:47], a[92:95], a[64:67], v[44:47]
v_mfma_f32_16x16x32_bf16 v[76:79], a[92:95], a[68:71], v[76:79]
v_mfma_f32_16x16x32_bf16 v[108:111], a[92:95], a[72:75], v[108:111]
v_mfma_f32_16x16x32_bf16 v[140:143], a[92:95], a[76:79], v[140:143]
s_waitcnt lgkmcnt(0)
v_mfma_f32_16x16x32_bf16 a[144:147], a[48:51], a[0:3], a[144:147]
s_waitcnt vmcnt(24)
v_mfma_f32_16x16x32_bf16 a[160:163], a[48:51], a[4:7], a[160:163]
s_barrier
v_mfma_f32_16x16x32_bf16 a[176:179], a[48:51], a[8:11], a[176:179]
s_add_u32 m0, s88, 0
ds_read_b128 a[64:67], v6 offset:0
v_mfma_f32_16x16x32_bf16 a[192:195], a[48:51], a[12:15], a[192:195]
s_mov_b32 s84, 3145728
ds_read_b64_tr_b16 a[80:81], v9 offset:16384
v_mfma_f32_16x16x32_bf16 a[148:151], a[52:55], a[0:3], a[148:151]
buffer_load_dwordx4 v3, s[48:51], s84 offen offset:0 lds
v_mfma_f32_16x16x32_bf16 a[164:167], a[52:55], a[4:7], a[164:167]
ds_read_b64_tr_b16 a[82:83], v9 offset:17408
v_mfma_f32_16x16x32_bf16 a[180:183], a[52:55], a[8:11], a[180:183]
s_mov_b32 s84, 3177472
ds_read_b64_tr_b16 a[84:85], v10 offset:16384
v_mfma_f32_16x16x32_bf16 a[196:199], a[52:55], a[12:15], a[196:199]
buffer_load_dwordx4 v3, s[48:51], s84 offen offset:1024 lds
v_mfma_f32_16x16x32_bf16 a[152:155], a[56:59], a[0:3], a[152:155]
ds_read_b64_tr_b16 a[86:87], v10 offset:17408
v_mfma_f32_16x16x32_bf16 a[168:171], a[56:59], a[4:7], a[168:171]
ds_read_b64_tr_b16 a[88:89], v11 offset:16384
v_mfma_f32_16x16x32_bf16 a[184:187], a[56:59], a[8:11], a[184:187]
ds_read_b64_tr_b16 a[90:91], v11 offset:17408
v_mfma_f32_16x16x32_bf16 a[200:203], a[56:59], a[12:15], a[200:203]
s_add_u32 m0, s89, 0
ds_read_b128 a[68:71], v6 offset:2048
v_mfma_f32_16x16x32_bf16 a[156:159], a[60:63], a[0:3], a[156:159]
s_mov_b32 s84, 1327104
ds_read_b64_tr_b16 a[92:93], v12 offset:16384
v_mfma_f32_16x16x32_bf16 a[172:175], a[60:63], a[4:7], a[172:175]
buffer_load_dwordx4 v4, s[52:55], s84 offen lds
v_mfma_f32_16x16x32_bf16 a[188:191], a[60:63], a[8:11], a[188:191]
ds_read_b64_tr_b16 a[94:95], v12 offset:17408
v_mfma_f32_16x16x32_bf16 a[204:207], a[60:63], a[12:15], a[204:207]
ds_read_b64_tr_b16 a[96:97], v13 offset:16384
v_mfma_f32_16x16x32_bf16 v[48:51], a[32:35], a[0:3], v[48:51]
s_add_u32 s85, s99, 32768
ds_read_b64_tr_b16 a[98:99], v13 offset:17408
v_mfma_f32_16x16x32_bf16 v[80:83], a[32:35], a[4:7], v[80:83]
buffer_store_dwordx4 v[208:211], v1, s[56:59], s85 offen sc1
v_mfma_f32_16x16x32_bf16 v[112:115], a[32:35], a[8:11], v[112:115]
ds_read_b64_tr_b16 a[100:101], v14 offset:16384
v_mfma_f32_16x16x32_bf16 a[128:131], a[32:35], a[12:15], a[128:131]
ds_read_b64_tr_b16 a[102:103], v14 offset:17408
v_mfma_f32_16x16x32_bf16 v[52:55], a[36:39], a[0:3], v[52:55]
ds_read_b128 a[72:75], v6 offset:4096
v_mfma_f32_16x16x32_bf16 v[84:87], a[36:39], a[4:7], v[84:87]
s_add_u32 m0, s86, 69632
ds_read_b64_tr_b16 a[104:105], v15 offset:16384
v_mfma_f32_16x16x32_bf16 v[116:119], a[36:39], a[8:11], v[116:119]
s_add_u32 s84, s96, 768
ds_read_b64_tr_b16 a[106:107], v15 offset:17408
v_mfma_f32_16x16x32_bf16 a[132:135], a[36:39], a[12:15], a[132:135]
buffer_load_dwordx4 v2, s[44:47], s84 offen offset:0 lds
v_mfma_f32_16x16x32_bf16 v[56:59], a[40:43], a[0:3], v[56:59]
ds_read_b64_tr_b16 a[108:109], v16 offset:16384
v_mfma_f32_16x16x32_bf16 v[88:91], a[40:43], a[4:7], v[88:91]
s_add_u32 s84, s96, 9984
ds_read_b64_tr_b16 a[110:111], v16 offset:17408
v_mfma_f32_16x16x32_bf16 v[120:123], a[40:43], a[8:11], v[120:123]
buffer_load_dwordx4 v2, s[44:47], s84 offen offset:1024 lds
v_mfma_f32_16x16x32_bf16 a[136:139], a[40:43], a[12:15], a[136:139]
ds_read_b64_tr_b16 a[112:113], v17 offset:16384
v_mfma_f32_16x16x32_bf16 v[60:63], a[44:47], a[0:3], v[60:63]
ds_read_b64_tr_b16 a[114:115], v17 offset:16896
v_mfma_f32_16x16x32_bf16 v[92:95], a[44:47], a[4:7], v[92:95]
ds_read_b128 a[76:79], v6 offset:6144
v_mfma_f32_16x16x32_bf16 v[124:127], a[44:47], a[8:11], v[124:127]
s_add_u32 s84, s97, 4294966016
ds_read_b64_tr_b16 a[116:117], v18 offset:16384
v_mfma_f32_16x16x32_bf16 a[140:143], a[44:47], a[12:15], a[140:143]
buffer_load_dwordx4 v2, s[44:47], s84 offen offset:2048 lds
v_mfma_f32_16x16x32_bf16 v[32:35], a[16:19], a[0:3], v[32:35]
ds_read_b64_tr_b16 a[118:119], v18 offset:16896
v_mfma_f32_16x16x32_bf16 v[64:67], a[16:19], a[4:7], v[64:67]
ds_read_b64_tr_b16 a[120:121], v19 offset:16384
v_mfma_f32_16x16x32_bf16 v[96:99], a[16:19], a[8:11], v[96:99]
ds_read_b64_tr_b16 a[122:123], v19 offset:16896
v_mfma_f32_16x16x32_bf16 v[128:131], a[16:19], a[12:15], v[128:131]
s_add_u32 s84, s97, 7936
ds_read_b64_tr_b16 a[124:125], v20 offset:16384
v_mfma_f32_16x16x32_bf16 v[36:39], a[20:23], a[0:3], v[36:39]
buffer_load_dwordx4 v2, s[44:47], s84 offen offset:3072 lds
v_mfma_f32_16x16x32_bf16 v[68:71], a[20:23], a[4:7], v[68:71]
ds_read_b64_tr_b16 a[126:127], v20 offset:16896
v_mfma_f32_16x16x32_bf16 v[100:103], a[20:23], a[8:11], v[100:103]
v_mfma_f32_16x16x32_bf16 v[132:135], a[20:23], a[12:15], v[132:135]
v_mfma_f32_16x16x32_bf16 v[40:43], a[24:27], a[0:3], v[40:43]
s_add_u32 s85, s99, 33792
v_mfma_f32_16x16x32_bf16 v[72:75], a[24:27], a[4:7], v[72:75]
buffer_store_dwordx4 v[212:215], v1, s[56:59], s85 offen sc1
v_mfma_f32_16x16x32_bf16 v[104:107], a[24:27], a[8:11], v[104:107]
v_mfma_f32_16x16x32_bf16 v[136:139], a[24:27], a[12:15], v[136:139]
v_mfma_f32_16x16x32_bf16 v[44:47], a[28:31], a[0:3], v[44:47]
v_mfma_f32_16x16x32_bf16 v[76:79], a[28:31], a[4:7], v[76:79]
v_mfma_f32_16x16x32_bf16 v[108:111], a[28:31], a[8:11], v[108:111]
v_mfma_f32_16x16x32_bf16 v[140:143], a[28:31], a[12:15], v[140:143]
s_waitcnt lgkmcnt(0)
v_mfma_f32_16x16x32_bf16 a[144:147], a[112:115], a[64:67], a[144:147]
s_waitcnt vmcnt(19)
v_mfma_f32_16x16x32_bf16 a[160:163], a[112:115], a[68:71], a[160:163]
s_barrier
v_mfma_f32_16x16x32_bf16 a[176:179], a[112:115], a[72:75], a[176:179]
s_add_u32 m0, s88, 16384
ds_read_b128 a[0:3], v5 offset:32768
v_mfma_f32_16x16x32_bf16 a[192:195], a[112:115], a[76:79], a[192:195]
s_mov_b32 s84, 3407872
ds_read_b64_tr_b16 a[16:17], v9 offset:32768
v_mfma_f32_16x16x32_bf16 a[148:151], a[116:119], a[64:67], a[148:151]
buffer_load_dwordx4 v3, s[48:51], s84 offen offset:0 lds
v_mfma_f32_16x16x32_bf16 a[164:167], a[116:119], a[68:71], a[164:167]
ds_read_b64_tr_b16 a[18:19], v9 offset:33792
v_mfma_f32_16x16x32_bf16 a[180:183], a[116:119], a[72:75], a[180:183]
s_mov_b32 s84, 3439616
ds_read_b64_tr_b16 a[20:21], v10 offset:32768
v_mfma_f32_16x16x32_bf16 a[196:199], a[116:119], a[76:79], a[196:199]
buffer_load_dwordx4 v3, s[48:51], s84 offen offset:1024 lds
v_mfma_f32_16x16x32_bf16 a[152:155], a[120:123], a[64:67], a[152:155]
ds_read_b64_tr_b16 a[22:23], v10 offset:33792
v_mfma_f32_16x16x32_bf16 a[168:171], a[120:123], a[68:71], a[168:171]
ds_read_b64_tr_b16 a[24:25], v11 offset:32768
v_mfma_f32_16x16x32_bf16 a[184:187], a[120:123], a[72:75], a[184:187]
ds_read_b64_tr_b16 a[26:27], v11 offset:33792
v_mfma_f32_16x16x32_bf16 a[200:203], a[120:123], a[76:79], a[200:203]
s_add_u32 m0, s89, 16384
ds_read_b128 a[4:7], v5 offset:34816
v_mfma_f32_16x16x32_bf16 a[156:159], a[124:127], a[64:67], a[156:159]
s_mov_b32 s84, 1437696
ds_read_b64_tr_b16 a[28:29], v12 offset:32768
v_mfma_f32_16x16x32_bf16 a[172:175], a[124:127], a[68:71], a[172:175]
buffer_load_dwordx4 v4, s[52:55], s84 offen lds
v_mfma_f32_16x16x32_bf16 a[188:191], a[124:127], a[72:75], a[188:191]
ds_read_b64_tr_b16 a[30:31], v12 offset:33792
v_mfma_f32_16x16x32_bf16 a[204:207], a[124:127], a[76:79], a[204:207]
ds_read_b64_tr_b16 a[32:33], v13 offset:32768
v_mfma_f32_16x16x32_bf16 v[48:51], a[96:99], a[64:67], v[48:51]
s_add_u32 s85, s99, 34816
ds_read_b64_tr_b16 a[34:35], v13 offset:33792
v_mfma_f32_16x16x32_bf16 v[80:83], a[96:99], a[68:71], v[80:83]
buffer_store_dwordx4 v[216:219], v1, s[56:59], s85 offen sc1
v_mfma_f32_16x16x32_bf16 v[112:115], a[96:99], a[72:75], v[112:115]
ds_read_b64_tr_b16 a[36:37], v14 offset:32768
v_mfma_f32_16x16x32_bf16 a[128:131], a[96:99], a[76:79], a[128:131]
ds_read_b64_tr_b16 a[38:39], v14 offset:33792
v_mfma_f32_16x16x32_bf16 v[52:55], a[100:103], a[64:67], v[52:55]
ds_read_b128 a[8:11], v5 offset:36864
v_mfma_f32_16x16x32_bf16 v[84:87], a[100:103], a[68:71], v[84:87]
s_add_u32 m0, s86, 0
ds_read_b64_tr_b16 a[40:41], v15 offset:32768
v_mfma_f32_16x16x32_bf16 v[116:119], a[100:103], a[72:75], v[116:119]
s_add_u32 s84, s94, 896
ds_read_b64_tr_b16 a[42:43], v15 offset:33792
v_mfma_f32_16x16x32_bf16 a[132:135], a[100:103], a[76:79], a[132:135]
buffer_load_dwordx4 v2, s[44:47], s84 offen offset:0 lds
v_mfma_f32_16x16x32_bf16 v[56:59], a[104:107], a[64:67], v[56:59]
ds_read_b64_tr_b16 a[44:45], v16 offset:32768
v_mfma_f32_16x16x32_bf16 v[88:91], a[104:107], a[68:71], v[88:91]
s_add_u32 s84, s94, 10112
ds_read_b64_tr_b16 a[46:47], v16 offset:33792
v_mfma_f32_16x16x32_bf16 v[120:123], a[104:107], a[72:75], v[120:123]
buffer_load_dwordx4 v2, s[44:47], s84 offen offset:1024 lds
v_mfma_f32_16x16x32_bf16 a[136:139], a[104:107], a[76:79], a[136:139]
ds_read_b64_tr_b16 a[48:49], v17 offset:32768
v_mfma_f32_16x16x32_bf16 v[60:63], a[108:111], a[64:67], v[60:63]
ds_read_b64_tr_b16 a[50:51], v17 offset:33280
v_mfma_f32_16x16x32_bf16 v[92:95], a[108:111], a[68:71], v[92:95]
ds_read_b128 a[12:15], v5 offset:38912
v_mfma_f32_16x16x32_bf16 v[124:127], a[108:111], a[72:75], v[124:127]
s_add_u32 s84, s95, 4294966144
ds_read_b64_tr_b16 a[52:53], v18 offset:32768
v_mfma_f32_16x16x32_bf16 a[140:143], a[108:111], a[76:79], a[140:143]
buffer_load_dwordx4 v2, s[44:47], s84 offen offset:2048 lds
v_mfma_f32_16x16x32_bf16 v[32:35], a[80:83], a[64:67], v[32:35]
ds_read_b64_tr_b16 a[54:55], v18 offset:33280
v_mfma_f32_16x16x32_bf16 v[64:67], a[80:83], a[68:71], v[64:67]
ds_read_b64_tr_b16 a[56:57], v19 offset:32768
v_mfma_f32_16x16x32_bf16 v[96:99], a[80:83], a[72:75], v[96:99]
ds_read_b64_tr_b16 a[58:59], v19 offset:33280
v_mfma_f32_16x16x32_bf16 v[128:131], a[80:83], a[76:79], v[128:131]
s_add_u32 s84, s95, 8064
ds_read_b64_tr_b16 a[60:61], v20 offset:32768
v_mfma_f32_16x16x32_bf16 v[36:39], a[84:87], a[64:67], v[36:39]
buffer_load_dwordx4 v2, s[44:47], s84 offen offset:3072 lds
v_mfma_f32_16x16x32_bf16 v[68:71], a[84:87], a[68:71], v[68:71]
ds_read_b64_tr_b16 a[62:63], v20 offset:33280
v_mfma_f32_16x16x32_bf16 v[100:103], a[84:87], a[72:75], v[100:103]
v_mfma_f32_16x16x32_bf16 v[132:135], a[84:87], a[76:79], v[132:135]
v_mfma_f32_16x16x32_bf16 v[40:43], a[88:91], a[64:67], v[40:43]
s_add_u32 s85, s99, 35840
v_mfma_f32_16x16x32_bf16 v[72:75], a[88:91], a[68:71], v[72:75]
buffer_store_dwordx4 v[220:223], v1, s[56:59], s85 offen sc1
v_mfma_f32_16x16x32_bf16 v[104:107], a[88:91], a[72:75], v[104:107]
v_mfma_f32_16x16x32_bf16 v[136:139], a[88:91], a[76:79], v[136:139]
v_mfma_f32_16x16x32_bf16 v[44:47], a[92:95], a[64:67], v[44:47]
v_mfma_f32_16x16x32_bf16 v[76:79], a[92:95], a[68:71], v[76:79]
v_mfma_f32_16x16x32_bf16 v[108:111], a[92:95], a[72:75], v[108:111]
v_mfma_f32_16x16x32_bf16 v[140:143], a[92:95], a[76:79], v[140:143]
s_waitcnt lgkmcnt(0)
v_mfma_f32_16x16x32_bf16 a[144:147], a[48:51], a[0:3], a[144:147]
s_waitcnt vmcnt(24)
v_mfma_f32_16x16x32_bf16 a[160:163], a[48:51], a[4:7], a[160:163]
s_barrier
v_mfma_f32_16x16x32_bf16 a[176:179], a[48:51], a[8:11], a[176:179]
s_add_u32 m0, s88, 32768
ds_read_b128 a[64:67], v6 offset:32768
v_mfma_f32_16x16x32_bf16 a[192:195], a[48:51], a[12:15], a[192:195]
s_mov_b32 s84, 3670016
ds_read_b64_tr_b16 a[80:81], v9 offset:49152
v_mfma_f32_16x16x32_bf16 a[148:151], a[52:55], a[0:3], a[148:151]
buffer_load_dwordx4 v3, s[48:51], s84 offen offset:0 lds
v_mfma_f32_16x16x32_bf16 a[164:167], a[52:55], a[4:7], a[164:167]
ds_read_b64_tr_b16 a[82:83], v9 offset:50176
v_mfma_f32_16x16x32_bf16 a[180:183], a[52:55], a[8:11], a[180:183]
s_mov_b32 s84, 3701760
ds_read_b64_tr_b16 a[84:85], v10 offset:49152
v_mfma_f32_16x16x32_bf16 a[196:199], a[52:55], a[12:15], a[196:199]
buffer_load_dwordx4 v3, s[48:51], s84 offen offset:1024 lds
v_mfma_f32_16x16x32_bf16 a[152:155], a[56:59], a[0:3], a[152:155]
ds_read_b64_tr_b16 a[86:87], v10 offset:50176
v_mfma_f32_16x16x32_bf16 a[168:171], a[56:59], a[4:7], a[168:171]
ds_read_b64_tr_b16 a[88:89], v11 offset:49152
v_mfma_f32_16x16x32_bf16 a[184:187], a[56:59], a[8:11], a[184:187]
ds_read_b64_tr_b16 a[90:91], v11 offset:50176
v_mfma_f32_16x16x32_bf16 a[200:203], a[56:59], a[12:15], a[200:203]
s_add_u32 m0, s89, 32768
ds_read_b128 a[68:71], v6 offset:34816
v_mfma_f32_16x16x32_bf16 a[156:159], a[60:63], a[0:3], a[156:159]
s_mov_b32 s84, 1548288
ds_read_b64_tr_b16 a[92:93], v12 offset:49152
v_mfma_f32_16x16x32_bf16 a[172:175], a[60:63], a[4:7], a[172:175]
buffer_load_dwordx4 v4, s[52:55], s84 offen lds
v_mfma_f32_16x16x32_bf16 a[188:191], a[60:63], a[8:11], a[188:191]
ds_read_b64_tr_b16 a[94:95], v12 offset:50176
v_mfma_f32_16x16x32_bf16 a[204:207], a[60:63], a[12:15], a[204:207]
ds_read_b64_tr_b16 a[96:97], v13 offset:49152
v_mfma_f32_16x16x32_bf16 v[48:51], a[32:35], a[0:3], v[48:51]
s_add_u32 s85, s98, 49152
ds_read_b64_tr_b16 a[98:99], v13 offset:50176
v_mfma_f32_16x16x32_bf16 v[80:83], a[32:35], a[4:7], v[80:83]
buffer_store_dwordx4 v[224:227], v1, s[56:59], s85 offen sc1
v_mfma_f32_16x16x32_bf16 v[112:115], a[32:35], a[8:11], v[112:115]
ds_read_b64_tr_b16 a[100:101], v14 offset:49152
v_mfma_f32_16x16x32_bf16 a[128:131], a[32:35], a[12:15], a[128:131]
ds_read_b64_tr_b16 a[102:103], v14 offset:50176
v_mfma_f32_16x16x32_bf16 v[52:55], a[36:39], a[0:3], v[52:55]
ds_read_b128 a[72:75], v6 offset:36864
v_mfma_f32_16x16x32_bf16 v[84:87], a[36:39], a[4:7], v[84:87]
s_add_u32 m0, s86, 4096
ds_read_b64_tr_b16 a[104:105], v15 offset:49152
v_mfma_f32_16x16x32_bf16 v[116:119], a[36:39], a[8:11], v[116:119]
s_add_u32 s84, s96, 896
ds_read_b64_tr_b16 a[106:107], v15 offset:50176
v_mfma_f32_16x16x32_bf16 a[132:135], a[36:39], a[12:15], a[132:135]
buffer_load_dwordx4 v2, s[44:47], s84 offen offset:0 lds
v_mfma_f32_16x16x32_bf16 v[56:59], a[40:43], a[0:3], v[56:59]
ds_read_b64_tr_b16 a[108:109], v16 offset:49152
v_mfma_f32_16x16x32_bf16 v[88:91], a[40:43], a[4:7], v[88:91]
s_add_u32 s84, s96, 10112
ds_read_b64_tr_b16 a[110:111], v16 offset:50176
v_mfma_f32_16x16x32_bf16 v[120:123], a[40:43], a[8:11], v[120:123]
buffer_load_dwordx4 v2, s[44:47], s84 offen offset:1024 lds
v_mfma_f32_16x16x32_bf16 a[136:139], a[40:43], a[12:15], a[136:139]
ds_read_b64_tr_b16 a[112:113], v17 offset:49152
v_mfma_f32_16x16x32_bf16 v[60:63], a[44:47], a[0:3], v[60:63]
ds_read_b64_tr_b16 a[114:115], v17 offset:49664
v_mfma_f32_16x16x32_bf16 v[92:95], a[44:47], a[4:7], v[92:95]
ds_read_b128 a[76:79], v6 offset:38912
v_mfma_f32_16x16x32_bf16 v[124:127], a[44:47], a[8:11], v[124:127]
s_add_u32 s84, s97, 4294966144
ds_read_b64_tr_b16 a[116:117], v18 offset:49152
v_mfma_f32_16x16x32_bf16 a[140:143], a[44:47], a[12:15], a[140:143]
buffer_load_dwordx4 v2, s[44:47], s84 offen offset:2048 lds
v_mfma_f32_16x16x32_bf16 v[32:35], a[16:19], a[0:3], v[32:35]
ds_read_b64_tr_b16 a[118:119], v18 offset:49664
v_mfma_f32_16x16x32_bf16 v[64:67], a[16:19], a[4:7], v[64:67]
ds_read_b64_tr_b16 a[120:121], v19 offset:49152
v_mfma_f32_16x16x32_bf16 v[96:99], a[16:19], a[8:11], v[96:99]
ds_read_b64_tr_b16 a[122:123], v19 offset:49664
v_mfma_f32_16x16x32_bf16 v[128:131], a[16:19], a[12:15], v[128:131]
s_add_u32 s84, s97, 8064
ds_read_b64_tr_b16 a[124:125], v20 offset:49152
v_mfma_f32_16x16x32_bf16 v[36:39], a[20:23], a[0:3], v[36:39]
buffer_load_dwordx4 v2, s[44:47], s84 offen offset:3072 lds
v_mfma_f32_16x16x32_bf16 v[68:71], a[20:23], a[4:7], v[68:71]
ds_read_b64_tr_b16 a[126:127], v20 offset:49664
v_mfma_f32_16x16x32_bf16 v[100:103], a[20:23], a[8:11], v[100:103]
v_mfma_f32_16x16x32_bf16 v[132:135], a[20:23], a[12:15], v[132:135]
v_mfma_f32_16x16x32_bf16 v[40:43], a[24:27], a[0:3], v[40:43]
s_add_u32 s85, s98, 50176
v_mfma_f32_16x16x32_bf16 v[72:75], a[24:27], a[4:7], v[72:75]
buffer_store_dwordx4 v[228:231], v1, s[56:59], s85 offen sc1
v_mfma_f32_16x16x32_bf16 v[104:107], a[24:27], a[8:11], v[104:107]
v_mfma_f32_16x16x32_bf16 v[136:139], a[24:27], a[12:15], v[136:139]
v_mfma_f32_16x16x32_bf16 v[44:47], a[28:31], a[0:3], v[44:47]
v_mfma_f32_16x16x32_bf16 v[76:79], a[28:31], a[4:7], v[76:79]
v_mfma_f32_16x16x32_bf16 v[108:111], a[28:31], a[8:11], v[108:111]
v_mfma_f32_16x16x32_bf16 v[140:143], a[28:31], a[12:15], v[140:143]
s_waitcnt lgkmcnt(0)
v_mfma_f32_16x16x32_bf16 a[144:147], a[112:115], a[64:67], a[144:147]
s_waitcnt vmcnt(19)
v_mfma_f32_16x16x32_bf16 a[160:163], a[112:115], a[68:71], a[160:163]
s_barrier
v_mfma_f32_16x16x32_bf16 a[176:179], a[112:115], a[72:75], a[176:179]
s_add_u32 m0, s88, 49152
ds_read_b128 a[0:3], v7 offset:0
v_mfma_f32_16x16x32_bf16 a[192:195], a[112:115], a[76:79], a[192:195]
s_mov_b32 s84, 3932160
ds_read_b64_tr_b16 a[16:17], v9 offset:0
v_mfma_f32_16x16x32_bf16 a[148:151], a[116:119], a[64:67], a[148:151]
buffer_load_dwordx4 v3, s[48:51], s84 offen offset:0 lds
v_mfma_f32_16x16x32_bf16 a[164:167], a[116:119], a[68:71], a[164:167]
ds_read_b64_tr_b16 a[18:19], v9 offset:1024
v_mfma_f32_16x16x32_bf16 a[180:183], a[116:119], a[72:75], a[180:183]
s_mov_b32 s84, 3963904
ds_read_b64_tr_b16 a[20:21], v10 offset:0
v_mfma_f32_16x16x32_bf16 a[196:199], a[116:119], a[76:79], a[196:199]
buffer_load_dwordx4 v3, s[48:51], s84 offen offset:1024 lds
v_mfma_f32_16x16x32_bf16 a[152:155], a[120:123], a[64:67], a[152:155]
ds_read_b64_tr_b16 a[22:23], v10 offset:1024
v_mfma_f32_16x16x32_bf16 a[168:171], a[120:123], a[68:71], a[168:171]
ds_read_b64_tr_b16 a[24:25], v11 offset:0
v_mfma_f32_16x16x32_bf16 a[184:187], a[120:123], a[72:75], a[184:187]
ds_read_b64_tr_b16 a[26:27], v11 offset:1024
v_mfma_f32_16x16x32_bf16 a[200:203], a[120:123], a[76:79], a[200:203]
s_add_u32 m0, s89, 49152
ds_read_b128 a[4:7], v7 offset:2048
v_mfma_f32_16x16x32_bf16 a[156:159], a[124:127], a[64:67], a[156:159]
s_mov_b32 s84, 1658880
ds_read_b64_tr_b16 a[28:29], v12 offset:0
v_mfma_f32_16x16x32_bf16 a[172:175], a[124:127], a[68:71], a[172:175]
buffer_load_dwordx4 v4, s[52:55], s84 offen lds
v_mfma_f32_16x16x32_bf16 a[188:191], a[124:127], a[72:75], a[188:191]
ds_read_b64_tr_b16 a[30:31], v12 offset:1024
v_mfma_f32_16x16x32_bf16 a[204:207], a[124:127], a[76:79], a[204:207]
ds_read_b64_tr_b16 a[32:33], v13 offset:0
v_mfma_f32_16x16x32_bf16 v[48:51], a[96:99], a[64:67], v[48:51]
s_add_u32 s85, s98, 53248
ds_read_b64_tr_b16 a[34:35], v13 offset:1024
v_mfma_f32_16x16x32_bf16 v[80:83], a[96:99], a[68:71], v[80:83]
buffer_store_dwordx4 v[232:235], v1, s[56:59], s85 offen sc1
v_mfma_f32_16x16x32_bf16 v[112:115], a[96:99], a[72:75], v[112:115]
ds_read_b64_tr_b16 a[36:37], v14 offset:0
v_mfma_f32_16x16x32_bf16 a[128:131], a[96:99], a[76:79], a[128:131]
ds_read_b64_tr_b16 a[38:39], v14 offset:1024
v_mfma_f32_16x16x32_bf16 v[52:55], a[100:103], a[64:67], v[52:55]
ds_read_b128 a[8:11], v7 offset:4096
v_mfma_f32_16x16x32_bf16 v[84:87], a[100:103], a[68:71], v[84:87]
s_add_u32 m0, s86, 32768
ds_read_b64_tr_b16 a[40:41], v15 offset:0
v_mfma_f32_16x16x32_bf16 v[116:119], a[100:103], a[72:75], v[116:119]
s_add_u32 s84, s94, 1024
ds_read_b64_tr_b16 a[42:43], v15 offset:1024
v_mfma_f32_16x16x32_bf16 a[132:135], a[100:103], a[76:79], a[132:135]
buffer_load_dwordx4 v2, s[44:47], s84 offen offset:0 lds
v_mfma_f32_16x16x32_bf16 v[56:59], a[104:107], a[64:67], v[56:59]
ds_read_b64_tr_b16 a[44:45], v16 offset:0
v_mfma_f32_16x16x32_bf16 v[88:91], a[104:107], a[68:71], v[88:91]
s_add_u32 s84, s94, 10240
ds_read_b64_tr_b16 a[46:47], v16 offset:1024
v_mfma_f32_16x16x32_bf16 v[120:123], a[104:107], a[72:75], v[120:123]
buffer_load_dwordx4 v2, s[44:47], s84 offen offset:1024 lds
v_mfma_f32_16x16x32_bf16 a[136:139], a[104:107], a[76:79], a[136:139]
ds_read_b64_tr_b16 a[48:49], v17 offset:0
v_mfma_f32_16x16x32_bf16 v[60:63], a[108:111], a[64:67], v[60:63]
ds_read_b64_tr_b16 a[50:51], v17 offset:512
v_mfma_f32_16x16x32_bf16 v[92:95], a[108:111], a[68:71], v[92:95]
ds_read_b128 a[12:15], v7 offset:6144
v_mfma_f32_16x16x32_bf16 v[124:127], a[108:111], a[72:75], v[124:127]
s_add_u32 s84, s95, 4294966272
ds_read_b64_tr_b16 a[52:53], v18 offset:0
v_mfma_f32_16x16x32_bf16 a[140:143], a[108:111], a[76:79], a[140:143]
buffer_load_dwordx4 v2, s[44:47], s84 offen offset:2048 lds
v_mfma_f32_16x16x32_bf16 v[32:35], a[80:83], a[64:67], v[32:35]
ds_read_b64_tr_b16 a[54:55], v18 offset:512
v_mfma_f32_16x16x32_bf16 v[64:67], a[80:83], a[68:71], v[64:67]
ds_read_b64_tr_b16 a[56:57], v19 offset:0
v_mfma_f32_16x16x32_bf16 v[96:99], a[80:83], a[72:75], v[96:99]
ds_read_b64_tr_b16 a[58:59], v19 offset:512
v_mfma_f32_16x16x32_bf16 v[128:131], a[80:83], a[76:79], v[128:131]
s_add_u32 s84, s95, 8192
ds_read_b64_tr_b16 a[60:61], v20 offset:0
v_mfma_f32_16x16x32_bf16 v[36:39], a[84:87], a[64:67], v[36:39]
buffer_load_dwordx4 v2, s[44:47], s84 offen offset:3072 lds
v_mfma_f32_16x16x32_bf16 v[68:71], a[84:87], a[68:71], v[68:71]
ds_read_b64_tr_b16 a[62:63], v20 offset:512
v_mfma_f32_16x16x32_bf16 v[100:103], a[84:87], a[72:75], v[100:103]
v_mfma_f32_16x16x32_bf16 v[132:135], a[84:87], a[76:79], v[132:135]
v_mfma_f32_16x16x32_bf16 v[40:43], a[88:91], a[64:67], v[40:43]
s_add_u32 s85, s98, 54272
v_mfma_f32_16x16x32_bf16 v[72:75], a[88:91], a[68:71], v[72:75]
buffer_store_dwordx4 v[236:239], v1, s[56:59], s85 offen sc1
v_mfma_f32_16x16x32_bf16 v[104:107], a[88:91], a[72:75], v[104:107]
v_mfma_f32_16x16x32_bf16 v[136:139], a[88:91], a[76:79], v[136:139]
v_mfma_f32_16x16x32_bf16 v[44:47], a[92:95], a[64:67], v[44:47]
v_mfma_f32_16x16x32_bf16 v[76:79], a[92:95], a[68:71], v[76:79]
v_mfma_f32_16x16x32_bf16 v[108:111], a[92:95], a[72:75], v[108:111]
v_mfma_f32_16x16x32_bf16 v[140:143], a[92:95], a[76:79], v[140:143]
s_waitcnt lgkmcnt(0)
v_mfma_f32_16x16x32_bf16 a[144:147], a[48:51], a[0:3], a[144:147]
s_waitcnt vmcnt(24)
v_mfma_f32_16x16x32_bf16 a[160:163], a[48:51], a[4:7], a[160:163]
s_barrier
v_mfma_f32_16x16x32_bf16 a[176:179], a[48:51], a[8:11], a[176:179]
s_add_u32 m0, s88, 0
ds_read_b128 a[64:67], v8 offset:0
v_lshrrev_b32 v24, 4, v0
v_mfma_f32_16x16x32_bf16 a[192:195], a[48:51], a[12:15], a[192:195]
s_mov_b32 s84, 4194304
ds_read_b64_tr_b16 a[80:81], v9 offset:16384
v_lshlrev_b32 v25, 1, v24
v_mfma_f32_16x16x32_bf16 a[148:151], a[52:55], a[0:3], a[148:151]
buffer_load_dwordx4 v3, s[48:51], s84 offen offset:0 lds
v_mfma_f32_16x16x32_bf16 a[164:167], a[52:55], a[4:7], a[164:167]
ds_read_b64_tr_b16 a[82:83], v9 offset:17408
v_and_b32 v26, 15, v0
v_mfma_f32_16x16x32_bf16 a[180:183], a[52:55], a[8:11], a[180:183]
s_mov_b32 s84, 4226048
ds_read_b64_tr_b16 a[84:85], v10 offset:16384
v_xor_b32 v25, v25, v26
v_mfma_f32_16x16x32_bf16 a[196:199], a[52:55], a[12:15], a[196:199]
buffer_load_dwordx4 v3, s[48:51], s84 offen offset:1024 lds
v_mfma_f32_16x16x32_bf16 a[152:155], a[56:59], a[0:3], a[152:155]
s_lshl_b32 s80, s76, 3
ds_read_b64_tr_b16 a[86:87], v10 offset:17408
v_add_u32 v24, s80, v24
v_mfma_f32_16x16x32_bf16 a[168:171], a[56:59], a[4:7], a[168:171]
ds_read_b64_tr_b16 a[88:89], v11 offset:16384
v_mul_u32_u24 v24, 1280, v24
v_mfma_f32_16x16x32_bf16 a[184:187], a[56:59], a[8:11], a[184:187]
ds_read_b64_tr_b16 a[90:91], v11 offset:17408
v_lshl_add_u32 v22, v25, 4, v24
v_mfma_f32_16x16x32_bf16 a[200:203], a[56:59], a[12:15], a[200:203]
s_add_u32 m0, s89, 0
ds_read_b128 a[68:71], v8 offset:2048
v_xor_b32 v25, 8, v25
v_mfma_f32_16x16x32_bf16 a[156:159], a[60:63], a[0:3], a[156:159]
s_mov_b32 s84, 1769472
ds_read_b64_tr_b16 a[92:93], v12 offset:16384
v_lshl_add_u32 v23, v25, 4, v24
v_mfma_f32_16x16x32_bf16 a[172:175], a[60:63], a[4:7], a[172:175]
buffer_load_dwordx4 v4, s[52:55], s84 offen lds
v_mfma_f32_16x16x32_bf16 a[188:191], a[60:63], a[8:11], a[188:191]
ds_read_b64_tr_b16 a[94:95], v12 offset:17408
v_add_u32 v23, 4096, v23
v_mfma_f32_16x16x32_bf16 a[204:207], a[60:63], a[12:15], a[204:207]
ds_read_b64_tr_b16 a[96:97], v13 offset:16384
v_mfma_f32_16x16x32_bf16 v[48:51], a[32:35], a[0:3], v[48:51]
s_add_u32 s85, s99, 49152
ds_read_b64_tr_b16 a[98:99], v13 offset:17408
v_mfma_f32_16x16x32_bf16 v[80:83], a[32:35], a[4:7], v[80:83]
buffer_store_dwordx4 v[240:243], v1, s[56:59], s85 offen sc1
v_mfma_f32_16x16x32_bf16 v[112:115], a[32:35], a[8:11], v[112:115]
ds_read_b64_tr_b16 a[100:101], v14 offset:16384
v_mfma_f32_16x16x32_bf16 a[128:131], a[32:35], a[12:15], a[128:131]
ds_read_b64_tr_b16 a[102:103], v14 offset:17408
v_mfma_f32_16x16x32_bf16 v[52:55], a[36:39], a[0:3], v[52:55]
ds_read_b128 a[72:75], v8 offset:4096
v_mfma_f32_16x16x32_bf16 v[84:87], a[36:39], a[4:7], v[84:87]
s_add_u32 m0, s86, 36864
ds_read_b64_tr_b16 a[104:105], v15 offset:16384
v_mfma_f32_16x16x32_bf16 v[116:119], a[36:39], a[8:11], v[116:119]
s_add_u32 s84, s96, 1024
ds_read_b64_tr_b16 a[106:107], v15 offset:17408
v_mfma_f32_16x16x32_bf16 a[132:135], a[36:39], a[12:15], a[132:135]
buffer_load_dwordx4 v2, s[44:47], s84 offen offset:0 lds
v_mfma_f32_16x16x32_bf16 v[56:59], a[40:43], a[0:3], v[56:59]
ds_read_b64_tr_b16 a[108:109], v16 offset:16384
v_mfma_f32_16x16x32_bf16 v[88:91], a[40:43], a[4:7], v[88:91]
s_add_u32 s84, s96, 10240
ds_read_b64_tr_b16 a[110:111], v16 offset:17408
v_mfma_f32_16x16x32_bf16 v[120:123], a[40:43], a[8:11], v[120:123]
buffer_load_dwordx4 v2, s[44:47], s84 offen offset:1024 lds
v_mfma_f32_16x16x32_bf16 a[136:139], a[40:43], a[12:15], a[136:139]
ds_read_b64_tr_b16 a[112:113], v17 offset:16384
v_mfma_f32_16x16x32_bf16 v[60:63], a[44:47], a[0:3], v[60:63]
ds_read_b64_tr_b16 a[114:115], v17 offset:16896
v_mfma_f32_16x16x32_bf16 v[92:95], a[44:47], a[4:7], v[92:95]
ds_read_b128 a[76:79], v8 offset:6144
v_mfma_f32_16x16x32_bf16 v[124:127], a[44:47], a[8:11], v[124:127]
s_add_u32 s84, s97, 4294966272
ds_read_b64_tr_b16 a[116:117], v18 offset:16384
v_mfma_f32_16x16x32_bf16 a[140:143], a[44:47], a[12:15], a[140:143]
buffer_load_dwordx4 v2, s[44:47], s84 offen offset:2048 lds
v_mfma_f32_16x16x32_bf16 v[32:35], a[16:19], a[0:3], v[32:35]
ds_read_b64_tr_b16 a[118:119], v18 offset:16896
v_mfma_f32_16x16x32_bf16 v[64:67], a[16:19], a[4:7], v[64:67]
ds_read_b64_tr_b16 a[120:121], v19 offset:16384
v_mfma_f32_16x16x32_bf16 v[96:99], a[16:19], a[8:11], v[96:99]
ds_read_b64_tr_b16 a[122:123], v19 offset:16896
v_mfma_f32_16x16x32_bf16 v[128:131], a[16:19], a[12:15], v[128:131]
s_add_u32 s84, s97, 8192
ds_read_b64_tr_b16 a[124:125], v20 offset:16384
v_mfma_f32_16x16x32_bf16 v[36:39], a[20:23], a[0:3], v[36:39]
buffer_load_dwordx4 v2, s[44:47], s84 offen offset:3072 lds
v_mfma_f32_16x16x32_bf16 v[68:71], a[20:23], a[4:7], v[68:71]
ds_read_b64_tr_b16 a[126:127], v20 offset:16896
v_mfma_f32_16x16x32_bf16 v[100:103], a[20:23], a[8:11], v[100:103]
v_mfma_f32_16x16x32_bf16 v[132:135], a[20:23], a[12:15], v[132:135]
v_mfma_f32_16x16x32_bf16 v[40:43], a[24:27], a[0:3], v[40:43]
s_add_u32 s85, s99, 50176
v_mfma_f32_16x16x32_bf16 v[72:75], a[24:27], a[4:7], v[72:75]
buffer_store_dwordx4 v[244:247], v1, s[56:59], s85 offen sc1
v_mfma_f32_16x16x32_bf16 v[104:107], a[24:27], a[8:11], v[104:107]
v_mfma_f32_16x16x32_bf16 v[136:139], a[24:27], a[12:15], v[136:139]
v_mfma_f32_16x16x32_bf16 v[44:47], a[28:31], a[0:3], v[44:47]
v_mfma_f32_16x16x32_bf16 v[76:79], a[28:31], a[4:7], v[76:79]
v_mfma_f32_16x16x32_bf16 v[108:111], a[28:31], a[8:11], v[108:111]
v_mfma_f32_16x16x32_bf16 v[140:143], a[28:31], a[12:15], v[140:143]
s_waitcnt lgkmcnt(0)
v_mfma_f32_16x16x32_bf16 a[144:147], a[112:115], a[64:67], a[144:147]
s_waitcnt vmcnt(19)
v_mfma_f32_16x16x32_bf16 a[160:163], a[112:115], a[68:71], a[160:163]
s_barrier
v_mfma_f32_16x16x32_bf16 a[176:179], a[112:115], a[72:75], a[176:179]
s_add_u32 m0, s88, 16384
ds_read_b128 a[0:3], v5 offset:0
v_mfma_f32_16x16x32_bf16 a[192:195], a[112:115], a[76:79], a[192:195]
s_mov_b32 s84, 4456448
ds_read_b64_tr_b16 a[16:17], v9 offset:32768
v_mfma_f32_16x16x32_bf16 a[148:151], a[116:119], a[64:67], a[148:151]
buffer_load_dwordx4 v3, s[48:51], s84 offen offset:0 lds
v_mfma_f32_16x16x32_bf16 a[164:167], a[116:119], a[68:71], a[164:167]
s_getpc_b64 s[68:69]
L_pc_L_epi:
ds_read_b64_tr_b16 a[18:19], v9 offset:33792
v_mfma_f32_16x16x32_bf16 a[180:183], a[116:119], a[72:75], a[180:183]
s_mov_b32 s84, 4488192
ds_read_b64_tr_b16 a[20:21], v10 offset:32768
v_mfma_f32_16x16x32_bf16 a[196:199], a[116:119], a[76:79], a[196:199]
buffer_load_dwordx4 v3, s[48:51], s84 offen offset:1024 lds
v_mfma_f32_16x16x32_bf16 a[152:155], a[120:123], a[64:67], a[152:155]
s_add_u32 s68, s68, L_epi-L_pc_L_epi
s_addc_u32 s69, s69, 0
ds_read_b64_tr_b16 a[22:23], v10 offset:33792
v_mfma_f32_16x16x32_bf16 a[168:171], a[120:123], a[68:71], a[168:171]
s_and_b32 s69, s69, 0xffff
ds_read_b64_tr_b16 a[24:25], v11 offset:32768
v_mfma_f32_16x16x32_bf16 a[184:187], a[120:123], a[72:75], a[184:187]
s_mov_b32 s70, L_att_D2-L_epi
ds_read_b64_tr_b16 a[26:27], v11 offset:33792
v_mfma_f32_16x16x32_bf16 a[200:203], a[120:123], a[76:79], a[200:203]
s_add_u32 m0, s89, 16384
ds_read_b128 a[4:7], v5 offset:2048
v_mfma_f32_16x16x32_bf16 a[156:159], a[124:127], a[64:67], a[156:159]
s_mov_b32 s84, 1880064
ds_read_b64_tr_b16 a[28:29], v12 offset:32768
v_mfma_f32_16x16x32_bf16 a[172:175], a[124:127], a[68:71], a[172:175]
buffer_load_dwordx4 v4, s[52:55], s84 offen lds
v_mfma_f32_16x16x32_bf16 a[188:191], a[124:127], a[72:75], a[188:191]
s_mov_b32 s71, 0x20000
ds_read_b64_tr_b16 a[30:31], v12 offset:33792
v_lshlrev_b32 v31, 14, v0
v_mfma_f32_16x16x32_bf16 a[204:207], a[124:127], a[76:79], a[204:207]
s_lshr_b32 s80, s2, 3
ds_read_b64_tr_b16 a[32:33], v13 offset:32768
v_mfma_f32_16x16x32_bf16 v[48:51], a[96:99], a[64:67], v[48:51]
s_add_u32 s85, s99, 51200
ds_read_b64_tr_b16 a[34:35], v13 offset:33792
v_mfma_f32_16x16x32_bf16 v[80:83], a[96:99], a[68:71], v[80:83]
buffer_store_dwordx4 v[248:251], v1, s[56:59], s85 offen sc1
v_mfma_f32_16x16x32_bf16 v[112:115], a[96:99], a[72:75], v[112:115]
s_lshl_b32 s80, s80, 2
ds_read_b64_tr_b16 a[36:37], v14 offset:32768
v_mfma_f32_16x16x32_bf16 a[128:131], a[96:99], a[76:79], a[128:131]
s_add_u32 s80, s80, s76
ds_read_b64_tr_b16 a[38:39], v14 offset:33792
v_mfma_f32_16x16x32_bf16 v[52:55], a[100:103], a[64:67], v[52:55]
s_lshl_b32 s80, s80, 7
ds_read_b128 a[8:11], v5 offset:4096
v_mfma_f32_16x16x32_bf16 v[84:87], a[100:103], a[68:71], v[84:87]
s_add_u32 m0, s86, 65536
ds_read_b64_tr_b16 a[40:41], v15 offset:32768
v_mfma_f32_16x16x32_bf16 v[116:119], a[100:103], a[72:75], v[116:119]
s_add_u32 s84, s94, 1152
ds_read_b64_tr_b16 a[42:43], v15 offset:33792
v_mfma_f32_16x16x32_bf16 a[132:135], a[100:103], a[76:79], a[132:135]
buffer_load_dwordx4 v2, s[44:47], s84 offen offset:0 lds
v_mfma_f32_16x16x32_bf16 v[56:59], a[104:107], a[64:67], v[56:59]
ds_read_b64_tr_b16 a[44:45], v16 offset:32768
buffer_load_dword v30, v31, s[68:71], s80 offen
v_mfma_f32_16x16x32_bf16 v[88:91], a[104:107], a[68:71], v[88:91]
s_add_u32 s84, s94, 10368
ds_read_b64_tr_b16 a[46:47], v16 offset:33792
v_mfma_f32_16x16x32_bf16 v[120:123], a[104:107], a[72:75], v[120:123]
buffer_load_dwordx4 v2, s[44:47], s84 offen offset:1024 lds
v_mfma_f32_16x16x32_bf16 a[136:139], a[104:107], a[76:79], a[136:139]
ds_read_b64_tr_b16 a[48:49], v17 offset:32768
v_mfma_f32_16x16x32_bf16 v[60:63], a[108:111], a[64:67], v[60:63]
ds_read_b64_tr_b16 a[50:51], v17 offset:33280
v_mfma_f32_16x16x32_bf16 v[92:95], a[108:111], a[68:71], v[92:95]
ds_read_b128 a[12:15], v5 offset:6144
v_mfma_f32_16x16x32_bf16 v[124:127], a[108:111], a[72:75], v[124:127]
s_add_u32 s84, s95, 4294966400
ds_read_b64_tr_b16 a[52:53], v18 offset:32768
v_mfma_f32_16x16x32_bf16 a[140:143], a[108:111], a[76:79], a[140:143]
buffer_load_dwordx4 v2, s[44:47], s84 offen offset:2048 lds
v_mfma_f32_16x16x32_bf16 v[32:35], a[80:83], a[64:67], v[32:35]
ds_read_b64_tr_b16 a[54:55], v18 offset:33280
v_mfma_f32_16x16x32_bf16 v[64:67], a[80:83], a[68:71], v[64:67]
ds_read_b64_tr_b16 a[56:57], v19 offset:32768
v_mfma_f32_16x16x32_bf16 v[96:99], a[80:83], a[72:75], v[96:99]
ds_read_b64_tr_b16 a[58:59], v19 offset:33280
v_mfma_f32_16x16x32_bf16 v[128:131], a[80:83], a[76:79], v[128:131]
s_add_u32 s84, s95, 8320
ds_read_b64_tr_b16 a[60:61], v20 offset:32768
v_mfma_f32_16x16x32_bf16 v[36:39], a[84:87], a[64:67], v[36:39]
buffer_load_dwordx4 v2, s[44:47], s84 offen offset:3072 lds
v_mfma_f32_16x16x32_bf16 v[68:71], a[84:87], a[68:71], v[68:71]
ds_read_b64_tr_b16 a[62:63], v20 offset:33280
v_mfma_f32_16x16x32_bf16 v[100:103], a[84:87], a[72:75], v[100:103]
v_mfma_f32_16x16x32_bf16 v[132:135], a[84:87], a[76:79], v[132:135]
v_mfma_f32_16x16x32_bf16 v[40:43], a[88:91], a[64:67], v[40:43]
s_add_u32 s85, s99, 52224
v_mfma_f32_16x16x32_bf16 v[72:75], a[88:91], a[68:71], v[72:75]
buffer_store_dwordx4 v[252:255], v1, s[56:59], s85 offen sc1
v_mfma_f32_16x16x32_bf16 v[104:107], a[88:91], a[72:75], v[104:107]
v_mfma_f32_16x16x32_bf16 v[136:139], a[88:91], a[76:79], v[136:139]
v_mfma_f32_16x16x32_bf16 v[44:47], a[92:95], a[64:67], v[44:47]
v_mfma_f32_16x16x32_bf16 v[76:79], a[92:95], a[68:71], v[76:79]
v_mfma_f32_16x16x32_bf16 v[108:111], a[92:95], a[72:75], v[108:111]
v_mfma_f32_16x16x32_bf16 v[140:143], a[92:95], a[76:79], v[140:143]
s_waitcnt lgkmcnt(0)
v_mfma_f32_16x16x32_bf16 a[144:147], a[48:51], a[0:3], a[144:147]
s_waitcnt vmcnt(25)
v_mfma_f32_16x16x32_bf16 a[160:163], a[48:51], a[4:7], a[160:163]
s_barrier
v_mfma_f32_16x16x32_bf16 a[176:179], a[48:51], a[8:11], a[176:179]
s_add_u32 m0, s88, 32768
ds_read_b128 a[64:67], v6 offset:0
v_mfma_f32_16x16x32_bf16 a[192:195], a[48:51], a[12:15], a[192:195]
s_mov_b32 s84, 4718592
ds_read_b64_tr_b16 a[80:81], v9 offset:49152
v_mfma_f32_16x16x32_bf16 a[148:151], a[52:55], a[0:3], a[148:151]
buffer_load_dwordx4 v3, s[48:51], s84 offen offset:0 lds
v_mfma_f32_16x16x32_bf16 a[164:167], a[52:55], a[4:7], a[164:167]
s_lshl_b32 s79, s77, 7
ds_read_b64_tr_b16 a[82:83], v9 offset:50176
v_mfma_f32_16x16x32_bf16 a[180:183], a[52:55], a[8:11], a[180:183]
s_add_u32 s79, s79, 68222976
ds_read_b64_tr_b16 a[84:85], v10 offset:49152
v_mfma_f32_16x16x32_bf16 a[196:199], a[52:55], a[12:15], a[196:199]
s_add_u32 s81, s79, s3
ds_read_b64_tr_b16 a[86:87], v10 offset:50176
v_mov_b32 v27, 1
v_mfma_f32_16x16x32_bf16 a[152:155], a[56:59], a[0:3], a[152:155]
s_mov_b32 s84, 4750336
ds_read_b64_tr_b16 a[88:89], v11 offset:49152
v_mfma_f32_16x16x32_bf16 a[168:171], a[56:59], a[4:7], a[168:171]
buffer_load_dwordx4 v3, s[48:51], s84 offen offset:1024 lds
v_mfma_f32_16x16x32_bf16 a[184:187], a[56:59], a[8:11], a[184:187]
ds_read_b64_tr_b16 a[90:91], v11 offset:50176
v_mfma_f32_16x16x32_bf16 a[200:203], a[56:59], a[12:15], a[200:203]
ds_read_b128 a[68:71], v6 offset:2048
v_mfma_f32_16x16x32_bf16 a[156:159], a[60:63], a[0:3], a[156:159]
ds_read_b64_tr_b16 a[92:93], v12 offset:49152
v_mfma_f32_16x16x32_bf16 a[172:175], a[60:63], a[4:7], a[172:175]
ds_read_b64_tr_b16 a[94:95], v12 offset:50176
v_mfma_f32_16x16x32_bf16 a[188:191], a[60:63], a[8:11], a[188:191]
s_add_u32 m0, s89, 32768
ds_read_b64_tr_b16 a[96:97], v13 offset:49152
v_mfma_f32_16x16x32_bf16 a[204:207], a[60:63], a[12:15], a[204:207]
s_mov_b32 s84, 1990656
ds_read_b64_tr_b16 a[98:99], v13 offset:50176
v_mfma_f32_16x16x32_bf16 v[48:51], a[32:35], a[0:3], v[48:51]
buffer_load_dwordx4 v4, s[52:55], s84 offen lds
v_mfma_f32_16x16x32_bf16 v[80:83], a[32:35], a[4:7], v[80:83]
ds_read_b64_tr_b16 a[100:101], v14 offset:49152
v_mfma_f32_16x16x32_bf16 v[112:115], a[32:35], a[8:11], v[112:115]
ds_read_b64_tr_b16 a[102:103], v14 offset:50176
v_mfma_f32_16x16x32_bf16 a[128:131], a[32:35], a[12:15], a[128:131]
ds_read_b128 a[72:75], v6 offset:4096
v_mfma_f32_16x16x32_bf16 v[52:55], a[36:39], a[0:3], v[52:55]
s_add_u32 m0, s86, 69632
ds_read_b64_tr_b16 a[104:105], v15 offset:49152
v_mfma_f32_16x16x32_bf16 v[84:87], a[36:39], a[4:7], v[84:87]
s_add_u32 s84, s96, 1152
v_mfma_f32_16x16x32_bf16 v[116:119], a[36:39], a[8:11], v[116:119]
buffer_load_dwordx4 v2, s[44:47], s84 offen offset:0 lds
v_mfma_f32_16x16x32_bf16 a[132:135], a[36:39], a[12:15], a[132:135]
ds_read_b64_tr_b16 a[106:107], v15 offset:50176
v_mfma_f32_16x16x32_bf16 v[56:59], a[40:43], a[0:3], v[56:59]
ds_read_b64_tr_b16 a[108:109], v16 offset:49152
v_mfma_f32_16x16x32_bf16 v[88:91], a[40:43], a[4:7], v[88:91]
ds_read_b64_tr_b16 a[110:111], v16 offset:50176
v_mfma_f32_16x16x32_bf16 v[120:123], a[40:43], a[8:11], v[120:123]
s_add_u32 s84, s96, 10368
ds_read_b64_tr_b16 a[112:113], v17 offset:49152
v_mfma_f32_16x16x32_bf16 a[136:139], a[40:43], a[12:15], a[136:139]
buffer_load_dwordx4 v2, s[44:47], s84 offen offset:1024 lds
v_mfma_f32_16x16x32_bf16 v[60:63], a[44:47], a[0:3], v[60:63]
ds_read_b64_tr_b16 a[114:115], v17 offset:49664
v_mfma_f32_16x16x32_bf16 v[92:95], a[44:47], a[4:7], v[92:95]
ds_read_b128 a[76:79], v6 offset:6144
v_mfma_f32_16x16x32_bf16 v[124:127], a[44:47], a[8:11], v[124:127]
ds_read_b64_tr_b16 a[116:117], v18 offset:49152
v_mfma_f32_16x16x32_bf16 a[140:143], a[44:47], a[12:15], a[140:143]
ds_read_b64_tr_b16 a[118:119], v18 offset:49664
v_mfma_f32_16x16x32_bf16 v[32:35], a[16:19], a[0:3], v[32:35]
s_add_u32 s84, s97, 4294966400
ds_read_b64_tr_b16 a[120:121], v19 offset:49152
v_mfma_f32_16x16x32_bf16 v[64:67], a[16:19], a[4:7], v[64:67]
buffer_load_dwordx4 v2, s[44:47], s84 offen offset:2048 lds
v_mfma_f32_16x16x32_bf16 v[96:99], a[16:19], a[8:11], v[96:99]
ds_read_b64_tr_b16 a[122:123], v19 offset:49664
v_mfma_f32_16x16x32_bf16 v[128:131], a[16:19], a[12:15], v[128:131]
ds_read_b64_tr_b16 a[124:125], v20 offset:49152
v_mfma_f32_16x16x32_bf16 v[36:39], a[20:23], a[0:3], v[36:39]
ds_read_b64_tr_b16 a[126:127], v20 offset:49664
v_mfma_f32_16x16x32_bf16 v[68:71], a[20:23], a[4:7], v[68:71]
v_mfma_f32_16x16x32_bf16 v[100:103], a[20:23], a[8:11], v[100:103]
s_add_u32 s84, s97, 8320
v_mfma_f32_16x16x32_bf16 v[132:135], a[20:23], a[12:15], v[132:135]
buffer_load_dwordx4 v2, s[44:47], s84 offen offset:3072 lds
v_mfma_f32_16x16x32_bf16 v[40:43], a[24:27], a[0:3], v[40:43]
v_mfma_f32_16x16x32_bf16 v[72:75], a[24:27], a[4:7], v[72:75]
v_mfma_f32_16x16x32_bf16 v[104:107], a[24:27], a[8:11], v[104:107]
v_mfma_f32_16x16x32_bf16 v[136:139], a[24:27], a[12:15], v[136:139]
v_mfma_f32_16x16x32_bf16 v[44:47], a[28:31], a[0:3], v[44:47]
v_mfma_f32_16x16x32_bf16 v[76:79], a[28:31], a[4:7], v[76:79]
v_mfma_f32_16x16x32_bf16 v[108:111], a[28:31], a[8:11], v[108:111]
v_mfma_f32_16x16x32_bf16 v[140:143], a[28:31], a[12:15], v[140:143]
s_waitcnt lgkmcnt(0)
v_mfma_f32_16x16x32_bf16 a[144:147], a[112:115], a[64:67], a[144:147]
s_waitcnt vmcnt(7)
v_mfma_f32_16x16x32_bf16 a[160:163], a[112:115], a[68:71], a[160:163]
s_barrier
v_mfma_f32_16x16x32_bf16 a[176:179], a[112:115], a[72:75], a[176:179]
s_add_u32 m0, s88, 49152
ds_read_b128 a[0:3], v5 offset:32768
v_mfma_f32_16x16x32_bf16 a[192:195], a[112:115], a[76:79], a[192:195]
s_mov_b32 s84, 4980736
ds_read_b64_tr_b16 a[16:17], v9 offset:0
v_mfma_f32_16x16x32_bf16 a[148:151], a[116:119], a[64:67], a[148:151]
buffer_load_dwordx4 v3, s[48:51], s84 offen offset:0 lds
v_mfma_f32_16x16x32_bf16 a[164:167], a[116:119], a[68:71], a[164:167]
ds_read_b64_tr_b16 a[18:19], v9 offset:1024
buffer_atomic_add v27, v21, s[56:59], s81 offen sc1
v_mfma_f32_16x16x32_bf16 a[180:183], a[116:119], a[72:75], a[180:183]
ds_read_b64_tr_b16 a[20:21], v10 offset:0
v_accvgpr_read_b32 v176, a144
v_mfma_f32_16x16x32_bf16 a[196:199], a[116:119], a[76:79], a[196:199]
ds_read_b64_tr_b16 a[22:23], v10 offset:1024
v_accvgpr_read_b32 v177, a145
v_mfma_f32_16x16x32_bf16 a[152:155], a[120:123], a[64:67], a[152:155]
s_mov_b32 s84, 5012480
ds_read_b64_tr_b16 a[24:25], v11 offset:0
v_accvgpr_read_b32 v178, a146
v_mfma_f32_16x16x32_bf16 a[168:171], a[120:123], a[68:71], a[168:171]
buffer_load_dwordx4 v3, s[48:51], s84 offen offset:1024 lds
v_mfma_f32_16x16x32_bf16 a[184:187], a[120:123], a[72:75], a[184:187]
ds_read_b64_tr_b16 a[26:27], v11 offset:1024
v_accvgpr_read_b32 v179, a147
v_mfma_f32_16x16x32_bf16 a[200:203], a[120:123], a[76:79], a[200:203]
ds_read_b128 a[4:7], v5 offset:34816
v_accvgpr_read_b32 v180, a148
v_mfma_f32_16x16x32_bf16 a[156:159], a[124:127], a[64:67], a[156:159]
ds_read_b64_tr_b16 a[28:29], v12 offset:0
v_accvgpr_read_b32 v181, a149
v_mfma_f32_16x16x32_bf16 a[172:175], a[124:127], a[68:71], a[172:175]
ds_read_b64_tr_b16 a[30:31], v12 offset:1024
v_accvgpr_read_b32 v182, a150
v_mfma_f32_16x16x32_bf16 a[188:191], a[124:127], a[72:75], a[188:191]
s_add_u32 m0, s89, 49152
ds_read_b64_tr_b16 a[32:33], v13 offset:0
v_accvgpr_read_b32 v183, a151
v_mfma_f32_16x16x32_bf16 a[204:207], a[124:127], a[76:79], a[204:207]
s_mov_b32 s84, 2101248
ds_read_b64_tr_b16 a[34:35], v13 offset:1024
v_accvgpr_read_b32 v184, a152
v_mfma_f32_16x16x32_bf16 v[48:51], a[96:99], a[64:67], v[48:51]
buffer_load_dwordx4 v4, s[52:55], s84 offen lds
v_mfma_f32_16x16x32_bf16 v[80:83], a[96:99], a[68:71], v[80:83]
ds_read_b64_tr_b16 a[36:37], v14 offset:0
v_accvgpr_read_b32 v185, a153
v_mfma_f32_16x16x32_bf16 v[112:115], a[96:99], a[72:75], v[112:115]
ds_read_b64_tr_b16 a[38:39], v14 offset:1024
v_accvgpr_read_b32 v186, a154
v_mfma_f32_16x16x32_bf16 a[128:131], a[96:99], a[76:79], a[128:131]
ds_read_b128 a[8:11], v5 offset:36864
v_accvgpr_read_b32 v187, a155
v_mfma_f32_16x16x32_bf16 v[52:55], a[100:103], a[64:67], v[52:55]
s_add_u32 m0, s88, 4294868992
ds_read_b64_tr_b16 a[40:41], v15 offset:0
v_accvgpr_read_b32 v188, a156
v_mfma_f32_16x16x32_bf16 v[84:87], a[100:103], a[68:71], v[84:87]
buffer_load_dwordx4 v22, s[64:67], s36 offen offset:0 nt lds
v_mfma_f32_16x16x32_bf16 v[116:119], a[100:103], a[72:75], v[116:119]
ds_read_b64_tr_b16 a[42:43], v15 offset:1024
v_accvgpr_read_b32 v189, a157
v_mfma_f32_16x16x32_bf16 a[132:135], a[100:103], a[76:79], a[132:135]
ds_read_b64_tr_b16 a[44:45], v16 offset:0
v_accvgpr_read_b32 v190, a158
v_mfma_f32_16x16x32_bf16 v[56:59], a[104:107], a[64:67], v[56:59]
ds_read_b64_tr_b16 a[46:47], v16 offset:1024
v_accvgpr_read_b32 v191, a159
v_mfma_f32_16x16x32_bf16 v[88:91], a[104:107], a[68:71], v[88:91]
ds_read_b64_tr_b16 a[48:49], v17 offset:0
v_accvgpr_read_b32 v144, a128
v_mfma_f32_16x16x32_bf16 v[120:123], a[104:107], a[72:75], v[120:123]
buffer_load_dwordx4 v23, s[64:67], s36 offen offset:1024 nt lds
v_mfma_f32_16x16x32_bf16 a[136:139], a[104:107], a[76:79], a[136:139]
ds_read_b64_tr_b16 a[50:51], v17 offset:512
v_accvgpr_read_b32 v145, a129
v_mfma_f32_16x16x32_bf16 v[60:63], a[108:111], a[64:67], v[60:63]
ds_read_b128 a[12:15], v5 offset:38912
v_accvgpr_read_b32 v146, a130
v_mfma_f32_16x16x32_bf16 v[92:95], a[108:111], a[68:71], v[92:95]
ds_read_b64_tr_b16 a[52:53], v18 offset:0
v_accvgpr_read_b32 v147, a131
v_mfma_f32_16x16x32_bf16 v[124:127], a[108:111], a[72:75], v[124:127]
ds_read_b64_tr_b16 a[54:55], v18 offset:512
v_accvgpr_read_b32 v148, a132
v_mfma_f32_16x16x32_bf16 a[140:143], a[108:111], a[76:79], a[140:143]
v_accvgpr_read_b32 v149, a133
v_accvgpr_read_b32 v150, a134
v_mfma_f32_16x16x32_bf16 v[32:35], a[80:83], a[64:67], v[32:35]
s_add_u32 m0, s88, 4294877184
ds_read_b64_tr_b16 a[56:57], v19 offset:0
v_accvgpr_read_b32 v151, a135
v_mfma_f32_16x16x32_bf16 v[64:67], a[80:83], a[68:71], v[64:67]
buffer_load_dwordx4 v22, s[64:67], s37 offen offset:0 nt lds
v_mfma_f32_16x16x32_bf16 v[96:99], a[80:83], a[72:75], v[96:99]
ds_read_b64_tr_b16 a[58:59], v19 offset:512
v_accvgpr_read_b32 v152, a136
v_mfma_f32_16x16x32_bf16 v[128:131], a[80:83], a[76:79], v[128:131]
ds_read_b64_tr_b16 a[60:61], v20 offset:0
v_accvgpr_read_b32 v153, a137
v_mfma_f32_16x16x32_bf16 v[36:39], a[84:87], a[64:67], v[36:39]
ds_read_b64_tr_b16 a[62:63], v20 offset:512
v_accvgpr_read_b32 v154, a138
v_mfma_f32_16x16x32_bf16 v[68:71], a[84:87], a[68:71], v[68:71]
v_accvgpr_read_b32 v155, a139
v_accvgpr_read_b32 v156, a140
v_mfma_f32_16x16x32_bf16 v[100:103], a[84:87], a[72:75], v[100:103]
buffer_load_dwordx4 v23, s[64:67], s37 offen offset:1024 nt lds
v_mfma_f32_16x16x32_bf16 v[132:135], a[84:87], a[76:79], v[132:135]
v_accvgpr_read_b32 v157, a141
v_accvgpr_read_b32 v158, a142
v_mfma_f32_16x16x32_bf16 v[40:43], a[88:91], a[64:67], v[40:43]
v_accvgpr_read_b32 v159, a143
v_mfma_f32_16x16x32_bf16 v[72:75], a[88:91], a[68:71], v[72:75]
v_mfma_f32_16x16x32_bf16 v[104:107], a[88:91], a[72:75], v[104:107]
v_mfma_f32_16x16x32_bf16 v[136:139], a[88:91], a[76:79], v[136:139]
v_mfma_f32_16x16x32_bf16 v[44:47], a[92:95], a[64:67], v[44:47]
v_mfma_f32_16x16x32_bf16 v[76:79], a[92:95], a[68:71], v[76:79]
v_mfma_f32_16x16x32_bf16 v[108:111], a[92:95], a[72:75], v[108:111]
v_mfma_f32_16x16x32_bf16 v[140:143], a[92:95], a[76:79], v[140:143]
s_waitcnt lgkmcnt(0)
v_mfma_f32_16x16x32_bf16 v[176:179], a[48:51], a[0:3], v[176:179]
s_waitcnt vmcnt(22)
v_mfma_f32_16x16x32_bf16 a[160:163], a[48:51], a[4:7], a[160:163]
s_barrier
v_mfma_f32_16x16x32_bf16 a[176:179], a[48:51], a[8:11], a[176:179]
s_add_u32 m0, s88, 4294885376
ds_read_b128 a[64:67], v6 offset:32768
v_mfma_f32_16x16x32_bf16 a[192:195], a[48:51], a[12:15], a[192:195]
buffer_load_dwordx4 v22, s[64:67], s38 offen offset:0 nt lds
v_mfma_f32_16x16x32_bf16 v[180:183], a[52:55], a[0:3], v[180:183]
s_lshl_b32 s85, s78, 16
ds_read_b64_tr_b16 a[80:81], v9 offset:16384
v_mfma_f32_16x16x32_bf16 a[164:167], a[52:55], a[4:7], a[164:167]
s_add_u32 s82, s86, 8192
ds_read_b64_tr_b16 a[82:83], v9 offset:17408
v_mfma_f32_16x16x32_bf16 a[180:183], a[52:55], a[8:11], a[180:183]
s_add_u32 s94, s85, s82
ds_read_b64_tr_b16 a[84:85], v10 offset:16384
v_accvgpr_read_b32 v192, a160
v_mfma_f32_16x16x32_bf16 a[196:199], a[52:55], a[12:15], a[196:199]
s_and_b32 s82, s82, 0x7fff
ds_read_b64_tr_b16 a[86:87], v10 offset:17408
v_accvgpr_read_b32 v193, a161
v_mfma_f32_16x16x32_bf16 v[184:187], a[56:59], a[0:3], v[184:187]
s_add_u32 s34, s85, s82
ds_read_b64_tr_b16 a[88:89], v11 offset:16384
v_accvgpr_read_b32 v194, a162
v_mfma_f32_16x16x32_bf16 a[168:171], a[56:59], a[4:7], a[168:171]
ds_read_b64_tr_b16 a[90:91], v11 offset:17408
v_accvgpr_read_b32 v195, a163
v_mfma_f32_16x16x32_bf16 a[184:187], a[56:59], a[8:11], a[184:187]
ds_read_b128 a[68:71], v6 offset:34816
v_accvgpr_read_b32 v208, a176
v_mfma_f32_16x16x32_bf16 a[200:203], a[56:59], a[12:15], a[200:203]
v_accvgpr_read_b32 v209, a177
v_accvgpr_read_b32 v210, a178
v_mfma_f32_16x16x32_bf16 v[188:191], a[60:63], a[0:3], v[188:191]
buffer_load_dwordx4 v23, s[64:67], s38 offen offset:1024 nt lds
v_mfma_f32_16x16x32_bf16 a[172:175], a[60:63], a[4:7], a[172:175]
ds_read_b64_tr_b16 a[92:93], v12 offset:16384
v_accvgpr_read_b32 v211, a179
v_mfma_f32_16x16x32_bf16 a[188:191], a[60:63], a[8:11], a[188:191]
ds_read_b64_tr_b16 a[94:95], v12 offset:17408
v_accvgpr_read_b32 v196, a164
v_mfma_f32_16x16x32_bf16 a[204:207], a[60:63], a[12:15], a[204:207]
ds_read_b64_tr_b16 a[96:97], v13 offset:16384
v_accvgpr_read_b32 v197, a165
v_mfma_f32_16x16x32_bf16 v[48:51], a[32:35], a[0:3], v[48:51]
ds_read_b64_tr_b16 a[98:99], v13 offset:17408
v_accvgpr_read_b32 v198, a166
v_mfma_f32_16x16x32_bf16 v[80:83], a[32:35], a[4:7], v[80:83]
ds_read_b64_tr_b16 a[100:101], v14 offset:16384
v_accvgpr_read_b32 v199, a167
v_mfma_f32_16x16x32_bf16 v[112:115], a[32:35], a[8:11], v[112:115]
ds_read_b64_tr_b16 a[102:103], v14 offset:17408
v_accvgpr_read_b32 v212, a180
v_mfma_f32_16x16x32_bf16 v[144:147], a[32:35], a[12:15], v[144:147]
ds_read_b128 a[72:75], v6 offset:36864
v_accvgpr_read_b32 v213, a181
v_mfma_f32_16x16x32_bf16 v[52:55], a[36:39], a[0:3], v[52:55]
ds_read_b64_tr_b16 a[104:105], v15 offset:16384
v_accvgpr_read_b32 v214, a182
v_mfma_f32_16x16x32_bf16 v[84:87], a[36:39], a[4:7], v[84:87]
v_accvgpr_read_b32 v215, a183
v_accvgpr_read_b32 v200, a168
v_mfma_f32_16x16x32_bf16 v[116:119], a[36:39], a[8:11], v[116:119]
ds_read_b64_tr_b16 a[106:107], v15 offset:17408
v_accvgpr_read_b32 v201, a169
v_mfma_f32_16x16x32_bf16 v[148:151], a[36:39], a[12:15], v[148:151]
s_add_u32 m0, s88, 4294893568
ds_read_b64_tr_b16 a[108:109], v16 offset:16384
v_accvgpr_read_b32 v202, a170
v_mfma_f32_16x16x32_bf16 v[56:59], a[40:43], a[0:3], v[56:59]
buffer_load_dwordx4 v22, s[64:67], s39 offen offset:0 nt lds
v_mfma_f32_16x16x32_bf16 v[88:91], a[40:43], a[4:7], v[88:91]
ds_read_b64_tr_b16 a[110:111], v16 offset:17408
v_accvgpr_read_b32 v203, a171
v_mfma_f32_16x16x32_bf16 v[120:123], a[40:43], a[8:11], v[120:123]
ds_read_b64_tr_b16 a[112:113], v17 offset:16384
v_accvgpr_read_b32 v216, a184
v_mfma_f32_16x16x32_bf16 v[152:155], a[40:43], a[12:15], v[152:155]
ds_read_b64_tr_b16 a[114:115], v17 offset:16896
v_accvgpr_read_b32 v217, a185
v_mfma_f32_16x16x32_bf16 v[60:63], a[44:47], a[0:3], v[60:63]
ds_read_b128 a[76:79], v6 offset:38912
v_accvgpr_read_b32 v218, a186
v_mfma_f32_16x16x32_bf16 v[92:95], a[44:47], a[4:7], v[92:95]
ds_read_b64_tr_b16 a[116:117], v18 offset:16384
v_accvgpr_read_b32 v219, a187
v_mfma_f32_16x16x32_bf16 v[124:127], a[44:47], a[8:11], v[124:127]
ds_read_b64_tr_b16 a[118:119], v18 offset:16896
v_accvgpr_read_b32 v204, a172
v_mfma_f32_16x16x32_bf16 v[156:159], a[44:47], a[12:15], v[156:159]
v_accvgpr_read_b32 v205, a173
v_accvgpr_read_b32 v206, a174
v_mfma_f32_16x16x32_bf16 v[32:35], a[16:19], a[0:3], v[32:35]
ds_read_b64_tr_b16 a[120:121], v19 offset:16384
v_accvgpr_read_b32 v207, a175
v_mfma_f32_16x16x32_bf16 v[64:67], a[16:19], a[4:7], v[64:67]
ds_read_b64_tr_b16 a[122:123], v19 offset:16896
v_accvgpr_read_b32 v220, a188
v_mfma_f32_16x16x32_bf16 v[96:99], a[16:19], a[8:11], v[96:99]
buffer_load_dwordx4 v23, s[64:67], s39 offen offset:1024 nt lds
v_mfma_f32_16x16x32_bf16 v[128:131], a[16:19], a[12:15], v[128:131]
ds_read_b64_tr_b16 a[124:125], v20 offset:16384
v_accvgpr_read_b32 v221, a189
v_mfma_f32_16x16x32_bf16 v[36:39], a[20:23], a[0:3], v[36:39]
ds_read_b64_tr_b16 a[126:127], v20 offset:16896
v_accvgpr_read_b32 v222, a190
v_mfma_f32_16x16x32_bf16 v[68:71], a[20:23], a[4:7], v[68:71]
s_cmp_eq_u32 s78, 0
s_cselect_b32 s83, 0x10000, 0
v_accvgpr_read_b32 v223, a191
v_mfma_f32_16x16x32_bf16 v[100:103], a[20:23], a[8:11], v[100:103]
s_add_u32 s95, s94, 32768
v_mfma_f32_16x16x32_bf16 v[132:135], a[20:23], a[12:15], v[132:135]
s_add_u32 s87, s83, s86
v_mfma_f32_16x16x32_bf16 v[40:43], a[24:27], a[0:3], v[40:43]
s_add_u32 s87, s87, 8192
v_mfma_f32_16x16x32_bf16 v[72:75], a[24:27], a[4:7], v[72:75]
s_cmp_eq_u32 s76, 3
s_cselect_b32 s95, s83, s95
v_mfma_f32_16x16x32_bf16 v[104:107], a[24:27], a[8:11], v[104:107]
s_lshr_b32 s97, s86, 2
v_mfma_f32_16x16x32_bf16 v[136:139], a[24:27], a[12:15], v[136:139]
s_add_u32 s96, s85, s97
v_mfma_f32_16x16x32_bf16 v[44:47], a[28:31], a[0:3], v[44:47]
s_mov_b32 s98, 32768
v_mfma_f32_16x16x32_bf16 v[76:79], a[28:31], a[4:7], v[76:79]
s_mov_b32 s99, 98304
v_mfma_f32_16x16x32_bf16 v[108:111], a[28:31], a[8:11], v[108:111]
s_lshl_b32 s35, s78, 7
v_mfma_f32_16x16x32_bf16 v[140:143], a[28:31], a[12:15], v[140:143]
s_add_u32 s35, s35, s3
s_bfe_u32 s82, s2, 0x20001
s_lshl_b32 s83, s78, 2
s_add_u32 s82, s82, s83
s_lshl_b32 s82, s82, 7
s_add_u32 s82, s82, s3
s_add_u32 s100, s82, 68231168
s_add_u32 s35, s35, 68227072
s_waitcnt lgkmcnt(0)
v_mfma_f32_16x16x32_bf16 v[176:179], a[112:115], a[64:67], v[176:179]
s_waitcnt vmcnt(12)
v_mfma_f32_16x16x32_bf16 v[192:195], a[112:115], a[68:71], v[192:195]
s_barrier
v_mfma_f32_16x16x32_bf16 v[208:211], a[112:115], a[72:75], v[208:211]
s_add_u32 m0, s86, 32768
ds_read_b128 a[0:3], v7 offset:0
v_mfma_f32_16x16x32_bf16 a[192:195], a[112:115], a[76:79], a[192:195]
s_add_u32 s94, s94, 0
ds_read_b64_tr_b16 a[16:17], v9 offset:32768
v_mfma_f32_16x16x32_bf16 v[180:183], a[116:119], a[64:67], v[180:183]
buffer_load_dwordx4 v1, s[60:63], s94 offen offset:0 sc1 lds
v_mfma_f32_16x16x32_bf16 v[196:199], a[116:119], a[68:71], v[196:199]
s_lshl_b32 s82, s30, 19
ds_read_b64_tr_b16 a[18:19], v9 offset:33792
v_mfma_f32_16x16x32_bf16 v[212:215], a[116:119], a[72:75], v[212:215]
s_mul_i32 s83, s22, 122880
ds_read_b64_tr_b16 a[20:21], v10 offset:32768
v_mfma_f32_16x16x32_bf16 a[196:199], a[116:119], a[76:79], a[196:199]
s_add_u32 s82, s82, s83
ds_read_b64_tr_b16 a[22:23], v10 offset:33792
v_mfma_f32_16x16x32_bf16 v[184:187], a[120:123], a[64:67], v[184:187]
s_add_u32 s82, s82, 33554432
ds_read_b64_tr_b16 a[24:25], v11 offset:32768
v_accvgpr_read_b32 v224, a192
v_mfma_f32_16x16x32_bf16 v[200:203], a[120:123], a[68:71], v[200:203]
ds_read_b64_tr_b16 a[26:27], v11 offset:33792
v_accvgpr_read_b32 v225, a193
v_mfma_f32_16x16x32_bf16 v[216:219], a[120:123], a[72:75], v[216:219]
buffer_load_dwordx4 v1, s[60:63], s94 offen offset:1024 sc1 lds
v_mfma_f32_16x16x32_bf16 a[200:203], a[120:123], a[76:79], a[200:203]
ds_read_b128 a[4:7], v7 offset:2048
v_accvgpr_read_b32 v226, a194
v_mfma_f32_16x16x32_bf16 v[188:191], a[124:127], a[64:67], v[188:191]
ds_read_b64_tr_b16 a[28:29], v12 offset:32768
v_accvgpr_read_b32 v227, a195
v_mfma_f32_16x16x32_bf16 v[204:207], a[124:127], a[68:71], v[204:207]
ds_read_b64_tr_b16 a[30:31], v12 offset:33792
v_accvgpr_read_b32 v228, a196
v_mfma_f32_16x16x32_bf16 v[220:223], a[124:127], a[72:75], v[220:223]
ds_read_b64_tr_b16 a[32:33], v13 offset:32768
v_accvgpr_read_b32 v229, a197
v_mfma_f32_16x16x32_bf16 a[204:207], a[124:127], a[76:79], a[204:207]
ds_read_b64_tr_b16 a[34:35], v13 offset:33792
v_accvgpr_read_b32 v230, a198
v_mfma_f32_16x16x32_bf16 v[48:51], a[96:99], a[64:67], v[48:51]
v_accvgpr_read_b32 v231, a199
v_accvgpr_read_b32 v232, a200
v_mfma_f32_16x16x32_bf16 v[80:83], a[96:99], a[68:71], v[80:83]
ds_read_b64_tr_b16 a[36:37], v14 offset:32768
v_accvgpr_read_b32 v233, a201
v_mfma_f32_16x16x32_bf16 v[112:115], a[96:99], a[72:75], v[112:115]
ds_read_b64_tr_b16 a[38:39], v14 offset:33792
v_accvgpr_read_b32 v234, a202
v_mfma_f32_16x16x32_bf16 v[144:147], a[96:99], a[76:79], v[144:147]
buffer_load_dwordx4 v1, s[60:63], s94 offen offset:2048 sc1 lds
v_mfma_f32_16x16x32_bf16 v[52:55], a[100:103], a[64:67], v[52:55]
ds_read_b128 a[8:11], v7 offset:4096
v_accvgpr_read_b32 v235, a203
v_mfma_f32_16x16x32_bf16 v[84:87], a[100:103], a[68:71], v[84:87]
ds_read_b64_tr_b16 a[40:41], v15 offset:32768
v_accvgpr_read_b32 v236, a204
v_mfma_f32_16x16x32_bf16 v[116:119], a[100:103], a[72:75], v[116:119]
ds_read_b64_tr_b16 a[42:43], v15 offset:33792
v_accvgpr_read_b32 v237, a205
v_mfma_f32_16x16x32_bf16 v[148:151], a[100:103], a[76:79], v[148:151]
ds_read_b64_tr_b16 a[44:45], v16 offset:32768
v_accvgpr_read_b32 v238, a206
v_mfma_f32_16x16x32_bf16 v[56:59], a[104:107], a[64:67], v[56:59]
ds_read_b64_tr_b16 a[46:47], v16 offset:33792
v_accvgpr_read_b32 v239, a207
v_mfma_f32_16x16x32_bf16 v[88:91], a[104:107], a[68:71], v[88:91]
s_add_u32 s44, s32, s82
s_addc_u32 s45, s33, 0
ds_read_b64_tr_b16 a[48:49], v17 offset:32768
v_mfma_f32_16x16x32_bf16 v[120:123], a[104:107], a[72:75], v[120:123]
s_and_b32 s45, s45, 0xffff
v_mfma_f32_16x16x32_bf16 v[152:155], a[104:107], a[76:79], v[152:155]
buffer_load_dwordx4 v1, s[60:63], s94 offen offset:3072 sc1 lds
v_mfma_f32_16x16x32_bf16 v[60:63], a[108:111], a[64:67], v[60:63]
s_mov_b32 s46, 155648
ds_read_b64_tr_b16 a[50:51], v17 offset:33280
v_mfma_f32_16x16x32_bf16 v[92:95], a[108:111], a[68:71], v[92:95]
s_mov_b32 s47, 0x20000
ds_read_b128 a[12:15], v7 offset:6144
v_mfma_f32_16x16x32_bf16 v[124:127], a[108:111], a[72:75], v[124:127]
s_mul_i32 s82, s31, 5120
ds_read_b64_tr_b16 a[52:53], v18 offset:32768
v_mfma_f32_16x16x32_bf16 v[156:159], a[108:111], a[76:79], v[156:159]
s_mul_i32 s83, s22, 1228800
ds_read_b64_tr_b16 a[54:55], v18 offset:33280
v_mfma_f32_16x16x32_bf16 v[32:35], a[80:83], a[64:67], v[32:35]
s_add_u32 s82, s82, s83
ds_read_b64_tr_b16 a[56:57], v19 offset:32768
v_mfma_f32_16x16x32_bf16 v[64:67], a[80:83], a[68:71], v[64:67]
s_add_u32 s82, s82, 58720256
ds_read_b64_tr_b16 a[58:59], v19 offset:33280
v_mfma_f32_16x16x32_bf16 v[96:99], a[80:83], a[72:75], v[96:99]
s_add_u32 s48, s32, s82
s_addc_u32 s49, s33, 0
ds_read_b64_tr_b16 a[60:61], v20 offset:32768
v_mfma_f32_16x16x32_bf16 v[128:131], a[80:83], a[76:79], v[128:131]
s_and_b32 s49, s49, 0xffff
ds_read_b64_tr_b16 a[62:63], v20 offset:33280
v_mfma_f32_16x16x32_bf16 v[36:39], a[84:87], a[64:67], v[36:39]
s_add_u32 m0, s86, 36864
v_mfma_f32_16x16x32_bf16 v[68:71], a[84:87], a[68:71], v[68:71]
s_add_u32 s94, s94, 4096
v_mfma_f32_16x16x32_bf16 v[100:103], a[84:87], a[72:75], v[100:103]
buffer_load_dwordx4 v1, s[60:63], s94 offen offset:0 sc1 lds
v_mfma_f32_16x16x32_bf16 v[132:135], a[84:87], a[76:79], v[132:135]
s_mov_b32 s50, 1520640
v_mfma_f32_16x16x32_bf16 v[40:43], a[88:91], a[64:67], v[40:43]
s_mov_b32 s51, 0x20000
v_mfma_f32_16x16x32_bf16 v[72:75], a[88:91], a[68:71], v[72:75]
s_mov_b32 s52, s28
v_mfma_f32_16x16x32_bf16 v[104:107], a[88:91], a[72:75], v[104:107]
s_and_b32 s53, s29, 0xffff
v_mfma_f32_16x16x32_bf16 v[136:139], a[88:91], a[76:79], v[136:139]
s_mov_b32 s54, 2621440
v_mfma_f32_16x16x32_bf16 v[44:47], a[92:95], a[64:67], v[44:47]
s_mov_b32 s55, 0x20000
v_mfma_f32_16x16x32_bf16 v[76:79], a[92:95], a[68:71], v[76:79]
s_mul_i32 s82, s31, 160
v_mfma_f32_16x16x32_bf16 v[108:111], a[92:95], a[72:75], v[108:111]
s_add_u32 s64, s24, s82
s_addc_u32 s65, s25, 0
v_mfma_f32_16x16x32_bf16 v[140:143], a[92:95], a[76:79], v[140:143]
s_and_b32 s65, s65, 0xffff
s_mov_b32 s66, 160
s_mov_b32 s67, 0x20000
s_waitcnt lgkmcnt(0)
v_mfma_f32_16x16x32_bf16 v[176:179], a[48:51], a[0:3], v[176:179]
s_waitcnt vmcnt(13)
v_mfma_f32_16x16x32_bf16 v[192:195], a[48:51], a[4:7], v[192:195]
s_barrier
v_mfma_f32_16x16x32_bf16 v[208:211], a[48:51], a[8:11], v[208:211]
buffer_load_dwordx4 v1, s[60:63], s94 offen offset:1024 sc1 lds
v_mfma_f32_16x16x32_bf16 v[224:227], a[48:51], a[12:15], v[224:227]
ds_read_b128 a[64:67], v8 offset:0
v_mfma_f32_16x16x32_bf16 v[180:183], a[52:55], a[0:3], v[180:183]
ds_read_b64_tr_b16 a[80:81], v9 offset:49152
v_mfma_f32_16x16x32_bf16 v[196:199], a[52:55], a[4:7], v[196:199]
ds_read_b64_tr_b16 a[82:83], v9 offset:50176
v_mfma_f32_16x16x32_bf16 v[212:215], a[52:55], a[8:11], v[212:215]
ds_read_b64_tr_b16 a[84:85], v10 offset:49152
v_mfma_f32_16x16x32_bf16 v[228:231], a[52:55], a[12:15], v[228:231]
ds_read_b64_tr_b16 a[86:87], v10 offset:50176
v_mfma_f32_16x16x32_bf16 v[184:187], a[56:59], a[0:3], v[184:187]
ds_read_b64_tr_b16 a[88:89], v11 offset:49152
v_mfma_f32_16x16x32_bf16 v[200:203], a[56:59], a[4:7], v[200:203]
ds_read_b64_tr_b16 a[90:91], v11 offset:50176
v_mfma_f32_16x16x32_bf16 v[216:219], a[56:59], a[8:11], v[216:219]
buffer_load_dwordx4 v1, s[60:63], s94 offen offset:2048 sc1 lds
v_mfma_f32_16x16x32_bf16 v[232:235], a[56:59], a[12:15], v[232:235]
ds_read_b128 a[68:71], v8 offset:2048
v_mfma_f32_16x16x32_bf16 v[188:191], a[60:63], a[0:3], v[188:191]
ds_read_b64_tr_b16 a[92:93], v12 offset:49152
v_mfma_f32_16x16x32_bf16 v[204:207], a[60:63], a[4:7], v[204:207]
ds_read_b64_tr_b16 a[94:95], v12 offset:50176
v_mfma_f32_16x16x32_bf16 v[220:223], a[60:63], a[8:11], v[220:223]
ds_read_b64_tr_b16 a[96:97], v13 offset:49152
v_mfma_f32_16x16x32_bf16 v[236:239], a[60:63], a[12:15], v[236:239]
ds_read_b64_tr_b16 a[98:99], v13 offset:50176
v_mfma_f32_16x16x32_bf16 v[48:51], a[32:35], a[0:3], v[48:51]
v_mfma_f32_16x16x32_bf16 v[80:83], a[32:35], a[4:7], v[80:83]
ds_read_b64_tr_b16 a[100:101], v14 offset:49152
v_mfma_f32_16x16x32_bf16 v[112:115], a[32:35], a[8:11], v[112:115]
ds_read_b64_tr_b16 a[102:103], v14 offset:50176
v_mfma_f32_16x16x32_bf16 v[144:147], a[32:35], a[12:15], v[144:147]
buffer_load_dwordx4 v1, s[60:63], s94 offen offset:3072 sc1 lds
v_mfma_f32_16x16x32_bf16 v[52:55], a[36:39], a[0:3], v[52:55]
ds_read_b128 a[72:75], v8 offset:4096
v_mfma_f32_16x16x32_bf16 v[84:87], a[36:39], a[4:7], v[84:87]
ds_read_b64_tr_b16 a[104:105], v15 offset:49152
v_mfma_f32_16x16x32_bf16 v[116:119], a[36:39], a[8:11], v[116:119]
ds_read_b64_tr_b16 a[106:107], v15 offset:50176
v_mfma_f32_16x16x32_bf16 v[148:151], a[36:39], a[12:15], v[148:151]
ds_read_b64_tr_b16 a[108:109], v16 offset:49152
v_mfma_f32_16x16x32_bf16 v[56:59], a[40:43], a[0:3], v[56:59]
ds_read_b64_tr_b16 a[110:111], v16 offset:50176
v_mfma_f32_16x16x32_bf16 v[88:91], a[40:43], a[4:7], v[88:91]
ds_read_b64_tr_b16 a[112:113], v17 offset:49152
v_mfma_f32_16x16x32_bf16 v[120:123], a[40:43], a[8:11], v[120:123]
v_mfma_f32_16x16x32_bf16 v[152:155], a[40:43], a[12:15], v[152:155]
s_add_u32 m0, s97, 131072
ds_read_b64_tr_b16 a[114:115], v17 offset:49664
v_mfma_f32_16x16x32_bf16 v[60:63], a[44:47], a[0:3], v[60:63]
buffer_load_dwordx4 v1, s[60:63], s96 offen offset:0 sc1 lds
v_mfma_f32_16x16x32_bf16 v[92:95], a[44:47], a[4:7], v[92:95]
ds_read_b128 a[76:79], v8 offset:6144
v_mfma_f32_16x16x32_bf16 v[124:127], a[44:47], a[8:11], v[124:127]
ds_read_b64_tr_b16 a[116:117], v18 offset:49152
v_mfma_f32_16x16x32_bf16 v[156:159], a[44:47], a[12:15], v[156:159]
ds_read_b64_tr_b16 a[118:119], v18 offset:49664
v_mfma_f32_16x16x32_bf16 v[32:35], a[16:19], a[0:3], v[32:35]
ds_read_b64_tr_b16 a[120:121], v19 offset:49152
v_mfma_f32_16x16x32_bf16 v[64:67], a[16:19], a[4:7], v[64:67]
ds_read_b64_tr_b16 a[122:123], v19 offset:49664
v_mfma_f32_16x16x32_bf16 v[96:99], a[16:19], a[8:11], v[96:99]
ds_read_b64_tr_b16 a[124:125], v20 offset:49152
v_mfma_f32_16x16x32_bf16 v[128:131], a[16:19], a[12:15], v[128:131]
ds_read_b64_tr_b16 a[126:127], v20 offset:49664
v_mfma_f32_16x16x32_bf16 v[36:39], a[20:23], a[0:3], v[36:39]
buffer_load_dwordx4 v1, s[60:63], s96 offen offset:1024 sc1 lds
v_mfma_f32_16x16x32_bf16 v[68:71], a[20:23], a[4:7], v[68:71]
v_mfma_f32_16x16x32_bf16 v[100:103], a[20:23], a[8:11], v[100:103]
v_mfma_f32_16x16x32_bf16 v[132:135], a[20:23], a[12:15], v[132:135]
v_mfma_f32_16x16x32_bf16 v[40:43], a[24:27], a[0:3], v[40:43]
v_mfma_f32_16x16x32_bf16 v[72:75], a[24:27], a[4:7], v[72:75]
v_mfma_f32_16x16x32_bf16 v[104:107], a[24:27], a[8:11], v[104:107]
v_mfma_f32_16x16x32_bf16 v[136:139], a[24:27], a[12:15], v[136:139]
v_mfma_f32_16x16x32_bf16 v[44:47], a[28:31], a[0:3], v[44:47]
v_mfma_f32_16x16x32_bf16 v[76:79], a[28:31], a[4:7], v[76:79]
v_mfma_f32_16x16x32_bf16 v[108:111], a[28:31], a[8:11], v[108:111]
v_mfma_f32_16x16x32_bf16 v[140:143], a[28:31], a[12:15], v[140:143]
s_waitcnt lgkmcnt(0)
v_mfma_f32_16x16x32_bf16 v[176:179], a[112:115], a[64:67], v[176:179]
v_mfma_f32_16x16x32_bf16 v[192:195], a[112:115], a[68:71], v[192:195]
s_barrier
v_mfma_f32_16x16x32_bf16 v[208:211], a[112:115], a[72:75], v[208:211]
v_mov_b32 v2, v21
v_mov_b32 v3, 1
v_mfma_f32_16x16x32_bf16 v[224:227], a[112:115], a[76:79], v[224:227]
v_and_b32 v7, 1, v0
v_mul_u32_u24 v7, 0xaaaa, v7
v_mfma_f32_16x16x32_bf16 v[180:183], a[116:119], a[64:67], v[180:183]
v_add_u32 v7, 0x4444, v7
v_add_u32 v5, 32768, v1
v_mfma_f32_16x16x32_bf16 v[196:199], a[116:119], a[68:71], v[196:199]
v_sub_u32 v4, 7, v0
v_and_b32 v4, 1073741824, v4
v_mfma_f32_16x16x32_bf16 v[212:215], a[116:119], a[72:75], v[212:215]
v_lshl_or_b32 v8, v0, 7, v4
v_add_u32 v8, 68227072, v8
v_mfma_f32_16x16x32_bf16 v[228:231], a[116:119], a[76:79], v[228:231]
v_lshrrev_b32 v12, 2, v0
v_and_b32 v13, 7, v12
v_mfma_f32_16x16x32_bf16 v[184:187], a[120:123], a[64:67], v[184:187]
s_lshl_b32 s80, s76, 1
v_xor_b32 v13, s80, v13
v_lshlrev_b32 v12, 8, v12
v_mfma_f32_16x16x32_bf16 v[200:203], a[120:123], a[68:71], v[200:203]
v_lshl_add_u32 v12, v13, 5, v12
v_and_b32 v13, 3, v0
v_mfma_f32_16x16x32_bf16 v[216:219], a[120:123], a[72:75], v[216:219]
s_load_dword s26, s[32:33], s79 glc
v_lshl_add_u32 v12, v13, 3, v12
v_xor_b32 v13, 32, v12
v_mfma_f32_16x16x32_bf16 v[232:235], a[120:123], a[76:79], v[232:235]
s_lshl_b32 s80, s2, 15
v_mfma_f32_16x16x32_bf16 v[188:191], a[124:127], a[64:67], v[188:191]
s_add_u32 s80, s80, s88
v_mfma_f32_16x16x32_bf16 v[204:207], a[124:127], a[68:71], v[204:207]
s_add_u32 s36, s80, 58621952
v_mfma_f32_16x16x32_bf16 v[220:223], a[124:127], a[72:75], v[220:223]
s_cmp_lt_u32 s2, 228
s_cselect_b32 s36, s36, 1073741824
v_mfma_f32_16x16x32_bf16 v[236:239], a[124:127], a[76:79], v[236:239]
s_add_u32 s37, s36, 8192
v_mfma_f32_16x16x32_bf16 v[48:51], a[96:99], a[64:67], v[48:51]
s_add_u32 s38, s36, 16384
v_mfma_f32_16x16x32_bf16 v[80:83], a[96:99], a[68:71], v[80:83]
s_cmp_lt_u32 s2, 227
s_cselect_b32 s38, s38, 1073741824
v_mfma_f32_16x16x32_bf16 v[112:115], a[96:99], a[72:75], v[112:115]
s_add_u32 s39, s38, 8192
v_add_u32 v14, 131072, v1
v_mfma_f32_16x16x32_bf16 v[144:147], a[96:99], a[76:79], v[144:147]
v_mfma_f32_16x16x32_bf16 v[52:55], a[100:103], a[64:67], v[52:55]
v_mfma_f32_16x16x32_bf16 v[84:87], a[100:103], a[68:71], v[84:87]
v_mfma_f32_16x16x32_bf16 v[116:119], a[100:103], a[72:75], v[116:119]
v_mfma_f32_16x16x32_bf16 v[148:151], a[100:103], a[76:79], v[148:151]
v_mfma_f32_16x16x32_bf16 v[56:59], a[104:107], a[64:67], v[56:59]
v_mfma_f32_16x16x32_bf16 v[88:91], a[104:107], a[68:71], v[88:91]
v_mfma_f32_16x16x32_bf16 v[120:123], a[104:107], a[72:75], v[120:123]
v_mfma_f32_16x16x32_bf16 v[152:155], a[104:107], a[76:79], v[152:155]
v_mfma_f32_16x16x32_bf16 v[60:63], a[108:111], a[64:67], v[60:63]
v_mfma_f32_16x16x32_bf16 v[92:95], a[108:111], a[68:71], v[92:95]
v_mfma_f32_16x16x32_bf16 v[124:127], a[108:111], a[72:75], v[124:127]
v_mfma_f32_16x16x32_bf16 v[156:159], a[108:111], a[76:79], v[156:159]
v_mfma_f32_16x16x32_bf16 v[32:35], a[80:83], a[64:67], v[32:35]
v_mfma_f32_16x16x32_bf16 v[64:67], a[80:83], a[68:71], v[64:67]
v_mfma_f32_16x16x32_bf16 v[96:99], a[80:83], a[72:75], v[96:99]
v_mfma_f32_16x16x32_bf16 v[128:131], a[80:83], a[76:79], v[128:131]
v_mfma_f32_16x16x32_bf16 v[36:39], a[84:87], a[64:67], v[36:39]
v_mfma_f32_16x16x32_bf16 v[68:71], a[84:87], a[68:71], v[68:71]
v_mfma_f32_16x16x32_bf16 v[100:103], a[84:87], a[72:75], v[100:103]
v_mfma_f32_16x16x32_bf16 v[132:135], a[84:87], a[76:79], v[132:135]
v_mfma_f32_16x16x32_bf16 v[40:43], a[88:91], a[64:67], v[40:43]
v_mfma_f32_16x16x32_bf16 v[72:75], a[88:91], a[68:71], v[72:75]
v_mfma_f32_16x16x32_bf16 v[104:107], a[88:91], a[72:75], v[104:107]
v_mfma_f32_16x16x32_bf16 v[136:139], a[88:91], a[76:79], v[136:139]
v_mfma_f32_16x16x32_bf16 v[44:47], a[92:95], a[64:67], v[44:47]
v_mfma_f32_16x16x32_bf16 v[76:79], a[92:95], a[68:71], v[76:79]
v_mfma_f32_16x16x32_bf16 v[108:111], a[92:95], a[72:75], v[108:111]
v_mfma_f32_16x16x32_bf16 v[140:143], a[92:95], a[76:79], v[140:143]
L_epi:
s_mov_b32 s80, 0xbdd2d3e8
s_mov_b32 s81, 0xbdd2d3e8
v_mov_b32 v22, 0xc0135761
v_mov_b32 v23, 0xc0135761
s_lshl_b32 s82, s17, 13
s_add_u32 s82, s82, 50331648
s_cmp_lt_u32 s17, 27
s_cselect_b32 s82, s82, 1073741824
v_pk_mul_f32 v[160:161], v[176:177], v[176:177]
v_pk_mul_f32 v[162:163], v[178:179], v[178:179]
v_pk_mul_f32 v[164:165], v[180:181], v[180:181]
v_pk_mul_f32 v[166:167], v[182:183], v[182:183]
v_pk_mul_f32 v[168:169], v[184:185], v[184:185]
v_pk_mul_f32 v[170:171], v[186:187], v[186:187]
v_pk_mul_f32 v[172:173], v[188:189], v[188:189]
v_pk_mul_f32 v[174:175], v[190:191], v[190:191]
v_pk_fma_f32 v[160:161], v[160:161], s[80:81], v[22:23]
v_pk_fma_f32 v[162:163], v[162:163], s[80:81], v[22:23]
v_pk_fma_f32 v[164:165], v[164:165], s[80:81], v[22:23]
v_pk_fma_f32 v[166:167], v[166:167], s[80:81], v[22:23]
v_pk_fma_f32 v[168:169], v[168:169], s[80:81], v[22:23]
v_pk_fma_f32 v[170:171], v[170:171], s[80:81], v[22:23]
v_pk_fma_f32 v[172:173], v[172:173], s[80:81], v[22:23]
v_pk_fma_f32 v[174:175], v[174:175], s[80:81], v[22:23]
v_pk_mul_f32 v[160:161], v[160:161], v[176:177]
v_pk_mul_f32 v[162:163], v[162:163], v[178:179]
v_pk_mul_f32 v[164:165], v[164:165], v[180:181]
v_pk_mul_f32 v[166:167], v[166:167], v[182:183]
v_pk_mul_f32 v[168:169], v[168:169], v[184:185]
v_pk_mul_f32 v[170:171], v[170:171], v[186:187]
v_pk_mul_f32 v[172:173], v[172:173], v[188:189]
v_pk_mul_f32 v[174:175], v[174:175], v[190:191]
v_exp_f32 v160, v160
v_exp_f32 v161, v161
v_exp_f32 v162, v162
v_exp_f32 v163, v163
v_exp_f32 v164, v164
v_exp_f32 v165, v165
v_exp_f32 v166, v166
v_exp_f32 v167, v167
v_exp_f32 v168, v168
v_exp_f32 v169, v169
v_exp_f32 v170, v170
v_exp_f32 v171, v171
v_exp_f32 v172, v172
v_exp_f32 v173, v173
v_exp_f32 v174, v174
v_exp_f32 v175, v175
v_pk_add_f32 v[160:161], v[160:161], 1.0 op_sel_hi:[1,0]
v_pk_add_f32 v[162:163], v[162:163], 1.0 op_sel_hi:[1,0]
v_pk_add_f32 v[164:165], v[164:165], 1.0 op_sel_hi:[1,0]
v_pk_add_f32 v[166:167], v[166:167], 1.0 op_sel_hi:[1,0]
v_pk_add_f32 v[168:169], v[168:169], 1.0 op_sel_hi:[1,0]
v_pk_add_f32 v[170:171], v[170:171], 1.0 op_sel_hi:[1,0]
v_pk_add_f32 v[172:173], v[172:173], 1.0 op_sel_hi:[1,0]
v_pk_add_f32 v[174:175], v[174:175], 1.0 op_sel_hi:[1,0]
v_rcp_f32 v160, v160
v_rcp_f32 v161, v161
v_rcp_f32 v162, v162
v_rcp_f32 v163, v163
v_rcp_f32 v164, v164
v_rcp_f32 v165, v165
v_rcp_f32 v166, v166
v_rcp_f32 v167, v167
v_rcp_f32 v168, v168
v_rcp_f32 v169, v169
v_rcp_f32 v170, v170
v_rcp_f32 v171, v171
v_rcp_f32 v172, v172
v_rcp_f32 v173, v173
v_rcp_f32 v174, v174
v_rcp_f32 v175, v175
v_pk_mul_f32 v[160:161], v[160:161], v[176:177]
v_pk_mul_f32 v[162:163], v[162:163], v[178:179]
v_pk_mul_f32 v[164:165], v[164:165], v[180:181]
v_pk_mul_f32 v[166:167], v[166:167], v[182:183]
v_pk_mul_f32 v[168:169], v[168:169], v[184:185]
v_pk_mul_f32 v[170:171], v[170:171], v[186:187]
v_pk_mul_f32 v[172:173], v[172:173], v[188:189]
v_pk_mul_f32 v[174:175], v[174:175], v[190:191]
v_cvt_pk_bf16_f32 v176, v160, v161
v_cvt_pk_bf16_f32 v177, v162, v163
v_cvt_pk_bf16_f32 v178, v164, v165
v_cvt_pk_bf16_f32 v179, v166, v167
v_cvt_pk_bf16_f32 v180, v168, v169
v_cvt_pk_bf16_f32 v181, v170, v171
v_cvt_pk_bf16_f32 v182, v172, v173
v_cvt_pk_bf16_f32 v183, v174, v175
L_chain1:
s_waitcnt lgkmcnt(0)
s_cmp_ge_u32 s26, 8
s_cbranch_scc0 L_kv_spin0
L_kv_ok:
v_pk_mul_f32 v[160:161], v[192:193], v[192:193]
v_pk_mul_f32 v[162:163], v[194:195], v[194:195]
v_pk_mul_f32 v[164:165], v[196:197], v[196:197]
v_pk_mul_f32 v[166:167], v[198:199], v[198:199]
v_pk_mul_f32 v[168:169], v[200:201], v[200:201]
v_pk_mul_f32 v[170:171], v[202:203], v[202:203]
v_pk_mul_f32 v[172:173], v[204:205], v[204:205]
v_pk_mul_f32 v[174:175], v[206:207], v[206:207]
v_pk_fma_f32 v[160:161], v[160:161], s[80:81], v[22:23]
v_pk_fma_f32 v[162:163], v[162:163], s[80:81], v[22:23]
v_pk_fma_f32 v[164:165], v[164:165], s[80:81], v[22:23]
v_pk_fma_f32 v[166:167], v[166:167], s[80:81], v[22:23]
v_pk_fma_f32 v[168:169], v[168:169], s[80:81], v[22:23]
v_pk_fma_f32 v[170:171], v[170:171], s[80:81], v[22:23]
v_pk_fma_f32 v[172:173], v[172:173], s[80:81], v[22:23]
v_pk_fma_f32 v[174:175], v[174:175], s[80:81], v[22:23]
v_pk_mul_f32 v[160:161], v[160:161], v[192:193]
v_pk_mul_f32 v[162:163], v[162:163], v[194:195]
v_pk_mul_f32 v[164:165], v[164:165], v[196:197]
v_pk_mul_f32 v[166:167], v[166:167], v[198:199]
v_pk_mul_f32 v[168:169], v[168:169], v[200:201]
v_pk_mul_f32 v[170:171], v[170:171], v[202:203]
v_pk_mul_f32 v[172:173], v[172:173], v[204:205]
v_pk_mul_f32 v[174:175], v[174:175], v[206:207]
v_exp_f32 v160, v160
s_add_u32 m0, s86, 65536
v_exp_f32 v161, v161
s_add_u32 s95, s95, 0
v_exp_f32 v162, v162
buffer_load_dwordx4 v1, s[60:63], s95 offen offset:0 sc1 lds
v_exp_f32 v163, v163
v_exp_f32 v164, v164
v_exp_f32 v165, v165
buffer_load_dwordx4 v1, s[60:63], s95 offen offset:1024 sc1 lds
v_exp_f32 v166, v166
v_exp_f32 v167, v167
v_exp_f32 v168, v168
buffer_load_dwordx4 v1, s[60:63], s95 offen offset:2048 sc1 lds
v_exp_f32 v169, v169
v_exp_f32 v170, v170
v_exp_f32 v171, v171
buffer_load_dwordx4 v1, s[60:63], s95 offen offset:3072 sc1 lds
v_exp_f32 v172, v172
v_exp_f32 v173, v173
v_exp_f32 v174, v174
s_add_u32 m0, s86, 69632
v_exp_f32 v175, v175
s_add_u32 s95, s95, 4096
v_pk_add_f32 v[160:161], v[160:161], 1.0 op_sel_hi:[1,0]
v_pk_add_f32 v[162:163], v[162:163], 1.0 op_sel_hi:[1,0]
v_pk_add_f32 v[164:165], v[164:165], 1.0 op_sel_hi:[1,0]
v_pk_add_f32 v[166:167], v[166:167], 1.0 op_sel_hi:[1,0]
v_pk_add_f32 v[168:169], v[168:169], 1.0 op_sel_hi:[1,0]
v_pk_add_f32 v[170:171], v[170:171], 1.0 op_sel_hi:[1,0]
v_pk_add_f32 v[172:173], v[172:173], 1.0 op_sel_hi:[1,0]
v_pk_add_f32 v[174:175], v[174:175], 1.0 op_sel_hi:[1,0]
v_rcp_f32 v160, v160
buffer_load_dwordx4 v1, s[60:63], s95 offen offset:0 sc1 lds
v_rcp_f32 v161, v161
v_rcp_f32 v162, v162
v_rcp_f32 v163, v163
buffer_load_dwordx4 v1, s[60:63], s95 offen offset:1024 sc1 lds
v_rcp_f32 v164, v164
v_rcp_f32 v165, v165
v_rcp_f32 v166, v166
buffer_load_dwordx4 v1, s[60:63], s95 offen offset:2048 sc1 lds
v_rcp_f32 v167, v167
v_rcp_f32 v168, v168
v_rcp_f32 v169, v169
buffer_load_dwordx4 v1, s[60:63], s95 offen offset:3072 sc1 lds
v_rcp_f32 v170, v170
v_rcp_f32 v171, v171
v_rcp_f32 v172, v172
v_rcp_f32 v173, v173
v_rcp_f32 v174, v174
v_rcp_f32 v175, v175
v_pk_mul_f32 v[160:161], v[160:161], v[192:193]
v_pk_mul_f32 v[162:163], v[162:163], v[194:195]
v_pk_mul_f32 v[164:165], v[164:165], v[196:197]
v_pk_mul_f32 v[166:167], v[166:167], v[198:199]
v_pk_mul_f32 v[168:169], v[168:169], v[200:201]
v_pk_mul_f32 v[170:171], v[170:171], v[202:203]
v_pk_mul_f32 v[172:173], v[172:173], v[204:205]
v_pk_mul_f32 v[174:175], v[174:175], v[206:207]
v_cvt_pk_bf16_f32 v192, v160, v161
v_cvt_pk_bf16_f32 v193, v162, v163
v_cvt_pk_bf16_f32 v194, v164, v165
v_cvt_pk_bf16_f32 v195, v166, v167
v_cvt_pk_bf16_f32 v196, v168, v169
v_cvt_pk_bf16_f32 v197, v170, v171
v_cvt_pk_bf16_f32 v198, v172, v173
v_cvt_pk_bf16_f32 v199, v174, v175
v_pk_mul_f32 v[160:161], v[208:209], v[208:209]
v_pk_mul_f32 v[162:163], v[210:211], v[210:211]
v_pk_mul_f32 v[164:165], v[212:213], v[212:213]
v_pk_mul_f32 v[166:167], v[214:215], v[214:215]
v_pk_mul_f32 v[168:169], v[216:217], v[216:217]
v_pk_mul_f32 v[170:171], v[218:219], v[218:219]
v_pk_mul_f32 v[172:173], v[220:221], v[220:221]
v_pk_mul_f32 v[174:175], v[222:223], v[222:223]
v_pk_fma_f32 v[160:161], v[160:161], s[80:81], v[22:23]
v_pk_fma_f32 v[162:163], v[162:163], s[80:81], v[22:23]
v_pk_fma_f32 v[164:165], v[164:165], s[80:81], v[22:23]
v_pk_fma_f32 v[166:167], v[166:167], s[80:81], v[22:23]
v_pk_fma_f32 v[168:169], v[168:169], s[80:81], v[22:23]
v_pk_fma_f32 v[170:171], v[170:171], s[80:81], v[22:23]
v_pk_fma_f32 v[172:173], v[172:173], s[80:81], v[22:23]
v_pk_fma_f32 v[174:175], v[174:175], s[80:81], v[22:23]
v_pk_mul_f32 v[160:161], v[160:161], v[208:209]
v_pk_mul_f32 v[162:163], v[162:163], v[210:211]
v_pk_mul_f32 v[164:165], v[164:165], v[212:213]
v_pk_mul_f32 v[166:167], v[166:167], v[214:215]
v_pk_mul_f32 v[168:169], v[168:169], v[216:217]
v_pk_mul_f32 v[170:171], v[170:171], v[218:219]
v_pk_mul_f32 v[172:173], v[172:173], v[220:221]
v_pk_mul_f32 v[174:175], v[174:175], v[222:223]
v_exp_f32 v160, v160
s_lshr_b32 s101, s90, 2
v_exp_f32 v161, v161
s_mul_i32 s101, s101, 221184
v_exp_f32 v162, v162
s_and_b32 s84, s90, 3
v_exp_f32 v163, v163
s_lshl_b32 s84, s84, 10
v_exp_f32 v164, v164
s_add_u32 s101, s101, s84
v_exp_f32 v165, v165
s_add_u32 s101, s101, s82
v_exp_f32 v166, v166
s_add_u32 s84, s101, 4096
v_exp_f32 v167, v167
buffer_store_dwordx4 v[176:179], v1, s[56:59], s101 offen sc1
v_exp_f32 v168, v168
buffer_store_dwordx4 v[180:183], v1, s[56:59], s84 offen sc1
v_exp_f32 v169, v169
s_lshr_b32 s101, s91, 2
v_exp_f32 v170, v170
s_mul_i32 s101, s101, 221184
v_exp_f32 v171, v171
s_and_b32 s84, s91, 3
v_exp_f32 v172, v172
s_lshl_b32 s84, s84, 10
v_exp_f32 v173, v173
s_add_u32 s101, s101, s84
v_exp_f32 v174, v174
s_add_u32 s101, s101, s82
v_exp_f32 v175, v175
s_add_u32 s84, s101, 4096
v_pk_add_f32 v[160:161], v[160:161], 1.0 op_sel_hi:[1,0]
v_pk_add_f32 v[162:163], v[162:163], 1.0 op_sel_hi:[1,0]
v_pk_add_f32 v[164:165], v[164:165], 1.0 op_sel_hi:[1,0]
v_pk_add_f32 v[166:167], v[166:167], 1.0 op_sel_hi:[1,0]
v_pk_add_f32 v[168:169], v[168:169], 1.0 op_sel_hi:[1,0]
v_pk_add_f32 v[170:171], v[170:171], 1.0 op_sel_hi:[1,0]
v_pk_add_f32 v[172:173], v[172:173], 1.0 op_sel_hi:[1,0]
v_pk_add_f32 v[174:175], v[174:175], 1.0 op_sel_hi:[1,0]
v_rcp_f32 v160, v160
buffer_store_dwordx4 v[192:195], v1, s[56:59], s101 offen sc1
v_rcp_f32 v161, v161
buffer_store_dwordx4 v[196:199], v1, s[56:59], s84 offen sc1
v_rcp_f32 v162, v162
v_rcp_f32 v163, v163
v_rcp_f32 v164, v164
v_rcp_f32 v165, v165
v_rcp_f32 v166, v166
v_rcp_f32 v167, v167
v_rcp_f32 v168, v168
v_rcp_f32 v169, v169
v_rcp_f32 v170, v170
v_rcp_f32 v171, v171
v_rcp_f32 v172, v172
v_rcp_f32 v173, v173
v_rcp_f32 v174, v174
v_rcp_f32 v175, v175
v_pk_mul_f32 v[160:161], v[160:161], v[208:209]
v_pk_mul_f32 v[162:163], v[162:163], v[210:211]
v_pk_mul_f32 v[164:165], v[164:165], v[212:213]
v_pk_mul_f32 v[166:167], v[166:167], v[214:215]
v_pk_mul_f32 v[168:169], v[168:169], v[216:217]
v_pk_mul_f32 v[170:171], v[170:171], v[218:219]
v_pk_mul_f32 v[172:173], v[172:173], v[220:221]
v_pk_mul_f32 v[174:175], v[174:175], v[222:223]
v_cvt_pk_bf16_f32 v208, v160, v161
v_cvt_pk_bf16_f32 v209, v162, v163
v_cvt_pk_bf16_f32 v210, v164, v165
v_cvt_pk_bf16_f32 v211, v166, v167
v_cvt_pk_bf16_f32 v212, v168, v169
v_cvt_pk_bf16_f32 v213, v170, v171
v_cvt_pk_bf16_f32 v214, v172, v173
v_cvt_pk_bf16_f32 v215, v174, v175
v_pk_mul_f32 v[160:161], v[224:225], v[224:225]
v_pk_mul_f32 v[162:163], v[226:227], v[226:227]
v_pk_mul_f32 v[164:165], v[228:229], v[228:229]
v_pk_mul_f32 v[166:167], v[230:231], v[230:231]
v_pk_mul_f32 v[168:169], v[232:233], v[232:233]
v_pk_mul_f32 v[170:171], v[234:235], v[234:235]
v_pk_mul_f32 v[172:173], v[236:237], v[236:237]
v_pk_mul_f32 v[174:175], v[238:239], v[238:239]
v_pk_fma_f32 v[160:161], v[160:161], s[80:81], v[22:23]
v_pk_fma_f32 v[162:163], v[162:163], s[80:81], v[22:23]
v_pk_fma_f32 v[164:165], v[164:165], s[80:81], v[22:23]
v_pk_fma_f32 v[166:167], v[166:167], s[80:81], v[22:23]
v_pk_fma_f32 v[168:169], v[168:169], s[80:81], v[22:23]
v_pk_fma_f32 v[170:171], v[170:171], s[80:81], v[22:23]
v_pk_fma_f32 v[172:173], v[172:173], s[80:81], v[22:23]
v_pk_fma_f32 v[174:175], v[174:175], s[80:81], v[22:23]
v_pk_mul_f32 v[160:161], v[160:161], v[224:225]
v_pk_mul_f32 v[162:163], v[162:163], v[226:227]
v_pk_mul_f32 v[164:165], v[164:165], v[228:229]
v_pk_mul_f32 v[166:167], v[166:167], v[230:231]
v_pk_mul_f32 v[168:169], v[168:169], v[232:233]
v_pk_mul_f32 v[170:171], v[170:171], v[234:235]
v_pk_mul_f32 v[172:173], v[172:173], v[236:237]
v_pk_mul_f32 v[174:175], v[174:175], v[238:239]
v_exp_f32 v160, v160
s_lshr_b32 s101, s92, 2
v_exp_f32 v161, v161
s_mul_i32 s101, s101, 221184
v_exp_f32 v162, v162
s_and_b32 s84, s92, 3
v_exp_f32 v163, v163
s_lshl_b32 s84, s84, 10
v_exp_f32 v164, v164
s_add_u32 s101, s101, s84
v_exp_f32 v165, v165
s_add_u32 s101, s101, s82
v_exp_f32 v166, v166
s_add_u32 s84, s101, 4096
v_exp_f32 v167, v167
buffer_store_dwordx4 v[208:211], v1, s[56:59], s101 offen sc1
v_exp_f32 v168, v168
buffer_store_dwordx4 v[212:215], v1, s[56:59], s84 offen sc1
v_exp_f32 v169, v169
s_lshr_b32 s101, s93, 2
v_exp_f32 v170, v170
s_mul_i32 s101, s101, 221184
v_exp_f32 v171, v171
s_and_b32 s84, s93, 3
v_exp_f32 v172, v172
s_lshl_b32 s84, s84, 10
v_exp_f32 v173, v173
s_add_u32 s101, s101, s84
v_exp_f32 v174, v174
s_add_u32 s101, s101, s82
v_exp_f32 v175, v175
s_add_u32 s84, s101, 4096
v_pk_add_f32 v[160:161], v[160:161], 1.0 op_sel_hi:[1,0]
v_pk_add_f32 v[162:163], v[162:163], 1.0 op_sel_hi:[1,0]
v_pk_add_f32 v[164:165], v[164:165], 1.0 op_sel_hi:[1,0]
v_pk_add_f32 v[166:167], v[166:167], 1.0 op_sel_hi:[1,0]
v_pk_add_f32 v[168:169], v[168:169], 1.0 op_sel_hi:[1,0]
v_pk_add_f32 v[170:171], v[170:171], 1.0 op_sel_hi:[1,0]
v_pk_add_f32 v[172:173], v[172:173], 1.0 op_sel_hi:[1,0]
v_pk_add_f32 v[174:175], v[174:175], 1.0 op_sel_hi:[1,0]
v_rcp_f32 v160, v160
v_rcp_f32 v161, v161
v_rcp_f32 v162, v162
v_rcp_f32 v163, v163
v_rcp_f32 v164, v164
v_rcp_f32 v165, v165
v_rcp_f32 v166, v166
v_rcp_f32 v167, v167
v_rcp_f32 v168, v168
v_rcp_f32 v169, v169
v_rcp_f32 v170, v170
v_rcp_f32 v171, v171
v_rcp_f32 v172, v172
v_rcp_f32 v173, v173
v_rcp_f32 v174, v174
v_rcp_f32 v175, v175
v_pk_mul_f32 v[160:161], v[160:161], v[224:225]
v_pk_mul_f32 v[162:163], v[162:163], v[226:227]
v_pk_mul_f32 v[164:165], v[164:165], v[228:229]
v_pk_mul_f32 v[166:167], v[166:167], v[230:231]
v_pk_mul_f32 v[168:169], v[168:169], v[232:233]
v_pk_mul_f32 v[170:171], v[170:171], v[234:235]
v_pk_mul_f32 v[172:173], v[172:173], v[236:237]
v_pk_mul_f32 v[174:175], v[174:175], v[238:239]
v_cvt_pk_bf16_f32 v224, v160, v161
v_cvt_pk_bf16_f32 v225, v162, v163
v_cvt_pk_bf16_f32 v226, v164, v165
v_cvt_pk_bf16_f32 v227, v166, v167
v_cvt_pk_bf16_f32 v228, v168, v169
v_cvt_pk_bf16_f32 v229, v170, v171
v_cvt_pk_bf16_f32 v230, v172, v173
v_cvt_pk_bf16_f32 v231, v174, v175
s_mov_b32 s82, 0x3e0293ee
s_mov_b32 s83, s82
buffer_store_dwordx4 v[224:227], v1, s[56:59], s101 offen sc1
buffer_store_dwordx4 v[228:231], v1, s[56:59], s84 offen sc1
v_pk_mul_f32 v[32:33], v[32:33], s[82:83]
v_pk_mul_f32 v[34:35], v[34:35], s[82:83]
v_pk_mul_f32 v[36:37], v[36:37], s[82:83]
v_pk_mul_f32 v[38:39], v[38:39], s[82:83]
v_pk_mul_f32 v[40:41], v[40:41], s[82:83]
v_pk_mul_f32 v[42:43], v[42:43], s[82:83]
v_pk_mul_f32 v[44:45], v[44:45], s[82:83]
v_pk_mul_f32 v[46:47], v[46:47], s[82:83]
v_pk_mul_f32 v[48:49], v[48:49], s[82:83]
v_pk_mul_f32 v[50:51], v[50:51], s[82:83]
v_pk_mul_f32 v[52:53], v[52:53], s[82:83]
v_pk_mul_f32 v[54:55], v[54:55], s[82:83]
v_pk_mul_f32 v[56:57], v[56:57], s[82:83]
v_pk_mul_f32 v[58:59], v[58:59], s[82:83]
v_pk_mul_f32 v[60:61], v[60:61], s[82:83]
v_pk_mul_f32 v[62:63], v[62:63], s[82:83]
v_cvt_pk_bf16_f32 v176, v32, v33
v_cvt_pk_bf16_f32 v177, v34, v35
v_cvt_pk_bf16_f32 v178, v36, v37
v_cvt_pk_bf16_f32 v179, v38, v39
v_cvt_pk_bf16_f32 v180, v40, v41
v_cvt_pk_bf16_f32 v181, v42, v43
v_cvt_pk_bf16_f32 v182, v44, v45
v_cvt_pk_bf16_f32 v183, v46, v47
v_cvt_pk_bf16_f32 v184, v48, v49
v_cvt_pk_bf16_f32 v185, v50, v51
v_cvt_pk_bf16_f32 v186, v52, v53
v_cvt_pk_bf16_f32 v187, v54, v55
v_cvt_pk_bf16_f32 v188, v56, v57
v_cvt_pk_bf16_f32 v189, v58, v59
v_cvt_pk_bf16_f32 v190, v60, v61
v_cvt_pk_bf16_f32 v191, v62, v63
v_pk_mul_f32 v[64:65], v[64:65], s[82:83]
v_pk_mul_f32 v[66:67], v[66:67], s[82:83]
v_pk_mul_f32 v[68:69], v[68:69], s[82:83]
v_pk_mul_f32 v[70:71], v[70:71], s[82:83]
v_pk_mul_f32 v[72:73], v[72:73], s[82:83]
v_pk_mul_f32 v[74:75], v[74:75], s[82:83]
v_pk_mul_f32 v[76:77], v[76:77], s[82:83]
v_pk_mul_f32 v[78:79], v[78:79], s[82:83]
v_pk_mul_f32 v[80:81], v[80:81], s[82:83]
v_pk_mul_f32 v[82:83], v[82:83], s[82:83]
v_pk_mul_f32 v[84:85], v[84:85], s[82:83]
v_pk_mul_f32 v[86:87], v[86:87], s[82:83]
v_pk_mul_f32 v[88:89], v[88:89], s[82:83]
v_pk_mul_f32 v[90:91], v[90:91], s[82:83]
v_pk_mul_f32 v[92:93], v[92:93], s[82:83]
v_pk_mul_f32 v[94:95], v[94:95], s[82:83]
v_cvt_pk_bf16_f32 v192, v64, v65
v_cvt_pk_bf16_f32 v193, v66, v67
v_cvt_pk_bf16_f32 v194, v68, v69
v_cvt_pk_bf16_f32 v195, v70, v71
v_cvt_pk_bf16_f32 v196, v72, v73
v_cvt_pk_bf16_f32 v197, v74, v75
v_cvt_pk_bf16_f32 v198, v76, v77
v_cvt_pk_bf16_f32 v199, v78, v79
v_cvt_pk_bf16_f32 v200, v80, v81
v_cvt_pk_bf16_f32 v201, v82, v83
v_cvt_pk_bf16_f32 v202, v84, v85
v_cvt_pk_bf16_f32 v203, v86, v87
v_cvt_pk_bf16_f32 v204, v88, v89
v_cvt_pk_bf16_f32 v205, v90, v91
v_cvt_pk_bf16_f32 v206, v92, v93
v_cvt_pk_bf16_f32 v207, v94, v95
v_pk_mul_f32 v[96:97], v[96:97], s[82:83]
v_pk_mul_f32 v[98:99], v[98:99], s[82:83]
v_pk_mul_f32 v[100:101], v[100:101], s[82:83]
v_pk_mul_f32 v[102:103], v[102:103], s[82:83]
v_pk_mul_f32 v[104:105], v[104:105], s[82:83]
v_pk_mul_f32 v[106:107], v[106:107], s[82:83]
v_pk_mul_f32 v[108:109], v[108:109], s[82:83]
v_pk_mul_f32 v[110:111], v[110:111], s[82:83]
v_pk_mul_f32 v[112:113], v[112:113], s[82:83]
v_pk_mul_f32 v[114:115], v[114:115], s[82:83]
v_pk_mul_f32 v[116:117], v[116:117], s[82:83]
v_pk_mul_f32 v[118:119], v[118:119], s[82:83]
v_pk_mul_f32 v[120:121], v[120:121], s[82:83]
v_pk_mul_f32 v[122:123], v[122:123], s[82:83]
v_pk_mul_f32 v[124:125], v[124:125], s[82:83]
v_pk_mul_f32 v[126:127], v[126:127], s[82:83]
v_cvt_pk_bf16_f32 v208, v96, v97
v_cvt_pk_bf16_f32 v209, v98, v99
v_cvt_pk_bf16_f32 v210, v100, v101
v_cvt_pk_bf16_f32 v211, v102, v103
v_cvt_pk_bf16_f32 v212, v104, v105
v_cvt_pk_bf16_f32 v213, v106, v107
v_cvt_pk_bf16_f32 v214, v108, v109
v_cvt_pk_bf16_f32 v215, v110, v111
v_cvt_pk_bf16_f32 v216, v112, v113
v_cvt_pk_bf16_f32 v217, v114, v115
v_cvt_pk_bf16_f32 v218, v116, v117
v_cvt_pk_bf16_f32 v219, v118, v119
v_cvt_pk_bf16_f32 v220, v120, v121
v_cvt_pk_bf16_f32 v221, v122, v123
v_cvt_pk_bf16_f32 v222, v124, v125
v_cvt_pk_bf16_f32 v223, v126, v127
s_waitcnt vmcnt(16)
s_barrier
ds_read_b128 a[0:3], v14 offset:0
ds_read_b128 a[4:7], v14 offset:1024
ds_read_b128 a[8:11], v14 offset:2048
ds_read_b128 a[12:15], v14 offset:3072
ds_read_b128 a[16:19], v14 offset:4096
ds_read_b128 a[20:23], v14 offset:5120
ds_read_b128 a[24:27], v14 offset:6144
ds_read_b128 a[28:31], v14 offset:7168
v_pk_mul_f32 v[128:129], v[128:129], s[82:83]
v_pk_mul_f32 v[130:131], v[130:131], s[82:83]
v_pk_mul_f32 v[132:133], v[132:133], s[82:83]
v_pk_mul_f32 v[134:135], v[134:135], s[82:83]
v_pk_mul_f32 v[136:137], v[136:137], s[82:83]
v_pk_mul_f32 v[138:139], v[138:139], s[82:83]
v_pk_mul_f32 v[140:141], v[140:141], s[82:83]
v_pk_mul_f32 v[142:143], v[142:143], s[82:83]
v_pk_mul_f32 v[144:145], v[144:145], s[82:83]
v_pk_mul_f32 v[146:147], v[146:147], s[82:83]
v_pk_mul_f32 v[148:149], v[148:149], s[82:83]
v_pk_mul_f32 v[150:151], v[150:151], s[82:83]
v_pk_mul_f32 v[152:153], v[152:153], s[82:83]
v_pk_mul_f32 v[154:155], v[154:155], s[82:83]
v_pk_mul_f32 v[156:157], v[156:157], s[82:83]
v_pk_mul_f32 v[158:159], v[158:159], s[82:83]
v_cvt_pk_bf16_f32 v224, v128, v129
v_cvt_pk_bf16_f32 v225, v130, v131
v_cvt_pk_bf16_f32 v226, v132, v133
v_cvt_pk_bf16_f32 v227, v134, v135
v_cvt_pk_bf16_f32 v228, v136, v137
v_cvt_pk_bf16_f32 v229, v138, v139
v_cvt_pk_bf16_f32 v230, v140, v141
v_cvt_pk_bf16_f32 v231, v142, v143
v_cvt_pk_bf16_f32 v232, v144, v145
v_cvt_pk_bf16_f32 v233, v146, v147
v_cvt_pk_bf16_f32 v234, v148, v149
v_cvt_pk_bf16_f32 v235, v150, v151
v_cvt_pk_bf16_f32 v236, v152, v153
v_cvt_pk_bf16_f32 v237, v154, v155
v_cvt_pk_bf16_f32 v238, v156, v157
v_cvt_pk_bf16_f32 v239, v158, v159
s_lshl_b32 s89, s78, 1
s_cmp_ge_u32 s76, 2
s_waitcnt lgkmcnt(0)
s_cbranch_scc1 L_att_B1
v_mfma_f32_16x16x32_bf16 v[152:155], a[0:3], v[192:195], 0
s_mov_b32 s88, s35
ds_read_b128 a[96:99], v5 offset:0
ds_read_b64_tr_b16 a[128:129], v12 offset:0
v_accvgpr_read_b32 v144, a240
v_accvgpr_read_b32 v145, a241
v_mfma_f32_16x16x32_bf16 v[152:155], a[4:7], v[196:199], v[152:155]
s_mov_b32 s35, 1073741824
ds_read_b128 a[100:103], v5 offset:1024
ds_read_b64_tr_b16 a[130:131], v12 offset:4096
v_accvgpr_read_b32 v146, a242
v_accvgpr_read_b32 v147, a243
v_mfma_f32_16x16x32_bf16 v[152:155], a[8:11], v[200:203], v[152:155]
ds_read_b128 a[104:107], v5 offset:2048
ds_read_b64_tr_b16 a[132:133], v13 offset:0
v_accvgpr_read_b32 v148, a244
v_accvgpr_read_b32 v149, a245
v_mfma_f32_16x16x32_bf16 v[152:155], a[12:15], v[204:207], v[152:155]
ds_read_b128 a[108:111], v5 offset:3072
ds_read_b64_tr_b16 a[134:135], v13 offset:4096
v_accvgpr_read_b32 v150, a246
v_accvgpr_read_b32 v151, a247
v_mfma_f32_16x16x32_bf16 v[156:159], a[16:19], v[192:195], 0
ds_read_b128 a[112:115], v5 offset:4096
ds_read_b64_tr_b16 a[136:137], v12 offset:8192
v_mfma_f32_16x16x32_bf16 v[156:159], a[20:23], v[196:199], v[156:159]
ds_read_b128 a[116:119], v5 offset:5120
ds_read_b64_tr_b16 a[138:139], v12 offset:12288
v_mfma_f32_16x16x32_bf16 v[156:159], a[24:27], v[200:203], v[156:159]
ds_read_b128 a[120:123], v5 offset:6144
ds_read_b64_tr_b16 a[140:141], v13 offset:8192
v_mfma_f32_16x16x32_bf16 v[156:159], a[28:31], v[204:207], v[156:159]
ds_read_b128 a[124:127], v5 offset:7168
ds_read_b64_tr_b16 a[142:143], v13 offset:12288
v_mfma_f32_16x16x32_bf16 v[144:147], a[0:3], v[176:179], v[144:147]
ds_read_b64_tr_b16 a[144:145], v12 offset:16384
v_exp_f32 v152, v152
v_mfma_f32_16x16x32_bf16 v[144:147], a[4:7], v[180:183], v[144:147]
ds_read_b64_tr_b16 a[146:147], v12 offset:20480
v_exp_f32 v153, v153
s_nop 0
v_cvt_pk_bf16_f32 v244, v152, v153
v_mfma_f32_16x16x32_bf16 v[144:147], a[8:11], v[184:187], v[144:147]
ds_read_b64_tr_b16 a[148:149], v13 offset:16384
v_exp_f32 v154, v154
v_mfma_f32_16x16x32_bf16 v[144:147], a[12:15], v[188:191], v[144:147]
ds_read_b64_tr_b16 a[150:151], v13 offset:20480
v_exp_f32 v155, v155
s_nop 0
v_cvt_pk_bf16_f32 v245, v154, v155
v_mfma_f32_16x16x32_bf16 v[148:151], a[16:19], v[176:179], v[148:151]
ds_read_b64_tr_b16 a[152:153], v12 offset:24576
v_exp_f32 v156, v156
v_mfma_f32_16x16x32_bf16 v[148:151], a[20:23], v[180:183], v[148:151]
ds_read_b64_tr_b16 a[154:155], v12 offset:28672
v_exp_f32 v157, v157
s_nop 0
v_cvt_pk_bf16_f32 v246, v156, v157
v_mfma_f32_16x16x32_bf16 v[148:151], a[24:27], v[184:187], v[148:151]
ds_read_b64_tr_b16 a[156:157], v13 offset:24576
v_exp_f32 v158, v158
v_mfma_f32_16x16x32_bf16 v[148:151], a[28:31], v[188:191], v[148:151]
s_add_u32 m0, s99, s86
ds_read_b64_tr_b16 a[158:159], v13 offset:28672
v_exp_f32 v159, v159
s_nop 0
v_cvt_pk_bf16_f32 v247, v158, v159
v_mfma_f32_16x16x32_bf16 v[160:163], a[0:3], v[208:211], 0
v_exp_f32 v144, v144
v_mfma_f32_16x16x32_bf16 v[160:163], a[4:7], v[212:215], v[160:163]
buffer_load_dwordx4 v1, s[60:63], s87 offen offset:0 sc1 lds
v_mfma_f32_16x16x32_bf16 v[160:163], a[8:11], v[216:219], v[160:163]
v_exp_f32 v145, v145
v_mfma_f32_16x16x32_bf16 v[160:163], a[12:15], v[220:223], v[160:163]
s_waitcnt lgkmcnt(3)
ds_read_b128 a[64:67], v5 offset:8192
v_cvt_pk_bf16_f32 v240, v144, v145
v_mfma_f32_16x16x32_bf16 v[48:51], a[96:99], v[244:247], 0
v_exp_f32 v146, v146
v_mfma_f32_16x16x32_bf16 v[52:55], a[100:103], v[244:247], 0
buffer_load_dwordx4 v1, s[60:63], s87 offen offset:1024 sc1 lds
v_mfma_f32_16x16x32_bf16 v[56:59], a[104:107], v[244:247], 0
v_exp_f32 v147, v147
v_mfma_f32_16x16x32_bf16 v[60:63], a[108:111], v[244:247], 0
ds_read_b128 a[68:71], v5 offset:9216
v_cvt_pk_bf16_f32 v241, v146, v147
v_mfma_f32_16x16x32_bf16 v[164:167], a[16:19], v[208:211], 0
v_exp_f32 v148, v148
v_mfma_f32_16x16x32_bf16 v[164:167], a[20:23], v[212:215], v[164:167]
v_add_u32 v6, s98, v1
v_mfma_f32_16x16x32_bf16 v[164:167], a[24:27], v[216:219], v[164:167]
v_exp_f32 v149, v149
v_mfma_f32_16x16x32_bf16 v[164:167], a[28:31], v[220:223], v[164:167]
ds_read_b128 a[72:75], v5 offset:10240
v_cvt_pk_bf16_f32 v242, v148, v149
v_mfma_f32_16x16x32_bf16 v[64:67], a[112:115], v[244:247], 0
v_exp_f32 v150, v150
v_mfma_f32_16x16x32_bf16 v[68:71], a[116:119], v[244:247], 0
buffer_load_dwordx4 v1, s[60:63], s87 offen offset:2048 sc1 lds
v_mfma_f32_16x16x32_bf16 v[72:75], a[120:123], v[244:247], 0
v_exp_f32 v151, v151
v_mfma_f32_16x16x32_bf16 v[76:79], a[124:127], v[244:247], 0
ds_read_b128 a[76:79], v5 offset:11264
v_cvt_pk_bf16_f32 v243, v150, v151
v_mfma_f32_16x16x32_bf16 v[168:171], a[0:3], v[224:227], 0
s_lshl_b32 s82, s77, 14
v_exp_f32 v160, v160
v_mfma_f32_16x16x32_bf16 v[168:171], a[4:7], v[228:231], v[168:171]
buffer_load_dwordx4 v1, s[60:63], s87 offen offset:3072 sc1 lds
v_smfmac_f32_16x16x64_bf16 a[224:227], a[232:235], v[240:247], v7
s_add_u32 s82, s82, 33554432
v_mfma_f32_16x16x32_bf16 v[168:171], a[8:11], v[232:235], v[168:171]
s_add_u32 m0, m0, 4096
v_exp_f32 v161, v161
v_mfma_f32_16x16x32_bf16 v[168:171], a[12:15], v[236:239], v[168:171]
s_add_u32 s87, s87, 4096
ds_read_b128 a[80:83], v5 offset:12288
v_cvt_pk_bf16_f32 v248, v160, v161
v_mfma_f32_16x16x32_bf16 v[16:19], a[96:99], v[240:243], 0
s_lshr_b32 s94, s90, 2
v_exp_f32 v162, v162
v_mfma_f32_16x16x32_bf16 v[20:23], a[100:103], v[240:243], 0
buffer_load_dwordx4 v1, s[60:63], s87 offen offset:0 sc1 lds
v_mfma_f32_16x16x32_bf16 v[24:27], a[104:107], v[240:243], 0
s_lshl_b32 s94, s94, 19
v_exp_f32 v163, v163
v_mfma_f32_16x16x32_bf16 v[28:31], a[108:111], v[240:243], 0
s_and_b32 s83, s90, 3
ds_read_b128 a[84:87], v5 offset:13312
v_cvt_pk_bf16_f32 v249, v162, v163
v_mfma_f32_16x16x32_bf16 v[172:175], a[16:19], v[224:227], 0
s_lshl_b32 s83, s83, 10
v_exp_f32 v164, v164
v_mfma_f32_16x16x32_bf16 v[172:175], a[20:23], v[228:231], v[172:175]
s_add_u32 s94, s94, s83
v_mfma_f32_16x16x32_bf16 v[172:175], a[24:27], v[232:235], v[172:175]
s_add_u32 s94, s94, s82
v_exp_f32 v165, v165
v_mfma_f32_16x16x32_bf16 v[172:175], a[28:31], v[236:239], v[172:175]
s_lshr_b32 s95, s91, 2
ds_read_b128 a[88:91], v5 offset:14336
v_cvt_pk_bf16_f32 v250, v164, v165
v_mfma_f32_16x16x32_bf16 v[32:35], a[112:115], v[240:243], 0
s_lshl_b32 s95, s95, 19
v_exp_f32 v166, v166
v_mfma_f32_16x16x32_bf16 v[36:39], a[116:119], v[240:243], 0
s_waitcnt lgkmcnt(2)
buffer_load_dwordx4 v1, s[60:63], s87 offen offset:1024 sc1 lds
v_mfma_f32_16x16x32_bf16 v[40:43], a[120:123], v[240:243], 0
s_and_b32 s83, s91, 3
v_exp_f32 v167, v167
v_mfma_f32_16x16x32_bf16 v[44:47], a[124:127], v[240:243], 0
s_lshl_b32 s83, s83, 10
ds_read_b128 a[92:95], v5 offset:15360
v_cvt_pk_bf16_f32 v251, v166, v167
v_mfma_f32_16x16x32_bf16 v[152:155], a[64:67], v[192:195], 0
s_add_u32 s95, s95, s83
v_exp_f32 v168, v168
v_mfma_f32_16x16x32_bf16 v[152:155], a[68:71], v[196:199], v[152:155]
s_add_u32 s95, s95, s82
ds_read_b128 a[32:35], v6 offset:16384
v_mfma_f32_16x16x32_bf16 v[152:155], a[72:75], v[200:203], v[152:155]
s_lshr_b32 s96, s92, 2
v_exp_f32 v169, v169
v_mfma_f32_16x16x32_bf16 v[152:155], a[76:79], v[204:207], v[152:155]
s_lshl_b32 s96, s96, 19
ds_read_b128 a[36:39], v6 offset:17408
v_cvt_pk_bf16_f32 v252, v168, v169
v_mfma_f32_16x16x32_bf16 v[80:83], a[96:99], v[248:251], 0
s_and_b32 s83, s92, 3
v_exp_f32 v170, v170
v_mfma_f32_16x16x32_bf16 v[84:87], a[100:103], v[248:251], 0
s_waitcnt lgkmcnt(3)
buffer_load_dwordx4 v1, s[60:63], s87 offen offset:2048 sc1 lds
v_mfma_f32_16x16x32_bf16 v[88:91], a[104:107], v[248:251], 0
s_lshl_b32 s83, s83, 10
v_exp_f32 v171, v171
v_mfma_f32_16x16x32_bf16 v[92:95], a[108:111], v[248:251], 0
s_add_u32 s96, s96, s83
ds_read_b128 a[40:43], v6 offset:18432
v_cvt_pk_bf16_f32 v253, v170, v171
v_mfma_f32_16x16x32_bf16 v[156:159], a[80:83], v[192:195], 0
s_add_u32 s96, s96, s82
v_exp_f32 v172, v172
v_mfma_f32_16x16x32_bf16 v[156:159], a[84:87], v[196:199], v[156:159]
s_waitcnt lgkmcnt(2)
ds_read_b128 a[44:47], v6 offset:19456
buffer_load_dwordx4 v1, s[60:63], s87 offen offset:3072 sc1 lds
v_mfma_f32_16x16x32_bf16 v[156:159], a[88:91], v[200:203], v[156:159]
s_lshr_b32 s97, s93, 2
v_exp_f32 v173, v173
v_mfma_f32_16x16x32_bf16 v[156:159], a[92:95], v[204:207], v[156:159]
s_lshl_b32 s97, s97, 19
ds_read_b128 a[48:51], v6 offset:20480
v_cvt_pk_bf16_f32 v254, v172, v173
v_mfma_f32_16x16x32_bf16 v[96:99], a[112:115], v[248:251], 0
s_and_b32 s83, s93, 3
v_exp_f32 v174, v174
v_mfma_f32_16x16x32_bf16 v[100:103], a[116:119], v[248:251], 0
s_lshl_b32 s83, s83, 10
v_mfma_f32_16x16x32_bf16 v[104:107], a[120:123], v[248:251], 0
s_add_u32 s97, s97, s83
v_exp_f32 v175, v175
v_mfma_f32_16x16x32_bf16 v[108:111], a[124:127], v[248:251], 0
s_add_u32 s97, s97, s82
ds_read_b128 a[52:55], v6 offset:21504
v_cvt_pk_bf16_f32 v255, v174, v175
v_mfma_f32_16x16x32_bf16 v[160:163], a[64:67], v[208:211], 0
s_lshl_b32 s27, s22, 1
v_exp_f32 v152, v152
v_mfma_f32_16x16x32_bf16 v[160:163], a[68:71], v[212:215], v[160:163]
s_add_u32 s87, s87, 28672
v_smfmac_f32_16x16x64_bf16 a[228:231], a[232:235], v[248:255], v7
s_lshr_b32 s82, s76, 1
ds_read_b128 a[56:59], v6 offset:22528
v_mfma_f32_16x16x32_bf16 v[160:163], a[72:75], v[216:219], v[160:163]
s_add_u32 s82, s27, s82
v_exp_f32 v153, v153
v_mfma_f32_16x16x32_bf16 v[160:163], a[76:79], v[220:223], v[160:163]
s_lshl_b32 s82, s82, 2
ds_read_b128 a[60:63], v6 offset:23552
v_cvt_pk_bf16_f32 v244, v152, v153
v_mfma_f32_16x16x32_bf16 v[112:115], a[96:99], v[252:255], 0
s_add_u32 s83, s22, 0
v_exp_f32 v154, v154
v_mfma_f32_16x16x32_bf16 v[116:119], a[100:103], v[252:255], 0
s_cmp_eq_u32 s87, s34
s_cselect_b32 s80, 0x10000, 0
v_mfma_f32_16x16x32_bf16 v[120:123], a[104:107], v[252:255], 0
s_add_u32 s87, s87, s80
v_exp_f32 v155, v155
v_mfma_f32_16x16x32_bf16 v[124:127], a[108:111], v[252:255], 0
s_add_u32 s99, s99, 32768
ds_read_b128 a[0:3], v6 offset:24576
v_cvt_pk_bf16_f32 v245, v154, v155
v_mfma_f32_16x16x32_bf16 v[164:167], a[80:83], v[208:211], 0
s_and_b32 s99, s99, 0x1ffff
v_exp_f32 v156, v156
v_mfma_f32_16x16x32_bf16 v[164:167], a[84:87], v[212:215], v[164:167]
s_add_u32 s98, s98, 32768
buffer_store_dwordx4 a[128:131], v1, s[56:59], s36 offen offset:0 sc1
v_mfma_f32_16x16x32_bf16 v[164:167], a[88:91], v[216:219], v[164:167]
s_and_b32 s98, s98, 0x1ffff
v_exp_f32 v157, v157
v_mfma_f32_16x16x32_bf16 v[164:167], a[92:95], v[220:223], v[164:167]
s_and_b32 s83, s83, 3
ds_read_b128 a[4:7], v6 offset:25600
v_cvt_pk_bf16_f32 v246, v156, v157
v_mfma_f32_16x16x32_bf16 v[128:131], a[112:115], v[252:255], 0
s_add_u32 s83, s83, s82
v_exp_f32 v158, v158
v_mfma_f32_16x16x32_bf16 v[132:135], a[116:119], v[252:255], 0
s_lshl_b32 s68, s83, 10
v_mfma_f32_16x16x32_bf16 v[136:139], a[120:123], v[252:255], 0
s_add_u32 s83, s22, 1
v_exp_f32 v159, v159
v_mfma_f32_16x16x32_bf16 v[140:143], a[124:127], v[252:255], 0
s_and_b32 s83, s83, 3
ds_read_b128 a[8:11], v6 offset:26624
v_cvt_pk_bf16_f32 v247, v158, v159
v_mfma_f32_16x16x32_bf16 v[168:171], a[64:67], v[224:227], 0
s_add_u32 s83, s83, s82
v_exp_f32 v160, v160
v_mfma_f32_16x16x32_bf16 v[168:171], a[68:71], v[228:231], v[168:171]
s_lshl_b32 s69, s83, 10
v_add_u32 v5, s98, v1
v_smfmac_f32_16x16x64_bf16 a[224:227], a[236:239], v[240:247], v7
s_add_u32 s83, s22, 2
ds_read_b128 a[12:15], v6 offset:27648
v_mfma_f32_16x16x32_bf16 v[168:171], a[72:75], v[232:235], v[168:171]
s_and_b32 s83, s83, 3
v_exp_f32 v161, v161
v_mfma_f32_16x16x32_bf16 v[168:171], a[76:79], v[236:239], v[168:171]
s_add_u32 s83, s83, s82
ds_read_b128 a[16:19], v6 offset:28672
v_cvt_pk_bf16_f32 v248, v160, v161
v_mfma_f32_16x16x32_bf16 v[48:51], a[32:35], v[244:247], v[48:51]
s_lshl_b32 s70, s83, 10
s_waitcnt lgkmcnt(3)
v_exp_f32 v162, v162
v_mfma_f32_16x16x32_bf16 v[52:55], a[36:39], v[244:247], v[52:55]
s_add_u32 s83, s22, 3
v_mfma_f32_16x16x32_bf16 v[56:59], a[40:43], v[244:247], v[56:59]
s_and_b32 s83, s83, 3
v_exp_f32 v163, v163
v_mfma_f32_16x16x32_bf16 v[60:63], a[44:47], v[244:247], v[60:63]
s_add_u32 s83, s83, s82
ds_read_b128 a[20:23], v6 offset:29696
v_cvt_pk_bf16_f32 v249, v162, v163
v_mfma_f32_16x16x32_bf16 v[172:175], a[80:83], v[224:227], 0
s_lshl_b32 s71, s83, 10
v_exp_f32 v164, v164
v_mfma_f32_16x16x32_bf16 v[172:175], a[84:87], v[228:231], v[172:175]
buffer_store_dwordx4 a[132:135], v1, s[56:59], s36 offen offset:1024 sc1
v_mfma_f32_16x16x32_bf16 v[172:175], a[88:91], v[232:235], v[172:175]
s_and_b32 s83, s76, 1
v_exp_f32 v165, v165
v_mfma_f32_16x16x32_bf16 v[172:175], a[92:95], v[236:239], v[172:175]
s_add_u32 s27, s27, s83
ds_read_b128 a[24:27], v6 offset:30720
v_cvt_pk_bf16_f32 v250, v164, v165
v_mfma_f32_16x16x32_bf16 v[64:67], a[48:51], v[244:247], v[64:67]
s_mul_i32 s27, s27, 40960
v_exp_f32 v166, v166
v_mfma_f32_16x16x32_bf16 v[68:71], a[52:55], v[244:247], v[68:71]
s_lshl_b32 s83, s83, 1
v_mfma_f32_16x16x32_bf16 v[72:75], a[56:59], v[244:247], v[72:75]
s_lshr_b32 s82, s76, 1
v_exp_f32 v167, v167
v_mfma_f32_16x16x32_bf16 v[76:79], a[60:63], v[244:247], v[76:79]
s_add_u32 s83, s83, s82
ds_read_b128 a[28:31], v6 offset:31744
v_cvt_pk_bf16_f32 v251, v166, v167
v_mfma_f32_16x16x32_bf16 v[152:155], a[0:3], v[192:195], 0
s_waitcnt vmcnt(18)
v_exp_f32 v168, v168
v_mfma_f32_16x16x32_bf16 v[152:155], a[4:7], v[196:199], v[152:155]
s_barrier
s_waitcnt lgkmcnt(2)
ds_read_b128 a[96:99], v5 offset:0
v_mfma_f32_16x16x32_bf16 v[152:155], a[8:11], v[200:203], v[152:155]
s_add_u32 m0, s99, s86
v_exp_f32 v169, v169
v_mfma_f32_16x16x32_bf16 v[152:155], a[12:15], v[204:207], v[152:155]
s_mul_i32 s83, s83, 5120
ds_read_b128 a[100:103], v5 offset:1024
v_cvt_pk_bf16_f32 v252, v168, v169
v_mfma_f32_16x16x32_bf16 v[80:83], a[32:35], v[248:251], v[80:83]
s_and_b32 s82, s78, 1
v_exp_f32 v170, v170
v_mfma_f32_16x16x32_bf16 v[84:87], a[36:39], v[248:251], v[84:87]
buffer_load_dwordx4 v1, s[60:63], s87 offen offset:0 sc1 lds
v_mfma_f32_16x16x32_bf16 v[88:91], a[40:43], v[248:251], v[88:91]
s_mul_i32 s29, s82, 65536
v_exp_f32 v171, v171
v_mfma_f32_16x16x32_bf16 v[92:95], a[44:47], v[248:251], v[92:95]
s_add_u32 s29, s29, 32768
ds_read_b128 a[104:107], v5 offset:2048
v_cvt_pk_bf16_f32 v253, v170, v171
v_mfma_f32_16x16x32_bf16 v[156:159], a[16:19], v[192:195], 0
s_add_u32 s29, s29, s83
v_exp_f32 v172, v172
v_mfma_f32_16x16x32_bf16 v[156:159], a[20:23], v[196:199], v[156:159]
s_waitcnt lgkmcnt(2)
ds_read_b128 a[108:111], v5 offset:3072
buffer_store_dwordx4 a[136:139], v1, s[56:59], s37 offen offset:0 sc1
v_mfma_f32_16x16x32_bf16 v[156:159], a[24:27], v[200:203], v[156:159]
s_mul_i32 s32, s82, -57344
v_exp_f32 v173, v173
v_mfma_f32_16x16x32_bf16 v[156:159], a[28:31], v[204:207], v[156:159]
s_add_u32 s32, s32, 90112
ds_read_b128 a[112:115], v5 offset:4096
v_cvt_pk_bf16_f32 v254, v172, v173
v_mfma_f32_16x16x32_bf16 v[96:99], a[48:51], v[248:251], v[96:99]
s_add_u32 s32, s32, s83
v_exp_f32 v174, v174
v_mfma_f32_16x16x32_bf16 v[100:103], a[52:55], v[248:251], v[100:103]
buffer_load_dwordx4 v1, s[60:63], s87 offen offset:1024 sc1 lds
v_mfma_f32_16x16x32_bf16 v[104:107], a[56:59], v[248:251], v[104:107]
s_mul_i32 s33, s82, 69632
v_exp_f32 v175, v175
v_mfma_f32_16x16x32_bf16 v[108:111], a[60:63], v[248:251], v[108:111]
s_add_u32 s33, s33, 0
ds_read_b128 a[116:119], v5 offset:5120
v_cvt_pk_bf16_f32 v255, v174, v175
v_mfma_f32_16x16x32_bf16 v[160:163], a[0:3], v[208:211], 0
s_add_u32 s33, s33, s83
v_exp_f32 v152, v152
v_mfma_f32_16x16x32_bf16 v[160:163], a[4:7], v[212:215], v[160:163]
s_lshl_b32 s83, s76, 12
v_add_u32 v6, s98, v1
v_smfmac_f32_16x16x64_bf16 a[228:231], a[232:235], v[248:255], v7
s_mul_i32 s24, s82, 65536
ds_read_b128 a[120:123], v5 offset:6144
v_mfma_f32_16x16x32_bf16 v[160:163], a[8:11], v[216:219], v[160:163]
s_add_u32 s24, s24, 32768
v_exp_f32 v153, v153
v_mfma_f32_16x16x32_bf16 v[160:163], a[12:15], v[220:223], v[160:163]
s_add_u32 s24, s24, s83
ds_read_b128 a[124:127], v5 offset:7168
v_cvt_pk_bf16_f32 v244, v152, v153
v_mfma_f32_16x16x32_bf16 v[112:115], a[32:35], v[252:255], v[112:115]
s_mul_i32 s25, s82, -131072
v_exp_f32 v154, v154
v_mfma_f32_16x16x32_bf16 v[116:119], a[36:39], v[252:255], v[116:119]
buffer_load_dwordx4 v1, s[60:63], s87 offen offset:2048 sc1 lds
v_mfma_f32_16x16x32_bf16 v[120:123], a[40:43], v[252:255], v[120:123]
s_add_u32 s25, s25, 131072
v_exp_f32 v155, v155
v_mfma_f32_16x16x32_bf16 v[124:127], a[44:47], v[252:255], v[124:127]
s_add_u32 s25, s25, s83
ds_read_b128 a[64:67], v5 offset:8192
v_cvt_pk_bf16_f32 v245, v154, v155
v_mfma_f32_16x16x32_bf16 v[164:167], a[16:19], v[208:211], 0
s_mul_i32 s28, s82, -57344
v_exp_f32 v156, v156
v_mfma_f32_16x16x32_bf16 v[164:167], a[20:23], v[212:215], v[164:167]
buffer_load_dwordx4 v1, s[60:63], s87 offen offset:3072 sc1 lds
v_mfma_f32_16x16x32_bf16 v[164:167], a[24:27], v[216:219], v[164:167]
s_add_u32 s28, s28, 90112
v_exp_f32 v157, v157
v_mfma_f32_16x16x32_bf16 v[164:167], a[28:31], v[220:223], v[164:167]
s_add_u32 s28, s28, s83
ds_read_b128 a[68:71], v5 offset:9216
v_cvt_pk_bf16_f32 v246, v156, v157
v_mfma_f32_16x16x32_bf16 v[128:131], a[48:51], v[252:255], v[128:131]
v_exp_f32 v158, v158
v_mfma_f32_16x16x32_bf16 v[132:135], a[52:55], v[252:255], v[132:135]
buffer_store_dwordx4 a[140:143], v1, s[56:59], s37 offen offset:1024 sc1
v_mfma_f32_16x16x32_bf16 v[136:139], a[56:59], v[252:255], v[136:139]
v_exp_f32 v159, v159
v_mfma_f32_16x16x32_bf16 v[140:143], a[60:63], v[252:255], v[140:143]
ds_read_b128 a[72:75], v5 offset:10240
v_cvt_pk_bf16_f32 v247, v158, v159
v_mfma_f32_16x16x32_bf16 v[168:171], a[0:3], v[224:227], 0
v_exp_f32 v160, v160
v_accvgpr_read_b32 v152, a248
v_mfma_f32_16x16x32_bf16 v[168:171], a[4:7], v[228:231], v[168:171]
s_add_u32 m0, m0, 4096
v_accvgpr_read_b32 v153, a249
v_accvgpr_read_b32 v154, a250
v_accvgpr_read_b32 v155, a251
v_smfmac_f32_16x16x64_bf16 a[224:227], a[236:239], v[240:247], v7
s_add_u32 s87, s87, 4096
ds_read_b128 a[76:79], v5 offset:11264
v_accvgpr_read_b32 v156, a252
v_mfma_f32_16x16x32_bf16 v[168:171], a[8:11], v[232:235], v[168:171]
v_exp_f32 v161, v161
v_accvgpr_read_b32 v157, a253
v_mfma_f32_16x16x32_bf16 v[168:171], a[12:15], v[236:239], v[168:171]
ds_read_b128 a[80:83], v5 offset:12288
v_cvt_pk_bf16_f32 v248, v160, v161
v_accvgpr_read_b32 v158, a254
v_mfma_f32_16x16x32_bf16 v[48:51], a[96:99], v[244:247], v[48:51]
s_waitcnt lgkmcnt(3)
v_exp_f32 v162, v162
v_accvgpr_read_b32 v159, a255
v_mfma_f32_16x16x32_bf16 v[52:55], a[100:103], v[244:247], v[52:55]
buffer_load_dwordx4 v1, s[60:63], s87 offen offset:0 sc1 lds
v_mfma_f32_16x16x32_bf16 v[56:59], a[104:107], v[244:247], v[56:59]
v_exp_f32 v163, v163
v_mfma_f32_16x16x32_bf16 v[60:63], a[108:111], v[244:247], v[60:63]
ds_read_b128 a[84:87], v5 offset:13312
v_cvt_pk_bf16_f32 v249, v162, v163
v_mfma_f32_16x16x32_bf16 v[172:175], a[16:19], v[224:227], 0
v_exp_f32 v164, v164
v_mfma_f32_16x16x32_bf16 v[172:175], a[20:23], v[228:231], v[172:175]
buffer_load_dwordx4 v1, s[60:63], s87 offen offset:1024 sc1 lds
v_mfma_f32_16x16x32_bf16 v[172:175], a[24:27], v[232:235], v[172:175]
v_exp_f32 v165, v165
v_mfma_f32_16x16x32_bf16 v[172:175], a[28:31], v[236:239], v[172:175]
ds_read_b128 a[88:91], v5 offset:14336
v_cvt_pk_bf16_f32 v250, v164, v165
v_mfma_f32_16x16x32_bf16 v[64:67], a[112:115], v[244:247], v[64:67]
v_exp_f32 v166, v166
v_mfma_f32_16x16x32_bf16 v[68:71], a[116:119], v[244:247], v[68:71]
buffer_store_dwordx4 a[144:147], v1, s[56:59], s38 offen offset:0 sc1
v_mfma_f32_16x16x32_bf16 v[72:75], a[120:123], v[244:247], v[72:75]
v_exp_f32 v167, v167
v_mfma_f32_16x16x32_bf16 v[76:79], a[124:127], v[244:247], v[76:79]
ds_read_b128 a[92:95], v5 offset:15360
v_cvt_pk_bf16_f32 v251, v166, v167
v_mfma_f32_16x16x32_bf16 v[152:155], a[64:67], v[192:195], v[152:155]
v_exp_f32 v168, v168
v_mfma_f32_16x16x32_bf16 v[152:155], a[68:71], v[196:199], v[152:155]
s_waitcnt lgkmcnt(2)
ds_read_b128 a[32:35], v6 offset:16384
v_mfma_f32_16x16x32_bf16 v[152:155], a[72:75], v[200:203], v[152:155]
v_exp_f32 v169, v169
v_mfma_f32_16x16x32_bf16 v[152:155], a[76:79], v[204:207], v[152:155]
ds_read_b128 a[36:39], v6 offset:17408
v_cvt_pk_bf16_f32 v252, v168, v169
v_mfma_f32_16x16x32_bf16 v[80:83], a[96:99], v[248:251], v[80:83]
v_exp_f32 v170, v170
v_mfma_f32_16x16x32_bf16 v[84:87], a[100:103], v[248:251], v[84:87]
buffer_load_dwordx4 v1, s[60:63], s87 offen offset:2048 sc1 lds
v_mfma_f32_16x16x32_bf16 v[88:91], a[104:107], v[248:251], v[88:91]
v_exp_f32 v171, v171
v_mfma_f32_16x16x32_bf16 v[92:95], a[108:111], v[248:251], v[92:95]
ds_read_b128 a[40:43], v6 offset:18432
v_cvt_pk_bf16_f32 v253, v170, v171
v_mfma_f32_16x16x32_bf16 v[156:159], a[80:83], v[192:195], v[156:159]
v_exp_f32 v172, v172
v_mfma_f32_16x16x32_bf16 v[156:159], a[84:87], v[196:199], v[156:159]
s_waitcnt lgkmcnt(2)
ds_read_b128 a[44:47], v6 offset:19456
buffer_store_dwordx4 a[148:151], v1, s[56:59], s38 offen offset:1024 sc1
v_mfma_f32_16x16x32_bf16 v[156:159], a[88:91], v[200:203], v[156:159]
s_add_u32 s98, s98, 32768
v_exp_f32 v173, v173
v_mfma_f32_16x16x32_bf16 v[156:159], a[92:95], v[204:207], v[156:159]
s_and_b32 s98, s98, 0x1ffff
ds_read_b128 a[48:51], v6 offset:20480
v_cvt_pk_bf16_f32 v254, v172, v173
v_mfma_f32_16x16x32_bf16 v[96:99], a[112:115], v[248:251], v[96:99]
v_exp_f32 v174, v174
v_mfma_f32_16x16x32_bf16 v[100:103], a[116:119], v[248:251], v[100:103]
buffer_load_dwordx4 v1, s[60:63], s87 offen offset:3072 sc1 lds
v_mfma_f32_16x16x32_bf16 v[104:107], a[120:123], v[248:251], v[104:107]
v_exp_f32 v175, v175
v_mfma_f32_16x16x32_bf16 v[108:111], a[124:127], v[248:251], v[108:111]
ds_read_b128 a[52:55], v6 offset:21504
v_cvt_pk_bf16_f32 v255, v174, v175
v_mfma_f32_16x16x32_bf16 v[160:163], a[64:67], v[208:211], 0
v_exp_f32 v152, v152
v_mfma_f32_16x16x32_bf16 v[160:163], a[68:71], v[212:215], v[160:163]
v_smfmac_f32_16x16x64_bf16 a[228:231], a[232:235], v[248:255], v7
s_add_u32 s87, s87, 28672
ds_read_b128 a[56:59], v6 offset:22528
v_mfma_f32_16x16x32_bf16 v[160:163], a[72:75], v[216:219], v[160:163]
v_exp_f32 v153, v153
v_mfma_f32_16x16x32_bf16 v[160:163], a[76:79], v[220:223], v[160:163]
ds_read_b128 a[60:63], v6 offset:23552
v_cvt_pk_bf16_f32 v244, v152, v153
v_mfma_f32_16x16x32_bf16 v[112:115], a[96:99], v[252:255], v[112:115]
v_exp_f32 v154, v154
v_mfma_f32_16x16x32_bf16 v[116:119], a[100:103], v[252:255], v[116:119]
s_cmp_eq_u32 s87, s34
s_cselect_b32 s80, 0x10000, 0
v_add_u32 v5, s98, v1
v_mfma_f32_16x16x32_bf16 v[120:123], a[104:107], v[252:255], v[120:123]
s_add_u32 s87, s87, s80
v_exp_f32 v155, v155
v_mfma_f32_16x16x32_bf16 v[124:127], a[108:111], v[252:255], v[124:127]
s_add_u32 s99, s99, 32768
ds_read_b128 a[0:3], v6 offset:24576
v_cvt_pk_bf16_f32 v245, v154, v155
v_mfma_f32_16x16x32_bf16 v[164:167], a[80:83], v[208:211], 0
s_and_b32 s99, s99, 0x1ffff
v_exp_f32 v156, v156
v_mfma_f32_16x16x32_bf16 v[164:167], a[84:87], v[212:215], v[164:167]
buffer_store_dwordx4 a[152:155], v1, s[56:59], s39 offen offset:0 sc1
v_mfma_f32_16x16x32_bf16 v[164:167], a[88:91], v[216:219], v[164:167]
v_exp_f32 v157, v157
v_mfma_f32_16x16x32_bf16 v[164:167], a[92:95], v[220:223], v[164:167]
ds_read_b128 a[4:7], v6 offset:25600
v_cvt_pk_bf16_f32 v246, v156, v157
v_mfma_f32_16x16x32_bf16 v[128:131], a[112:115], v[252:255], v[128:131]
v_exp_f32 v158, v158
v_mfma_f32_16x16x32_bf16 v[132:135], a[116:119], v[252:255], v[132:135]
v_mfma_f32_16x16x32_bf16 v[136:139], a[120:123], v[252:255], v[136:139]
v_exp_f32 v159, v159
v_mfma_f32_16x16x32_bf16 v[140:143], a[124:127], v[252:255], v[140:143]
ds_read_b128 a[8:11], v6 offset:26624
v_cvt_pk_bf16_f32 v247, v158, v159
v_mfma_f32_16x16x32_bf16 v[168:171], a[64:67], v[224:227], 0
v_exp_f32 v160, v160
v_mfma_f32_16x16x32_bf16 v[168:171], a[68:71], v[228:231], v[168:171]
v_smfmac_f32_16x16x64_bf16 a[224:227], a[236:239], v[240:247], v7
ds_read_b128 a[12:15], v6 offset:27648
v_mfma_f32_16x16x32_bf16 v[168:171], a[72:75], v[232:235], v[168:171]
v_exp_f32 v161, v161
v_mfma_f32_16x16x32_bf16 v[168:171], a[76:79], v[236:239], v[168:171]
ds_read_b128 a[16:19], v6 offset:28672
v_cvt_pk_bf16_f32 v248, v160, v161
v_mfma_f32_16x16x32_bf16 v[48:51], a[32:35], v[244:247], v[48:51]
s_waitcnt lgkmcnt(3)
v_exp_f32 v162, v162
v_mfma_f32_16x16x32_bf16 v[52:55], a[36:39], v[244:247], v[52:55]
v_mfma_f32_16x16x32_bf16 v[56:59], a[40:43], v[244:247], v[56:59]
v_exp_f32 v163, v163
v_mfma_f32_16x16x32_bf16 v[60:63], a[44:47], v[244:247], v[60:63]
ds_read_b128 a[20:23], v6 offset:29696
v_cvt_pk_bf16_f32 v249, v162, v163
v_mfma_f32_16x16x32_bf16 v[172:175], a[80:83], v[224:227], 0
v_exp_f32 v164, v164
v_mfma_f32_16x16x32_bf16 v[172:175], a[84:87], v[228:231], v[172:175]
buffer_store_dwordx4 a[156:159], v1, s[56:59], s39 offen offset:1024 sc1
v_mfma_f32_16x16x32_bf16 v[172:175], a[88:91], v[232:235], v[172:175]
v_exp_f32 v165, v165
v_mfma_f32_16x16x32_bf16 v[172:175], a[92:95], v[236:239], v[172:175]
ds_read_b128 a[24:27], v6 offset:30720
v_cvt_pk_bf16_f32 v250, v164, v165
v_mfma_f32_16x16x32_bf16 v[64:67], a[48:51], v[244:247], v[64:67]
v_exp_f32 v166, v166
v_mfma_f32_16x16x32_bf16 v[68:71], a[52:55], v[244:247], v[68:71]
v_mfma_f32_16x16x32_bf16 v[72:75], a[56:59], v[244:247], v[72:75]
v_exp_f32 v167, v167
v_mfma_f32_16x16x32_bf16 v[76:79], a[60:63], v[244:247], v[76:79]
s_waitcnt lgkmcnt(1)
ds_read_b128 a[28:31], v6 offset:31744
v_cvt_pk_bf16_f32 v251, v166, v167
s_branch L_att_B2
L_att_B1:
v_mfma_f32_16x16x32_bf16 v[144:147], a[0:3], v[176:179], 0
s_mov_b32 s88, s35
ds_read_b128 a[96:99], v5 offset:0
ds_read_b64_tr_b16 a[128:129], v12 offset:0
v_mfma_f32_16x16x32_bf16 v[144:147], a[4:7], v[180:183], v[144:147]
s_mov_b32 s35, 1073741824
ds_read_b128 a[100:103], v5 offset:1024
ds_read_b64_tr_b16 a[130:131], v12 offset:4096
v_mfma_f32_16x16x32_bf16 v[144:147], a[8:11], v[184:187], v[144:147]
ds_read_b128 a[104:107], v5 offset:2048
ds_read_b64_tr_b16 a[132:133], v13 offset:0
v_mfma_f32_16x16x32_bf16 v[144:147], a[12:15], v[188:191], v[144:147]
ds_read_b128 a[108:111], v5 offset:3072
ds_read_b64_tr_b16 a[134:135], v13 offset:4096
v_mfma_f32_16x16x32_bf16 v[148:151], a[16:19], v[176:179], 0
ds_read_b128 a[112:115], v5 offset:4096
ds_read_b64_tr_b16 a[136:137], v12 offset:8192
v_mfma_f32_16x16x32_bf16 v[148:151], a[20:23], v[180:183], v[148:151]
ds_read_b128 a[116:119], v5 offset:5120
ds_read_b64_tr_b16 a[138:139], v12 offset:12288
v_mfma_f32_16x16x32_bf16 v[148:151], a[24:27], v[184:187], v[148:151]
ds_read_b128 a[120:123], v5 offset:6144
ds_read_b64_tr_b16 a[140:141], v13 offset:8192
v_mfma_f32_16x16x32_bf16 v[148:151], a[28:31], v[188:191], v[148:151]
ds_read_b128 a[124:127], v5 offset:7168
ds_read_b64_tr_b16 a[142:143], v13 offset:12288
v_mfma_f32_16x16x32_bf16 v[152:155], a[0:3], v[192:195], 0
ds_read_b64_tr_b16 a[144:145], v12 offset:16384
v_exp_f32 v144, v144
v_mfma_f32_16x16x32_bf16 v[152:155], a[4:7], v[196:199], v[152:155]
ds_read_b64_tr_b16 a[146:147], v12 offset:20480
v_exp_f32 v145, v145
s_nop 0
v_cvt_pk_bf16_f32 v240, v144, v145
v_mfma_f32_16x16x32_bf16 v[152:155], a[8:11], v[200:203], v[152:155]
ds_read_b64_tr_b16 a[148:149], v13 offset:16384
v_exp_f32 v146, v146
v_mfma_f32_16x16x32_bf16 v[152:155], a[12:15], v[204:207], v[152:155]
ds_read_b64_tr_b16 a[150:151], v13 offset:20480
v_exp_f32 v147, v147
s_nop 0
v_cvt_pk_bf16_f32 v241, v146, v147
v_mfma_f32_16x16x32_bf16 v[156:159], a[16:19], v[192:195], 0
ds_read_b64_tr_b16 a[152:153], v12 offset:24576
v_exp_f32 v148, v148
v_mfma_f32_16x16x32_bf16 v[156:159], a[20:23], v[196:199], v[156:159]
ds_read_b64_tr_b16 a[154:155], v12 offset:28672
v_exp_f32 v149, v149
s_nop 0
v_cvt_pk_bf16_f32 v242, v148, v149
v_mfma_f32_16x16x32_bf16 v[156:159], a[24:27], v[200:203], v[156:159]
ds_read_b64_tr_b16 a[156:157], v13 offset:24576
v_exp_f32 v150, v150
v_mfma_f32_16x16x32_bf16 v[156:159], a[28:31], v[204:207], v[156:159]
s_add_u32 m0, s99, s86
ds_read_b64_tr_b16 a[158:159], v13 offset:28672
v_exp_f32 v151, v151
s_nop 0
v_cvt_pk_bf16_f32 v243, v150, v151
v_mfma_f32_16x16x32_bf16 v[160:163], a[0:3], v[208:211], 0
v_exp_f32 v152, v152
v_mfma_f32_16x16x32_bf16 v[160:163], a[4:7], v[212:215], v[160:163]
buffer_load_dwordx4 v1, s[60:63], s87 offen offset:0 sc1 lds
v_mfma_f32_16x16x32_bf16 v[160:163], a[8:11], v[216:219], v[160:163]
v_exp_f32 v153, v153
v_mfma_f32_16x16x32_bf16 v[160:163], a[12:15], v[220:223], v[160:163]
s_waitcnt lgkmcnt(3)
ds_read_b128 a[64:67], v5 offset:8192
v_cvt_pk_bf16_f32 v244, v152, v153
v_mfma_f32_16x16x32_bf16 v[16:19], a[96:99], v[240:243], 0
v_exp_f32 v154, v154
v_mfma_f32_16x16x32_bf16 v[20:23], a[100:103], v[240:243], 0
buffer_load_dwordx4 v1, s[60:63], s87 offen offset:1024 sc1 lds
v_mfma_f32_16x16x32_bf16 v[24:27], a[104:107], v[240:243], 0
v_exp_f32 v155, v155
v_mfma_f32_16x16x32_bf16 v[28:31], a[108:111], v[240:243], 0
ds_read_b128 a[68:71], v5 offset:9216
v_cvt_pk_bf16_f32 v245, v154, v155
v_mfma_f32_16x16x32_bf16 v[164:167], a[16:19], v[208:211], 0
v_exp_f32 v156, v156
v_mfma_f32_16x16x32_bf16 v[164:167], a[20:23], v[212:215], v[164:167]
v_add_u32 v6, s98, v1
v_mfma_f32_16x16x32_bf16 v[164:167], a[24:27], v[216:219], v[164:167]
v_exp_f32 v157, v157
v_mfma_f32_16x16x32_bf16 v[164:167], a[28:31], v[220:223], v[164:167]
ds_read_b128 a[72:75], v5 offset:10240
v_cvt_pk_bf16_f32 v246, v156, v157
v_mfma_f32_16x16x32_bf16 v[32:35], a[112:115], v[240:243], 0
v_exp_f32 v158, v158
v_mfma_f32_16x16x32_bf16 v[36:39], a[116:119], v[240:243], 0
buffer_load_dwordx4 v1, s[60:63], s87 offen offset:2048 sc1 lds
v_mfma_f32_16x16x32_bf16 v[40:43], a[120:123], v[240:243], 0
v_exp_f32 v159, v159
v_mfma_f32_16x16x32_bf16 v[44:47], a[124:127], v[240:243], 0
ds_read_b128 a[76:79], v5 offset:11264
v_cvt_pk_bf16_f32 v247, v158, v159
v_mfma_f32_16x16x32_bf16 v[168:171], a[0:3], v[224:227], 0
s_lshl_b32 s82, s77, 14
v_exp_f32 v160, v160
v_accvgpr_read_b32 v144, a240
v_mfma_f32_16x16x32_bf16 v[168:171], a[4:7], v[228:231], v[168:171]
s_add_u32 s82, s82, 33554432
v_accvgpr_read_b32 v145, a241
v_accvgpr_read_b32 v146, a242
v_accvgpr_read_b32 v147, a243
v_smfmac_f32_16x16x64_bf16 a[224:227], a[232:235], v[240:247], v7
s_lshr_b32 s94, s90, 2
v_accvgpr_read_b32 v148, a244
v_accvgpr_read_b32 v149, a245
v_mfma_f32_16x16x32_bf16 v[168:171], a[8:11], v[232:235], v[168:171]
s_lshl_b32 s94, s94, 19
v_exp_f32 v161, v161
v_accvgpr_read_b32 v150, a246
v_mfma_f32_16x16x32_bf16 v[168:171], a[12:15], v[236:239], v[168:171]
s_and_b32 s83, s90, 3
ds_read_b128 a[80:83], v5 offset:12288
v_cvt_pk_bf16_f32 v248, v160, v161
v_accvgpr_read_b32 v151, a247
v_mfma_f32_16x16x32_bf16 v[48:51], a[96:99], v[244:247], 0
s_lshl_b32 s83, s83, 10
v_exp_f32 v162, v162
v_mfma_f32_16x16x32_bf16 v[52:55], a[100:103], v[244:247], 0
buffer_load_dwordx4 v1, s[60:63], s87 offen offset:3072 sc1 lds
v_mfma_f32_16x16x32_bf16 v[56:59], a[104:107], v[244:247], 0
s_add_u32 m0, m0, 4096
v_exp_f32 v163, v163
v_mfma_f32_16x16x32_bf16 v[60:63], a[108:111], v[244:247], 0
s_add_u32 s87, s87, 4096
ds_read_b128 a[84:87], v5 offset:13312
v_cvt_pk_bf16_f32 v249, v162, v163
v_mfma_f32_16x16x32_bf16 v[172:175], a[16:19], v[224:227], 0
s_add_u32 s94, s94, s83
v_exp_f32 v164, v164
v_mfma_f32_16x16x32_bf16 v[172:175], a[20:23], v[228:231], v[172:175]
buffer_load_dwordx4 v1, s[60:63], s87 offen offset:0 sc1 lds
v_mfma_f32_16x16x32_bf16 v[172:175], a[24:27], v[232:235], v[172:175]
s_add_u32 s94, s94, s82
v_exp_f32 v165, v165
v_mfma_f32_16x16x32_bf16 v[172:175], a[28:31], v[236:239], v[172:175]
s_lshr_b32 s95, s91, 2
ds_read_b128 a[88:91], v5 offset:14336
v_cvt_pk_bf16_f32 v250, v164, v165
v_mfma_f32_16x16x32_bf16 v[64:67], a[112:115], v[244:247], 0
s_lshl_b32 s95, s95, 19
v_exp_f32 v166, v166
v_mfma_f32_16x16x32_bf16 v[68:71], a[116:119], v[244:247], 0
s_waitcnt lgkmcnt(2)
buffer_load_dwordx4 v1, s[60:63], s87 offen offset:1024 sc1 lds
v_mfma_f32_16x16x32_bf16 v[72:75], a[120:123], v[244:247], 0
s_and_b32 s83, s91, 3
v_exp_f32 v167, v167
v_mfma_f32_16x16x32_bf16 v[76:79], a[124:127], v[244:247], 0
s_lshl_b32 s83, s83, 10
ds_read_b128 a[92:95], v5 offset:15360
v_cvt_pk_bf16_f32 v251, v166, v167
v_mfma_f32_16x16x32_bf16 v[144:147], a[64:67], v[176:179], v[144:147]
s_add_u32 s95, s95, s83
v_exp_f32 v168, v168
v_mfma_f32_16x16x32_bf16 v[144:147], a[68:71], v[180:183], v[144:147]
buffer_load_dwordx4 v1, s[60:63], s87 offen offset:2048 sc1 lds
v_mfma_f32_16x16x32_bf16 v[144:147], a[72:75], v[184:187], v[144:147]
s_add_u32 s95, s95, s82
v_exp_f32 v169, v169
v_mfma_f32_16x16x32_bf16 v[144:147], a[76:79], v[188:191], v[144:147]
s_lshr_b32 s96, s92, 2
ds_read_b128 a[32:35], v6 offset:16384
v_cvt_pk_bf16_f32 v252, v168, v169
v_mfma_f32_16x16x32_bf16 v[80:83], a[96:99], v[248:251], 0
s_lshl_b32 s96, s96, 19
v_exp_f32 v170, v170
v_mfma_f32_16x16x32_bf16 v[84:87], a[100:103], v[248:251], 0
s_waitcnt lgkmcnt(2)
buffer_load_dwordx4 v1, s[60:63], s87 offen offset:3072 sc1 lds
v_mfma_f32_16x16x32_bf16 v[88:91], a[104:107], v[248:251], 0
s_and_b32 s83, s92, 3
v_exp_f32 v171, v171
v_mfma_f32_16x16x32_bf16 v[92:95], a[108:111], v[248:251], 0
s_lshl_b32 s83, s83, 10
ds_read_b128 a[36:39], v6 offset:17408
v_cvt_pk_bf16_f32 v253, v170, v171
v_mfma_f32_16x16x32_bf16 v[148:151], a[80:83], v[176:179], v[148:151]
s_add_u32 s96, s96, s83
v_exp_f32 v172, v172
v_mfma_f32_16x16x32_bf16 v[148:151], a[84:87], v[180:183], v[148:151]
s_add_u32 s96, s96, s82
v_mfma_f32_16x16x32_bf16 v[148:151], a[88:91], v[184:187], v[148:151]
s_lshr_b32 s97, s93, 2
s_waitcnt lgkmcnt(1)
v_exp_f32 v173, v173
v_mfma_f32_16x16x32_bf16 v[148:151], a[92:95], v[188:191], v[148:151]
s_lshl_b32 s97, s97, 19
ds_read_b128 a[40:43], v6 offset:18432
v_cvt_pk_bf16_f32 v254, v172, v173
v_mfma_f32_16x16x32_bf16 v[96:99], a[112:115], v[248:251], 0
s_and_b32 s83, s93, 3
v_exp_f32 v174, v174
v_mfma_f32_16x16x32_bf16 v[100:103], a[116:119], v[248:251], 0
s_lshl_b32 s83, s83, 10
v_mfma_f32_16x16x32_bf16 v[104:107], a[120:123], v[248:251], 0
s_add_u32 s97, s97, s83
v_exp_f32 v175, v175
v_mfma_f32_16x16x32_bf16 v[108:111], a[124:127], v[248:251], 0
s_add_u32 s97, s97, s82
ds_read_b128 a[44:47], v6 offset:19456
v_cvt_pk_bf16_f32 v255, v174, v175
v_mfma_f32_16x16x32_bf16 v[152:155], a[64:67], v[192:195], 0
s_lshl_b32 s27, s22, 1
v_exp_f32 v144, v144
v_mfma_f32_16x16x32_bf16 v[152:155], a[68:71], v[196:199], v[152:155]
s_add_u32 s87, s87, 28672
v_smfmac_f32_16x16x64_bf16 a[228:231], a[232:235], v[248:255], v7
s_cmp_eq_u32 s87, s34
s_cselect_b32 s80, 0x10000, 0
v_mfma_f32_16x16x32_bf16 v[152:155], a[72:75], v[200:203], v[152:155]
s_add_u32 s87, s87, s80
v_exp_f32 v145, v145
v_mfma_f32_16x16x32_bf16 v[152:155], a[76:79], v[204:207], v[152:155]
s_add_u32 s99, s99, 32768
ds_read_b128 a[48:51], v6 offset:20480
v_cvt_pk_bf16_f32 v240, v144, v145
v_mfma_f32_16x16x32_bf16 v[112:115], a[96:99], v[252:255], 0
s_and_b32 s99, s99, 0x1ffff
v_exp_f32 v146, v146
v_mfma_f32_16x16x32_bf16 v[116:119], a[100:103], v[252:255], 0
s_add_u32 s98, s98, 32768
v_mfma_f32_16x16x32_bf16 v[120:123], a[104:107], v[252:255], 0
s_and_b32 s98, s98, 0x1ffff
v_exp_f32 v147, v147
v_mfma_f32_16x16x32_bf16 v[124:127], a[108:111], v[252:255], 0
s_lshr_b32 s82, s76, 1
ds_read_b128 a[52:55], v6 offset:21504
v_cvt_pk_bf16_f32 v241, v146, v147
v_mfma_f32_16x16x32_bf16 v[156:159], a[80:83], v[192:195], 0
s_add_u32 s82, s27, s82
v_exp_f32 v148, v148
v_mfma_f32_16x16x32_bf16 v[156:159], a[84:87], v[196:199], v[156:159]
buffer_store_dwordx4 a[128:131], v1, s[56:59], s36 offen offset:0 sc1
v_mfma_f32_16x16x32_bf16 v[156:159], a[88:91], v[200:203], v[156:159]
s_lshl_b32 s82, s82, 2
v_exp_f32 v149, v149
v_mfma_f32_16x16x32_bf16 v[156:159], a[92:95], v[204:207], v[156:159]
s_add_u32 s83, s22, 0
ds_read_b128 a[56:59], v6 offset:22528
v_cvt_pk_bf16_f32 v242, v148, v149
v_mfma_f32_16x16x32_bf16 v[128:131], a[112:115], v[252:255], 0
s_and_b32 s83, s83, 3
v_exp_f32 v150, v150
v_mfma_f32_16x16x32_bf16 v[132:135], a[116:119], v[252:255], 0
s_add_u32 s83, s83, s82
v_mfma_f32_16x16x32_bf16 v[136:139], a[120:123], v[252:255], 0
s_lshl_b32 s68, s83, 10
v_exp_f32 v151, v151
v_mfma_f32_16x16x32_bf16 v[140:143], a[124:127], v[252:255], 0
s_add_u32 s83, s22, 1
ds_read_b128 a[60:63], v6 offset:23552
v_cvt_pk_bf16_f32 v243, v150, v151
v_mfma_f32_16x16x32_bf16 v[160:163], a[64:67], v[208:211], 0
s_and_b32 s83, s83, 3
v_exp_f32 v152, v152
v_mfma_f32_16x16x32_bf16 v[160:163], a[68:71], v[212:215], v[160:163]
s_add_u32 s83, s83, s82
v_add_u32 v5, s98, v1
v_mfma_f32_16x16x32_bf16 v[160:163], a[72:75], v[216:219], v[160:163]
s_lshl_b32 s69, s83, 10
v_exp_f32 v153, v153
v_mfma_f32_16x16x32_bf16 v[160:163], a[76:79], v[220:223], v[160:163]
s_add_u32 s83, s22, 2
ds_read_b128 a[0:3], v6 offset:24576
v_cvt_pk_bf16_f32 v244, v152, v153
v_mfma_f32_16x16x32_bf16 v[16:19], a[32:35], v[240:243], v[16:19]
s_and_b32 s83, s83, 3
s_waitcnt lgkmcnt(2)
v_exp_f32 v154, v154
v_mfma_f32_16x16x32_bf16 v[20:23], a[36:39], v[240:243], v[20:23]
s_add_u32 s83, s83, s82
v_mfma_f32_16x16x32_bf16 v[24:27], a[40:43], v[240:243], v[24:27]
s_lshl_b32 s70, s83, 10
v_exp_f32 v155, v155
v_mfma_f32_16x16x32_bf16 v[28:31], a[44:47], v[240:243], v[28:31]
s_add_u32 s83, s22, 3
ds_read_b128 a[4:7], v6 offset:25600
v_cvt_pk_bf16_f32 v245, v154, v155
v_mfma_f32_16x16x32_bf16 v[164:167], a[80:83], v[208:211], 0
s_and_b32 s83, s83, 3
v_exp_f32 v156, v156
v_mfma_f32_16x16x32_bf16 v[164:167], a[84:87], v[212:215], v[164:167]
buffer_store_dwordx4 a[132:135], v1, s[56:59], s36 offen offset:1024 sc1
v_mfma_f32_16x16x32_bf16 v[164:167], a[88:91], v[216:219], v[164:167]
s_add_u32 s83, s83, s82
v_exp_f32 v157, v157
v_mfma_f32_16x16x32_bf16 v[164:167], a[92:95], v[220:223], v[164:167]
s_lshl_b32 s71, s83, 10
ds_read_b128 a[8:11], v6 offset:26624
v_cvt_pk_bf16_f32 v246, v156, v157
v_mfma_f32_16x16x32_bf16 v[32:35], a[48:51], v[240:243], v[32:35]
s_and_b32 s83, s76, 1
v_exp_f32 v158, v158
v_mfma_f32_16x16x32_bf16 v[36:39], a[52:55], v[240:243], v[36:39]
s_add_u32 s27, s27, s83
v_mfma_f32_16x16x32_bf16 v[40:43], a[56:59], v[240:243], v[40:43]
s_mul_i32 s27, s27, 40960
s_waitcnt lgkmcnt(1)
v_exp_f32 v159, v159
v_mfma_f32_16x16x32_bf16 v[44:47], a[60:63], v[240:243], v[44:47]
s_lshl_b32 s83, s83, 1
ds_read_b128 a[12:15], v6 offset:27648
v_cvt_pk_bf16_f32 v247, v158, v159
v_mfma_f32_16x16x32_bf16 v[168:171], a[64:67], v[224:227], 0
s_waitcnt vmcnt(18)
v_exp_f32 v160, v160
v_accvgpr_read_b32 v152, a248
v_mfma_f32_16x16x32_bf16 v[168:171], a[68:71], v[228:231], v[168:171]
s_barrier
v_accvgpr_read_b32 v153, a249
v_accvgpr_read_b32 v154, a250
v_accvgpr_read_b32 v155, a251
v_smfmac_f32_16x16x64_bf16 a[224:227], a[232:235], v[240:247], v7
s_add_u32 m0, s99, s86
v_accvgpr_read_b32 v156, a252
v_accvgpr_read_b32 v157, a253
v_mfma_f32_16x16x32_bf16 v[168:171], a[72:75], v[232:235], v[168:171]
s_lshr_b32 s82, s76, 1
v_exp_f32 v161, v161
v_accvgpr_read_b32 v158, a254
v_mfma_f32_16x16x32_bf16 v[168:171], a[76:79], v[236:239], v[168:171]
s_add_u32 s83, s83, s82
ds_read_b128 a[16:19], v6 offset:28672
v_cvt_pk_bf16_f32 v248, v160, v161
v_accvgpr_read_b32 v159, a255
v_mfma_f32_16x16x32_bf16 v[48:51], a[32:35], v[244:247], v[48:51]
s_mul_i32 s83, s83, 5120
v_exp_f32 v162, v162
v_mfma_f32_16x16x32_bf16 v[52:55], a[36:39], v[244:247], v[52:55]
buffer_load_dwordx4 v1, s[60:63], s87 offen offset:0 sc1 lds
v_mfma_f32_16x16x32_bf16 v[56:59], a[40:43], v[244:247], v[56:59]
s_and_b32 s82, s78, 1
v_exp_f32 v163, v163
v_mfma_f32_16x16x32_bf16 v[60:63], a[44:47], v[244:247], v[60:63]
s_mul_i32 s29, s82, 65536
ds_read_b128 a[20:23], v6 offset:29696
v_cvt_pk_bf16_f32 v249, v162, v163
v_mfma_f32_16x16x32_bf16 v[172:175], a[80:83], v[224:227], 0
s_add_u32 s29, s29, 32768
v_exp_f32 v164, v164
v_mfma_f32_16x16x32_bf16 v[172:175], a[84:87], v[228:231], v[172:175]
buffer_load_dwordx4 v1, s[60:63], s87 offen offset:1024 sc1 lds
v_mfma_f32_16x16x32_bf16 v[172:175], a[88:91], v[232:235], v[172:175]
s_add_u32 s29, s29, s83
v_exp_f32 v165, v165
v_mfma_f32_16x16x32_bf16 v[172:175], a[92:95], v[236:239], v[172:175]
s_mul_i32 s32, s82, -57344
ds_read_b128 a[24:27], v6 offset:30720
v_cvt_pk_bf16_f32 v250, v164, v165
v_mfma_f32_16x16x32_bf16 v[64:67], a[48:51], v[244:247], v[64:67]
s_add_u32 s32, s32, 90112
v_exp_f32 v166, v166
v_mfma_f32_16x16x32_bf16 v[68:71], a[52:55], v[244:247], v[68:71]
s_waitcnt lgkmcnt(2)
buffer_store_dwordx4 a[136:139], v1, s[56:59], s37 offen offset:0 sc1
v_mfma_f32_16x16x32_bf16 v[72:75], a[56:59], v[244:247], v[72:75]
s_add_u32 s32, s32, s83
v_exp_f32 v167, v167
v_mfma_f32_16x16x32_bf16 v[76:79], a[60:63], v[244:247], v[76:79]
s_mul_i32 s33, s82, 69632
ds_read_b128 a[28:31], v6 offset:31744
v_cvt_pk_bf16_f32 v251, v166, v167
v_mfma_f32_16x16x32_bf16 v[152:155], a[0:3], v[192:195], v[152:155]
s_add_u32 s33, s33, 0
v_exp_f32 v168, v168
v_mfma_f32_16x16x32_bf16 v[152:155], a[4:7], v[196:199], v[152:155]
s_add_u32 s33, s33, s83
ds_read_b128 a[96:99], v5 offset:0
v_mfma_f32_16x16x32_bf16 v[152:155], a[8:11], v[200:203], v[152:155]
s_lshl_b32 s83, s76, 12
v_exp_f32 v169, v169
v_mfma_f32_16x16x32_bf16 v[152:155], a[12:15], v[204:207], v[152:155]
s_mul_i32 s24, s82, 65536
ds_read_b128 a[100:103], v5 offset:1024
v_cvt_pk_bf16_f32 v252, v168, v169
v_mfma_f32_16x16x32_bf16 v[80:83], a[32:35], v[248:251], v[80:83]
s_add_u32 s24, s24, 32768
v_exp_f32 v170, v170
v_mfma_f32_16x16x32_bf16 v[84:87], a[36:39], v[248:251], v[84:87]
s_waitcnt lgkmcnt(3)
buffer_load_dwordx4 v1, s[60:63], s87 offen offset:2048 sc1 lds
v_mfma_f32_16x16x32_bf16 v[88:91], a[40:43], v[248:251], v[88:91]
s_add_u32 s24, s24, s83
v_exp_f32 v171, v171
v_mfma_f32_16x16x32_bf16 v[92:95], a[44:47], v[248:251], v[92:95]
s_mul_i32 s25, s82, -131072
ds_read_b128 a[104:107], v5 offset:2048
v_cvt_pk_bf16_f32 v253, v170, v171
v_mfma_f32_16x16x32_bf16 v[156:159], a[16:19], v[192:195], v[156:159]
s_add_u32 s25, s25, 131072
v_exp_f32 v172, v172
v_mfma_f32_16x16x32_bf16 v[156:159], a[20:23], v[196:199], v[156:159]
s_waitcnt lgkmcnt(2)
ds_read_b128 a[108:111], v5 offset:3072
buffer_store_dwordx4 a[140:143], v1, s[56:59], s37 offen offset:1024 sc1
v_mfma_f32_16x16x32_bf16 v[156:159], a[24:27], v[200:203], v[156:159]
s_add_u32 s25, s25, s83
v_exp_f32 v173, v173
v_mfma_f32_16x16x32_bf16 v[156:159], a[28:31], v[204:207], v[156:159]
s_mul_i32 s28, s82, -57344
ds_read_b128 a[112:115], v5 offset:4096
v_cvt_pk_bf16_f32 v254, v172, v173
v_mfma_f32_16x16x32_bf16 v[96:99], a[48:51], v[248:251], v[96:99]
s_add_u32 s28, s28, 90112
v_exp_f32 v174, v174
v_mfma_f32_16x16x32_bf16 v[100:103], a[52:55], v[248:251], v[100:103]
buffer_load_dwordx4 v1, s[60:63], s87 offen offset:3072 sc1 lds
v_mfma_f32_16x16x32_bf16 v[104:107], a[56:59], v[248:251], v[104:107]
s_add_u32 s28, s28, s83
v_exp_f32 v175, v175
v_mfma_f32_16x16x32_bf16 v[108:111], a[60:63], v[248:251], v[108:111]
ds_read_b128 a[116:119], v5 offset:5120
v_cvt_pk_bf16_f32 v255, v174, v175
v_mfma_f32_16x16x32_bf16 v[160:163], a[0:3], v[208:211], 0
v_exp_f32 v152, v152
v_mfma_f32_16x16x32_bf16 v[160:163], a[4:7], v[212:215], v[160:163]
s_add_u32 m0, m0, 4096
v_add_u32 v6, s98, v1
v_smfmac_f32_16x16x64_bf16 a[228:231], a[232:235], v[248:255], v7
s_add_u32 s87, s87, 4096
ds_read_b128 a[120:123], v5 offset:6144
v_mfma_f32_16x16x32_bf16 v[160:163], a[8:11], v[216:219], v[160:163]
v_exp_f32 v153, v153
v_mfma_f32_16x16x32_bf16 v[160:163], a[12:15], v[220:223], v[160:163]
ds_read_b128 a[124:127], v5 offset:7168
v_cvt_pk_bf16_f32 v244, v152, v153
v_mfma_f32_16x16x32_bf16 v[112:115], a[32:35], v[252:255], v[112:115]
v_exp_f32 v154, v154
v_mfma_f32_16x16x32_bf16 v[116:119], a[36:39], v[252:255], v[116:119]
buffer_load_dwordx4 v1, s[60:63], s87 offen offset:0 sc1 lds
v_mfma_f32_16x16x32_bf16 v[120:123], a[40:43], v[252:255], v[120:123]
v_exp_f32 v155, v155
v_mfma_f32_16x16x32_bf16 v[124:127], a[44:47], v[252:255], v[124:127]
ds_read_b128 a[64:67], v5 offset:8192
v_cvt_pk_bf16_f32 v245, v154, v155
v_mfma_f32_16x16x32_bf16 v[164:167], a[16:19], v[208:211], 0
v_exp_f32 v156, v156
v_mfma_f32_16x16x32_bf16 v[164:167], a[20:23], v[212:215], v[164:167]
buffer_load_dwordx4 v1, s[60:63], s87 offen offset:1024 sc1 lds
v_mfma_f32_16x16x32_bf16 v[164:167], a[24:27], v[216:219], v[164:167]
v_exp_f32 v157, v157
v_mfma_f32_16x16x32_bf16 v[164:167], a[28:31], v[220:223], v[164:167]
ds_read_b128 a[68:71], v5 offset:9216
v_cvt_pk_bf16_f32 v246, v156, v157
v_mfma_f32_16x16x32_bf16 v[128:131], a[48:51], v[252:255], v[128:131]
v_exp_f32 v158, v158
v_mfma_f32_16x16x32_bf16 v[132:135], a[52:55], v[252:255], v[132:135]
buffer_store_dwordx4 a[144:147], v1, s[56:59], s38 offen offset:0 sc1
v_mfma_f32_16x16x32_bf16 v[136:139], a[56:59], v[252:255], v[136:139]
v_exp_f32 v159, v159
v_mfma_f32_16x16x32_bf16 v[140:143], a[60:63], v[252:255], v[140:143]
ds_read_b128 a[72:75], v5 offset:10240
v_cvt_pk_bf16_f32 v247, v158, v159
v_mfma_f32_16x16x32_bf16 v[168:171], a[0:3], v[224:227], 0
v_exp_f32 v160, v160
v_mfma_f32_16x16x32_bf16 v[168:171], a[4:7], v[228:231], v[168:171]
v_smfmac_f32_16x16x64_bf16 a[224:227], a[236:239], v[240:247], v7
ds_read_b128 a[76:79], v5 offset:11264
v_mfma_f32_16x16x32_bf16 v[168:171], a[8:11], v[232:235], v[168:171]
v_exp_f32 v161, v161
v_mfma_f32_16x16x32_bf16 v[168:171], a[12:15], v[236:239], v[168:171]
ds_read_b128 a[80:83], v5 offset:12288
v_cvt_pk_bf16_f32 v248, v160, v161
v_mfma_f32_16x16x32_bf16 v[48:51], a[96:99], v[244:247], v[48:51]
s_waitcnt lgkmcnt(3)
v_exp_f32 v162, v162
v_mfma_f32_16x16x32_bf16 v[52:55], a[100:103], v[244:247], v[52:55]
buffer_load_dwordx4 v1, s[60:63], s87 offen offset:2048 sc1 lds
v_mfma_f32_16x16x32_bf16 v[56:59], a[104:107], v[244:247], v[56:59]
v_exp_f32 v163, v163
v_mfma_f32_16x16x32_bf16 v[60:63], a[108:111], v[244:247], v[60:63]
ds_read_b128 a[84:87], v5 offset:13312
v_cvt_pk_bf16_f32 v249, v162, v163
v_mfma_f32_16x16x32_bf16 v[172:175], a[16:19], v[224:227], 0
v_exp_f32 v164, v164
v_mfma_f32_16x16x32_bf16 v[172:175], a[20:23], v[228:231], v[172:175]
buffer_load_dwordx4 v1, s[60:63], s87 offen offset:3072 sc1 lds
v_mfma_f32_16x16x32_bf16 v[172:175], a[24:27], v[232:235], v[172:175]
v_exp_f32 v165, v165
v_mfma_f32_16x16x32_bf16 v[172:175], a[28:31], v[236:239], v[172:175]
ds_read_b128 a[88:91], v5 offset:14336
v_cvt_pk_bf16_f32 v250, v164, v165
v_mfma_f32_16x16x32_bf16 v[64:67], a[112:115], v[244:247], v[64:67]
v_exp_f32 v166, v166
v_mfma_f32_16x16x32_bf16 v[68:71], a[116:119], v[244:247], v[68:71]
buffer_store_dwordx4 a[148:151], v1, s[56:59], s38 offen offset:1024 sc1
v_mfma_f32_16x16x32_bf16 v[72:75], a[120:123], v[244:247], v[72:75]
v_exp_f32 v167, v167
v_mfma_f32_16x16x32_bf16 v[76:79], a[124:127], v[244:247], v[76:79]
ds_read_b128 a[92:95], v5 offset:15360
v_cvt_pk_bf16_f32 v251, v166, v167
v_mfma_f32_16x16x32_bf16 v[160:163], a[64:67], v[208:211], 0
v_exp_f32 v168, v168
v_mfma_f32_16x16x32_bf16 v[160:163], a[68:71], v[212:215], v[160:163]
s_waitcnt lgkmcnt(2)
ds_read_b128 a[32:35], v6 offset:16384
v_mfma_f32_16x16x32_bf16 v[160:163], a[72:75], v[216:219], v[160:163]
s_add_u32 s87, s87, 28672
v_exp_f32 v169, v169
v_mfma_f32_16x16x32_bf16 v[160:163], a[76:79], v[220:223], v[160:163]
ds_read_b128 a[36:39], v6 offset:17408
v_cvt_pk_bf16_f32 v252, v168, v169
v_mfma_f32_16x16x32_bf16 v[80:83], a[96:99], v[248:251], v[80:83]
v_exp_f32 v170, v170
v_mfma_f32_16x16x32_bf16 v[84:87], a[100:103], v[248:251], v[84:87]
s_cmp_eq_u32 s87, s34
s_cselect_b32 s80, 0x10000, 0
ds_read_b128 a[40:43], v6 offset:18432
v_mfma_f32_16x16x32_bf16 v[88:91], a[104:107], v[248:251], v[88:91]
s_add_u32 s87, s87, s80
v_exp_f32 v171, v171
v_mfma_f32_16x16x32_bf16 v[92:95], a[108:111], v[248:251], v[92:95]
s_add_u32 s99, s99, 32768
ds_read_b128 a[44:47], v6 offset:19456
v_cvt_pk_bf16_f32 v253, v170, v171
v_mfma_f32_16x16x32_bf16 v[164:167], a[80:83], v[208:211], 0
s_and_b32 s99, s99, 0x1ffff
v_exp_f32 v172, v172
v_mfma_f32_16x16x32_bf16 v[164:167], a[84:87], v[212:215], v[164:167]
s_waitcnt lgkmcnt(3)
ds_read_b128 a[48:51], v6 offset:20480
buffer_store_dwordx4 a[152:155], v1, s[56:59], s39 offen offset:0 sc1
v_mfma_f32_16x16x32_bf16 v[164:167], a[88:91], v[216:219], v[164:167]
s_add_u32 s98, s98, 32768
v_exp_f32 v173, v173
v_mfma_f32_16x16x32_bf16 v[164:167], a[92:95], v[220:223], v[164:167]
s_and_b32 s98, s98, 0x1ffff
ds_read_b128 a[52:55], v6 offset:21504
v_cvt_pk_bf16_f32 v254, v172, v173
v_mfma_f32_16x16x32_bf16 v[96:99], a[112:115], v[248:251], v[96:99]
v_exp_f32 v174, v174
v_mfma_f32_16x16x32_bf16 v[100:103], a[116:119], v[248:251], v[100:103]
ds_read_b128 a[56:59], v6 offset:22528
v_mfma_f32_16x16x32_bf16 v[104:107], a[120:123], v[248:251], v[104:107]
v_exp_f32 v175, v175
v_mfma_f32_16x16x32_bf16 v[108:111], a[124:127], v[248:251], v[108:111]
ds_read_b128 a[60:63], v6 offset:23552
v_cvt_pk_bf16_f32 v255, v174, v175
v_mfma_f32_16x16x32_bf16 v[168:171], a[64:67], v[224:227], 0
v_exp_f32 v160, v160
v_mfma_f32_16x16x32_bf16 v[168:171], a[68:71], v[228:231], v[168:171]
ds_read_b128 a[0:3], v6 offset:24576
v_smfmac_f32_16x16x64_bf16 a[228:231], a[232:235], v[248:255], v7
ds_read_b128 a[4:7], v6 offset:25600
v_mfma_f32_16x16x32_bf16 v[168:171], a[72:75], v[232:235], v[168:171]
v_exp_f32 v161, v161
v_mfma_f32_16x16x32_bf16 v[168:171], a[76:79], v[236:239], v[168:171]
ds_read_b128 a[8:11], v6 offset:26624
v_cvt_pk_bf16_f32 v248, v160, v161
v_mfma_f32_16x16x32_bf16 v[112:115], a[96:99], v[252:255], v[112:115]
v_exp_f32 v162, v162
v_mfma_f32_16x16x32_bf16 v[116:119], a[100:103], v[252:255], v[116:119]
ds_read_b128 a[12:15], v6 offset:27648
v_add_u32 v5, s98, v1
v_mfma_f32_16x16x32_bf16 v[120:123], a[104:107], v[252:255], v[120:123]
v_exp_f32 v163, v163
v_mfma_f32_16x16x32_bf16 v[124:127], a[108:111], v[252:255], v[124:127]
ds_read_b128 a[16:19], v6 offset:28672
v_cvt_pk_bf16_f32 v249, v162, v163
v_mfma_f32_16x16x32_bf16 v[172:175], a[80:83], v[224:227], 0
v_exp_f32 v164, v164
v_mfma_f32_16x16x32_bf16 v[172:175], a[84:87], v[228:231], v[172:175]
ds_read_b128 a[20:23], v6 offset:29696
buffer_store_dwordx4 a[156:159], v1, s[56:59], s39 offen offset:1024 sc1
v_mfma_f32_16x16x32_bf16 v[172:175], a[88:91], v[232:235], v[172:175]
v_exp_f32 v165, v165
v_mfma_f32_16x16x32_bf16 v[172:175], a[92:95], v[236:239], v[172:175]
ds_read_b128 a[24:27], v6 offset:30720
v_cvt_pk_bf16_f32 v250, v164, v165
v_mfma_f32_16x16x32_bf16 v[128:131], a[112:115], v[252:255], v[128:131]
v_exp_f32 v166, v166
v_mfma_f32_16x16x32_bf16 v[132:135], a[116:119], v[252:255], v[132:135]
v_mfma_f32_16x16x32_bf16 v[136:139], a[120:123], v[252:255], v[136:139]
v_exp_f32 v167, v167
v_mfma_f32_16x16x32_bf16 v[140:143], a[124:127], v[252:255], v[140:143]
s_waitcnt lgkmcnt(2)
ds_read_b128 a[28:31], v6 offset:31744
v_cvt_pk_bf16_f32 v251, v166, v167
L_att_B2:
s_cmp_eq_u32 s89, 0
s_cbranch_scc1 L_att_S
.p2align 4
L_att_A:
v_mfma_f32_16x16x32_bf16 v[144:147], a[0:3], v[176:179], 0
s_waitcnt vmcnt(8)
v_exp_f32 v168, v168
v_mfma_f32_16x16x32_bf16 v[144:147], a[4:7], v[180:183], v[144:147]
s_barrier
v_mfma_f32_16x16x32_bf16 v[144:147], a[8:11], v[184:187], v[144:147]
v_exp_f32 v169, v169
v_mfma_f32_16x16x32_bf16 v[144:147], a[12:15], v[188:191], v[144:147]
ds_read_b128 a[96:99], v5 offset:0
v_cvt_pk_bf16_f32 v252, v168, v169
v_mfma_f32_16x16x32_bf16 v[80:83], a[32:35], v[248:251], v[80:83]
v_exp_f32 v170, v170
v_mfma_f32_16x16x32_bf16 v[84:87], a[36:39], v[248:251], v[84:87]
buffer_atomic_add v3, v2, s[56:59], s35 offen sc1
v_mfma_f32_16x16x32_bf16 v[88:91], a[40:43], v[248:251], v[88:91]
v_exp_f32 v171, v171
v_mfma_f32_16x16x32_bf16 v[92:95], a[44:47], v[248:251], v[92:95]
s_waitcnt lgkmcnt(1)
ds_read_b128 a[100:103], v5 offset:1024
v_cvt_pk_bf16_f32 v253, v170, v171
v_mfma_f32_16x16x32_bf16 v[148:151], a[16:19], v[176:179], 0
s_add_u32 m0, s99, s86
v_exp_f32 v172, v172
v_mfma_f32_16x16x32_bf16 v[148:151], a[20:23], v[180:183], v[148:151]
buffer_load_dwordx4 v1, s[60:63], s87 offen offset:0 sc1 lds
v_mfma_f32_16x16x32_bf16 v[148:151], a[24:27], v[184:187], v[148:151]
v_exp_f32 v173, v173
v_mfma_f32_16x16x32_bf16 v[148:151], a[28:31], v[188:191], v[148:151]
ds_read_b128 a[104:107], v5 offset:2048
v_cvt_pk_bf16_f32 v254, v172, v173
v_mfma_f32_16x16x32_bf16 v[96:99], a[48:51], v[248:251], v[96:99]
v_exp_f32 v174, v174
v_mfma_f32_16x16x32_bf16 v[100:103], a[52:55], v[248:251], v[100:103]
v_mfma_f32_16x16x32_bf16 v[104:107], a[56:59], v[248:251], v[104:107]
v_exp_f32 v175, v175
v_mfma_f32_16x16x32_bf16 v[108:111], a[60:63], v[248:251], v[108:111]
ds_read_b128 a[108:111], v5 offset:3072
v_cvt_pk_bf16_f32 v255, v174, v175
v_mfma_f32_16x16x32_bf16 v[152:155], a[0:3], v[192:195], 0
v_exp_f32 v144, v144
v_mfma_f32_16x16x32_bf16 v[152:155], a[4:7], v[196:199], v[152:155]
v_add_u32 v6, s98, v1
v_smfmac_f32_16x16x64_bf16 a[228:231], a[232:235], v[248:255], v7
v_mfma_f32_16x16x32_bf16 v[152:155], a[8:11], v[200:203], v[152:155]
v_exp_f32 v145, v145
v_mfma_f32_16x16x32_bf16 v[152:155], a[12:15], v[204:207], v[152:155]
ds_read_b128 a[112:115], v5 offset:4096
v_cvt_pk_bf16_f32 v240, v144, v145
v_mfma_f32_16x16x32_bf16 v[112:115], a[32:35], v[252:255], v[112:115]
v_exp_f32 v146, v146
v_mfma_f32_16x16x32_bf16 v[116:119], a[36:39], v[252:255], v[116:119]
buffer_load_dwordx4 v1, s[60:63], s87 offen offset:1024 sc1 lds
v_mfma_f32_16x16x32_bf16 v[120:123], a[40:43], v[252:255], v[120:123]
v_exp_f32 v147, v147
v_mfma_f32_16x16x32_bf16 v[124:127], a[44:47], v[252:255], v[124:127]
ds_read_b128 a[116:119], v5 offset:5120
v_cvt_pk_bf16_f32 v241, v146, v147
v_mfma_f32_16x16x32_bf16 v[156:159], a[16:19], v[192:195], 0
v_exp_f32 v148, v148
v_mfma_f32_16x16x32_bf16 v[156:159], a[20:23], v[196:199], v[156:159]
buffer_load_dwordx4 v1, s[60:63], s87 offen offset:2048 sc1 lds
v_mfma_f32_16x16x32_bf16 v[156:159], a[24:27], v[200:203], v[156:159]
v_exp_f32 v149, v149
v_mfma_f32_16x16x32_bf16 v[156:159], a[28:31], v[204:207], v[156:159]
ds_read_b128 a[120:123], v5 offset:6144
v_cvt_pk_bf16_f32 v242, v148, v149
v_mfma_f32_16x16x32_bf16 v[128:131], a[48:51], v[252:255], v[128:131]
v_exp_f32 v150, v150
v_mfma_f32_16x16x32_bf16 v[132:135], a[52:55], v[252:255], v[132:135]
v_mfma_f32_16x16x32_bf16 v[136:139], a[56:59], v[252:255], v[136:139]
v_exp_f32 v151, v151
v_mfma_f32_16x16x32_bf16 v[140:143], a[60:63], v[252:255], v[140:143]
ds_read_b128 a[124:127], v5 offset:7168
v_cvt_pk_bf16_f32 v243, v150, v151
v_mfma_f32_16x16x32_bf16 v[160:163], a[0:3], v[208:211], 0
v_exp_f32 v152, v152
v_mfma_f32_16x16x32_bf16 v[160:163], a[4:7], v[212:215], v[160:163]
v_mfma_f32_16x16x32_bf16 v[160:163], a[8:11], v[216:219], v[160:163]
v_exp_f32 v153, v153
v_mfma_f32_16x16x32_bf16 v[160:163], a[12:15], v[220:223], v[160:163]
s_waitcnt lgkmcnt(1)
ds_read_b128 a[64:67], v5 offset:8192
v_cvt_pk_bf16_f32 v244, v152, v153
v_mfma_f32_16x16x32_bf16 v[16:19], a[96:99], v[240:243], v[16:19]
v_exp_f32 v154, v154
v_mfma_f32_16x16x32_bf16 v[20:23], a[100:103], v[240:243], v[20:23]
buffer_load_dwordx4 v1, s[60:63], s87 offen offset:3072 sc1 lds
v_mfma_f32_16x16x32_bf16 v[24:27], a[104:107], v[240:243], v[24:27]
v_exp_f32 v155, v155
v_mfma_f32_16x16x32_bf16 v[28:31], a[108:111], v[240:243], v[28:31]
s_add_u32 m0, m0, 4096
ds_read_b128 a[68:71], v5 offset:9216
v_cvt_pk_bf16_f32 v245, v154, v155
v_mfma_f32_16x16x32_bf16 v[164:167], a[16:19], v[208:211], 0
s_add_u32 s87, s87, 4096
v_exp_f32 v156, v156
v_mfma_f32_16x16x32_bf16 v[164:167], a[20:23], v[212:215], v[164:167]
buffer_load_dwordx4 v1, s[60:63], s87 offen offset:0 sc1 lds
v_mfma_f32_16x16x32_bf16 v[164:167], a[24:27], v[216:219], v[164:167]
v_exp_f32 v157, v157
v_mfma_f32_16x16x32_bf16 v[164:167], a[28:31], v[220:223], v[164:167]
ds_read_b128 a[72:75], v5 offset:10240
v_cvt_pk_bf16_f32 v246, v156, v157
v_mfma_f32_16x16x32_bf16 v[32:35], a[112:115], v[240:243], v[32:35]
v_exp_f32 v158, v158
v_mfma_f32_16x16x32_bf16 v[36:39], a[116:119], v[240:243], v[36:39]
v_mfma_f32_16x16x32_bf16 v[40:43], a[120:123], v[240:243], v[40:43]
s_waitcnt lgkmcnt(1)
v_exp_f32 v159, v159
v_mfma_f32_16x16x32_bf16 v[44:47], a[124:127], v[240:243], v[44:47]
ds_read_b128 a[76:79], v5 offset:11264
v_cvt_pk_bf16_f32 v247, v158, v159
v_mfma_f32_16x16x32_bf16 v[168:171], a[0:3], v[224:227], 0
v_exp_f32 v160, v160
v_mfma_f32_16x16x32_bf16 v[168:171], a[4:7], v[228:231], v[168:171]
v_smfmac_f32_16x16x64_bf16 a[224:227], a[232:235], v[240:247], v7
v_mfma_f32_16x16x32_bf16 v[168:171], a[8:11], v[232:235], v[168:171]
v_exp_f32 v161, v161
v_mfma_f32_16x16x32_bf16 v[168:171], a[12:15], v[236:239], v[168:171]
ds_read_b128 a[80:83], v5 offset:12288
v_cvt_pk_bf16_f32 v248, v160, v161
v_mfma_f32_16x16x32_bf16 v[48:51], a[96:99], v[244:247], v[48:51]
v_exp_f32 v162, v162
v_mfma_f32_16x16x32_bf16 v[52:55], a[100:103], v[244:247], v[52:55]
buffer_load_dwordx4 v1, s[60:63], s87 offen offset:1024 sc1 lds
v_mfma_f32_16x16x32_bf16 v[56:59], a[104:107], v[244:247], v[56:59]
v_exp_f32 v163, v163
v_mfma_f32_16x16x32_bf16 v[60:63], a[108:111], v[244:247], v[60:63]
ds_read_b128 a[84:87], v5 offset:13312
v_cvt_pk_bf16_f32 v249, v162, v163
v_mfma_f32_16x16x32_bf16 v[172:175], a[16:19], v[224:227], 0
v_exp_f32 v164, v164
v_mfma_f32_16x16x32_bf16 v[172:175], a[20:23], v[228:231], v[172:175]
buffer_load_dwordx4 v1, s[60:63], s87 offen offset:2048 sc1 lds
v_mfma_f32_16x16x32_bf16 v[172:175], a[24:27], v[232:235], v[172:175]
v_exp_f32 v165, v165
v_mfma_f32_16x16x32_bf16 v[172:175], a[28:31], v[236:239], v[172:175]
ds_read_b128 a[88:91], v5 offset:14336
v_cvt_pk_bf16_f32 v250, v164, v165
v_mfma_f32_16x16x32_bf16 v[64:67], a[112:115], v[244:247], v[64:67]
v_exp_f32 v166, v166
v_mfma_f32_16x16x32_bf16 v[68:71], a[116:119], v[244:247], v[68:71]
v_mfma_f32_16x16x32_bf16 v[72:75], a[120:123], v[244:247], v[72:75]
v_exp_f32 v167, v167
v_mfma_f32_16x16x32_bf16 v[76:79], a[124:127], v[244:247], v[76:79]
ds_read_b128 a[92:95], v5 offset:15360
v_cvt_pk_bf16_f32 v251, v166, v167
v_mfma_f32_16x16x32_bf16 v[144:147], a[64:67], v[176:179], 0
v_exp_f32 v168, v168
v_mfma_f32_16x16x32_bf16 v[144:147], a[68:71], v[180:183], v[144:147]
s_waitcnt lgkmcnt(2)
v_mfma_f32_16x16x32_bf16 v[144:147], a[72:75], v[184:187], v[144:147]
v_exp_f32 v169, v169
v_mfma_f32_16x16x32_bf16 v[144:147], a[76:79], v[188:191], v[144:147]
ds_read_b128 a[32:35], v6 offset:16384
v_cvt_pk_bf16_f32 v252, v168, v169
v_mfma_f32_16x16x32_bf16 v[80:83], a[96:99], v[248:251], v[80:83]
v_exp_f32 v170, v170
v_mfma_f32_16x16x32_bf16 v[84:87], a[100:103], v[248:251], v[84:87]
buffer_load_dwordx4 v1, s[60:63], s87 offen offset:3072 sc1 lds
v_mfma_f32_16x16x32_bf16 v[88:91], a[104:107], v[248:251], v[88:91]
v_exp_f32 v171, v171
v_mfma_f32_16x16x32_bf16 v[92:95], a[108:111], v[248:251], v[92:95]
ds_read_b128 a[36:39], v6 offset:17408
v_cvt_pk_bf16_f32 v253, v170, v171
v_mfma_f32_16x16x32_bf16 v[148:151], a[80:83], v[176:179], 0
v_exp_f32 v172, v172
v_mfma_f32_16x16x32_bf16 v[148:151], a[84:87], v[180:183], v[148:151]
s_waitcnt lgkmcnt(2)
v_mfma_f32_16x16x32_bf16 v[148:151], a[88:91], v[184:187], v[148:151]
v_exp_f32 v173, v173
v_mfma_f32_16x16x32_bf16 v[148:151], a[92:95], v[188:191], v[148:151]
ds_read_b128 a[40:43], v6 offset:18432
v_cvt_pk_bf16_f32 v254, v172, v173
v_mfma_f32_16x16x32_bf16 v[96:99], a[112:115], v[248:251], v[96:99]
v_exp_f32 v174, v174
v_mfma_f32_16x16x32_bf16 v[100:103], a[116:119], v[248:251], v[100:103]
v_mfma_f32_16x16x32_bf16 v[104:107], a[120:123], v[248:251], v[104:107]
v_exp_f32 v175, v175
v_mfma_f32_16x16x32_bf16 v[108:111], a[124:127], v[248:251], v[108:111]
ds_read_b128 a[44:47], v6 offset:19456
v_cvt_pk_bf16_f32 v255, v174, v175
v_mfma_f32_16x16x32_bf16 v[152:155], a[64:67], v[192:195], 0
v_exp_f32 v144, v144
v_mfma_f32_16x16x32_bf16 v[152:155], a[68:71], v[196:199], v[152:155]
s_add_u32 s87, s87, 28672
v_smfmac_f32_16x16x64_bf16 a[228:231], a[232:235], v[248:255], v7
s_cmp_eq_u32 s87, s34
s_cselect_b32 s80, 0x10000, 0
v_mfma_f32_16x16x32_bf16 v[152:155], a[72:75], v[200:203], v[152:155]
s_add_u32 s87, s87, s80
v_exp_f32 v145, v145
v_mfma_f32_16x16x32_bf16 v[152:155], a[76:79], v[204:207], v[152:155]
s_add_u32 s99, s99, 32768
ds_read_b128 a[48:51], v6 offset:20480
v_cvt_pk_bf16_f32 v240, v144, v145
v_mfma_f32_16x16x32_bf16 v[112:115], a[96:99], v[252:255], v[112:115]
s_and_b32 s99, s99, 0x1ffff
v_exp_f32 v146, v146
v_mfma_f32_16x16x32_bf16 v[116:119], a[100:103], v[252:255], v[116:119]
s_add_u32 s98, s98, 32768
v_mfma_f32_16x16x32_bf16 v[120:123], a[104:107], v[252:255], v[120:123]
s_and_b32 s98, s98, 0x1ffff
v_exp_f32 v147, v147
v_mfma_f32_16x16x32_bf16 v[124:127], a[108:111], v[252:255], v[124:127]
s_mov_b32 s35, s88
ds_read_b128 a[52:55], v6 offset:21504
v_cvt_pk_bf16_f32 v241, v146, v147
v_mfma_f32_16x16x32_bf16 v[156:159], a[80:83], v[192:195], 0
s_mov_b32 s88, 1073741824
v_exp_f32 v148, v148
v_mfma_f32_16x16x32_bf16 v[156:159], a[84:87], v[196:199], v[156:159]
v_mfma_f32_16x16x32_bf16 v[156:159], a[88:91], v[200:203], v[156:159]
v_exp_f32 v149, v149
v_mfma_f32_16x16x32_bf16 v[156:159], a[92:95], v[204:207], v[156:159]
ds_read_b128 a[56:59], v6 offset:22528
v_cvt_pk_bf16_f32 v242, v148, v149
v_mfma_f32_16x16x32_bf16 v[128:131], a[112:115], v[252:255], v[128:131]
v_exp_f32 v150, v150
v_mfma_f32_16x16x32_bf16 v[132:135], a[116:119], v[252:255], v[132:135]
v_mfma_f32_16x16x32_bf16 v[136:139], a[120:123], v[252:255], v[136:139]
v_exp_f32 v151, v151
v_mfma_f32_16x16x32_bf16 v[140:143], a[124:127], v[252:255], v[140:143]
ds_read_b128 a[60:63], v6 offset:23552
v_cvt_pk_bf16_f32 v243, v150, v151
v_mfma_f32_16x16x32_bf16 v[160:163], a[64:67], v[208:211], 0
v_exp_f32 v152, v152
v_mfma_f32_16x16x32_bf16 v[160:163], a[68:71], v[212:215], v[160:163]
v_mfma_f32_16x16x32_bf16 v[160:163], a[72:75], v[216:219], v[160:163]
v_exp_f32 v153, v153
v_mfma_f32_16x16x32_bf16 v[160:163], a[76:79], v[220:223], v[160:163]
s_waitcnt lgkmcnt(1)
ds_read_b128 a[0:3], v6 offset:24576
v_cvt_pk_bf16_f32 v244, v152, v153
v_mfma_f32_16x16x32_bf16 v[16:19], a[32:35], v[240:243], v[16:19]
v_exp_f32 v154, v154
v_mfma_f32_16x16x32_bf16 v[20:23], a[36:39], v[240:243], v[20:23]
v_add_u32 v5, s98, v1
v_mfma_f32_16x16x32_bf16 v[24:27], a[40:43], v[240:243], v[24:27]
v_exp_f32 v155, v155
v_mfma_f32_16x16x32_bf16 v[28:31], a[44:47], v[240:243], v[28:31]
ds_read_b128 a[4:7], v6 offset:25600
v_cvt_pk_bf16_f32 v245, v154, v155
v_mfma_f32_16x16x32_bf16 v[164:167], a[80:83], v[208:211], 0
v_exp_f32 v156, v156
v_mfma_f32_16x16x32_bf16 v[164:167], a[84:87], v[212:215], v[164:167]
v_mfma_f32_16x16x32_bf16 v[164:167], a[88:91], v[216:219], v[164:167]
v_exp_f32 v157, v157
v_mfma_f32_16x16x32_bf16 v[164:167], a[92:95], v[220:223], v[164:167]
ds_read_b128 a[8:11], v6 offset:26624
v_cvt_pk_bf16_f32 v246, v156, v157
v_mfma_f32_16x16x32_bf16 v[32:35], a[48:51], v[240:243], v[32:35]
v_exp_f32 v158, v158
v_mfma_f32_16x16x32_bf16 v[36:39], a[52:55], v[240:243], v[36:39]
v_mfma_f32_16x16x32_bf16 v[40:43], a[56:59], v[240:243], v[40:43]
s_waitcnt lgkmcnt(1)
v_exp_f32 v159, v159
v_mfma_f32_16x16x32_bf16 v[44:47], a[60:63], v[240:243], v[44:47]
ds_read_b128 a[12:15], v6 offset:27648
v_cvt_pk_bf16_f32 v247, v158, v159
v_mfma_f32_16x16x32_bf16 v[168:171], a[64:67], v[224:227], 0
v_exp_f32 v160, v160
v_mfma_f32_16x16x32_bf16 v[168:171], a[68:71], v[228:231], v[168:171]
v_smfmac_f32_16x16x64_bf16 a[224:227], a[232:235], v[240:247], v7
v_mfma_f32_16x16x32_bf16 v[168:171], a[72:75], v[232:235], v[168:171]
v_exp_f32 v161, v161
v_mfma_f32_16x16x32_bf16 v[168:171], a[76:79], v[236:239], v[168:171]
ds_read_b128 a[16:19], v6 offset:28672
v_cvt_pk_bf16_f32 v248, v160, v161
v_mfma_f32_16x16x32_bf16 v[48:51], a[32:35], v[244:247], v[48:51]
v_exp_f32 v162, v162
v_mfma_f32_16x16x32_bf16 v[52:55], a[36:39], v[244:247], v[52:55]
v_mfma_f32_16x16x32_bf16 v[56:59], a[40:43], v[244:247], v[56:59]
v_exp_f32 v163, v163
v_mfma_f32_16x16x32_bf16 v[60:63], a[44:47], v[244:247], v[60:63]
s_sub_u32 s89, s89, 1
ds_read_b128 a[20:23], v6 offset:29696
v_cvt_pk_bf16_f32 v249, v162, v163
v_mfma_f32_16x16x32_bf16 v[172:175], a[80:83], v[224:227], 0
s_cmp_lg_u32 s89, 0
v_exp_f32 v164, v164
v_mfma_f32_16x16x32_bf16 v[172:175], a[84:87], v[228:231], v[172:175]
v_mfma_f32_16x16x32_bf16 v[172:175], a[88:91], v[232:235], v[172:175]
v_exp_f32 v165, v165
v_mfma_f32_16x16x32_bf16 v[172:175], a[92:95], v[236:239], v[172:175]
ds_read_b128 a[24:27], v6 offset:30720
v_cvt_pk_bf16_f32 v250, v164, v165
v_mfma_f32_16x16x32_bf16 v[64:67], a[48:51], v[244:247], v[64:67]
v_exp_f32 v166, v166
v_mfma_f32_16x16x32_bf16 v[68:71], a[52:55], v[244:247], v[68:71]
v_mfma_f32_16x16x32_bf16 v[72:75], a[56:59], v[244:247], v[72:75]
v_exp_f32 v167, v167
v_mfma_f32_16x16x32_bf16 v[76:79], a[60:63], v[244:247], v[76:79]
s_waitcnt lgkmcnt(1)
ds_read_b128 a[28:31], v6 offset:31744
v_cvt_pk_bf16_f32 v251, v166, v167
s_cbranch_scc1 L_att_A
L_att_S:
s_lshl_b32 s89, s78, 1
s_sub_u32 s89, 14, s89
s_cmp_eq_u32 s89, 0
s_cselect_b32 s81, s3, 1073741824
buffer_load_dword v4, v8, s[56:59], s81 offen sc1
s_getpc_b64 s[36:37]
L_pc_L_att_D:
s_add_u32 s36, s36, L_att_D-L_pc_L_att_D
s_addc_u32 s37, s37, 0
s_and_b32 s37, s37, 0xffff
s_mov_b32 s38, L_tail_end-L_att_D
s_mov_b32 s39, 0x20000
v_lshlrev_b32 v9, 9, v0
s_lshl_b32 s80, s76, 7
buffer_load_dword v9, v9, s[36:39], s80 offen
v_accvgpr_read_b32 v12, a224
v_accvgpr_read_b32 v13, a225
v_accvgpr_read_b32 v14, a226
v_accvgpr_read_b32 v15, a227
v_accvgpr_read_b32 v144, a240
v_accvgpr_read_b32 v145, a241
v_accvgpr_read_b32 v146, a242
v_accvgpr_read_b32 v147, a243
v_accvgpr_read_b32 v148, a244
v_accvgpr_read_b32 v149, a245
v_accvgpr_read_b32 v150, a246
v_accvgpr_read_b32 v151, a247
v_add_f32 v12, v12, v13
v_add_f32 v14, v14, v15
v_rcp_f32 v12, v12
v_rcp_f32 v14, v14
v_accvgpr_read_b32 v152, a248
v_accvgpr_read_b32 v153, a249
v_accvgpr_read_b32 v154, a250
v_accvgpr_read_b32 v155, a251
v_accvgpr_read_b32 v156, a252
v_accvgpr_read_b32 v157, a253
v_accvgpr_read_b32 v158, a254
v_accvgpr_read_b32 v159, a255
v_pk_mul_f32 v[16:17], v[16:17], v[12:13] op_sel_hi:[1,0]
v_pk_mul_f32 v[18:19], v[18:19], v[12:13] op_sel_hi:[1,0]
v_pk_mul_f32 v[20:21], v[20:21], v[12:13] op_sel_hi:[1,0]
v_pk_mul_f32 v[22:23], v[22:23], v[12:13] op_sel_hi:[1,0]
s_add_u32 s84, s94, 0
v_cvt_pk_bf16_f32 v16, v16, v17
v_cvt_pk_bf16_f32 v17, v18, v19
v_cvt_pk_bf16_f32 v18, v20, v21
v_cvt_pk_bf16_f32 v19, v22, v23
buffer_store_dwordx4 v[16:19], v1, s[56:59], s84 offen sc1
v_pk_mul_f32 v[24:25], v[24:25], v[12:13] op_sel_hi:[1,0]
v_pk_mul_f32 v[26:27], v[26:27], v[12:13] op_sel_hi:[1,0]
v_pk_mul_f32 v[28:29], v[28:29], v[12:13] op_sel_hi:[1,0]
v_pk_mul_f32 v[30:31], v[30:31], v[12:13] op_sel_hi:[1,0]
s_add_u32 s84, s94, 4096
v_cvt_pk_bf16_f32 v24, v24, v25
v_cvt_pk_bf16_f32 v25, v26, v27
v_cvt_pk_bf16_f32 v26, v28, v29
v_cvt_pk_bf16_f32 v27, v30, v31
buffer_store_dwordx4 v[24:27], v1, s[56:59], s84 offen sc1
v_pk_mul_f32 v[32:33], v[32:33], v[12:13] op_sel_hi:[1,0]
v_pk_mul_f32 v[34:35], v[34:35], v[12:13] op_sel_hi:[1,0]
v_pk_mul_f32 v[36:37], v[36:37], v[12:13] op_sel_hi:[1,0]
v_pk_mul_f32 v[38:39], v[38:39], v[12:13] op_sel_hi:[1,0]
s_add_u32 s84, s94, 8192
v_cvt_pk_bf16_f32 v32, v32, v33
v_cvt_pk_bf16_f32 v33, v34, v35
v_cvt_pk_bf16_f32 v34, v36, v37
v_cvt_pk_bf16_f32 v35, v38, v39
buffer_store_dwordx4 v[32:35], v1, s[56:59], s84 offen sc1
v_pk_mul_f32 v[40:41], v[40:41], v[12:13] op_sel_hi:[1,0]
v_pk_mul_f32 v[42:43], v[42:43], v[12:13] op_sel_hi:[1,0]
v_pk_mul_f32 v[44:45], v[44:45], v[12:13] op_sel_hi:[1,0]
v_pk_mul_f32 v[46:47], v[46:47], v[12:13] op_sel_hi:[1,0]
s_add_u32 s84, s94, 12288
v_cvt_pk_bf16_f32 v40, v40, v41
v_cvt_pk_bf16_f32 v41, v42, v43
v_cvt_pk_bf16_f32 v42, v44, v45
v_cvt_pk_bf16_f32 v43, v46, v47
buffer_store_dwordx4 v[40:43], v1, s[56:59], s84 offen sc1
v_pk_mul_f32 v[48:49], v[48:49], v[14:15] op_sel_hi:[1,0]
v_pk_mul_f32 v[50:51], v[50:51], v[14:15] op_sel_hi:[1,0]
v_pk_mul_f32 v[52:53], v[52:53], v[14:15] op_sel_hi:[1,0]
v_pk_mul_f32 v[54:55], v[54:55], v[14:15] op_sel_hi:[1,0]
s_add_u32 s84, s95, 0
v_cvt_pk_bf16_f32 v48, v48, v49
v_cvt_pk_bf16_f32 v49, v50, v51
v_cvt_pk_bf16_f32 v50, v52, v53
v_cvt_pk_bf16_f32 v51, v54, v55
buffer_store_dwordx4 v[48:51], v1, s[56:59], s84 offen sc1
v_pk_mul_f32 v[56:57], v[56:57], v[14:15] op_sel_hi:[1,0]
v_pk_mul_f32 v[58:59], v[58:59], v[14:15] op_sel_hi:[1,0]
v_pk_mul_f32 v[60:61], v[60:61], v[14:15] op_sel_hi:[1,0]
v_pk_mul_f32 v[62:63], v[62:63], v[14:15] op_sel_hi:[1,0]
s_add_u32 s84, s95, 4096
v_cvt_pk_bf16_f32 v56, v56, v57
v_cvt_pk_bf16_f32 v57, v58, v59
v_cvt_pk_bf16_f32 v58, v60, v61
v_cvt_pk_bf16_f32 v59, v62, v63
buffer_store_dwordx4 v[56:59], v1, s[56:59], s84 offen sc1
v_pk_mul_f32 v[64:65], v[64:65], v[14:15] op_sel_hi:[1,0]
v_pk_mul_f32 v[66:67], v[66:67], v[14:15] op_sel_hi:[1,0]
v_pk_mul_f32 v[68:69], v[68:69], v[14:15] op_sel_hi:[1,0]
v_pk_mul_f32 v[70:71], v[70:71], v[14:15] op_sel_hi:[1,0]
s_add_u32 s84, s95, 8192
v_cvt_pk_bf16_f32 v64, v64, v65
v_cvt_pk_bf16_f32 v65, v66, v67
v_cvt_pk_bf16_f32 v66, v68, v69
v_cvt_pk_bf16_f32 v67, v70, v71
buffer_store_dwordx4 v[64:67], v1, s[56:59], s84 offen sc1
v_pk_mul_f32 v[72:73], v[72:73], v[14:15] op_sel_hi:[1,0]
v_pk_mul_f32 v[74:75], v[74:75], v[14:15] op_sel_hi:[1,0]
v_pk_mul_f32 v[76:77], v[76:77], v[14:15] op_sel_hi:[1,0]
v_pk_mul_f32 v[78:79], v[78:79], v[14:15] op_sel_hi:[1,0]
s_add_u32 s84, s95, 12288
v_cvt_pk_bf16_f32 v72, v72, v73
v_cvt_pk_bf16_f32 v73, v74, v75
v_cvt_pk_bf16_f32 v74, v76, v77
v_cvt_pk_bf16_f32 v75, v78, v79
buffer_store_dwordx4 v[72:75], v1, s[56:59], s84 offen sc1
s_cmp_eq_u32 s89, 0
s_cbranch_scc1 L_att_D
.p2align 4
L_att_C:
v_mfma_f32_16x16x32_bf16 v[160:163], a[0:3], v[208:211], 0
s_waitcnt vmcnt(8)
v_exp_f32 v168, v168
v_mfma_f32_16x16x32_bf16 v[160:163], a[4:7], v[212:215], v[160:163]
s_barrier
ds_read_b128 a[96:99], v5 offset:0
v_add_u32 v6, s98, v1
v_mfma_f32_16x16x32_bf16 v[160:163], a[8:11], v[216:219], v[160:163]
v_exp_f32 v169, v169
v_mfma_f32_16x16x32_bf16 v[160:163], a[12:15], v[220:223], v[160:163]
ds_read_b128 a[100:103], v5 offset:1024
v_cvt_pk_bf16_f32 v252, v168, v169
v_mfma_f32_16x16x32_bf16 v[80:83], a[32:35], v[248:251], v[80:83]
v_exp_f32 v170, v170
v_mfma_f32_16x16x32_bf16 v[84:87], a[36:39], v[248:251], v[84:87]
ds_read_b128 a[104:107], v5 offset:2048
buffer_atomic_add v3, v2, s[56:59], s35 offen sc1
v_mfma_f32_16x16x32_bf16 v[88:91], a[40:43], v[248:251], v[88:91]
s_waitcnt lgkmcnt(3)
v_exp_f32 v171, v171
v_mfma_f32_16x16x32_bf16 v[92:95], a[44:47], v[248:251], v[92:95]
s_add_u32 m0, s99, s86
ds_read_b128 a[108:111], v5 offset:3072
v_cvt_pk_bf16_f32 v253, v170, v171
v_mfma_f32_16x16x32_bf16 v[164:167], a[16:19], v[208:211], 0
v_exp_f32 v172, v172
v_mfma_f32_16x16x32_bf16 v[164:167], a[20:23], v[212:215], v[164:167]
ds_read_b128 a[112:115], v5 offset:4096
buffer_load_dwordx4 v1, s[60:63], s87 offen offset:0 sc1 lds
v_mfma_f32_16x16x32_bf16 v[164:167], a[24:27], v[216:219], v[164:167]
v_exp_f32 v173, v173
v_mfma_f32_16x16x32_bf16 v[164:167], a[28:31], v[220:223], v[164:167]
ds_read_b128 a[116:119], v5 offset:5120
v_cvt_pk_bf16_f32 v254, v172, v173
v_mfma_f32_16x16x32_bf16 v[96:99], a[48:51], v[248:251], v[96:99]
v_exp_f32 v174, v174
v_mfma_f32_16x16x32_bf16 v[100:103], a[52:55], v[248:251], v[100:103]
ds_read_b128 a[120:123], v5 offset:6144
buffer_load_dwordx4 v1, s[60:63], s87 offen offset:1024 sc1 lds
v_mfma_f32_16x16x32_bf16 v[104:107], a[56:59], v[248:251], v[104:107]
v_exp_f32 v175, v175
v_mfma_f32_16x16x32_bf16 v[108:111], a[60:63], v[248:251], v[108:111]
ds_read_b128 a[124:127], v5 offset:7168
v_cvt_pk_bf16_f32 v255, v174, v175
v_mfma_f32_16x16x32_bf16 v[168:171], a[0:3], v[224:227], 0
v_exp_f32 v160, v160
v_mfma_f32_16x16x32_bf16 v[168:171], a[4:7], v[228:231], v[168:171]
ds_read_b128 a[64:67], v5 offset:8192
v_smfmac_f32_16x16x64_bf16 a[228:231], a[232:235], v[248:255], v7
ds_read_b128 a[68:71], v5 offset:9216
v_mfma_f32_16x16x32_bf16 v[168:171], a[8:11], v[232:235], v[168:171]
v_exp_f32 v161, v161
v_mfma_f32_16x16x32_bf16 v[168:171], a[12:15], v[236:239], v[168:171]
ds_read_b128 a[72:75], v5 offset:10240
v_cvt_pk_bf16_f32 v248, v160, v161
v_mfma_f32_16x16x32_bf16 v[112:115], a[32:35], v[252:255], v[112:115]
v_exp_f32 v162, v162
v_mfma_f32_16x16x32_bf16 v[116:119], a[36:39], v[252:255], v[116:119]
ds_read_b128 a[76:79], v5 offset:11264
buffer_load_dwordx4 v1, s[60:63], s87 offen offset:2048 sc1 lds
v_mfma_f32_16x16x32_bf16 v[120:123], a[40:43], v[252:255], v[120:123]
v_exp_f32 v163, v163
v_mfma_f32_16x16x32_bf16 v[124:127], a[44:47], v[252:255], v[124:127]
ds_read_b128 a[80:83], v5 offset:12288
v_cvt_pk_bf16_f32 v249, v162, v163
v_mfma_f32_16x16x32_bf16 v[172:175], a[16:19], v[224:227], 0
s_add_u32 s98, s98, 32768
v_exp_f32 v164, v164
v_mfma_f32_16x16x32_bf16 v[172:175], a[20:23], v[228:231], v[172:175]
ds_read_b128 a[84:87], v5 offset:13312
buffer_load_dwordx4 v1, s[60:63], s87 offen offset:3072 sc1 lds
v_mfma_f32_16x16x32_bf16 v[172:175], a[24:27], v[232:235], v[172:175]
s_add_u32 m0, m0, 4096
v_exp_f32 v165, v165
v_mfma_f32_16x16x32_bf16 v[172:175], a[28:31], v[236:239], v[172:175]
s_add_u32 s87, s87, 4096
ds_read_b128 a[88:91], v5 offset:14336
v_cvt_pk_bf16_f32 v250, v164, v165
v_mfma_f32_16x16x32_bf16 v[128:131], a[48:51], v[252:255], v[128:131]
s_and_b32 s98, s98, 0x1ffff
v_exp_f32 v166, v166
v_mfma_f32_16x16x32_bf16 v[132:135], a[52:55], v[252:255], v[132:135]
s_waitcnt lgkmcnt(3)
buffer_load_dwordx4 v1, s[60:63], s87 offen offset:0 sc1 lds
v_mfma_f32_16x16x32_bf16 v[136:139], a[56:59], v[252:255], v[136:139]
s_mov_b32 s35, s88
v_exp_f32 v167, v167
v_mfma_f32_16x16x32_bf16 v[140:143], a[60:63], v[252:255], v[140:143]
s_mov_b32 s88, 1073741824
ds_read_b128 a[92:95], v5 offset:15360
v_cvt_pk_bf16_f32 v251, v166, v167
v_mfma_f32_16x16x32_bf16 v[160:163], a[64:67], v[208:211], 0
v_exp_f32 v168, v168
v_mfma_f32_16x16x32_bf16 v[160:163], a[68:71], v[212:215], v[160:163]
ds_read_b128 a[32:35], v6 offset:16384
v_mfma_f32_16x16x32_bf16 v[160:163], a[72:75], v[216:219], v[160:163]
v_exp_f32 v169, v169
v_mfma_f32_16x16x32_bf16 v[160:163], a[76:79], v[220:223], v[160:163]
ds_read_b128 a[36:39], v6 offset:17408
v_cvt_pk_bf16_f32 v252, v168, v169
v_mfma_f32_16x16x32_bf16 v[80:83], a[96:99], v[248:251], v[80:83]
v_exp_f32 v170, v170
v_mfma_f32_16x16x32_bf16 v[84:87], a[100:103], v[248:251], v[84:87]
ds_read_b128 a[40:43], v6 offset:18432
buffer_load_dwordx4 v1, s[60:63], s87 offen offset:1024 sc1 lds
v_mfma_f32_16x16x32_bf16 v[88:91], a[104:107], v[248:251], v[88:91]
v_exp_f32 v171, v171
v_mfma_f32_16x16x32_bf16 v[92:95], a[108:111], v[248:251], v[92:95]
s_waitcnt lgkmcnt(3)
ds_read_b128 a[44:47], v6 offset:19456
v_cvt_pk_bf16_f32 v253, v170, v171
v_mfma_f32_16x16x32_bf16 v[164:167], a[80:83], v[208:211], 0
v_exp_f32 v172, v172
v_mfma_f32_16x16x32_bf16 v[164:167], a[84:87], v[212:215], v[164:167]
ds_read_b128 a[48:51], v6 offset:20480
buffer_load_dwordx4 v1, s[60:63], s87 offen offset:2048 sc1 lds
v_mfma_f32_16x16x32_bf16 v[164:167], a[88:91], v[216:219], v[164:167]
v_exp_f32 v173, v173
v_mfma_f32_16x16x32_bf16 v[164:167], a[92:95], v[220:223], v[164:167]
ds_read_b128 a[52:55], v6 offset:21504
v_cvt_pk_bf16_f32 v254, v172, v173
v_mfma_f32_16x16x32_bf16 v[96:99], a[112:115], v[248:251], v[96:99]
v_exp_f32 v174, v174
v_mfma_f32_16x16x32_bf16 v[100:103], a[116:119], v[248:251], v[100:103]
ds_read_b128 a[56:59], v6 offset:22528
buffer_load_dwordx4 v1, s[60:63], s87 offen offset:3072 sc1 lds
v_mfma_f32_16x16x32_bf16 v[104:107], a[120:123], v[248:251], v[104:107]
s_add_u32 s87, s87, 28672
v_exp_f32 v175, v175
v_mfma_f32_16x16x32_bf16 v[108:111], a[124:127], v[248:251], v[108:111]
s_add_u32 s99, s99, 32768
ds_read_b128 a[60:63], v6 offset:23552
v_cvt_pk_bf16_f32 v255, v174, v175
v_mfma_f32_16x16x32_bf16 v[168:171], a[64:67], v[224:227], 0
s_and_b32 s99, s99, 0x1ffff
v_exp_f32 v160, v160
v_mfma_f32_16x16x32_bf16 v[168:171], a[68:71], v[228:231], v[168:171]
ds_read_b128 a[0:3], v6 offset:24576
v_smfmac_f32_16x16x64_bf16 a[228:231], a[232:235], v[248:255], v7
ds_read_b128 a[4:7], v6 offset:25600
v_mfma_f32_16x16x32_bf16 v[168:171], a[72:75], v[232:235], v[168:171]
v_exp_f32 v161, v161
v_mfma_f32_16x16x32_bf16 v[168:171], a[76:79], v[236:239], v[168:171]
ds_read_b128 a[8:11], v6 offset:26624
v_cvt_pk_bf16_f32 v248, v160, v161
v_mfma_f32_16x16x32_bf16 v[112:115], a[96:99], v[252:255], v[112:115]
v_exp_f32 v162, v162
v_mfma_f32_16x16x32_bf16 v[116:119], a[100:103], v[252:255], v[116:119]
ds_read_b128 a[12:15], v6 offset:27648
v_mfma_f32_16x16x32_bf16 v[120:123], a[104:107], v[252:255], v[120:123]
v_exp_f32 v163, v163
v_mfma_f32_16x16x32_bf16 v[124:127], a[108:111], v[252:255], v[124:127]
ds_read_b128 a[16:19], v6 offset:28672
v_cvt_pk_bf16_f32 v249, v162, v163
v_mfma_f32_16x16x32_bf16 v[172:175], a[80:83], v[224:227], 0
v_exp_f32 v164, v164
v_mfma_f32_16x16x32_bf16 v[172:175], a[84:87], v[228:231], v[172:175]
ds_read_b128 a[20:23], v6 offset:29696
v_mfma_f32_16x16x32_bf16 v[172:175], a[88:91], v[232:235], v[172:175]
v_exp_f32 v165, v165
v_mfma_f32_16x16x32_bf16 v[172:175], a[92:95], v[236:239], v[172:175]
ds_read_b128 a[24:27], v6 offset:30720
v_cvt_pk_bf16_f32 v250, v164, v165
v_mfma_f32_16x16x32_bf16 v[128:131], a[112:115], v[252:255], v[128:131]
v_exp_f32 v166, v166
v_mfma_f32_16x16x32_bf16 v[132:135], a[116:119], v[252:255], v[132:135]
v_add_u32 v5, s98, v1
v_mfma_f32_16x16x32_bf16 v[136:139], a[120:123], v[252:255], v[136:139]
v_exp_f32 v167, v167
v_mfma_f32_16x16x32_bf16 v[140:143], a[124:127], v[252:255], v[140:143]
s_waitcnt lgkmcnt(2)
ds_read_b128 a[28:31], v6 offset:31744
v_cvt_pk_bf16_f32 v251, v166, v167
v_mfma_f32_16x16x32_bf16 v[160:163], a[0:3], v[208:211], 0
s_waitcnt vmcnt(8)
v_exp_f32 v168, v168
v_mfma_f32_16x16x32_bf16 v[160:163], a[4:7], v[212:215], v[160:163]
s_barrier
ds_read_b128 a[96:99], v5 offset:0
v_add_u32 v6, s98, v1
v_mfma_f32_16x16x32_bf16 v[160:163], a[8:11], v[216:219], v[160:163]
s_cmp_eq_u32 s89, 1
v_exp_f32 v169, v169
v_mfma_f32_16x16x32_bf16 v[160:163], a[12:15], v[220:223], v[160:163]
s_cselect_b32 s81, s3, 1073741824
ds_read_b128 a[100:103], v5 offset:1024
v_cvt_pk_bf16_f32 v252, v168, v169
v_mfma_f32_16x16x32_bf16 v[80:83], a[32:35], v[248:251], v[80:83]
v_exp_f32 v170, v170
v_mfma_f32_16x16x32_bf16 v[84:87], a[36:39], v[248:251], v[84:87]
ds_read_b128 a[104:107], v5 offset:2048
buffer_load_dword v4, v8, s[56:59], s81 offen sc1
v_mfma_f32_16x16x32_bf16 v[88:91], a[40:43], v[248:251], v[88:91]
v_exp_f32 v171, v171
v_mfma_f32_16x16x32_bf16 v[92:95], a[44:47], v[248:251], v[92:95]
s_add_u32 m0, s99, s86
ds_read_b128 a[108:111], v5 offset:3072
v_cvt_pk_bf16_f32 v253, v170, v171
v_mfma_f32_16x16x32_bf16 v[164:167], a[16:19], v[208:211], 0
s_waitcnt lgkmcnt(3)
v_exp_f32 v172, v172
v_mfma_f32_16x16x32_bf16 v[164:167], a[20:23], v[212:215], v[164:167]
ds_read_b128 a[112:115], v5 offset:4096
buffer_load_dwordx4 v1, s[60:63], s87 offen offset:0 sc1 lds
v_mfma_f32_16x16x32_bf16 v[164:167], a[24:27], v[216:219], v[164:167]
v_exp_f32 v173, v173
v_mfma_f32_16x16x32_bf16 v[164:167], a[28:31], v[220:223], v[164:167]
ds_read_b128 a[116:119], v5 offset:5120
v_cvt_pk_bf16_f32 v254, v172, v173
v_mfma_f32_16x16x32_bf16 v[96:99], a[48:51], v[248:251], v[96:99]
v_exp_f32 v174, v174
v_mfma_f32_16x16x32_bf16 v[100:103], a[52:55], v[248:251], v[100:103]
ds_read_b128 a[120:123], v5 offset:6144
buffer_load_dwordx4 v1, s[60:63], s87 offen offset:1024 sc1 lds
v_mfma_f32_16x16x32_bf16 v[104:107], a[56:59], v[248:251], v[104:107]
v_exp_f32 v175, v175
v_mfma_f32_16x16x32_bf16 v[108:111], a[60:63], v[248:251], v[108:111]
ds_read_b128 a[124:127], v5 offset:7168
v_cvt_pk_bf16_f32 v255, v174, v175
v_mfma_f32_16x16x32_bf16 v[168:171], a[0:3], v[224:227], 0
v_exp_f32 v160, v160
v_mfma_f32_16x16x32_bf16 v[168:171], a[4:7], v[228:231], v[168:171]
ds_read_b128 a[64:67], v5 offset:8192
v_smfmac_f32_16x16x64_bf16 a[228:231], a[232:235], v[248:255], v7
ds_read_b128 a[68:71], v5 offset:9216
v_mfma_f32_16x16x32_bf16 v[168:171], a[8:11], v[232:235], v[168:171]
v_exp_f32 v161, v161
v_mfma_f32_16x16x32_bf16 v[168:171], a[12:15], v[236:239], v[168:171]
ds_read_b128 a[72:75], v5 offset:10240
v_cvt_pk_bf16_f32 v248, v160, v161
v_mfma_f32_16x16x32_bf16 v[112:115], a[32:35], v[252:255], v[112:115]
v_exp_f32 v162, v162
v_mfma_f32_16x16x32_bf16 v[116:119], a[36:39], v[252:255], v[116:119]
ds_read_b128 a[76:79], v5 offset:11264
buffer_load_dwordx4 v1, s[60:63], s87 offen offset:2048 sc1 lds
v_mfma_f32_16x16x32_bf16 v[120:123], a[40:43], v[252:255], v[120:123]
v_exp_f32 v163, v163
v_mfma_f32_16x16x32_bf16 v[124:127], a[44:47], v[252:255], v[124:127]
ds_read_b128 a[80:83], v5 offset:12288
v_cvt_pk_bf16_f32 v249, v162, v163
v_mfma_f32_16x16x32_bf16 v[172:175], a[16:19], v[224:227], 0
s_add_u32 s98, s98, 32768
v_exp_f32 v164, v164
v_mfma_f32_16x16x32_bf16 v[172:175], a[20:23], v[228:231], v[172:175]
ds_read_b128 a[84:87], v5 offset:13312
buffer_load_dwordx4 v1, s[60:63], s87 offen offset:3072 sc1 lds
v_mfma_f32_16x16x32_bf16 v[172:175], a[24:27], v[232:235], v[172:175]
s_add_u32 m0, m0, 4096
v_exp_f32 v165, v165
v_mfma_f32_16x16x32_bf16 v[172:175], a[28:31], v[236:239], v[172:175]
s_add_u32 s87, s87, 4096
ds_read_b128 a[88:91], v5 offset:14336
v_cvt_pk_bf16_f32 v250, v164, v165
v_mfma_f32_16x16x32_bf16 v[128:131], a[48:51], v[252:255], v[128:131]
s_and_b32 s98, s98, 0x1ffff
v_exp_f32 v166, v166
v_mfma_f32_16x16x32_bf16 v[132:135], a[52:55], v[252:255], v[132:135]
buffer_load_dwordx4 v1, s[60:63], s87 offen offset:0 sc1 lds
v_mfma_f32_16x16x32_bf16 v[136:139], a[56:59], v[252:255], v[136:139]
v_exp_f32 v167, v167
v_mfma_f32_16x16x32_bf16 v[140:143], a[60:63], v[252:255], v[140:143]
s_waitcnt lgkmcnt(2)
ds_read_b128 a[92:95], v5 offset:15360
v_cvt_pk_bf16_f32 v251, v166, v167
v_mfma_f32_16x16x32_bf16 v[160:163], a[64:67], v[208:211], 0
v_exp_f32 v168, v168
v_mfma_f32_16x16x32_bf16 v[160:163], a[68:71], v[212:215], v[160:163]
ds_read_b128 a[32:35], v6 offset:16384
v_mfma_f32_16x16x32_bf16 v[160:163], a[72:75], v[216:219], v[160:163]
v_exp_f32 v169, v169
v_mfma_f32_16x16x32_bf16 v[160:163], a[76:79], v[220:223], v[160:163]
ds_read_b128 a[36:39], v6 offset:17408
v_cvt_pk_bf16_f32 v252, v168, v169
v_mfma_f32_16x16x32_bf16 v[80:83], a[96:99], v[248:251], v[80:83]
v_exp_f32 v170, v170
v_mfma_f32_16x16x32_bf16 v[84:87], a[100:103], v[248:251], v[84:87]
ds_read_b128 a[40:43], v6 offset:18432
buffer_load_dwordx4 v1, s[60:63], s87 offen offset:1024 sc1 lds
v_mfma_f32_16x16x32_bf16 v[88:91], a[104:107], v[248:251], v[88:91]
v_exp_f32 v171, v171
v_mfma_f32_16x16x32_bf16 v[92:95], a[108:111], v[248:251], v[92:95]
ds_read_b128 a[44:47], v6 offset:19456
v_cvt_pk_bf16_f32 v253, v170, v171
v_mfma_f32_16x16x32_bf16 v[164:167], a[80:83], v[208:211], 0
s_waitcnt lgkmcnt(3)
v_exp_f32 v172, v172
v_mfma_f32_16x16x32_bf16 v[164:167], a[84:87], v[212:215], v[164:167]
ds_read_b128 a[48:51], v6 offset:20480
buffer_load_dwordx4 v1, s[60:63], s87 offen offset:2048 sc1 lds
v_mfma_f32_16x16x32_bf16 v[164:167], a[88:91], v[216:219], v[164:167]
v_exp_f32 v173, v173
v_mfma_f32_16x16x32_bf16 v[164:167], a[92:95], v[220:223], v[164:167]
ds_read_b128 a[52:55], v6 offset:21504
v_cvt_pk_bf16_f32 v254, v172, v173
v_mfma_f32_16x16x32_bf16 v[96:99], a[112:115], v[248:251], v[96:99]
v_exp_f32 v174, v174
v_mfma_f32_16x16x32_bf16 v[100:103], a[116:119], v[248:251], v[100:103]
ds_read_b128 a[56:59], v6 offset:22528
buffer_load_dwordx4 v1, s[60:63], s87 offen offset:3072 sc1 lds
v_mfma_f32_16x16x32_bf16 v[104:107], a[120:123], v[248:251], v[104:107]
s_add_u32 s87, s87, 28672
v_exp_f32 v175, v175
v_mfma_f32_16x16x32_bf16 v[108:111], a[124:127], v[248:251], v[108:111]
s_add_u32 s99, s99, 32768
ds_read_b128 a[60:63], v6 offset:23552
v_cvt_pk_bf16_f32 v255, v174, v175
v_mfma_f32_16x16x32_bf16 v[168:171], a[64:67], v[224:227], 0
s_and_b32 s99, s99, 0x1ffff
v_exp_f32 v160, v160
v_mfma_f32_16x16x32_bf16 v[168:171], a[68:71], v[228:231], v[168:171]
s_sub_u32 s89, s89, 1
ds_read_b128 a[0:3], v6 offset:24576
v_smfmac_f32_16x16x64_bf16 a[228:231], a[232:235], v[248:255], v7
s_cmp_lg_u32 s89, 0
ds_read_b128 a[4:7], v6 offset:25600
v_mfma_f32_16x16x32_bf16 v[168:171], a[72:75], v[232:235], v[168:171]
v_exp_f32 v161, v161
v_mfma_f32_16x16x32_bf16 v[168:171], a[76:79], v[236:239], v[168:171]
ds_read_b128 a[8:11], v6 offset:26624
v_cvt_pk_bf16_f32 v248, v160, v161
v_mfma_f32_16x16x32_bf16 v[112:115], a[96:99], v[252:255], v[112:115]
v_exp_f32 v162, v162
v_mfma_f32_16x16x32_bf16 v[116:119], a[100:103], v[252:255], v[116:119]
ds_read_b128 a[12:15], v6 offset:27648
v_mfma_f32_16x16x32_bf16 v[120:123], a[104:107], v[252:255], v[120:123]
v_exp_f32 v163, v163
v_mfma_f32_16x16x32_bf16 v[124:127], a[108:111], v[252:255], v[124:127]
ds_read_b128 a[16:19], v6 offset:28672
v_cvt_pk_bf16_f32 v249, v162, v163
v_mfma_f32_16x16x32_bf16 v[172:175], a[80:83], v[224:227], 0
v_exp_f32 v164, v164
v_mfma_f32_16x16x32_bf16 v[172:175], a[84:87], v[228:231], v[172:175]
ds_read_b128 a[20:23], v6 offset:29696
v_mfma_f32_16x16x32_bf16 v[172:175], a[88:91], v[232:235], v[172:175]
v_exp_f32 v165, v165
v_mfma_f32_16x16x32_bf16 v[172:175], a[92:95], v[236:239], v[172:175]
ds_read_b128 a[24:27], v6 offset:30720
v_cvt_pk_bf16_f32 v250, v164, v165
v_mfma_f32_16x16x32_bf16 v[128:131], a[112:115], v[252:255], v[128:131]
v_exp_f32 v166, v166
v_mfma_f32_16x16x32_bf16 v[132:135], a[116:119], v[252:255], v[132:135]
v_add_u32 v5, s98, v1
v_mfma_f32_16x16x32_bf16 v[136:139], a[120:123], v[252:255], v[136:139]
v_exp_f32 v167, v167
v_mfma_f32_16x16x32_bf16 v[140:143], a[124:127], v[252:255], v[140:143]
s_waitcnt lgkmcnt(2)
ds_read_b128 a[28:31], v6 offset:31744
v_cvt_pk_bf16_f32 v251, v166, v167
s_cbranch_scc1 L_att_C
L_att_D:
L_chain2:
s_waitcnt vmcnt(8) lgkmcnt(0)
v_cmp_eq_u32 vcc, 32, v4
s_add_u32 s80, vcc_lo, s3
s_cmp_ge_u32 s80, 0xff
s_cbranch_scc0 L_mid_spin0
L_mid_ok:
s_cmp_ge_u32 s76, 2
s_barrier
s_cbranch_scc1 L_att_D1
v_mfma_f32_16x16x32_bf16 v[144:147], a[0:3], v[208:211], v[144:147]
s_add_u32 m0, s29, 16384
v_exp_f32 v168, v168
v_mfma_f32_16x16x32_bf16 v[144:147], a[4:7], v[212:215], v[144:147]
s_add_u32 s85, s27, 0
ds_read_b128 a[96:99], v5 offset:0
v_add_u32 v6, s98, v1
v_mfma_f32_16x16x32_bf16 v[144:147], a[8:11], v[216:219], v[144:147]
v_exp_f32 v169, v169
v_mfma_f32_16x16x32_bf16 v[144:147], a[12:15], v[220:223], v[144:147]
ds_read_b128 a[100:103], v5 offset:1024
v_cvt_pk_bf16_f32 v252, v168, v169
v_mfma_f32_16x16x32_bf16 v[80:83], a[32:35], v[248:251], v[80:83]
v_exp_f32 v170, v170
v_mfma_f32_16x16x32_bf16 v[84:87], a[36:39], v[248:251], v[84:87]
ds_read_b128 a[104:107], v5 offset:2048
buffer_load_dwordx4 v1, s[72:75], s85 offen offset:0 sc1 lds
v_mfma_f32_16x16x32_bf16 v[88:91], a[40:43], v[248:251], v[88:91]
v_exp_f32 v171, v171
v_mfma_f32_16x16x32_bf16 v[92:95], a[44:47], v[248:251], v[92:95]
s_waitcnt lgkmcnt(3)
ds_read_b128 a[108:111], v5 offset:3072
v_cvt_pk_bf16_f32 v253, v170, v171
v_mfma_f32_16x16x32_bf16 v[148:151], a[16:19], v[208:211], v[148:151]
v_exp_f32 v172, v172
v_mfma_f32_16x16x32_bf16 v[148:151], a[20:23], v[212:215], v[148:151]
ds_read_b128 a[112:115], v5 offset:4096
buffer_load_dwordx4 v1, s[72:75], s85 offen offset:1024 sc1 lds
v_mfma_f32_16x16x32_bf16 v[148:151], a[24:27], v[216:219], v[148:151]
v_exp_f32 v173, v173
v_mfma_f32_16x16x32_bf16 v[148:151], a[28:31], v[220:223], v[148:151]
ds_read_b128 a[116:119], v5 offset:5120
v_cvt_pk_bf16_f32 v254, v172, v173
v_mfma_f32_16x16x32_bf16 v[96:99], a[48:51], v[248:251], v[96:99]
v_exp_f32 v174, v174
v_mfma_f32_16x16x32_bf16 v[100:103], a[52:55], v[248:251], v[100:103]
ds_read_b128 a[120:123], v5 offset:6144
buffer_load_dwordx4 v1, s[72:75], s85 offen offset:2048 sc1 lds
v_mfma_f32_16x16x32_bf16 v[104:107], a[56:59], v[248:251], v[104:107]
v_exp_f32 v175, v175
v_mfma_f32_16x16x32_bf16 v[108:111], a[60:63], v[248:251], v[108:111]
ds_read_b128 a[124:127], v5 offset:7168
v_cvt_pk_bf16_f32 v255, v174, v175
v_mfma_f32_16x16x32_bf16 v[168:171], a[0:3], v[224:227], 0
v_exp_f32 v144, v144
v_mfma_f32_16x16x32_bf16 v[168:171], a[4:7], v[228:231], v[168:171]
ds_read_b128 a[64:67], v5 offset:8192
v_smfmac_f32_16x16x64_bf16 a[228:231], a[232:235], v[248:255], v7
ds_read_b128 a[68:71], v5 offset:9216
v_mfma_f32_16x16x32_bf16 v[168:171], a[8:11], v[232:235], v[168:171]
v_exp_f32 v145, v145
v_mfma_f32_16x16x32_bf16 v[168:171], a[12:15], v[236:239], v[168:171]
ds_read_b128 a[72:75], v5 offset:10240
v_cvt_pk_bf16_f32 v248, v144, v145
v_mfma_f32_16x16x32_bf16 v[112:115], a[32:35], v[252:255], v[112:115]
v_exp_f32 v146, v146
v_mfma_f32_16x16x32_bf16 v[116:119], a[36:39], v[252:255], v[116:119]
ds_read_b128 a[76:79], v5 offset:11264
buffer_load_dwordx4 v1, s[72:75], s85 offen offset:3072 sc1 lds
v_mfma_f32_16x16x32_bf16 v[120:123], a[40:43], v[252:255], v[120:123]
s_add_u32 m0, s29, 20480
v_exp_f32 v147, v147
v_mfma_f32_16x16x32_bf16 v[124:127], a[44:47], v[252:255], v[124:127]
s_add_u32 s85, s27, 4096
ds_read_b128 a[80:83], v5 offset:12288
v_cvt_pk_bf16_f32 v249, v146, v147
v_mfma_f32_16x16x32_bf16 v[172:175], a[16:19], v[224:227], 0
s_add_u32 s98, s98, 32768
v_exp_f32 v148, v148
v_mfma_f32_16x16x32_bf16 v[172:175], a[20:23], v[228:231], v[172:175]
s_and_b32 s98, s98, 0x1ffff
ds_read_b128 a[84:87], v5 offset:13312
v_mfma_f32_16x16x32_bf16 v[172:175], a[24:27], v[232:235], v[172:175]
v_exp_f32 v149, v149
v_mfma_f32_16x16x32_bf16 v[172:175], a[28:31], v[236:239], v[172:175]
ds_read_b128 a[88:91], v5 offset:14336
v_cvt_pk_bf16_f32 v250, v148, v149
v_mfma_f32_16x16x32_bf16 v[128:131], a[48:51], v[252:255], v[128:131]
v_exp_f32 v150, v150
v_mfma_f32_16x16x32_bf16 v[132:135], a[52:55], v[252:255], v[132:135]
s_waitcnt lgkmcnt(3)
buffer_load_dwordx4 v1, s[72:75], s85 offen offset:0 sc1 lds
v_mfma_f32_16x16x32_bf16 v[136:139], a[56:59], v[252:255], v[136:139]
s_add_u32 m0, s24, 0
v_exp_f32 v151, v151
v_mfma_f32_16x16x32_bf16 v[140:143], a[60:63], v[252:255], v[140:143]
s_add_u32 s79, s68, 0
ds_read_b128 a[92:95], v5 offset:15360
v_cvt_pk_bf16_f32 v251, v150, v151
v_mfma_f32_16x16x32_bf16 v[160:163], a[64:67], v[224:227], 0
v_exp_f32 v168, v168
v_add_u32 v5, s98, v1
v_mfma_f32_16x16x32_bf16 v[160:163], a[68:71], v[228:231], v[160:163]
ds_read_b128 a[0:3], v6 offset:24576
ds_read_b128 a[4:7], v6 offset:25600
v_mfma_f32_16x16x32_bf16 v[160:163], a[72:75], v[232:235], v[160:163]
v_exp_f32 v169, v169
v_mfma_f32_16x16x32_bf16 v[160:163], a[76:79], v[236:239], v[160:163]
ds_read_b128 a[8:11], v6 offset:26624
v_cvt_pk_bf16_f32 v252, v168, v169
v_mfma_f32_16x16x32_bf16 v[80:83], a[96:99], v[248:251], v[80:83]
v_exp_f32 v170, v170
v_mfma_f32_16x16x32_bf16 v[84:87], a[100:103], v[248:251], v[84:87]
ds_read_b128 a[12:15], v6 offset:27648
ds_read_b128 a[16:19], v6 offset:28672
v_mfma_f32_16x16x32_bf16 v[88:91], a[104:107], v[248:251], v[88:91]
v_exp_f32 v171, v171
v_mfma_f32_16x16x32_bf16 v[92:95], a[108:111], v[248:251], v[92:95]
s_waitcnt lgkmcnt(5)
ds_read_b128 a[20:23], v6 offset:29696
v_cvt_pk_bf16_f32 v253, v170, v171
v_mfma_f32_16x16x32_bf16 v[164:167], a[80:83], v[224:227], 0
v_exp_f32 v172, v172
v_mfma_f32_16x16x32_bf16 v[164:167], a[84:87], v[228:231], v[164:167]
ds_read_b128 a[24:27], v6 offset:30720
ds_read_b128 a[28:31], v6 offset:31744
v_mfma_f32_16x16x32_bf16 v[164:167], a[88:91], v[232:235], v[164:167]
v_exp_f32 v173, v173
v_mfma_f32_16x16x32_bf16 v[164:167], a[92:95], v[236:239], v[164:167]
ds_read_b128 a[32:35], v6 offset:16384
v_cvt_pk_bf16_f32 v254, v172, v173
v_mfma_f32_16x16x32_bf16 v[96:99], a[112:115], v[248:251], v[96:99]
v_exp_f32 v174, v174
v_mfma_f32_16x16x32_bf16 v[100:103], a[116:119], v[248:251], v[100:103]
ds_read_b128 a[36:39], v6 offset:17408
ds_read_b128 a[40:43], v6 offset:18432
v_mfma_f32_16x16x32_bf16 v[104:107], a[120:123], v[248:251], v[104:107]
v_exp_f32 v175, v175
v_mfma_f32_16x16x32_bf16 v[108:111], a[124:127], v[248:251], v[108:111]
s_waitcnt lgkmcnt(5)
ds_read_b128 a[44:47], v6 offset:19456
v_cvt_pk_bf16_f32 v255, v174, v175
v_mfma_f32_16x16x32_bf16 v[168:171], a[0:3], v[224:227], 0
s_waitcnt vmcnt(5)
v_exp_f32 v160, v160
v_mfma_f32_16x16x32_bf16 v[168:171], a[4:7], v[228:231], v[168:171]
s_barrier
ds_read_b128 a[48:51], v6 offset:20480
ds_read_b128 a[52:55], v6 offset:21504
v_smfmac_f32_16x16x64_bf16 a[228:231], a[232:235], v[248:255], v7
ds_read_b128 a[56:59], v6 offset:22528
v_mfma_f32_16x16x32_bf16 v[168:171], a[8:11], v[232:235], v[168:171]
v_exp_f32 v161, v161
v_mfma_f32_16x16x32_bf16 v[168:171], a[12:15], v[236:239], v[168:171]
ds_read_b128 a[60:63], v6 offset:23552
v_cvt_pk_bf16_f32 v244, v160, v161
v_mfma_f32_16x16x32_bf16 v[112:115], a[96:99], v[252:255], v[112:115]
v_exp_f32 v162, v162
v_mfma_f32_16x16x32_bf16 v[116:119], a[100:103], v[252:255], v[116:119]
ds_read_b128 a[64:67], v5 offset:8192
ds_read_b128 a[68:71], v5 offset:9216
v_mfma_f32_16x16x32_bf16 v[120:123], a[104:107], v[252:255], v[120:123]
v_exp_f32 v163, v163
v_mfma_f32_16x16x32_bf16 v[124:127], a[108:111], v[252:255], v[124:127]
ds_read_b128 a[72:75], v5 offset:10240
v_cvt_pk_bf16_f32 v245, v162, v163
v_mfma_f32_16x16x32_bf16 v[172:175], a[16:19], v[224:227], 0
v_exp_f32 v164, v164
v_mfma_f32_16x16x32_bf16 v[172:175], a[20:23], v[228:231], v[172:175]
s_waitcnt lgkmcnt(4)
ds_read_b128 a[76:79], v5 offset:11264
ds_read_b128 a[80:83], v5 offset:12288
v_mfma_f32_16x16x32_bf16 v[172:175], a[24:27], v[232:235], v[172:175]
v_exp_f32 v165, v165
v_mfma_f32_16x16x32_bf16 v[172:175], a[28:31], v[236:239], v[172:175]
ds_read_b128 a[84:87], v5 offset:13312
v_cvt_pk_bf16_f32 v246, v164, v165
v_mfma_f32_16x16x32_bf16 v[128:131], a[112:115], v[252:255], v[128:131]
v_exp_f32 v166, v166
v_mfma_f32_16x16x32_bf16 v[132:135], a[116:119], v[252:255], v[132:135]
s_waitcnt lgkmcnt(4)
ds_read_b128 a[88:91], v5 offset:14336
buffer_load_dwordx4 v1, s[40:43], s79 offen sc1 lds
v_mfma_f32_16x16x32_bf16 v[136:139], a[120:123], v[252:255], v[136:139]
s_add_u32 m0, s24, 1024
v_exp_f32 v167, v167
v_mfma_f32_16x16x32_bf16 v[140:143], a[124:127], v[252:255], v[140:143]
s_add_u32 s79, s69, 0
ds_read_b128 a[92:95], v5 offset:15360
v_cvt_pk_bf16_f32 v247, v166, v167
v_mfma_f32_16x16x32_bf16 v[152:155], a[64:67], v[224:227], v[152:155]
v_exp_f32 v168, v168
v_mfma_f32_16x16x32_bf16 v[152:155], a[68:71], v[228:231], v[152:155]
ds_read_b128 a[96:99], v5 offset:0
v_add_u32 v6, s98, v1
v_smfmac_f32_16x16x64_bf16 a[228:231], a[236:239], v[240:247], v7
s_waitcnt lgkmcnt(3)
ds_read_b128 a[100:103], v5 offset:1024
v_mfma_f32_16x16x32_bf16 v[152:155], a[72:75], v[232:235], v[152:155]
v_exp_f32 v169, v169
v_mfma_f32_16x16x32_bf16 v[152:155], a[76:79], v[236:239], v[152:155]
ds_read_b128 a[104:107], v5 offset:2048
v_cvt_pk_bf16_f32 v252, v168, v169
v_mfma_f32_16x16x32_bf16 v[112:115], a[32:35], v[244:247], v[112:115]
v_exp_f32 v170, v170
v_mfma_f32_16x16x32_bf16 v[116:119], a[36:39], v[244:247], v[116:119]
ds_read_b128 a[108:111], v5 offset:3072
buffer_load_dwordx4 v1, s[40:43], s79 offen sc1 lds
v_mfma_f32_16x16x32_bf16 v[120:123], a[40:43], v[244:247], v[120:123]
s_add_u32 m0, s24, 2048
v_exp_f32 v171, v171
v_mfma_f32_16x16x32_bf16 v[124:127], a[44:47], v[244:247], v[124:127]
s_add_u32 s79, s70, 0
ds_read_b128 a[112:115], v5 offset:4096
v_cvt_pk_bf16_f32 v253, v170, v171
v_mfma_f32_16x16x32_bf16 v[156:159], a[80:83], v[224:227], v[156:159]
v_exp_f32 v172, v172
v_mfma_f32_16x16x32_bf16 v[156:159], a[84:87], v[228:231], v[156:159]
s_waitcnt lgkmcnt(3)
ds_read_b128 a[116:119], v5 offset:5120
v_mfma_f32_16x16x32_bf16 v[156:159], a[88:91], v[232:235], v[156:159]
v_exp_f32 v173, v173
v_mfma_f32_16x16x32_bf16 v[156:159], a[92:95], v[236:239], v[156:159]
ds_read_b128 a[120:123], v5 offset:6144
v_cvt_pk_bf16_f32 v254, v172, v173
v_mfma_f32_16x16x32_bf16 v[128:131], a[48:51], v[244:247], v[128:131]
v_exp_f32 v174, v174
v_mfma_f32_16x16x32_bf16 v[132:135], a[52:55], v[244:247], v[132:135]
buffer_load_dwordx4 v1, s[40:43], s79 offen sc1 lds
v_mfma_f32_16x16x32_bf16 v[136:139], a[56:59], v[244:247], v[136:139]
s_add_u32 m0, s24, 3072
v_exp_f32 v175, v175
v_mfma_f32_16x16x32_bf16 v[140:143], a[60:63], v[244:247], v[140:143]
s_add_u32 s79, s71, 0
ds_read_b128 a[124:127], v5 offset:7168
v_cvt_pk_bf16_f32 v255, v174, v175
s_nop 1
v_mfma_f32_16x16x32_bf16 v[112:115], a[96:99], v[252:255], v[112:115]
ds_read_b128 a[32:35], v6 offset:16384
v_exp_f32 v152, v152
v_smfmac_f32_16x16x64_bf16 a[228:231], a[236:239], v[248:255], v7
ds_read_b128 a[36:39], v6 offset:17408
v_mfma_f32_16x16x32_bf16 v[116:119], a[100:103], v[252:255], v[116:119]
s_waitcnt lgkmcnt(3)
ds_read_b128 a[40:43], v6 offset:18432
v_exp_f32 v153, v153
s_nop 0
v_cvt_pk_bf16_f32 v244, v152, v153
v_mfma_f32_16x16x32_bf16 v[120:123], a[104:107], v[252:255], v[120:123]
ds_read_b128 a[44:47], v6 offset:19456
v_exp_f32 v154, v154
v_mfma_f32_16x16x32_bf16 v[124:127], a[108:111], v[252:255], v[124:127]
ds_read_b128 a[48:51], v6 offset:20480
v_exp_f32 v155, v155
s_nop 0
v_cvt_pk_bf16_f32 v245, v154, v155
v_mfma_f32_16x16x32_bf16 v[128:131], a[112:115], v[252:255], v[128:131]
ds_read_b128 a[52:55], v6 offset:21504
v_exp_f32 v156, v156
v_mfma_f32_16x16x32_bf16 v[132:135], a[116:119], v[252:255], v[132:135]
ds_read_b128 a[56:59], v6 offset:22528
v_exp_f32 v157, v157
s_nop 0
v_cvt_pk_bf16_f32 v246, v156, v157
v_mfma_f32_16x16x32_bf16 v[136:139], a[120:123], v[252:255], v[136:139]
s_waitcnt lgkmcnt(6)
v_exp_f32 v158, v158
v_mfma_f32_16x16x32_bf16 v[140:143], a[124:127], v[252:255], v[140:143]
ds_read_b128 a[60:63], v6 offset:23552
v_exp_f32 v159, v159
s_nop 0
v_cvt_pk_bf16_f32 v247, v158, v159
s_nop 1
v_mfma_f32_16x16x32_bf16 v[112:115], a[32:35], v[244:247], v[112:115]
s_waitcnt lgkmcnt(5)
buffer_load_dwordx4 v1, s[40:43], s79 offen sc1 lds
v_smfmac_f32_16x16x64_bf16 a[228:231], a[236:239], v[240:247], v7
s_add_u32 m0, s29, 36864
v_mfma_f32_16x16x32_bf16 v[116:119], a[36:39], v[244:247], v[116:119]
s_add_u32 s85, s27, 327680
v_mfma_f32_16x16x32_bf16 v[120:123], a[40:43], v[244:247], v[120:123]
s_waitcnt lgkmcnt(2)
buffer_load_dwordx4 v1, s[72:75], s85 offen offset:0 sc1 lds
v_mfma_f32_16x16x32_bf16 v[124:127], a[44:47], v[244:247], v[124:127]
buffer_load_dwordx4 v1, s[72:75], s85 offen offset:1024 sc1 lds
v_mfma_f32_16x16x32_bf16 v[128:131], a[48:51], v[244:247], v[128:131]
buffer_load_dwordx4 v1, s[72:75], s85 offen offset:2048 sc1 lds
v_mfma_f32_16x16x32_bf16 v[132:135], a[52:55], v[244:247], v[132:135]
s_waitcnt lgkmcnt(0)
buffer_load_dwordx4 v1, s[72:75], s85 offen offset:3072 sc1 lds
v_mfma_f32_16x16x32_bf16 v[136:139], a[56:59], v[244:247], v[136:139]
s_add_u32 m0, s29, 40960
v_mfma_f32_16x16x32_bf16 v[140:143], a[60:63], v[244:247], v[140:143]
s_add_u32 s85, s27, 331776
buffer_load_dwordx4 v1, s[72:75], s85 offen offset:0 sc1 lds
s_add_u32 m0, s25, 0
s_add_u32 s79, s68, 32768
buffer_load_dwordx4 v1, s[40:43], s79 offen sc1 lds
s_add_u32 m0, s25, 1024
s_add_u32 s79, s69, 32768
buffer_load_dwordx4 v1, s[40:43], s79 offen sc1 lds
s_add_u32 m0, s25, 2048
s_add_u32 s79, s70, 32768
buffer_load_dwordx4 v1, s[40:43], s79 offen sc1 lds
s_add_u32 m0, s25, 3072
s_add_u32 s79, s71, 32768
buffer_load_dwordx4 v1, s[40:43], s79 offen sc1 lds
s_waitcnt vmcnt(9)
s_barrier
s_branch L_att_D2
L_att_D1:
v_mfma_f32_16x16x32_bf16 v[160:163], a[0:3], v[208:211], 0
s_add_u32 m0, s29, 16384
v_exp_f32 v168, v168
v_mfma_f32_16x16x32_bf16 v[160:163], a[4:7], v[212:215], v[160:163]
s_add_u32 s85, s27, 0
ds_read_b128 a[96:99], v5 offset:0
v_add_u32 v6, s98, v1
v_mfma_f32_16x16x32_bf16 v[160:163], a[8:11], v[216:219], v[160:163]
v_exp_f32 v169, v169
v_mfma_f32_16x16x32_bf16 v[160:163], a[12:15], v[220:223], v[160:163]
ds_read_b128 a[100:103], v5 offset:1024
v_cvt_pk_bf16_f32 v252, v168, v169
v_mfma_f32_16x16x32_bf16 v[80:83], a[32:35], v[248:251], v[80:83]
v_exp_f32 v170, v170
v_mfma_f32_16x16x32_bf16 v[84:87], a[36:39], v[248:251], v[84:87]
ds_read_b128 a[104:107], v5 offset:2048
buffer_load_dwordx4 v1, s[72:75], s85 offen offset:0 sc1 lds
v_mfma_f32_16x16x32_bf16 v[88:91], a[40:43], v[248:251], v[88:91]
v_exp_f32 v171, v171
v_mfma_f32_16x16x32_bf16 v[92:95], a[44:47], v[248:251], v[92:95]
s_waitcnt lgkmcnt(3)
ds_read_b128 a[108:111], v5 offset:3072
v_cvt_pk_bf16_f32 v253, v170, v171
v_mfma_f32_16x16x32_bf16 v[164:167], a[16:19], v[208:211], 0
v_exp_f32 v172, v172
v_mfma_f32_16x16x32_bf16 v[164:167], a[20:23], v[212:215], v[164:167]
ds_read_b128 a[112:115], v5 offset:4096
buffer_load_dwordx4 v1, s[72:75], s85 offen offset:1024 sc1 lds
v_mfma_f32_16x16x32_bf16 v[164:167], a[24:27], v[216:219], v[164:167]
v_exp_f32 v173, v173
v_mfma_f32_16x16x32_bf16 v[164:167], a[28:31], v[220:223], v[164:167]
ds_read_b128 a[116:119], v5 offset:5120
v_cvt_pk_bf16_f32 v254, v172, v173
v_mfma_f32_16x16x32_bf16 v[96:99], a[48:51], v[248:251], v[96:99]
v_exp_f32 v174, v174
v_mfma_f32_16x16x32_bf16 v[100:103], a[52:55], v[248:251], v[100:103]
ds_read_b128 a[120:123], v5 offset:6144
buffer_load_dwordx4 v1, s[72:75], s85 offen offset:2048 sc1 lds
v_mfma_f32_16x16x32_bf16 v[104:107], a[56:59], v[248:251], v[104:107]
v_exp_f32 v175, v175
v_mfma_f32_16x16x32_bf16 v[108:111], a[60:63], v[248:251], v[108:111]
ds_read_b128 a[124:127], v5 offset:7168
v_cvt_pk_bf16_f32 v255, v174, v175
v_mfma_f32_16x16x32_bf16 v[168:171], a[0:3], v[224:227], 0
v_exp_f32 v160, v160
v_mfma_f32_16x16x32_bf16 v[168:171], a[4:7], v[228:231], v[168:171]
ds_read_b128 a[64:67], v5 offset:8192
v_smfmac_f32_16x16x64_bf16 a[228:231], a[232:235], v[248:255], v7
ds_read_b128 a[68:71], v5 offset:9216
v_mfma_f32_16x16x32_bf16 v[168:171], a[8:11], v[232:235], v[168:171]
v_exp_f32 v161, v161
v_mfma_f32_16x16x32_bf16 v[168:171], a[12:15], v[236:239], v[168:171]
ds_read_b128 a[72:75], v5 offset:10240
v_cvt_pk_bf16_f32 v248, v160, v161
v_mfma_f32_16x16x32_bf16 v[112:115], a[32:35], v[252:255], v[112:115]
v_exp_f32 v162, v162
v_mfma_f32_16x16x32_bf16 v[116:119], a[36:39], v[252:255], v[116:119]
ds_read_b128 a[76:79], v5 offset:11264
buffer_load_dwordx4 v1, s[72:75], s85 offen offset:3072 sc1 lds
v_mfma_f32_16x16x32_bf16 v[120:123], a[40:43], v[252:255], v[120:123]
s_add_u32 m0, s29, 20480
v_exp_f32 v163, v163
v_mfma_f32_16x16x32_bf16 v[124:127], a[44:47], v[252:255], v[124:127]
s_add_u32 s85, s27, 4096
ds_read_b128 a[80:83], v5 offset:12288
v_cvt_pk_bf16_f32 v249, v162, v163
v_mfma_f32_16x16x32_bf16 v[172:175], a[16:19], v[224:227], 0
s_add_u32 s98, s98, 32768
v_exp_f32 v164, v164
v_mfma_f32_16x16x32_bf16 v[172:175], a[20:23], v[228:231], v[172:175]
s_and_b32 s98, s98, 0x1ffff
ds_read_b128 a[84:87], v5 offset:13312
v_mfma_f32_16x16x32_bf16 v[172:175], a[24:27], v[232:235], v[172:175]
v_exp_f32 v165, v165
v_mfma_f32_16x16x32_bf16 v[172:175], a[28:31], v[236:239], v[172:175]
ds_read_b128 a[88:91], v5 offset:14336
v_cvt_pk_bf16_f32 v250, v164, v165
v_mfma_f32_16x16x32_bf16 v[128:131], a[48:51], v[252:255], v[128:131]
v_exp_f32 v166, v166
v_mfma_f32_16x16x32_bf16 v[132:135], a[52:55], v[252:255], v[132:135]
s_waitcnt lgkmcnt(3)
buffer_load_dwordx4 v1, s[72:75], s85 offen offset:0 sc1 lds
v_mfma_f32_16x16x32_bf16 v[136:139], a[56:59], v[252:255], v[136:139]
s_add_u32 m0, s24, 0
v_exp_f32 v167, v167
v_mfma_f32_16x16x32_bf16 v[140:143], a[60:63], v[252:255], v[140:143]
s_add_u32 s79, s68, 0
ds_read_b128 a[92:95], v5 offset:15360
v_cvt_pk_bf16_f32 v251, v166, v167
v_mfma_f32_16x16x32_bf16 v[144:147], a[64:67], v[208:211], v[144:147]
v_exp_f32 v168, v168
v_add_u32 v5, s98, v1
v_mfma_f32_16x16x32_bf16 v[144:147], a[68:71], v[212:215], v[144:147]
ds_read_b128 a[32:35], v6 offset:16384
buffer_load_dwordx4 v1, s[40:43], s79 offen sc1 lds
v_mfma_f32_16x16x32_bf16 v[144:147], a[72:75], v[216:219], v[144:147]
s_add_u32 m0, s24, 1024
v_exp_f32 v169, v169
v_mfma_f32_16x16x32_bf16 v[144:147], a[76:79], v[220:223], v[144:147]
s_add_u32 s79, s69, 0
ds_read_b128 a[36:39], v6 offset:17408
v_cvt_pk_bf16_f32 v252, v168, v169
v_mfma_f32_16x16x32_bf16 v[80:83], a[96:99], v[248:251], v[80:83]
v_exp_f32 v170, v170
v_mfma_f32_16x16x32_bf16 v[84:87], a[100:103], v[248:251], v[84:87]
s_waitcnt lgkmcnt(3)
ds_read_b128 a[40:43], v6 offset:18432
buffer_load_dwordx4 v1, s[40:43], s79 offen sc1 lds
v_mfma_f32_16x16x32_bf16 v[88:91], a[104:107], v[248:251], v[88:91]
s_add_u32 m0, s24, 2048
v_exp_f32 v171, v171
v_mfma_f32_16x16x32_bf16 v[92:95], a[108:111], v[248:251], v[92:95]
s_add_u32 s79, s70, 0
ds_read_b128 a[44:47], v6 offset:19456
v_cvt_pk_bf16_f32 v253, v170, v171
v_mfma_f32_16x16x32_bf16 v[148:151], a[80:83], v[208:211], v[148:151]
v_exp_f32 v172, v172
v_mfma_f32_16x16x32_bf16 v[148:151], a[84:87], v[212:215], v[148:151]
s_waitcnt lgkmcnt(3)
ds_read_b128 a[48:51], v6 offset:20480
buffer_load_dwordx4 v1, s[40:43], s79 offen sc1 lds
v_mfma_f32_16x16x32_bf16 v[148:151], a[88:91], v[216:219], v[148:151]
s_add_u32 m0, s24, 3072
v_exp_f32 v173, v173
v_mfma_f32_16x16x32_bf16 v[148:151], a[92:95], v[220:223], v[148:151]
s_add_u32 s79, s71, 0
ds_read_b128 a[52:55], v6 offset:21504
v_cvt_pk_bf16_f32 v254, v172, v173
v_mfma_f32_16x16x32_bf16 v[96:99], a[112:115], v[248:251], v[96:99]
v_exp_f32 v174, v174
v_mfma_f32_16x16x32_bf16 v[100:103], a[116:119], v[248:251], v[100:103]
ds_read_b128 a[56:59], v6 offset:22528
buffer_load_dwordx4 v1, s[40:43], s79 offen sc1 lds
v_mfma_f32_16x16x32_bf16 v[104:107], a[120:123], v[248:251], v[104:107]
v_exp_f32 v175, v175
v_mfma_f32_16x16x32_bf16 v[108:111], a[124:127], v[248:251], v[108:111]
ds_read_b128 a[60:63], v6 offset:23552
v_cvt_pk_bf16_f32 v255, v174, v175
v_mfma_f32_16x16x32_bf16 v[168:171], a[64:67], v[224:227], 0
s_waitcnt vmcnt(9)
v_exp_f32 v144, v144
v_mfma_f32_16x16x32_bf16 v[168:171], a[68:71], v[228:231], v[168:171]
s_barrier
ds_read_b128 a[0:3], v6 offset:24576
v_smfmac_f32_16x16x64_bf16 a[228:231], a[232:235], v[248:255], v7
s_add_u32 m0, s29, 36864
ds_read_b128 a[4:7], v6 offset:25600
v_mfma_f32_16x16x32_bf16 v[168:171], a[72:75], v[232:235], v[168:171]
s_add_u32 s85, s27, 327680
v_exp_f32 v145, v145
v_mfma_f32_16x16x32_bf16 v[168:171], a[76:79], v[236:239], v[168:171]
ds_read_b128 a[8:11], v6 offset:26624
v_cvt_pk_bf16_f32 v248, v144, v145
v_mfma_f32_16x16x32_bf16 v[112:115], a[96:99], v[252:255], v[112:115]
v_exp_f32 v146, v146
v_mfma_f32_16x16x32_bf16 v[116:119], a[100:103], v[252:255], v[116:119]
ds_read_b128 a[12:15], v6 offset:27648
buffer_load_dwordx4 v1, s[72:75], s85 offen offset:0 sc1 lds
v_mfma_f32_16x16x32_bf16 v[120:123], a[104:107], v[252:255], v[120:123]
v_exp_f32 v147, v147
v_mfma_f32_16x16x32_bf16 v[124:127], a[108:111], v[252:255], v[124:127]
ds_read_b128 a[16:19], v6 offset:28672
v_cvt_pk_bf16_f32 v249, v146, v147
v_mfma_f32_16x16x32_bf16 v[172:175], a[80:83], v[224:227], 0
v_exp_f32 v148, v148
v_mfma_f32_16x16x32_bf16 v[172:175], a[84:87], v[228:231], v[172:175]
ds_read_b128 a[20:23], v6 offset:29696
buffer_load_dwordx4 v1, s[72:75], s85 offen offset:1024 sc1 lds
v_mfma_f32_16x16x32_bf16 v[172:175], a[88:91], v[232:235], v[172:175]
v_exp_f32 v149, v149
v_mfma_f32_16x16x32_bf16 v[172:175], a[92:95], v[236:239], v[172:175]
ds_read_b128 a[24:27], v6 offset:30720
v_cvt_pk_bf16_f32 v250, v148, v149
v_mfma_f32_16x16x32_bf16 v[128:131], a[112:115], v[252:255], v[128:131]
v_exp_f32 v150, v150
v_mfma_f32_16x16x32_bf16 v[132:135], a[116:119], v[252:255], v[132:135]
buffer_load_dwordx4 v1, s[72:75], s85 offen offset:2048 sc1 lds
v_mfma_f32_16x16x32_bf16 v[136:139], a[120:123], v[252:255], v[136:139]
v_exp_f32 v151, v151
v_mfma_f32_16x16x32_bf16 v[140:143], a[124:127], v[252:255], v[140:143]
s_waitcnt lgkmcnt(2)
ds_read_b128 a[28:31], v6 offset:31744
v_cvt_pk_bf16_f32 v251, v150, v151
v_mfma_f32_16x16x32_bf16 v[152:155], a[0:3], v[224:227], v[152:155]
v_exp_f32 v168, v168
v_mfma_f32_16x16x32_bf16 v[152:155], a[4:7], v[228:231], v[152:155]
ds_read_b128 a[96:99], v5 offset:0
v_mfma_f32_16x16x32_bf16 v[152:155], a[8:11], v[232:235], v[152:155]
v_exp_f32 v169, v169
v_mfma_f32_16x16x32_bf16 v[152:155], a[12:15], v[236:239], v[152:155]
ds_read_b128 a[100:103], v5 offset:1024
v_cvt_pk_bf16_f32 v252, v168, v169
v_mfma_f32_16x16x32_bf16 v[80:83], a[32:35], v[248:251], v[80:83]
v_exp_f32 v170, v170
v_mfma_f32_16x16x32_bf16 v[84:87], a[36:39], v[248:251], v[84:87]
ds_read_b128 a[104:107], v5 offset:2048
buffer_load_dwordx4 v1, s[72:75], s85 offen offset:3072 sc1 lds
v_mfma_f32_16x16x32_bf16 v[88:91], a[40:43], v[248:251], v[88:91]
s_add_u32 m0, s29, 40960
v_exp_f32 v171, v171
v_mfma_f32_16x16x32_bf16 v[92:95], a[44:47], v[248:251], v[92:95]
s_add_u32 s85, s27, 331776
ds_read_b128 a[108:111], v5 offset:3072
v_cvt_pk_bf16_f32 v253, v170, v171
v_mfma_f32_16x16x32_bf16 v[156:159], a[16:19], v[224:227], v[156:159]
s_waitcnt lgkmcnt(3)
v_exp_f32 v172, v172
v_mfma_f32_16x16x32_bf16 v[156:159], a[20:23], v[228:231], v[156:159]
ds_read_b128 a[112:115], v5 offset:4096
buffer_load_dwordx4 v1, s[72:75], s85 offen offset:0 sc1 lds
v_mfma_f32_16x16x32_bf16 v[156:159], a[24:27], v[232:235], v[156:159]
s_add_u32 m0, s25, 0
v_exp_f32 v173, v173
v_mfma_f32_16x16x32_bf16 v[156:159], a[28:31], v[236:239], v[156:159]
s_add_u32 s79, s68, 32768
ds_read_b128 a[116:119], v5 offset:5120
v_cvt_pk_bf16_f32 v254, v172, v173
v_mfma_f32_16x16x32_bf16 v[96:99], a[48:51], v[248:251], v[96:99]
v_exp_f32 v174, v174
v_mfma_f32_16x16x32_bf16 v[100:103], a[52:55], v[248:251], v[100:103]
ds_read_b128 a[120:123], v5 offset:6144
buffer_load_dwordx4 v1, s[40:43], s79 offen sc1 lds
v_mfma_f32_16x16x32_bf16 v[104:107], a[56:59], v[248:251], v[104:107]
v_exp_f32 v175, v175
v_mfma_f32_16x16x32_bf16 v[108:111], a[60:63], v[248:251], v[108:111]
ds_read_b128 a[124:127], v5 offset:7168
v_cvt_pk_bf16_f32 v255, v174, v175
s_nop 1
v_mfma_f32_16x16x32_bf16 v[112:115], a[32:35], v[252:255], v[112:115]
s_add_u32 m0, s25, 1024
v_exp_f32 v152, v152
v_smfmac_f32_16x16x64_bf16 a[228:231], a[232:235], v[248:255], v7
s_add_u32 s79, s69, 32768
v_mfma_f32_16x16x32_bf16 v[116:119], a[36:39], v[252:255], v[116:119]
v_exp_f32 v153, v153
s_nop 0
v_cvt_pk_bf16_f32 v244, v152, v153
v_mfma_f32_16x16x32_bf16 v[120:123], a[40:43], v[252:255], v[120:123]
v_exp_f32 v154, v154
v_mfma_f32_16x16x32_bf16 v[124:127], a[44:47], v[252:255], v[124:127]
v_exp_f32 v155, v155
s_nop 0
v_cvt_pk_bf16_f32 v245, v154, v155
v_mfma_f32_16x16x32_bf16 v[128:131], a[48:51], v[252:255], v[128:131]
v_exp_f32 v156, v156
v_mfma_f32_16x16x32_bf16 v[132:135], a[52:55], v[252:255], v[132:135]
v_exp_f32 v157, v157
s_nop 0
v_cvt_pk_bf16_f32 v246, v156, v157
v_mfma_f32_16x16x32_bf16 v[136:139], a[56:59], v[252:255], v[136:139]
v_exp_f32 v158, v158
v_mfma_f32_16x16x32_bf16 v[140:143], a[60:63], v[252:255], v[140:143]
v_exp_f32 v159, v159
s_nop 0
v_cvt_pk_bf16_f32 v247, v158, v159
s_nop 1
v_mfma_f32_16x16x32_bf16 v[112:115], a[96:99], v[244:247], v[112:115]
s_waitcnt lgkmcnt(0)
buffer_load_dwordx4 v1, s[40:43], s79 offen sc1 lds
v_smfmac_f32_16x16x64_bf16 a[228:231], a[236:239], v[240:247], v7
s_add_u32 m0, s25, 2048
v_mfma_f32_16x16x32_bf16 v[116:119], a[100:103], v[244:247], v[116:119]
s_add_u32 s79, s70, 32768
v_mfma_f32_16x16x32_bf16 v[120:123], a[104:107], v[244:247], v[120:123]
buffer_load_dwordx4 v1, s[40:43], s79 offen sc1 lds
v_mfma_f32_16x16x32_bf16 v[124:127], a[108:111], v[244:247], v[124:127]
s_add_u32 m0, s25, 3072
v_mfma_f32_16x16x32_bf16 v[128:131], a[112:115], v[244:247], v[128:131]
s_add_u32 s79, s71, 32768
v_mfma_f32_16x16x32_bf16 v[132:135], a[116:119], v[244:247], v[132:135]
buffer_load_dwordx4 v1, s[40:43], s79 offen sc1 lds
v_mfma_f32_16x16x32_bf16 v[136:139], a[120:123], v[244:247], v[136:139]
v_mfma_f32_16x16x32_bf16 v[140:143], a[124:127], v[244:247], v[140:143]
s_waitcnt vmcnt(9)
s_barrier
L_att_D2:
s_nop 3
v_accvgpr_read_b32 v144, a224
v_accvgpr_read_b32 v145, a225
v_accvgpr_read_b32 v146, a226
v_accvgpr_read_b32 v147, a227
v_accvgpr_read_b32 v148, a228
v_accvgpr_read_b32 v149, a229
v_accvgpr_read_b32 v150, a230
v_accvgpr_read_b32 v151, a231
v_add_f32 v152, v144, v145
v_add_f32 v154, v146, v147
v_add_f32 v156, v148, v149
v_add_f32 v158, v150, v151
v_min3_f32 v12, v152, v154, v156
v_add_f32 v14, v152, v154
v_add_f32 v15, v156, v158
v_min_f32 v12, v12, v158
v_add_f32 v14, v14, v15
v_mov_b32 v15, 0x4b800000
v_cmp_lt_f32 vcc, 0x33800000, v12
v_cmp_gt_f32 s[80:81], v15, v14
s_and_b64 vcc, vcc, s[80:81]
s_cmp_eq_u64 vcc, exec
s_cbranch_scc0 L_slow
L_slow_ret:
v_rcp_f32 v156, v156
v_rcp_f32 v158, v158
s_lshr_b32 s80, s76, 1
s_lshl_b32 s80, s80, 13
s_and_b32 s81, s76, 1
s_mul_i32 s81, s81, 10240
v_subrev_u32 v5, s80, v1
v_subrev_u32 v6, s81, v1
v_add_u32 v9, s24, v5
v_add_u32 v10, s25, v5
v_add_u32 v11, s28, v5
v_add_u32 v12, s29, v6
v_add_u32 v13, s32, v6
v_add_u32 v14, s33, v6
ds_read_b128 a[144:147], v12 offset:16384
ds_read_b128 a[128:131], v9 offset:0
ds_read_b128 a[132:135], v9 offset:1024
ds_read_b128 a[136:139], v9 offset:2048
ds_read_b128 a[140:143], v9 offset:3072
ds_read_b128 a[148:151], v12 offset:17408
ds_read_b128 a[152:155], v12 offset:18432
ds_read_b128 a[156:159], v12 offset:19456
ds_read_b128 a[160:163], v12 offset:20480
s_add_u32 m0, s32, 0
s_add_u32 s85, s27, 655360
buffer_load_dwordx4 v1, s[72:75], s85 offen offset:0 sc1 lds
buffer_load_dwordx4 v1, s[72:75], s85 offen offset:1024 sc1 lds
buffer_load_dwordx4 v1, s[72:75], s85 offen offset:2048 sc1 lds
buffer_load_dwordx4 v1, s[72:75], s85 offen offset:3072 sc1 lds
s_add_u32 m0, s32, 4096
s_add_u32 s85, s27, 659456
buffer_load_dwordx4 v1, s[72:75], s85 offen offset:0 sc1 lds
s_add_u32 m0, s25, 16384
s_add_u32 s79, s68, 65536
buffer_load_dwordx4 v1, s[40:43], s79 offen sc1 lds
s_add_u32 m0, s25, 17408
s_add_u32 s79, s69, 65536
buffer_load_dwordx4 v1, s[40:43], s79 offen sc1 lds
s_add_u32 m0, s25, 18432
s_add_u32 s79, s70, 65536
buffer_load_dwordx4 v1, s[40:43], s79 offen sc1 lds
s_add_u32 m0, s25, 19456
s_add_u32 s79, s71, 65536
buffer_load_dwordx4 v1, s[40:43], s79 offen sc1 lds
v_pk_mul_f32 v[80:81], v[80:81], v[156:157] op_sel_hi:[1,0]
v_pk_mul_f32 v[82:83], v[82:83], v[156:157] op_sel_hi:[1,0]
v_pk_mul_f32 v[84:85], v[84:85], v[156:157] op_sel_hi:[1,0]
v_pk_mul_f32 v[86:87], v[86:87], v[156:157] op_sel_hi:[1,0]
s_add_u32 s84, s96, 0
v_cvt_pk_bf16_f32 v80, v80, v81
v_cvt_pk_bf16_f32 v81, v82, v83
v_cvt_pk_bf16_f32 v82, v84, v85
v_cvt_pk_bf16_f32 v83, v86, v87
buffer_store_dwordx4 v[80:83], v1, s[56:59], s84 offen sc1
v_pk_mul_f32 v[88:89], v[88:89], v[156:157] op_sel_hi:[1,0]
v_pk_mul_f32 v[90:91], v[90:91], v[156:157] op_sel_hi:[1,0]
v_pk_mul_f32 v[92:93], v[92:93], v[156:157] op_sel_hi:[1,0]
v_pk_mul_f32 v[94:95], v[94:95], v[156:157] op_sel_hi:[1,0]
s_add_u32 s84, s96, 4096
v_cvt_pk_bf16_f32 v88, v88, v89
v_cvt_pk_bf16_f32 v89, v90, v91
v_cvt_pk_bf16_f32 v90, v92, v93
v_cvt_pk_bf16_f32 v91, v94, v95
buffer_store_dwordx4 v[88:91], v1, s[56:59], s84 offen sc1
v_pk_mul_f32 v[96:97], v[96:97], v[156:157] op_sel_hi:[1,0]
v_pk_mul_f32 v[98:99], v[98:99], v[156:157] op_sel_hi:[1,0]
v_pk_mul_f32 v[100:101], v[100:101], v[156:157] op_sel_hi:[1,0]
v_pk_mul_f32 v[102:103], v[102:103], v[156:157] op_sel_hi:[1,0]
s_add_u32 s84, s96, 8192
v_cvt_pk_bf16_f32 v96, v96, v97
v_cvt_pk_bf16_f32 v97, v98, v99
v_cvt_pk_bf16_f32 v98, v100, v101
v_cvt_pk_bf16_f32 v99, v102, v103
buffer_store_dwordx4 v[96:99], v1, s[56:59], s84 offen sc1
v_pk_mul_f32 v[104:105], v[104:105], v[156:157] op_sel_hi:[1,0]
v_pk_mul_f32 v[106:107], v[106:107], v[156:157] op_sel_hi:[1,0]
v_pk_mul_f32 v[108:109], v[108:109], v[156:157] op_sel_hi:[1,0]
v_pk_mul_f32 v[110:111], v[110:111], v[156:157] op_sel_hi:[1,0]
s_add_u32 s84, s96, 12288
v_cvt_pk_bf16_f32 v104, v104, v105
v_cvt_pk_bf16_f32 v105, v106, v107
v_cvt_pk_bf16_f32 v106, v108, v109
v_cvt_pk_bf16_f32 v107, v110, v111
buffer_store_dwordx4 v[104:107], v1, s[56:59], s84 offen sc1
v_pk_mul_f32 v[112:113], v[112:113], v[158:159] op_sel_hi:[1,0]
v_pk_mul_f32 v[114:115], v[114:115], v[158:159] op_sel_hi:[1,0]
v_pk_mul_f32 v[116:117], v[116:117], v[158:159] op_sel_hi:[1,0]
v_pk_mul_f32 v[118:119], v[118:119], v[158:159] op_sel_hi:[1,0]
s_add_u32 s84, s97, 0
v_cvt_pk_bf16_f32 v112, v112, v113
v_cvt_pk_bf16_f32 v113, v114, v115
v_cvt_pk_bf16_f32 v114, v116, v117
v_cvt_pk_bf16_f32 v115, v118, v119
buffer_store_dwordx4 v[112:115], v1, s[56:59], s84 offen sc1
v_pk_mul_f32 v[120:121], v[120:121], v[158:159] op_sel_hi:[1,0]
v_pk_mul_f32 v[122:123], v[122:123], v[158:159] op_sel_hi:[1,0]
v_pk_mul_f32 v[124:125], v[124:125], v[158:159] op_sel_hi:[1,0]
v_pk_mul_f32 v[126:127], v[126:127], v[158:159] op_sel_hi:[1,0]
s_add_u32 s84, s97, 4096
v_cvt_pk_bf16_f32 v120, v120, v121
v_cvt_pk_bf16_f32 v121, v122, v123
v_cvt_pk_bf16_f32 v122, v124, v125
v_cvt_pk_bf16_f32 v123, v126, v127
buffer_store_dwordx4 v[120:123], v1, s[56:59], s84 offen sc1
v_pk_mul_f32 v[128:129], v[128:129], v[158:159] op_sel_hi:[1,0]
v_pk_mul_f32 v[130:131], v[130:131], v[158:159] op_sel_hi:[1,0]
v_pk_mul_f32 v[132:133], v[132:133], v[158:159] op_sel_hi:[1,0]
v_pk_mul_f32 v[134:135], v[134:135], v[158:159] op_sel_hi:[1,0]
s_add_u32 s84, s97, 8192
v_cvt_pk_bf16_f32 v128, v128, v129
v_cvt_pk_bf16_f32 v129, v130, v131
v_cvt_pk_bf16_f32 v130, v132, v133
v_cvt_pk_bf16_f32 v131, v134, v135
buffer_store_dwordx4 v[128:131], v1, s[56:59], s84 offen sc1
v_pk_mul_f32 v[136:137], v[136:137], v[158:159] op_sel_hi:[1,0]
v_pk_mul_f32 v[138:139], v[138:139], v[158:159] op_sel_hi:[1,0]
v_pk_mul_f32 v[140:141], v[140:141], v[158:159] op_sel_hi:[1,0]
v_pk_mul_f32 v[142:143], v[142:143], v[158:159] op_sel_hi:[1,0]
s_add_u32 s84, s97, 12288
v_cvt_pk_bf16_f32 v136, v136, v137
v_cvt_pk_bf16_f32 v137, v138, v139
v_cvt_pk_bf16_f32 v138, v140, v141
v_cvt_pk_bf16_f32 v139, v142, v143
buffer_store_dwordx4 v[136:139], v1, s[56:59], s84 offen sc1
s_waitcnt lgkmcnt(0)
v_mfma_f32_16x16x32_bf16 v[144:147], a[144:147], a[128:131], 0
s_add_u32 m0, s33, 0
ds_read_b128 a[180:183], v12 offset:26624
v_mfma_f32_16x16x32_bf16 v[164:167], a[144:147], a[132:135], 0
s_add_u32 s85, s27, 983040
ds_read_b128 a[164:167], v9 offset:8192
v_mfma_f32_16x16x32_bf16 v[184:187], a[144:147], a[136:139], 0
buffer_load_dwordx4 v1, s[72:75], s85 offen offset:0 sc1 lds
v_mfma_f32_16x16x32_bf16 v[204:207], a[144:147], a[140:143], 0
buffer_load_dwordx4 v1, s[72:75], s85 offen offset:1024 sc1 lds
v_mfma_f32_16x16x32_bf16 v[148:151], a[148:151], a[128:131], 0
s_lshr_b32 s80, s30, 1
ds_read_b128 a[168:171], v9 offset:9216
v_mfma_f32_16x16x32_bf16 v[168:171], a[148:151], a[132:135], 0
buffer_load_dwordx4 v1, s[72:75], s85 offen offset:2048 sc1 lds
v_mfma_f32_16x16x32_bf16 v[188:191], a[148:151], a[136:139], 0
s_sub_u32 s81, 15, s80
ds_read_b128 a[172:175], v9 offset:10240
v_mfma_f32_16x16x32_bf16 v[208:211], a[148:151], a[140:143], 0
s_min_u32 s80, s80, s81
ds_read_b128 a[176:179], v9 offset:11264
v_mfma_f32_16x16x32_bf16 v[152:155], a[152:155], a[128:131], 0
s_lshl_b32 s80, s80, 2
ds_read_b128 a[184:187], v12 offset:27648
v_mfma_f32_16x16x32_bf16 v[172:175], a[152:155], a[132:135], 0
buffer_load_dwordx4 v1, s[72:75], s85 offen offset:3072 sc1 lds
v_mfma_f32_16x16x32_bf16 v[192:195], a[152:155], a[136:139], 0
s_add_u32 s80, s80, s22
ds_read_b128 a[188:191], v12 offset:28672
v_mfma_f32_16x16x32_bf16 v[212:215], a[152:155], a[140:143], 0
s_lshl_b32 s80, s80, 7
ds_read_b128 a[192:195], v12 offset:29696
v_mfma_f32_16x16x32_bf16 v[156:159], a[156:159], a[128:131], 0
s_add_u32 m0, s33, 4096
ds_read_b128 a[196:199], v12 offset:30720
v_mfma_f32_16x16x32_bf16 v[176:179], a[156:159], a[132:135], 0
s_add_u32 s85, s27, 987136
v_mfma_f32_16x16x32_bf16 v[196:199], a[156:159], a[136:139], 0
buffer_load_dwordx4 v1, s[72:75], s85 offen offset:0 sc1 lds
v_mfma_f32_16x16x32_bf16 v[216:219], a[156:159], a[140:143], 0
s_add_u32 m0, s28, 20480
v_mfma_f32_16x16x32_bf16 v[160:163], a[160:163], a[128:131], 0
s_add_u32 s79, s68, 98304
v_mfma_f32_16x16x32_bf16 v[180:183], a[160:163], a[132:135], 0
buffer_load_dwordx4 v1, s[40:43], s79 offen sc1 lds
v_mfma_f32_16x16x32_bf16 v[200:203], a[160:163], a[136:139], 0
s_add_u32 s80, s80, s3
v_mfma_f32_16x16x32_bf16 v[220:223], a[160:163], a[140:143], 0
s_add_u32 s101, s80, 68231168
s_waitcnt lgkmcnt(0)
v_mfma_f32_16x16x32_bf16 v[144:147], a[180:183], a[164:167], v[144:147]
s_waitcnt vmcnt(23)
v_mfma_f32_16x16x32_bf16 v[164:167], a[180:183], a[168:171], v[164:167]
s_barrier
v_mfma_f32_16x16x32_bf16 v[184:187], a[180:183], a[172:175], v[184:187]
s_add_u32 m0, s28, 21504
ds_read_b128 a[144:147], v12 offset:36864
v_mfma_f32_16x16x32_bf16 v[204:207], a[180:183], a[176:179], v[204:207]
s_add_u32 s79, s69, 98304
ds_read_b128 a[128:131], v10 offset:0
v_mfma_f32_16x16x32_bf16 v[148:151], a[184:187], a[164:167], v[148:151]
buffer_load_dwordx4 v1, s[40:43], s79 offen sc1 lds
v_mfma_f32_16x16x32_bf16 v[168:171], a[184:187], a[168:171], v[168:171]
s_add_u32 m0, s28, 22528
ds_read_b128 a[132:135], v10 offset:1024
v_mfma_f32_16x16x32_bf16 v[188:191], a[184:187], a[172:175], v[188:191]
s_add_u32 s79, s70, 98304
ds_read_b128 a[136:139], v10 offset:2048
v_mfma_f32_16x16x32_bf16 v[208:211], a[184:187], a[176:179], v[208:211]
buffer_load_dwordx4 v1, s[40:43], s79 offen sc1 lds
v_mfma_f32_16x16x32_bf16 v[152:155], a[188:191], a[164:167], v[152:155]
s_add_u32 m0, s28, 23552
ds_read_b128 a[140:143], v10 offset:3072
v_mfma_f32_16x16x32_bf16 v[172:175], a[188:191], a[168:171], v[172:175]
s_add_u32 s79, s71, 98304
ds_read_b128 a[148:151], v12 offset:37888
v_mfma_f32_16x16x32_bf16 v[192:195], a[188:191], a[172:175], v[192:195]
buffer_load_dwordx4 v1, s[40:43], s79 offen sc1 lds
v_mfma_f32_16x16x32_bf16 v[212:215], a[188:191], a[176:179], v[212:215]
s_add_u32 m0, s29, 16384
ds_read_b128 a[152:155], v12 offset:38912
v_mfma_f32_16x16x32_bf16 v[156:159], a[192:195], a[164:167], v[156:159]
s_add_u32 s85, s27, 1310720
ds_read_b128 a[156:159], v12 offset:39936
v_mfma_f32_16x16x32_bf16 v[176:179], a[192:195], a[168:171], v[176:179]
buffer_load_dwordx4 v1, s[72:75], s85 offen offset:0 sc1 lds
v_mfma_f32_16x16x32_bf16 v[196:199], a[192:195], a[172:175], v[196:199]
buffer_load_dwordx4 v1, s[72:75], s85 offen offset:1024 sc1 lds
v_mfma_f32_16x16x32_bf16 v[216:219], a[192:195], a[176:179], v[216:219]
ds_read_b128 a[160:163], v12 offset:40960
v_mfma_f32_16x16x32_bf16 v[160:163], a[196:199], a[164:167], v[160:163]
buffer_load_dwordx4 v1, s[72:75], s85 offen offset:2048 sc1 lds
v_mfma_f32_16x16x32_bf16 v[180:183], a[196:199], a[168:171], v[180:183]
v_mfma_f32_16x16x32_bf16 v[200:203], a[196:199], a[172:175], v[200:203]
v_mfma_f32_16x16x32_bf16 v[220:223], a[196:199], a[176:179], v[220:223]
s_waitcnt lgkmcnt(0)
v_mfma_f32_16x16x32_bf16 v[144:147], a[144:147], a[128:131], v[144:147]
buffer_load_dwordx4 v1, s[72:75], s85 offen offset:3072 sc1 lds
v_mfma_f32_16x16x32_bf16 v[164:167], a[144:147], a[132:135], v[164:167]
ds_read_b128 a[180:183], v12 offset:47104
v_mfma_f32_16x16x32_bf16 v[184:187], a[144:147], a[136:139], v[184:187]
s_add_u32 m0, s29, 20480
ds_read_b128 a[164:167], v10 offset:8192
v_mfma_f32_16x16x32_bf16 v[204:207], a[144:147], a[140:143], v[204:207]
s_add_u32 s85, s27, 1314816
ds_read_b128 a[168:171], v10 offset:9216
v_mfma_f32_16x16x32_bf16 v[148:151], a[148:151], a[128:131], v[148:151]
buffer_load_dwordx4 v1, s[72:75], s85 offen offset:0 sc1 lds
v_mfma_f32_16x16x32_bf16 v[168:171], a[148:151], a[132:135], v[168:171]
s_add_u32 m0, s24, 0
ds_read_b128 a[172:175], v10 offset:10240
v_mfma_f32_16x16x32_bf16 v[188:191], a[148:151], a[136:139], v[188:191]
s_add_u32 s79, s68, 131072
ds_read_b128 a[176:179], v10 offset:11264
v_mfma_f32_16x16x32_bf16 v[208:211], a[148:151], a[140:143], v[208:211]
buffer_load_dwordx4 v1, s[40:43], s79 offen sc1 lds
v_mfma_f32_16x16x32_bf16 v[152:155], a[152:155], a[128:131], v[152:155]
ds_read_b128 a[184:187], v12 offset:48128
v_mfma_f32_16x16x32_bf16 v[172:175], a[152:155], a[132:135], v[172:175]
s_add_u32 m0, s24, 1024
ds_read_b128 a[188:191], v12 offset:49152
v_mfma_f32_16x16x32_bf16 v[192:195], a[152:155], a[136:139], v[192:195]
s_add_u32 s79, s69, 131072
ds_read_b128 a[192:195], v12 offset:50176
v_mfma_f32_16x16x32_bf16 v[212:215], a[152:155], a[140:143], v[212:215]
buffer_load_dwordx4 v1, s[40:43], s79 offen sc1 lds
v_mfma_f32_16x16x32_bf16 v[156:159], a[156:159], a[128:131], v[156:159]
s_add_u32 m0, s24, 2048
ds_read_b128 a[196:199], v12 offset:51200
v_mfma_f32_16x16x32_bf16 v[176:179], a[156:159], a[132:135], v[176:179]
s_add_u32 s79, s70, 131072
v_mfma_f32_16x16x32_bf16 v[196:199], a[156:159], a[136:139], v[196:199]
buffer_load_dwordx4 v1, s[40:43], s79 offen sc1 lds
v_mfma_f32_16x16x32_bf16 v[216:219], a[156:159], a[140:143], v[216:219]
s_add_u32 m0, s24, 3072
v_mfma_f32_16x16x32_bf16 v[160:163], a[160:163], a[128:131], v[160:163]
s_add_u32 s79, s71, 131072
v_mfma_f32_16x16x32_bf16 v[180:183], a[160:163], a[132:135], v[180:183]
buffer_load_dwordx4 v1, s[40:43], s79 offen sc1 lds
v_mfma_f32_16x16x32_bf16 v[200:203], a[160:163], a[136:139], v[200:203]
v_mfma_f32_16x16x32_bf16 v[220:223], a[160:163], a[140:143], v[220:223]
s_waitcnt lgkmcnt(0)
v_mfma_f32_16x16x32_bf16 v[144:147], a[180:183], a[164:167], v[144:147]
s_waitcnt vmcnt(26)
v_mfma_f32_16x16x32_bf16 v[164:167], a[180:183], a[168:171], v[164:167]
s_barrier
v_mfma_f32_16x16x32_bf16 v[184:187], a[180:183], a[172:175], v[184:187]
s_add_u32 m0, s29, 36864
ds_read_b128 a[144:147], v13 offset:0
v_mfma_f32_16x16x32_bf16 v[204:207], a[180:183], a[176:179], v[204:207]
s_add_u32 s85, s27, 1638400
ds_read_b128 a[128:131], v10 offset:16384
v_mfma_f32_16x16x32_bf16 v[148:151], a[184:187], a[164:167], v[148:151]
buffer_load_dwordx4 v1, s[72:75], s85 offen offset:0 sc1 lds
v_mfma_f32_16x16x32_bf16 v[168:171], a[184:187], a[168:171], v[168:171]
buffer_load_dwordx4 v1, s[72:75], s85 offen offset:1024 sc1 lds
v_mfma_f32_16x16x32_bf16 v[188:191], a[184:187], a[172:175], v[188:191]
ds_read_b128 a[132:135], v10 offset:17408
v_mfma_f32_16x16x32_bf16 v[208:211], a[184:187], a[176:179], v[208:211]
ds_read_b128 a[136:139], v10 offset:18432
v_mfma_f32_16x16x32_bf16 v[152:155], a[188:191], a[164:167], v[152:155]
buffer_load_dwordx4 v1, s[72:75], s85 offen offset:2048 sc1 lds
v_mfma_f32_16x16x32_bf16 v[172:175], a[188:191], a[168:171], v[172:175]
ds_read_b128 a[140:143], v10 offset:19456
v_mfma_f32_16x16x32_bf16 v[192:195], a[188:191], a[172:175], v[192:195]
ds_read_b128 a[148:151], v13 offset:1024
v_mfma_f32_16x16x32_bf16 v[212:215], a[188:191], a[176:179], v[212:215]
buffer_load_dwordx4 v1, s[72:75], s85 offen offset:3072 sc1 lds
v_mfma_f32_16x16x32_bf16 v[156:159], a[192:195], a[164:167], v[156:159]
ds_read_b128 a[152:155], v13 offset:2048
v_mfma_f32_16x16x32_bf16 v[176:179], a[192:195], a[168:171], v[176:179]
ds_read_b128 a[156:159], v13 offset:3072
v_mfma_f32_16x16x32_bf16 v[196:199], a[192:195], a[172:175], v[196:199]
ds_read_b128 a[160:163], v13 offset:4096
v_mfma_f32_16x16x32_bf16 v[216:219], a[192:195], a[176:179], v[216:219]
s_add_u32 m0, s29, 40960
v_mfma_f32_16x16x32_bf16 v[160:163], a[196:199], a[164:167], v[160:163]
s_add_u32 s85, s27, 1642496
v_mfma_f32_16x16x32_bf16 v[180:183], a[196:199], a[168:171], v[180:183]
buffer_load_dwordx4 v1, s[72:75], s85 offen offset:0 sc1 lds
v_mfma_f32_16x16x32_bf16 v[200:203], a[196:199], a[172:175], v[200:203]
v_mfma_f32_16x16x32_bf16 v[220:223], a[196:199], a[176:179], v[220:223]
s_waitcnt lgkmcnt(0)
v_mfma_f32_16x16x32_bf16 v[144:147], a[144:147], a[128:131], v[144:147]
s_add_u32 m0, s25, 0
ds_read_b128 a[180:183], v13 offset:10240
v_mfma_f32_16x16x32_bf16 v[164:167], a[144:147], a[132:135], v[164:167]
s_add_u32 s79, s68, 163840
ds_read_b128 a[164:167], v10 offset:24576
v_mfma_f32_16x16x32_bf16 v[184:187], a[144:147], a[136:139], v[184:187]
buffer_load_dwordx4 v1, s[40:43], s79 offen sc1 lds
v_mfma_f32_16x16x32_bf16 v[204:207], a[144:147], a[140:143], v[204:207]
ds_read_b128 a[168:171], v10 offset:25600
v_mfma_f32_16x16x32_bf16 v[148:151], a[148:151], a[128:131], v[148:151]
s_add_u32 m0, s25, 1024
ds_read_b128 a[172:175], v10 offset:26624
v_mfma_f32_16x16x32_bf16 v[168:171], a[148:151], a[132:135], v[168:171]
s_add_u32 s79, s69, 163840
ds_read_b128 a[176:179], v10 offset:27648
v_mfma_f32_16x16x32_bf16 v[188:191], a[148:151], a[136:139], v[188:191]
buffer_load_dwordx4 v1, s[40:43], s79 offen sc1 lds
v_mfma_f32_16x16x32_bf16 v[208:211], a[148:151], a[140:143], v[208:211]
ds_read_b128 a[184:187], v13 offset:11264
v_mfma_f32_16x16x32_bf16 v[152:155], a[152:155], a[128:131], v[152:155]
ds_read_b128 a[188:191], v13 offset:12288
v_mfma_f32_16x16x32_bf16 v[172:175], a[152:155], a[132:135], v[172:175]
s_add_u32 m0, s25, 2048
ds_read_b128 a[192:195], v13 offset:13312
v_mfma_f32_16x16x32_bf16 v[192:195], a[152:155], a[136:139], v[192:195]
s_add_u32 s79, s70, 163840
ds_read_b128 a[196:199], v13 offset:14336
v_mfma_f32_16x16x32_bf16 v[212:215], a[152:155], a[140:143], v[212:215]
buffer_load_dwordx4 v1, s[40:43], s79 offen sc1 lds
v_mfma_f32_16x16x32_bf16 v[156:159], a[156:159], a[128:131], v[156:159]
v_mfma_f32_16x16x32_bf16 v[176:179], a[156:159], a[132:135], v[176:179]
v_mfma_f32_16x16x32_bf16 v[196:199], a[156:159], a[136:139], v[196:199]
s_add_u32 m0, s25, 3072
v_mfma_f32_16x16x32_bf16 v[216:219], a[156:159], a[140:143], v[216:219]
s_add_u32 s79, s71, 163840
v_mfma_f32_16x16x32_bf16 v[160:163], a[160:163], a[128:131], v[160:163]
buffer_load_dwordx4 v1, s[40:43], s79 offen sc1 lds
v_mfma_f32_16x16x32_bf16 v[180:183], a[160:163], a[132:135], v[180:183]
v_mfma_f32_16x16x32_bf16 v[200:203], a[160:163], a[136:139], v[200:203]
v_mfma_f32_16x16x32_bf16 v[220:223], a[160:163], a[140:143], v[220:223]
s_waitcnt lgkmcnt(0)
v_mfma_f32_16x16x32_bf16 v[144:147], a[180:183], a[164:167], v[144:147]
s_waitcnt vmcnt(18)
v_mfma_f32_16x16x32_bf16 v[164:167], a[180:183], a[168:171], v[164:167]
s_barrier
v_mfma_f32_16x16x32_bf16 v[184:187], a[180:183], a[172:175], v[184:187]
buffer_atomic_add v3, v2, s[56:59], s100 offen sc1
v_mfma_f32_16x16x32_bf16 v[204:207], a[180:183], a[176:179], v[204:207]
s_add_u32 m0, s32, 0
ds_read_b128 a[144:147], v14 offset:0
v_mfma_f32_16x16x32_bf16 v[148:151], a[184:187], a[164:167], v[148:151]
s_add_u32 s85, s27, 1966080
ds_read_b128 a[128:131], v11 offset:20480
v_mfma_f32_16x16x32_bf16 v[168:171], a[184:187], a[168:171], v[168:171]
buffer_load_dwordx4 v1, s[72:75], s85 offen offset:0 sc1 lds
v_mfma_f32_16x16x32_bf16 v[188:191], a[184:187], a[172:175], v[188:191]
buffer_load_dwordx4 v1, s[72:75], s85 offen offset:1024 sc1 lds
v_mfma_f32_16x16x32_bf16 v[208:211], a[184:187], a[176:179], v[208:211]
ds_read_b128 a[132:135], v11 offset:21504
v_mfma_f32_16x16x32_bf16 v[152:155], a[188:191], a[164:167], v[152:155]
buffer_load_dwordx4 v1, s[72:75], s85 offen offset:2048 sc1 lds
v_mfma_f32_16x16x32_bf16 v[172:175], a[188:191], a[168:171], v[172:175]
ds_read_b128 a[136:139], v11 offset:22528
v_mfma_f32_16x16x32_bf16 v[192:195], a[188:191], a[172:175], v[192:195]
ds_read_b128 a[140:143], v11 offset:23552
v_mfma_f32_16x16x32_bf16 v[212:215], a[188:191], a[176:179], v[212:215]
buffer_load_dwordx4 v1, s[72:75], s85 offen offset:3072 sc1 lds
v_mfma_f32_16x16x32_bf16 v[156:159], a[192:195], a[164:167], v[156:159]
ds_read_b128 a[148:151], v14 offset:1024
v_mfma_f32_16x16x32_bf16 v[176:179], a[192:195], a[168:171], v[176:179]
ds_read_b128 a[152:155], v14 offset:2048
v_mfma_f32_16x16x32_bf16 v[196:199], a[192:195], a[172:175], v[196:199]
ds_read_b128 a[156:159], v14 offset:3072
v_mfma_f32_16x16x32_bf16 v[216:219], a[192:195], a[176:179], v[216:219]
s_add_u32 m0, s32, 4096
ds_read_b128 a[160:163], v14 offset:4096
v_mfma_f32_16x16x32_bf16 v[160:163], a[196:199], a[164:167], v[160:163]
s_add_u32 s85, s27, 1970176
v_mfma_f32_16x16x32_bf16 v[180:183], a[196:199], a[168:171], v[180:183]
buffer_load_dwordx4 v1, s[72:75], s85 offen offset:0 sc1 lds
v_mfma_f32_16x16x32_bf16 v[200:203], a[196:199], a[172:175], v[200:203]
v_mfma_f32_16x16x32_bf16 v[220:223], a[196:199], a[176:179], v[220:223]
s_waitcnt lgkmcnt(0)
v_mfma_f32_16x16x32_bf16 v[144:147], a[144:147], a[128:131], v[144:147]
s_add_u32 m0, s25, 16384
ds_read_b128 a[180:183], v14 offset:10240
v_mfma_f32_16x16x32_bf16 v[164:167], a[144:147], a[132:135], v[164:167]
s_add_u32 s79, s68, 196608
ds_read_b128 a[164:167], v11 offset:28672
v_mfma_f32_16x16x32_bf16 v[184:187], a[144:147], a[136:139], v[184:187]
buffer_load_dwordx4 v1, s[40:43], s79 offen sc1 lds
v_mfma_f32_16x16x32_bf16 v[204:207], a[144:147], a[140:143], v[204:207]
ds_read_b128 a[168:171], v11 offset:29696
v_mfma_f32_16x16x32_bf16 v[148:151], a[148:151], a[128:131], v[148:151]
s_add_u32 m0, s25, 17408
ds_read_b128 a[172:175], v11 offset:30720
v_mfma_f32_16x16x32_bf16 v[168:171], a[148:151], a[132:135], v[168:171]
s_add_u32 s79, s69, 196608
ds_read_b128 a[176:179], v11 offset:31744
v_mfma_f32_16x16x32_bf16 v[188:191], a[148:151], a[136:139], v[188:191]
buffer_load_dwordx4 v1, s[40:43], s79 offen sc1 lds
v_mfma_f32_16x16x32_bf16 v[208:211], a[148:151], a[140:143], v[208:211]
ds_read_b128 a[184:187], v14 offset:11264
v_mfma_f32_16x16x32_bf16 v[152:155], a[152:155], a[128:131], v[152:155]
ds_read_b128 a[188:191], v14 offset:12288
v_mfma_f32_16x16x32_bf16 v[172:175], a[152:155], a[132:135], v[172:175]
s_add_u32 m0, s25, 18432
ds_read_b128 a[192:195], v14 offset:13312
v_mfma_f32_16x16x32_bf16 v[192:195], a[152:155], a[136:139], v[192:195]
s_add_u32 s79, s70, 196608
ds_read_b128 a[196:199], v14 offset:14336
v_mfma_f32_16x16x32_bf16 v[212:215], a[152:155], a[140:143], v[212:215]
buffer_load_dwordx4 v1, s[40:43], s79 offen sc1 lds
v_mfma_f32_16x16x32_bf16 v[156:159], a[156:159], a[128:131], v[156:159]
v_mfma_f32_16x16x32_bf16 v[176:179], a[156:159], a[132:135], v[176:179]
v_mfma_f32_16x16x32_bf16 v[196:199], a[156:159], a[136:139], v[196:199]
s_add_u32 m0, s25, 19456
v_mfma_f32_16x16x32_bf16 v[216:219], a[156:159], a[140:143], v[216:219]
s_add_u32 s79, s71, 196608
v_mfma_f32_16x16x32_bf16 v[160:163], a[160:163], a[128:131], v[160:163]
buffer_load_dwordx4 v1, s[40:43], s79 offen sc1 lds
v_mfma_f32_16x16x32_bf16 v[180:183], a[160:163], a[132:135], v[180:183]
v_mfma_f32_16x16x32_bf16 v[200:203], a[160:163], a[136:139], v[200:203]
v_mfma_f32_16x16x32_bf16 v[220:223], a[160:163], a[140:143], v[220:223]
s_waitcnt lgkmcnt(0)
v_mfma_f32_16x16x32_bf16 v[144:147], a[180:183], a[164:167], v[144:147]
s_waitcnt vmcnt(19)
v_mfma_f32_16x16x32_bf16 v[164:167], a[180:183], a[168:171], v[164:167]
s_barrier
v_mfma_f32_16x16x32_bf16 v[184:187], a[180:183], a[172:175], v[184:187]
s_add_u32 m0, s33, 0
ds_read_b128 a[144:147], v12 offset:16384
v_mfma_f32_16x16x32_bf16 v[204:207], a[180:183], a[176:179], v[204:207]
s_add_u32 s85, s27, 0
ds_read_b128 a[128:131], v9 offset:0
v_mfma_f32_16x16x32_bf16 v[148:151], a[184:187], a[164:167], v[148:151]
buffer_load_dwordx4 v1, s[48:51], s85 offen offset:0 sc1 lds
v_mfma_f32_16x16x32_bf16 v[168:171], a[184:187], a[168:171], v[168:171]
buffer_load_dwordx4 v1, s[48:51], s85 offen offset:1024 sc1 lds
v_mfma_f32_16x16x32_bf16 v[188:191], a[184:187], a[172:175], v[188:191]
ds_read_b128 a[132:135], v9 offset:1024
v_mfma_f32_16x16x32_bf16 v[208:211], a[184:187], a[176:179], v[208:211]
ds_read_b128 a[136:139], v9 offset:2048
v_mfma_f32_16x16x32_bf16 v[152:155], a[188:191], a[164:167], v[152:155]
buffer_load_dwordx4 v1, s[48:51], s85 offen offset:2048 sc1 lds
v_mfma_f32_16x16x32_bf16 v[172:175], a[188:191], a[168:171], v[172:175]
ds_read_b128 a[140:143], v9 offset:3072
v_mfma_f32_16x16x32_bf16 v[192:195], a[188:191], a[172:175], v[192:195]
ds_read_b128 a[148:151], v12 offset:17408
v_mfma_f32_16x16x32_bf16 v[212:215], a[188:191], a[176:179], v[212:215]
buffer_load_dwordx4 v1, s[48:51], s85 offen offset:3072 sc1 lds
v_mfma_f32_16x16x32_bf16 v[156:159], a[192:195], a[164:167], v[156:159]
ds_read_b128 a[152:155], v12 offset:18432
v_mfma_f32_16x16x32_bf16 v[176:179], a[192:195], a[168:171], v[176:179]
ds_read_b128 a[156:159], v12 offset:19456
v_mfma_f32_16x16x32_bf16 v[196:199], a[192:195], a[172:175], v[196:199]
ds_read_b128 a[160:163], v12 offset:20480
v_mfma_f32_16x16x32_bf16 v[216:219], a[192:195], a[176:179], v[216:219]
s_add_u32 m0, s33, 4096
v_mfma_f32_16x16x32_bf16 v[160:163], a[196:199], a[164:167], v[160:163]
s_add_u32 s85, s27, 4096
v_mfma_f32_16x16x32_bf16 v[180:183], a[196:199], a[168:171], v[180:183]
buffer_load_dwordx4 v1, s[48:51], s85 offen offset:0 sc1 lds
v_mfma_f32_16x16x32_bf16 v[200:203], a[196:199], a[172:175], v[200:203]
v_mfma_f32_16x16x32_bf16 v[220:223], a[196:199], a[176:179], v[220:223]
s_waitcnt lgkmcnt(0)
v_mfma_f32_16x16x32_bf16 v[144:147], a[144:147], a[128:131], v[144:147]
buffer_load_dword v4, v2, s[56:59], s101 offen sc1
v_mfma_f32_16x16x32_bf16 v[164:167], a[144:147], a[132:135], v[164:167]
ds_read_b128 a[180:183], v12 offset:26624
v_mfma_f32_16x16x32_bf16 v[184:187], a[144:147], a[136:139], v[184:187]
ds_read_b128 a[164:167], v9 offset:8192
v_mfma_f32_16x16x32_bf16 v[204:207], a[144:147], a[140:143], v[204:207]
ds_read_b128 a[168:171], v9 offset:9216
v_mfma_f32_16x16x32_bf16 v[148:151], a[148:151], a[128:131], v[148:151]
ds_read_b128 a[172:175], v9 offset:10240
v_mfma_f32_16x16x32_bf16 v[168:171], a[148:151], a[132:135], v[168:171]
ds_read_b128 a[176:179], v9 offset:11264
v_mfma_f32_16x16x32_bf16 v[188:191], a[148:151], a[136:139], v[188:191]
ds_read_b128 a[184:187], v12 offset:27648
v_mfma_f32_16x16x32_bf16 v[208:211], a[148:151], a[140:143], v[208:211]
ds_read_b128 a[188:191], v12 offset:28672
v_mfma_f32_16x16x32_bf16 v[152:155], a[152:155], a[128:131], v[152:155]
ds_read_b128 a[192:195], v12 offset:29696
v_mfma_f32_16x16x32_bf16 v[172:175], a[152:155], a[132:135], v[172:175]
ds_read_b128 a[196:199], v12 offset:30720
v_mfma_f32_16x16x32_bf16 v[192:195], a[152:155], a[136:139], v[192:195]
v_mfma_f32_16x16x32_bf16 v[212:215], a[152:155], a[140:143], v[212:215]
v_mfma_f32_16x16x32_bf16 v[156:159], a[156:159], a[128:131], v[156:159]
v_mfma_f32_16x16x32_bf16 v[176:179], a[156:159], a[132:135], v[176:179]
v_mfma_f32_16x16x32_bf16 v[196:199], a[156:159], a[136:139], v[196:199]
v_mfma_f32_16x16x32_bf16 v[216:219], a[156:159], a[140:143], v[216:219]
v_mfma_f32_16x16x32_bf16 v[160:163], a[160:163], a[128:131], v[160:163]
v_mfma_f32_16x16x32_bf16 v[180:183], a[160:163], a[132:135], v[180:183]
v_mfma_f32_16x16x32_bf16 v[200:203], a[160:163], a[136:139], v[200:203]
v_mfma_f32_16x16x32_bf16 v[220:223], a[160:163], a[140:143], v[220:223]
s_waitcnt lgkmcnt(0)
v_mfma_f32_16x16x32_bf16 v[144:147], a[180:183], a[164:167], v[144:147]
s_waitcnt vmcnt(16)
v_mfma_f32_16x16x32_bf16 v[164:167], a[180:183], a[168:171], v[164:167]
s_barrier
v_mfma_f32_16x16x32_bf16 v[184:187], a[180:183], a[172:175], v[184:187]
s_add_u32 m0, s29, 16384
ds_read_b128 a[144:147], v12 offset:36864
v_mfma_f32_16x16x32_bf16 v[204:207], a[180:183], a[176:179], v[204:207]
s_add_u32 s85, s27, 81920
ds_read_b128 a[128:131], v10 offset:0
v_mfma_f32_16x16x32_bf16 v[148:151], a[184:187], a[164:167], v[148:151]
buffer_load_dwordx4 v1, s[48:51], s85 offen offset:0 sc1 lds
v_mfma_f32_16x16x32_bf16 v[168:171], a[184:187], a[168:171], v[168:171]
buffer_load_dwordx4 v1, s[48:51], s85 offen offset:1024 sc1 lds
v_mfma_f32_16x16x32_bf16 v[188:191], a[184:187], a[172:175], v[188:191]
ds_read_b128 a[132:135], v10 offset:1024
v_mfma_f32_16x16x32_bf16 v[208:211], a[184:187], a[176:179], v[208:211]
ds_read_b128 a[136:139], v10 offset:2048
v_mfma_f32_16x16x32_bf16 v[152:155], a[188:191], a[164:167], v[152:155]
buffer_load_dwordx4 v1, s[48:51], s85 offen offset:2048 sc1 lds
v_mfma_f32_16x16x32_bf16 v[172:175], a[188:191], a[168:171], v[172:175]
ds_read_b128 a[140:143], v10 offset:3072
v_mfma_f32_16x16x32_bf16 v[192:195], a[188:191], a[172:175], v[192:195]
ds_read_b128 a[148:151], v12 offset:37888
v_mfma_f32_16x16x32_bf16 v[212:215], a[188:191], a[176:179], v[212:215]
buffer_load_dwordx4 v1, s[48:51], s85 offen offset:3072 sc1 lds
v_mfma_f32_16x16x32_bf16 v[156:159], a[192:195], a[164:167], v[156:159]
ds_read_b128 a[152:155], v12 offset:38912
v_mfma_f32_16x16x32_bf16 v[176:179], a[192:195], a[168:171], v[176:179]
ds_read_b128 a[156:159], v12 offset:39936
v_mfma_f32_16x16x32_bf16 v[196:199], a[192:195], a[172:175], v[196:199]
ds_read_b128 a[160:163], v12 offset:40960
v_mfma_f32_16x16x32_bf16 v[216:219], a[192:195], a[176:179], v[216:219]
s_add_u32 m0, s29, 20480
v_mfma_f32_16x16x32_bf16 v[160:163], a[196:199], a[164:167], v[160:163]
s_add_u32 s85, s27, 86016
v_mfma_f32_16x16x32_bf16 v[180:183], a[196:199], a[168:171], v[180:183]
buffer_load_dwordx4 v1, s[48:51], s85 offen offset:0 sc1 lds
v_mfma_f32_16x16x32_bf16 v[200:203], a[196:199], a[172:175], v[200:203]
v_mfma_f32_16x16x32_bf16 v[220:223], a[196:199], a[176:179], v[220:223]
s_waitcnt lgkmcnt(0)
v_mfma_f32_16x16x32_bf16 v[144:147], a[144:147], a[128:131], v[144:147]
ds_read_b128 a[180:183], v12 offset:47104
v_mfma_f32_16x16x32_bf16 v[164:167], a[144:147], a[132:135], v[164:167]
ds_read_b128 a[164:167], v10 offset:8192
v_mfma_f32_16x16x32_bf16 v[184:187], a[144:147], a[136:139], v[184:187]
ds_read_b128 a[168:171], v10 offset:9216
v_mfma_f32_16x16x32_bf16 v[204:207], a[144:147], a[140:143], v[204:207]
ds_read_b128 a[172:175], v10 offset:10240
v_mfma_f32_16x16x32_bf16 v[148:151], a[148:151], a[128:131], v[148:151]
ds_read_b128 a[176:179], v10 offset:11264
v_mfma_f32_16x16x32_bf16 v[168:171], a[148:151], a[132:135], v[168:171]
ds_read_b128 a[184:187], v12 offset:48128
v_mfma_f32_16x16x32_bf16 v[188:191], a[148:151], a[136:139], v[188:191]
ds_read_b128 a[188:191], v12 offset:49152
v_mfma_f32_16x16x32_bf16 v[208:211], a[148:151], a[140:143], v[208:211]
ds_read_b128 a[192:195], v12 offset:50176
v_mfma_f32_16x16x32_bf16 v[152:155], a[152:155], a[128:131], v[152:155]
ds_read_b128 a[196:199], v12 offset:51200
v_mfma_f32_16x16x32_bf16 v[172:175], a[152:155], a[132:135], v[172:175]
v_mfma_f32_16x16x32_bf16 v[192:195], a[152:155], a[136:139], v[192:195]
v_mfma_f32_16x16x32_bf16 v[212:215], a[152:155], a[140:143], v[212:215]
v_mfma_f32_16x16x32_bf16 v[156:159], a[156:159], a[128:131], v[156:159]
v_mfma_f32_16x16x32_bf16 v[176:179], a[156:159], a[132:135], v[176:179]
v_mfma_f32_16x16x32_bf16 v[196:199], a[156:159], a[136:139], v[196:199]
v_mfma_f32_16x16x32_bf16 v[216:219], a[156:159], a[140:143], v[216:219]
v_mfma_f32_16x16x32_bf16 v[160:163], a[160:163], a[128:131], v[160:163]
v_mfma_f32_16x16x32_bf16 v[180:183], a[160:163], a[132:135], v[180:183]
v_mfma_f32_16x16x32_bf16 v[200:203], a[160:163], a[136:139], v[200:203]
v_mfma_f32_16x16x32_bf16 v[220:223], a[160:163], a[140:143], v[220:223]
s_waitcnt vmcnt(5)
v_readfirstlane_b32 s26, v4
s_add_u32 s26, s26, s3
s_cmp_ge_u32 s26, 8
s_cbranch_scc0 L_ctx_spin0
L_ctx_ok:
s_waitcnt lgkmcnt(0)
v_mfma_f32_16x16x32_bf16 v[144:147], a[180:183], a[164:167], v[144:147]
v_mfma_f32_16x16x32_bf16 v[164:167], a[180:183], a[168:171], v[164:167]
s_barrier
v_mfma_f32_16x16x32_bf16 v[184:187], a[180:183], a[172:175], v[184:187]
s_add_u32 m0, s28, 20480
ds_read_b128 a[144:147], v13 offset:0
v_mfma_f32_16x16x32_bf16 v[204:207], a[180:183], a[176:179], v[204:207]
s_add_u32 s79, s68, 0
ds_read_b128 a[128:131], v10 offset:16384
v_mfma_f32_16x16x32_bf16 v[148:151], a[184:187], a[164:167], v[148:151]
buffer_load_dwordx4 v1, s[44:47], s79 offen sc1 lds
v_mfma_f32_16x16x32_bf16 v[168:171], a[184:187], a[168:171], v[168:171]
s_add_u32 m0, s28, 21504
ds_read_b128 a[132:135], v10 offset:17408
v_mfma_f32_16x16x32_bf16 v[188:191], a[184:187], a[172:175], v[188:191]
s_add_u32 s79, s69, 0
ds_read_b128 a[136:139], v10 offset:18432
v_mfma_f32_16x16x32_bf16 v[208:211], a[184:187], a[176:179], v[208:211]
buffer_load_dwordx4 v1, s[44:47], s79 offen sc1 lds
v_mfma_f32_16x16x32_bf16 v[152:155], a[188:191], a[164:167], v[152:155]
s_add_u32 m0, s28, 22528
ds_read_b128 a[140:143], v10 offset:19456
v_mfma_f32_16x16x32_bf16 v[172:175], a[188:191], a[168:171], v[172:175]
s_add_u32 s79, s70, 0
ds_read_b128 a[148:151], v13 offset:1024
v_mfma_f32_16x16x32_bf16 v[192:195], a[188:191], a[172:175], v[192:195]
buffer_load_dwordx4 v1, s[44:47], s79 offen sc1 lds
v_mfma_f32_16x16x32_bf16 v[212:215], a[188:191], a[176:179], v[212:215]
s_add_u32 m0, s28, 23552
ds_read_b128 a[152:155], v13 offset:2048
v_mfma_f32_16x16x32_bf16 v[156:159], a[192:195], a[164:167], v[156:159]
s_add_u32 s79, s71, 0
ds_read_b128 a[156:159], v13 offset:3072
v_mfma_f32_16x16x32_bf16 v[176:179], a[192:195], a[168:171], v[176:179]
buffer_load_dwordx4 v1, s[44:47], s79 offen sc1 lds
v_mfma_f32_16x16x32_bf16 v[196:199], a[192:195], a[172:175], v[196:199]
s_add_u32 m0, s24, 0
ds_read_b128 a[160:163], v13 offset:4096
v_mfma_f32_16x16x32_bf16 v[216:219], a[192:195], a[176:179], v[216:219]
s_add_u32 s79, s68, 8192
v_mfma_f32_16x16x32_bf16 v[160:163], a[196:199], a[164:167], v[160:163]
buffer_load_dwordx4 v1, s[44:47], s79 offen sc1 lds
v_mfma_f32_16x16x32_bf16 v[180:183], a[196:199], a[168:171], v[180:183]
s_add_u32 m0, s24, 1024
v_mfma_f32_16x16x32_bf16 v[200:203], a[196:199], a[172:175], v[200:203]
s_add_u32 s79, s69, 8192
v_mfma_f32_16x16x32_bf16 v[220:223], a[196:199], a[176:179], v[220:223]
buffer_load_dwordx4 v1, s[44:47], s79 offen sc1 lds
s_waitcnt lgkmcnt(0)
v_mfma_f32_16x16x32_bf16 v[144:147], a[144:147], a[128:131], v[144:147]
s_add_u32 m0, s24, 2048
ds_read_b128 a[180:183], v13 offset:10240
v_mfma_f32_16x16x32_bf16 v[164:167], a[144:147], a[132:135], v[164:167]
s_add_u32 s79, s70, 8192
ds_read_b128 a[164:167], v10 offset:24576
v_mfma_f32_16x16x32_bf16 v[184:187], a[144:147], a[136:139], v[184:187]
buffer_load_dwordx4 v1, s[44:47], s79 offen sc1 lds
v_mfma_f32_16x16x32_bf16 v[204:207], a[144:147], a[140:143], v[204:207]
s_add_u32 m0, s24, 3072
ds_read_b128 a[168:171], v10 offset:25600
v_mfma_f32_16x16x32_bf16 v[148:151], a[148:151], a[128:131], v[148:151]
s_add_u32 s79, s71, 8192
ds_read_b128 a[172:175], v10 offset:26624
v_mfma_f32_16x16x32_bf16 v[168:171], a[148:151], a[132:135], v[168:171]
buffer_load_dwordx4 v1, s[44:47], s79 offen sc1 lds
v_mfma_f32_16x16x32_bf16 v[188:191], a[148:151], a[136:139], v[188:191]
s_add_u32 m0, s29, 36864
ds_read_b128 a[176:179], v10 offset:27648
v_mfma_f32_16x16x32_bf16 v[208:211], a[148:151], a[140:143], v[208:211]
s_add_u32 s85, s27, 163840
ds_read_b128 a[184:187], v13 offset:11264
v_mfma_f32_16x16x32_bf16 v[152:155], a[152:155], a[128:131], v[152:155]
buffer_load_dwordx4 v1, s[48:51], s85 offen offset:0 sc1 lds
v_mfma_f32_16x16x32_bf16 v[172:175], a[152:155], a[132:135], v[172:175]
buffer_load_dwordx4 v1, s[48:51], s85 offen offset:1024 sc1 lds
v_mfma_f32_16x16x32_bf16 v[192:195], a[152:155], a[136:139], v[192:195]
ds_read_b128 a[188:191], v13 offset:12288
v_mfma_f32_16x16x32_bf16 v[212:215], a[152:155], a[140:143], v[212:215]
ds_read_b128 a[192:195], v13 offset:13312
v_mfma_f32_16x16x32_bf16 v[156:159], a[156:159], a[128:131], v[156:159]
buffer_load_dwordx4 v1, s[48:51], s85 offen offset:2048 sc1 lds
v_mfma_f32_16x16x32_bf16 v[176:179], a[156:159], a[132:135], v[176:179]
ds_read_b128 a[196:199], v13 offset:14336
v_mfma_f32_16x16x32_bf16 v[196:199], a[156:159], a[136:139], v[196:199]
v_mfma_f32_16x16x32_bf16 v[216:219], a[156:159], a[140:143], v[216:219]
buffer_load_dwordx4 v1, s[48:51], s85 offen offset:3072 sc1 lds
v_mfma_f32_16x16x32_bf16 v[160:163], a[160:163], a[128:131], v[160:163]
v_mfma_f32_16x16x32_bf16 v[180:183], a[160:163], a[132:135], v[180:183]
v_mfma_f32_16x16x32_bf16 v[200:203], a[160:163], a[136:139], v[200:203]
v_mfma_f32_16x16x32_bf16 v[220:223], a[160:163], a[140:143], v[220:223]
s_waitcnt lgkmcnt(0)
v_mfma_f32_16x16x32_bf16 v[144:147], a[180:183], a[164:167], v[144:147]
s_waitcnt vmcnt(8)
v_mfma_f32_16x16x32_bf16 v[164:167], a[180:183], a[168:171], v[164:167]
s_barrier
v_mfma_f32_16x16x32_bf16 v[184:187], a[180:183], a[172:175], v[184:187]
s_add_u32 m0, s29, 40960
ds_read_b128 a[144:147], v14 offset:0
v_mfma_f32_16x16x32_bf16 v[204:207], a[180:183], a[176:179], v[204:207]
s_add_u32 s85, s27, 167936
ds_read_b128 a[128:131], v11 offset:20480
v_mfma_f32_16x16x32_bf16 v[148:151], a[184:187], a[164:167], v[148:151]
buffer_load_dwordx4 v1, s[48:51], s85 offen offset:0 sc1 lds
v_mfma_f32_16x16x32_bf16 v[168:171], a[184:187], a[168:171], v[168:171]
s_add_u32 m0, s25, 0
ds_read_b128 a[132:135], v11 offset:21504
v_mfma_f32_16x16x32_bf16 v[188:191], a[184:187], a[172:175], v[188:191]
s_add_u32 s79, s68, 16384
ds_read_b128 a[136:139], v11 offset:22528
v_mfma_f32_16x16x32_bf16 v[208:211], a[184:187], a[176:179], v[208:211]
buffer_load_dwordx4 v1, s[44:47], s79 offen sc1 lds
v_mfma_f32_16x16x32_bf16 v[152:155], a[188:191], a[164:167], v[152:155]
s_add_u32 m0, s25, 1024
ds_read_b128 a[140:143], v11 offset:23552
v_mfma_f32_16x16x32_bf16 v[172:175], a[188:191], a[168:171], v[172:175]
s_add_u32 s79, s69, 16384
ds_read_b128 a[148:151], v14 offset:1024
v_mfma_f32_16x16x32_bf16 v[192:195], a[188:191], a[172:175], v[192:195]
buffer_load_dwordx4 v1, s[44:47], s79 offen sc1 lds
v_mfma_f32_16x16x32_bf16 v[212:215], a[188:191], a[176:179], v[212:215]
s_add_u32 m0, s25, 2048
ds_read_b128 a[152:155], v14 offset:2048
v_mfma_f32_16x16x32_bf16 v[156:159], a[192:195], a[164:167], v[156:159]
s_add_u32 s79, s70, 16384
ds_read_b128 a[156:159], v14 offset:3072
v_mfma_f32_16x16x32_bf16 v[176:179], a[192:195], a[168:171], v[176:179]
buffer_load_dwordx4 v1, s[44:47], s79 offen sc1 lds
v_mfma_f32_16x16x32_bf16 v[196:199], a[192:195], a[172:175], v[196:199]
s_add_u32 m0, s25, 3072
ds_read_b128 a[160:163], v14 offset:4096
v_mfma_f32_16x16x32_bf16 v[216:219], a[192:195], a[176:179], v[216:219]
s_add_u32 s79, s71, 16384
v_mfma_f32_16x16x32_bf16 v[160:163], a[196:199], a[164:167], v[160:163]
buffer_load_dwordx4 v1, s[44:47], s79 offen sc1 lds
v_mfma_f32_16x16x32_bf16 v[180:183], a[196:199], a[168:171], v[180:183]
s_add_u32 m0, s32, 0
v_mfma_f32_16x16x32_bf16 v[200:203], a[196:199], a[172:175], v[200:203]
s_add_u32 s85, s27, 245760
v_mfma_f32_16x16x32_bf16 v[220:223], a[196:199], a[176:179], v[220:223]
buffer_load_dwordx4 v1, s[48:51], s85 offen offset:0 sc1 lds
s_waitcnt lgkmcnt(0)
v_mfma_f32_16x16x32_bf16 v[16:19], a[144:147], a[128:131], 0
buffer_load_dwordx4 v1, s[48:51], s85 offen offset:1024 sc1 lds
v_mfma_f32_16x16x32_bf16 v[36:39], a[144:147], a[132:135], 0
ds_read_b128 a[180:183], v14 offset:10240
v_mfma_f32_16x16x32_bf16 v[56:59], a[144:147], a[136:139], 0
buffer_load_dwordx4 v1, s[48:51], s85 offen offset:2048 sc1 lds
v_mfma_f32_16x16x32_bf16 v[76:79], a[144:147], a[140:143], 0
ds_read_b128 a[164:167], v11 offset:28672
v_mfma_f32_16x16x32_bf16 v[20:23], a[148:151], a[128:131], 0
ds_read_b128 a[168:171], v11 offset:29696
v_mfma_f32_16x16x32_bf16 v[40:43], a[148:151], a[132:135], 0
buffer_load_dwordx4 v1, s[48:51], s85 offen offset:3072 sc1 lds
v_mfma_f32_16x16x32_bf16 v[60:63], a[148:151], a[136:139], 0
ds_read_b128 a[172:175], v11 offset:30720
v_mfma_f32_16x16x32_bf16 v[80:83], a[148:151], a[140:143], 0
ds_read_b128 a[176:179], v11 offset:31744
v_mfma_f32_16x16x32_bf16 v[24:27], a[152:155], a[128:131], 0
ds_read_b128 a[184:187], v14 offset:11264
v_mfma_f32_16x16x32_bf16 v[44:47], a[152:155], a[132:135], 0
s_add_u32 m0, s32, 4096
ds_read_b128 a[188:191], v14 offset:12288
v_mfma_f32_16x16x32_bf16 v[64:67], a[152:155], a[136:139], 0
s_add_u32 s85, s27, 249856
ds_read_b128 a[192:195], v14 offset:13312
v_mfma_f32_16x16x32_bf16 v[84:87], a[152:155], a[140:143], 0
buffer_load_dwordx4 v1, s[48:51], s85 offen offset:0 sc1 lds
v_mfma_f32_16x16x32_bf16 v[28:31], a[156:159], a[128:131], 0
s_add_u32 m0, s25, 16384
ds_read_b128 a[196:199], v14 offset:14336
v_mfma_f32_16x16x32_bf16 v[48:51], a[156:159], a[132:135], 0
s_add_u32 s79, s68, 24576
v_mfma_f32_16x16x32_bf16 v[68:71], a[156:159], a[136:139], 0
buffer_load_dwordx4 v1, s[44:47], s79 offen sc1 lds
v_mfma_f32_16x16x32_bf16 v[88:91], a[156:159], a[140:143], 0
s_add_u32 m0, s25, 17408
v_mfma_f32_16x16x32_bf16 v[32:35], a[160:163], a[128:131], 0
s_add_u32 s79, s69, 24576
v_mfma_f32_16x16x32_bf16 v[52:55], a[160:163], a[132:135], 0
buffer_load_dwordx4 v1, s[44:47], s79 offen sc1 lds
v_mfma_f32_16x16x32_bf16 v[72:75], a[160:163], a[136:139], 0
v_mfma_f32_16x16x32_bf16 v[92:95], a[160:163], a[140:143], 0
s_waitcnt lgkmcnt(0)
v_mfma_f32_16x16x32_bf16 v[16:19], a[180:183], a[164:167], v[16:19]
s_waitcnt vmcnt(16)
v_mfma_f32_16x16x32_bf16 v[36:39], a[180:183], a[168:171], v[36:39]
s_barrier
v_mfma_f32_16x16x32_bf16 v[56:59], a[180:183], a[172:175], v[56:59]
s_add_u32 m0, s25, 18432
ds_read_b128 a[144:147], v12 offset:16384
v_mfma_f32_16x16x32_bf16 v[76:79], a[180:183], a[176:179], v[76:79]
s_add_u32 s79, s70, 24576
ds_read_b128 a[128:131], v9 offset:0
v_mfma_f32_16x16x32_bf16 v[20:23], a[184:187], a[164:167], v[20:23]
buffer_load_dwordx4 v1, s[44:47], s79 offen sc1 lds
v_mfma_f32_16x16x32_bf16 v[40:43], a[184:187], a[168:171], v[40:43]
s_add_u32 m0, s25, 19456
ds_read_b128 a[132:135], v9 offset:1024
v_mfma_f32_16x16x32_bf16 v[60:63], a[184:187], a[172:175], v[60:63]
s_add_u32 s79, s71, 24576
ds_read_b128 a[136:139], v9 offset:2048
v_mfma_f32_16x16x32_bf16 v[80:83], a[184:187], a[176:179], v[80:83]
buffer_load_dwordx4 v1, s[44:47], s79 offen sc1 lds
v_mfma_f32_16x16x32_bf16 v[24:27], a[188:191], a[164:167], v[24:27]
s_add_u32 m0, s33, 0
ds_read_b128 a[140:143], v9 offset:3072
v_mfma_f32_16x16x32_bf16 v[44:47], a[188:191], a[168:171], v[44:47]
s_add_u32 s85, s27, 327680
ds_read_b128 a[148:151], v12 offset:17408
v_mfma_f32_16x16x32_bf16 v[64:67], a[188:191], a[172:175], v[64:67]
buffer_load_dwordx4 v1, s[48:51], s85 offen offset:0 sc1 lds
v_mfma_f32_16x16x32_bf16 v[84:87], a[188:191], a[176:179], v[84:87]
buffer_load_dwordx4 v1, s[48:51], s85 offen offset:1024 sc1 lds
v_mfma_f32_16x16x32_bf16 v[28:31], a[192:195], a[164:167], v[28:31]
ds_read_b128 a[152:155], v12 offset:18432
v_mfma_f32_16x16x32_bf16 v[48:51], a[192:195], a[168:171], v[48:51]
buffer_load_dwordx4 v1, s[48:51], s85 offen offset:2048 sc1 lds
v_mfma_f32_16x16x32_bf16 v[68:71], a[192:195], a[172:175], v[68:71]
ds_read_b128 a[156:159], v12 offset:19456
v_mfma_f32_16x16x32_bf16 v[88:91], a[192:195], a[176:179], v[88:91]
ds_read_b128 a[160:163], v12 offset:20480
v_mfma_f32_16x16x32_bf16 v[32:35], a[196:199], a[164:167], v[32:35]
buffer_load_dwordx4 v1, s[48:51], s85 offen offset:3072 sc1 lds
v_mfma_f32_16x16x32_bf16 v[52:55], a[196:199], a[168:171], v[52:55]
v_mfma_f32_16x16x32_bf16 v[72:75], a[196:199], a[172:175], v[72:75]
v_mfma_f32_16x16x32_bf16 v[92:95], a[196:199], a[176:179], v[92:95]
s_waitcnt lgkmcnt(0)
v_mfma_f32_16x16x32_bf16 v[16:19], a[144:147], a[128:131], v[16:19]
s_add_u32 m0, s33, 4096
ds_read_b128 a[180:183], v12 offset:26624
v_and_b32 v8, 15, v0
v_mfma_f32_16x16x32_bf16 v[36:39], a[144:147], a[132:135], v[36:39]
s_add_u32 s85, s27, 331776
ds_read_b128 a[164:167], v9 offset:8192
v_lshlrev_b32 v5, 2, v8
v_mfma_f32_16x16x32_bf16 v[56:59], a[144:147], a[136:139], v[56:59]
buffer_load_dwordx4 v1, s[48:51], s85 offen offset:0 sc1 lds
v_mfma_f32_16x16x32_bf16 v[76:79], a[144:147], a[140:143], v[76:79]
ds_read_b128 a[168:171], v9 offset:9216
v_lshrrev_b32 v6, 4, v0
v_mfma_f32_16x16x32_bf16 v[20:23], a[148:151], a[128:131], v[20:23]
s_add_u32 m0, s28, 20480
ds_read_b128 a[172:175], v9 offset:10240
v_lshlrev_b32 v6, 3, v6
v_mfma_f32_16x16x32_bf16 v[40:43], a[148:151], a[132:135], v[40:43]
s_add_u32 s79, s68, 32768
ds_read_b128 a[176:179], v9 offset:11264
v_mfma_f32_16x16x32_bf16 v[60:63], a[148:151], a[136:139], v[60:63]
buffer_load_dwordx4 v1, s[44:47], s79 offen sc1 lds
v_mfma_f32_16x16x32_bf16 v[80:83], a[148:151], a[140:143], v[80:83]
s_mul_i32 s80, s76, 2816
ds_read_b128 a[184:187], v12 offset:27648
v_mul_u32_u24 v8, 176, v8
v_mfma_f32_16x16x32_bf16 v[24:27], a[152:155], a[128:131], v[24:27]
ds_read_b128 a[188:191], v12 offset:28672
v_add3_u32 v8, v8, v6, s80
v_mfma_f32_16x16x32_bf16 v[44:47], a[152:155], a[132:135], v[44:47]
s_add_u32 m0, s28, 21504
ds_read_b128 a[192:195], v12 offset:29696
v_mfma_f32_16x16x32_bf16 v[64:67], a[152:155], a[136:139], v[64:67]
s_add_u32 s79, s69, 32768
ds_read_b128 a[196:199], v12 offset:30720
v_mfma_f32_16x16x32_bf16 v[84:87], a[152:155], a[140:143], v[84:87]
buffer_load_dwordx4 v1, s[44:47], s79 offen sc1 lds
v_mfma_f32_16x16x32_bf16 v[28:31], a[156:159], a[128:131], v[28:31]
s_lshl_b32 s80, s30, 8
v_mfma_f32_16x16x32_bf16 v[48:51], a[156:159], a[132:135], v[48:51]
s_add_u32 s80, s80, 68157440
v_mfma_f32_16x16x32_bf16 v[68:71], a[156:159], a[136:139], v[68:71]
s_add_u32 m0, s28, 22528
v_mfma_f32_16x16x32_bf16 v[88:91], a[156:159], a[140:143], v[88:91]
s_add_u32 s79, s70, 32768
v_mfma_f32_16x16x32_bf16 v[32:35], a[160:163], a[128:131], v[32:35]
buffer_load_dwordx4 v1, s[44:47], s79 offen sc1 lds
v_mfma_f32_16x16x32_bf16 v[52:55], a[160:163], a[132:135], v[52:55]
v_mfma_f32_16x16x32_bf16 v[72:75], a[160:163], a[136:139], v[72:75]
v_mfma_f32_16x16x32_bf16 v[92:95], a[160:163], a[140:143], v[92:95]
s_waitcnt lgkmcnt(0)
v_mfma_f32_16x16x32_bf16 v[16:19], a[180:183], a[164:167], v[16:19]
s_waitcnt vmcnt(17)
v_mfma_f32_16x16x32_bf16 v[36:39], a[180:183], a[168:171], v[36:39]
s_barrier
v_mfma_f32_16x16x32_bf16 v[56:59], a[180:183], a[172:175], v[56:59]
s_add_u32 m0, s28, 23552
ds_read_b128 a[144:147], v12 offset:36864
v_mfma_f32_16x16x32_bf16 v[76:79], a[180:183], a[176:179], v[76:79]
s_add_u32 s79, s71, 32768
ds_read_b128 a[128:131], v10 offset:0
v_mfma_f32_16x16x32_bf16 v[20:23], a[184:187], a[164:167], v[20:23]
buffer_load_dwordx4 v1, s[44:47], s79 offen sc1 lds
v_mfma_f32_16x16x32_bf16 v[40:43], a[184:187], a[168:171], v[40:43]
s_add_u32 m0, s29, 16384
ds_read_b128 a[132:135], v10 offset:1024
v_mfma_f32_16x16x32_bf16 v[60:63], a[184:187], a[172:175], v[60:63]
s_add_u32 s85, s27, 409600
ds_read_b128 a[136:139], v10 offset:2048
v_mfma_f32_16x16x32_bf16 v[80:83], a[184:187], a[176:179], v[80:83]
buffer_load_dwordx4 v1, s[48:51], s85 offen offset:0 sc1 lds
v_mfma_f32_16x16x32_bf16 v[24:27], a[188:191], a[164:167], v[24:27]
buffer_load_dwordx4 v1, s[48:51], s85 offen offset:1024 sc1 lds
v_mfma_f32_16x16x32_bf16 v[44:47], a[188:191], a[168:171], v[44:47]
s_bfe_u32 s81, s68, 0x2000a
ds_read_b128 a[140:143], v10 offset:3072
v_mfma_f32_16x16x32_bf16 v[64:67], a[188:191], a[172:175], v[64:67]
s_lshl_b32 s81, s81, 6
ds_read_b128 a[148:151], v12 offset:37888
v_mfma_f32_16x16x32_bf16 v[84:87], a[188:191], a[176:179], v[84:87]
buffer_load_dwordx4 v1, s[48:51], s85 offen offset:2048 sc1 lds
v_mfma_f32_16x16x32_bf16 v[28:31], a[192:195], a[164:167], v[28:31]
s_add_u32 s81, s81, s80
ds_read_b128 a[152:155], v12 offset:38912
v_mfma_f32_16x16x32_bf16 v[48:51], a[192:195], a[168:171], v[48:51]
ds_read_b128 a[156:159], v12 offset:39936
v_mfma_f32_16x16x32_bf16 v[68:71], a[192:195], a[172:175], v[68:71]
ds_read_b128 a[160:163], v12 offset:40960
v_mfma_f32_16x16x32_bf16 v[88:91], a[192:195], a[176:179], v[88:91]
buffer_load_dwordx4 v1, s[48:51], s85 offen offset:3072 sc1 lds
v_mfma_f32_16x16x32_bf16 v[32:35], a[196:199], a[164:167], v[32:35]
buffer_load_dword v96, v5, s[56:59], s81 offen sc1
v_mfma_f32_16x16x32_bf16 v[52:55], a[196:199], a[168:171], v[52:55]
v_mfma_f32_16x16x32_bf16 v[72:75], a[196:199], a[172:175], v[72:75]
v_mfma_f32_16x16x32_bf16 v[92:95], a[196:199], a[176:179], v[92:95]
s_waitcnt lgkmcnt(0)
v_mfma_f32_16x16x32_bf16 v[16:19], a[144:147], a[128:131], v[16:19]
s_add_u32 m0, s29, 20480
ds_read_b128 a[180:183], v12 offset:47104
v_mfma_f32_16x16x32_bf16 v[36:39], a[144:147], a[132:135], v[36:39]
s_add_u32 s85, s27, 413696
ds_read_b128 a[164:167], v10 offset:8192
v_mfma_f32_16x16x32_bf16 v[56:59], a[144:147], a[136:139], v[56:59]
buffer_load_dwordx4 v1, s[48:51], s85 offen offset:0 sc1 lds
v_mfma_f32_16x16x32_bf16 v[76:79], a[144:147], a[140:143], v[76:79]
s_bfe_u32 s81, s69, 0x2000a
ds_read_b128 a[168:171], v10 offset:9216
v_mfma_f32_16x16x32_bf16 v[20:23], a[148:151], a[128:131], v[20:23]
s_add_u32 m0, s24, 0
ds_read_b128 a[172:175], v10 offset:10240
v_mfma_f32_16x16x32_bf16 v[40:43], a[148:151], a[132:135], v[40:43]
s_add_u32 s79, s68, 40960
ds_read_b128 a[176:179], v10 offset:11264
v_mfma_f32_16x16x32_bf16 v[60:63], a[148:151], a[136:139], v[60:63]
buffer_load_dwordx4 v1, s[44:47], s79 offen sc1 lds
v_mfma_f32_16x16x32_bf16 v[80:83], a[148:151], a[140:143], v[80:83]
s_lshl_b32 s81, s81, 6
ds_read_b128 a[184:187], v12 offset:48128
v_mfma_f32_16x16x32_bf16 v[24:27], a[152:155], a[128:131], v[24:27]
s_add_u32 s81, s81, s80
ds_read_b128 a[188:191], v12 offset:49152
v_mfma_f32_16x16x32_bf16 v[44:47], a[152:155], a[132:135], v[44:47]
s_add_u32 m0, s24, 1024
ds_read_b128 a[192:195], v12 offset:50176
v_mfma_f32_16x16x32_bf16 v[64:67], a[152:155], a[136:139], v[64:67]
s_add_u32 s79, s69, 40960
ds_read_b128 a[196:199], v12 offset:51200
v_mfma_f32_16x16x32_bf16 v[84:87], a[152:155], a[140:143], v[84:87]
buffer_load_dwordx4 v1, s[44:47], s79 offen sc1 lds
v_mfma_f32_16x16x32_bf16 v[28:31], a[156:159], a[128:131], v[28:31]
buffer_load_dword v98, v5, s[56:59], s81 offen sc1
v_mfma_f32_16x16x32_bf16 v[48:51], a[156:159], a[132:135], v[48:51]
v_mfma_f32_16x16x32_bf16 v[68:71], a[156:159], a[136:139], v[68:71]
s_add_u32 m0, s24, 2048
v_mfma_f32_16x16x32_bf16 v[88:91], a[156:159], a[140:143], v[88:91]
s_add_u32 s79, s70, 40960
v_mfma_f32_16x16x32_bf16 v[32:35], a[160:163], a[128:131], v[32:35]
buffer_load_dwordx4 v1, s[44:47], s79 offen sc1 lds
v_mfma_f32_16x16x32_bf16 v[52:55], a[160:163], a[132:135], v[52:55]
v_mfma_f32_16x16x32_bf16 v[72:75], a[160:163], a[136:139], v[72:75]
v_mfma_f32_16x16x32_bf16 v[92:95], a[160:163], a[140:143], v[92:95]
s_waitcnt lgkmcnt(0)
v_mfma_f32_16x16x32_bf16 v[16:19], a[180:183], a[164:167], v[16:19]
s_waitcnt vmcnt(19)
v_mfma_f32_16x16x32_bf16 v[36:39], a[180:183], a[168:171], v[36:39]
s_barrier
v_mfma_f32_16x16x32_bf16 v[56:59], a[180:183], a[172:175], v[56:59]
s_add_u32 m0, s24, 3072
ds_read_b128 a[144:147], v13 offset:0
v_mfma_f32_16x16x32_bf16 v[76:79], a[180:183], a[176:179], v[76:79]
s_add_u32 s79, s71, 40960
ds_read_b128 a[128:131], v10 offset:16384
v_mfma_f32_16x16x32_bf16 v[20:23], a[184:187], a[164:167], v[20:23]
buffer_load_dwordx4 v1, s[44:47], s79 offen sc1 lds
v_mfma_f32_16x16x32_bf16 v[40:43], a[184:187], a[168:171], v[40:43]
s_add_u32 m0, s29, 36864
ds_read_b128 a[132:135], v10 offset:17408
v_mfma_f32_16x16x32_bf16 v[60:63], a[184:187], a[172:175], v[60:63]
s_add_u32 s85, s27, 491520
ds_read_b128 a[136:139], v10 offset:18432
v_mfma_f32_16x16x32_bf16 v[80:83], a[184:187], a[176:179], v[80:83]
buffer_load_dwordx4 v1, s[48:51], s85 offen offset:0 sc1 lds
v_mfma_f32_16x16x32_bf16 v[24:27], a[188:191], a[164:167], v[24:27]
buffer_load_dwordx4 v1, s[48:51], s85 offen offset:1024 sc1 lds
v_mfma_f32_16x16x32_bf16 v[44:47], a[188:191], a[168:171], v[44:47]
s_bfe_u32 s81, s70, 0x2000a
ds_read_b128 a[140:143], v10 offset:19456
v_mfma_f32_16x16x32_bf16 v[64:67], a[188:191], a[172:175], v[64:67]
s_lshl_b32 s81, s81, 6
ds_read_b128 a[148:151], v13 offset:1024
v_mfma_f32_16x16x32_bf16 v[84:87], a[188:191], a[176:179], v[84:87]
buffer_load_dwordx4 v1, s[48:51], s85 offen offset:2048 sc1 lds
v_mfma_f32_16x16x32_bf16 v[28:31], a[192:195], a[164:167], v[28:31]
s_add_u32 s81, s81, s80
ds_read_b128 a[152:155], v13 offset:2048
v_mfma_f32_16x16x32_bf16 v[48:51], a[192:195], a[168:171], v[48:51]
ds_read_b128 a[156:159], v13 offset:3072
v_mfma_f32_16x16x32_bf16 v[68:71], a[192:195], a[172:175], v[68:71]
ds_read_b128 a[160:163], v13 offset:4096
v_mfma_f32_16x16x32_bf16 v[88:91], a[192:195], a[176:179], v[88:91]
buffer_load_dwordx4 v1, s[48:51], s85 offen offset:3072 sc1 lds
v_mfma_f32_16x16x32_bf16 v[32:35], a[196:199], a[164:167], v[32:35]
buffer_load_dword v100, v5, s[56:59], s81 offen sc1
v_mfma_f32_16x16x32_bf16 v[52:55], a[196:199], a[168:171], v[52:55]
v_mfma_f32_16x16x32_bf16 v[72:75], a[196:199], a[172:175], v[72:75]
v_mfma_f32_16x16x32_bf16 v[92:95], a[196:199], a[176:179], v[92:95]
s_waitcnt lgkmcnt(0)
v_mfma_f32_16x16x32_bf16 v[16:19], a[144:147], a[128:131], v[16:19]
s_add_u32 m0, s29, 40960
ds_read_b128 a[180:183], v13 offset:10240
v_mfma_f32_16x16x32_bf16 v[36:39], a[144:147], a[132:135], v[36:39]
s_add_u32 s85, s27, 495616
ds_read_b128 a[164:167], v10 offset:24576
v_mfma_f32_16x16x32_bf16 v[56:59], a[144:147], a[136:139], v[56:59]
buffer_load_dwordx4 v1, s[48:51], s85 offen offset:0 sc1 lds
v_mfma_f32_16x16x32_bf16 v[76:79], a[144:147], a[140:143], v[76:79]
s_bfe_u32 s81, s71, 0x2000a
ds_read_b128 a[168:171], v10 offset:25600
v_mfma_f32_16x16x32_bf16 v[20:23], a[148:151], a[128:131], v[20:23]
s_add_u32 m0, s25, 0
ds_read_b128 a[172:175], v10 offset:26624
v_mfma_f32_16x16x32_bf16 v[40:43], a[148:151], a[132:135], v[40:43]
s_add_u32 s79, s68, 49152
ds_read_b128 a[176:179], v10 offset:27648
v_mfma_f32_16x16x32_bf16 v[60:63], a[148:151], a[136:139], v[60:63]
buffer_load_dwordx4 v1, s[44:47], s79 offen sc1 lds
v_mfma_f32_16x16x32_bf16 v[80:83], a[148:151], a[140:143], v[80:83]
s_lshl_b32 s81, s81, 6
ds_read_b128 a[184:187], v13 offset:11264
v_mfma_f32_16x16x32_bf16 v[24:27], a[152:155], a[128:131], v[24:27]
s_add_u32 s81, s81, s80
ds_read_b128 a[188:191], v13 offset:12288
v_mfma_f32_16x16x32_bf16 v[44:47], a[152:155], a[132:135], v[44:47]
s_add_u32 m0, s25, 1024
ds_read_b128 a[192:195], v13 offset:13312
v_mfma_f32_16x16x32_bf16 v[64:67], a[152:155], a[136:139], v[64:67]
s_add_u32 s79, s69, 49152
ds_read_b128 a[196:199], v13 offset:14336
v_mfma_f32_16x16x32_bf16 v[84:87], a[152:155], a[140:143], v[84:87]
buffer_load_dwordx4 v1, s[44:47], s79 offen sc1 lds
v_mfma_f32_16x16x32_bf16 v[28:31], a[156:159], a[128:131], v[28:31]
buffer_load_dword v102, v5, s[56:59], s81 offen sc1
v_mfma_f32_16x16x32_bf16 v[48:51], a[156:159], a[132:135], v[48:51]
v_mfma_f32_16x16x32_bf16 v[68:71], a[156:159], a[136:139], v[68:71]
s_add_u32 m0, s25, 2048
v_mfma_f32_16x16x32_bf16 v[88:91], a[156:159], a[140:143], v[88:91]
s_add_u32 s79, s70, 49152
v_mfma_f32_16x16x32_bf16 v[32:35], a[160:163], a[128:131], v[32:35]
buffer_load_dwordx4 v1, s[44:47], s79 offen sc1 lds
v_mfma_f32_16x16x32_bf16 v[52:55], a[160:163], a[132:135], v[52:55]
v_mfma_f32_16x16x32_bf16 v[72:75], a[160:163], a[136:139], v[72:75]
v_mfma_f32_16x16x32_bf16 v[92:95], a[160:163], a[140:143], v[92:95]
s_waitcnt lgkmcnt(0)
v_mfma_f32_16x16x32_bf16 v[16:19], a[180:183], a[164:167], v[16:19]
s_waitcnt vmcnt(21)
v_mfma_f32_16x16x32_bf16 v[36:39], a[180:183], a[168:171], v[36:39]
s_barrier
v_mfma_f32_16x16x32_bf16 v[56:59], a[180:183], a[172:175], v[56:59]
s_add_u32 m0, s25, 3072
ds_read_b128 a[144:147], v14 offset:0
v_mfma_f32_16x16x32_bf16 v[76:79], a[180:183], a[176:179], v[76:79]
s_add_u32 s79, s71, 49152
ds_read_b128 a[128:131], v11 offset:20480
v_mfma_f32_16x16x32_bf16 v[20:23], a[184:187], a[164:167], v[20:23]
buffer_load_dwordx4 v1, s[44:47], s79 offen sc1 lds
v_mfma_f32_16x16x32_bf16 v[40:43], a[184:187], a[168:171], v[40:43]
s_add_u32 m0, s32, 0
ds_read_b128 a[132:135], v11 offset:21504
v_mfma_f32_16x16x32_bf16 v[60:63], a[184:187], a[172:175], v[60:63]
s_add_u32 s85, s27, 573440
ds_read_b128 a[136:139], v11 offset:22528
v_mfma_f32_16x16x32_bf16 v[80:83], a[184:187], a[176:179], v[80:83]
buffer_load_dwordx4 v1, s[48:51], s85 offen offset:0 sc1 lds
v_mfma_f32_16x16x32_bf16 v[24:27], a[188:191], a[164:167], v[24:27]
buffer_load_dwordx4 v1, s[48:51], s85 offen offset:1024 sc1 lds
v_mfma_f32_16x16x32_bf16 v[44:47], a[188:191], a[168:171], v[44:47]
ds_read_b128 a[140:143], v11 offset:23552
buffer_load_dwordx2 v[104:105], v6, s[64:67], 0 offen offset:0
v_mfma_f32_16x16x32_bf16 v[64:67], a[188:191], a[172:175], v[64:67]
ds_read_b128 a[148:151], v14 offset:1024
buffer_load_dwordx2 v[106:107], v6, s[64:67], 0 offen offset:32
v_mfma_f32_16x16x32_bf16 v[84:87], a[188:191], a[176:179], v[84:87]
buffer_load_dwordx4 v1, s[48:51], s85 offen offset:2048 sc1 lds
v_mfma_f32_16x16x32_bf16 v[28:31], a[192:195], a[164:167], v[28:31]
ds_read_b128 a[152:155], v14 offset:2048
v_mfma_f32_16x16x32_bf16 v[48:51], a[192:195], a[168:171], v[48:51]
ds_read_b128 a[156:159], v14 offset:3072
v_mfma_f32_16x16x32_bf16 v[68:71], a[192:195], a[172:175], v[68:71]
ds_read_b128 a[160:163], v14 offset:4096
v_mfma_f32_16x16x32_bf16 v[88:91], a[192:195], a[176:179], v[88:91]
buffer_load_dwordx4 v1, s[48:51], s85 offen offset:3072 sc1 lds
v_mfma_f32_16x16x32_bf16 v[32:35], a[196:199], a[164:167], v[32:35]
buffer_load_dwordx2 v[108:109], v6, s[64:67], 0 offen offset:64
v_mfma_f32_16x16x32_bf16 v[52:55], a[196:199], a[168:171], v[52:55]
buffer_load_dwordx2 v[110:111], v6, s[64:67], 0 offen offset:96
v_mfma_f32_16x16x32_bf16 v[72:75], a[196:199], a[172:175], v[72:75]
buffer_load_dwordx2 v[112:113], v6, s[64:67], 0 offen offset:128
v_mfma_f32_16x16x32_bf16 v[92:95], a[196:199], a[176:179], v[92:95]
s_waitcnt lgkmcnt(0)
v_mfma_f32_16x16x32_bf16 v[16:19], a[144:147], a[128:131], v[16:19]
s_add_u32 m0, s32, 4096
ds_read_b128 a[180:183], v14 offset:10240
v_mfma_f32_16x16x32_bf16 v[36:39], a[144:147], a[132:135], v[36:39]
s_add_u32 s85, s27, 577536
ds_read_b128 a[164:167], v11 offset:28672
v_mfma_f32_16x16x32_bf16 v[56:59], a[144:147], a[136:139], v[56:59]
buffer_load_dwordx4 v1, s[48:51], s85 offen offset:0 sc1 lds
v_mfma_f32_16x16x32_bf16 v[76:79], a[144:147], a[140:143], v[76:79]
ds_read_b128 a[168:171], v11 offset:29696
v_mfma_f32_16x16x32_bf16 v[20:23], a[148:151], a[128:131], v[20:23]
s_add_u32 m0, s25, 16384
ds_read_b128 a[172:175], v11 offset:30720
v_mfma_f32_16x16x32_bf16 v[40:43], a[148:151], a[132:135], v[40:43]
s_add_u32 s79, s68, 57344
ds_read_b128 a[176:179], v11 offset:31744
v_mfma_f32_16x16x32_bf16 v[60:63], a[148:151], a[136:139], v[60:63]
buffer_load_dwordx4 v1, s[44:47], s79 offen sc1 lds
v_mfma_f32_16x16x32_bf16 v[80:83], a[148:151], a[140:143], v[80:83]
ds_read_b128 a[184:187], v14 offset:11264
v_mfma_f32_16x16x32_bf16 v[24:27], a[152:155], a[128:131], v[24:27]
ds_read_b128 a[188:191], v14 offset:12288
v_mfma_f32_16x16x32_bf16 v[44:47], a[152:155], a[132:135], v[44:47]
s_add_u32 m0, s25, 17408
ds_read_b128 a[192:195], v14 offset:13312
v_mfma_f32_16x16x32_bf16 v[64:67], a[152:155], a[136:139], v[64:67]
s_add_u32 s79, s69, 57344
ds_read_b128 a[196:199], v14 offset:14336
v_mfma_f32_16x16x32_bf16 v[84:87], a[152:155], a[140:143], v[84:87]
buffer_load_dwordx4 v1, s[44:47], s79 offen sc1 lds
v_mfma_f32_16x16x32_bf16 v[28:31], a[156:159], a[128:131], v[28:31]
v_mfma_f32_16x16x32_bf16 v[48:51], a[156:159], a[132:135], v[48:51]
v_mfma_f32_16x16x32_bf16 v[68:71], a[156:159], a[136:139], v[68:71]
s_add_u32 m0, s25, 18432
v_mfma_f32_16x16x32_bf16 v[88:91], a[156:159], a[140:143], v[88:91]
s_add_u32 s79, s70, 57344
v_mfma_f32_16x16x32_bf16 v[32:35], a[160:163], a[128:131], v[32:35]
buffer_load_dwordx4 v1, s[44:47], s79 offen sc1 lds
v_mfma_f32_16x16x32_bf16 v[52:55], a[160:163], a[132:135], v[52:55]
v_mfma_f32_16x16x32_bf16 v[72:75], a[160:163], a[136:139], v[72:75]
v_mfma_f32_16x16x32_bf16 v[92:95], a[160:163], a[140:143], v[92:95]
s_waitcnt lgkmcnt(0)
v_mfma_f32_16x16x32_bf16 v[16:19], a[180:183], a[164:167], v[16:19]
s_waitcnt vmcnt(24)
v_mfma_f32_16x16x32_bf16 v[36:39], a[180:183], a[168:171], v[36:39]
s_barrier
v_mfma_f32_16x16x32_bf16 v[56:59], a[180:183], a[172:175], v[56:59]
s_add_u32 m0, s25, 19456
ds_read_b128 a[144:147], v12 offset:16384
v_mfma_f32_16x16x32_bf16 v[76:79], a[180:183], a[176:179], v[76:79]
s_add_u32 s79, s71, 57344
ds_read_b128 a[128:131], v9 offset:0
v_mfma_f32_16x16x32_bf16 v[20:23], a[184:187], a[164:167], v[20:23]
buffer_load_dwordx4 v1, s[44:47], s79 offen sc1 lds
v_mfma_f32_16x16x32_bf16 v[40:43], a[184:187], a[168:171], v[40:43]
s_add_u32 m0, s33, 0
ds_read_b128 a[132:135], v9 offset:1024
v_mfma_f32_16x16x32_bf16 v[60:63], a[184:187], a[172:175], v[60:63]
s_add_u32 s85, s27, 655360
ds_read_b128 a[136:139], v9 offset:2048
v_mfma_f32_16x16x32_bf16 v[80:83], a[184:187], a[176:179], v[80:83]
buffer_load_dwordx4 v1, s[48:51], s85 offen offset:0 sc1 lds
v_mfma_f32_16x16x32_bf16 v[24:27], a[188:191], a[164:167], v[24:27]
buffer_load_dwordx4 v1, s[48:51], s85 offen offset:1024 sc1 lds
v_mfma_f32_16x16x32_bf16 v[44:47], a[188:191], a[168:171], v[44:47]
ds_read_b128 a[140:143], v9 offset:3072
v_mfma_f32_16x16x32_bf16 v[64:67], a[188:191], a[172:175], v[64:67]
ds_read_b128 a[148:151], v12 offset:17408
v_mfma_f32_16x16x32_bf16 v[84:87], a[188:191], a[176:179], v[84:87]
buffer_load_dwordx4 v1, s[48:51], s85 offen offset:2048 sc1 lds
v_mfma_f32_16x16x32_bf16 v[28:31], a[192:195], a[164:167], v[28:31]
ds_read_b128 a[152:155], v12 offset:18432
v_mfma_f32_16x16x32_bf16 v[48:51], a[192:195], a[168:171], v[48:51]
ds_read_b128 a[156:159], v12 offset:19456
v_mfma_f32_16x16x32_bf16 v[68:71], a[192:195], a[172:175], v[68:71]
ds_read_b128 a[160:163], v12 offset:20480
v_mfma_f32_16x16x32_bf16 v[88:91], a[192:195], a[176:179], v[88:91]
buffer_load_dwordx4 v1, s[48:51], s85 offen offset:3072 sc1 lds
v_mfma_f32_16x16x32_bf16 v[32:35], a[196:199], a[164:167], v[32:35]
v_mfma_f32_16x16x32_bf16 v[52:55], a[196:199], a[168:171], v[52:55]
v_mfma_f32_16x16x32_bf16 v[72:75], a[196:199], a[172:175], v[72:75]
v_mfma_f32_16x16x32_bf16 v[92:95], a[196:199], a[176:179], v[92:95]
s_waitcnt lgkmcnt(0)
v_mfma_f32_16x16x32_bf16 v[16:19], a[144:147], a[128:131], v[16:19]
s_add_u32 m0, s33, 4096
ds_read_b128 a[180:183], v12 offset:26624
v_mfma_f32_16x16x32_bf16 v[36:39], a[144:147], a[132:135], v[36:39]
s_add_u32 s85, s27, 659456
ds_read_b128 a[164:167], v9 offset:8192
v_mfma_f32_16x16x32_bf16 v[56:59], a[144:147], a[136:139], v[56:59]
buffer_load_dwordx4 v1, s[48:51], s85 offen offset:0 sc1 lds
v_mfma_f32_16x16x32_bf16 v[76:79], a[144:147], a[140:143], v[76:79]
s_lshl_b32 s80, s23, 4
ds_read_b128 a[168:171], v9 offset:9216
v_mfma_f32_16x16x32_bf16 v[20:23], a[148:151], a[128:131], v[20:23]
s_add_u32 m0, s28, 20480
ds_read_b128 a[172:175], v9 offset:10240
v_mfma_f32_16x16x32_bf16 v[40:43], a[148:151], a[132:135], v[40:43]
s_add_u32 s79, s68, 65536
ds_read_b128 a[176:179], v9 offset:11264
v_mfma_f32_16x16x32_bf16 v[60:63], a[148:151], a[136:139], v[60:63]
buffer_load_dwordx4 v1, s[44:47], s79 offen sc1 lds
v_mfma_f32_16x16x32_bf16 v[80:83], a[148:151], a[140:143], v[80:83]
s_add_u32 s80, s80, s76
ds_read_b128 a[184:187], v12 offset:27648
v_mfma_f32_16x16x32_bf16 v[24:27], a[152:155], a[128:131], v[24:27]
s_mul_i32 s80, s80, 8192
ds_read_b128 a[188:191], v12 offset:28672
v_mfma_f32_16x16x32_bf16 v[44:47], a[152:155], a[132:135], v[44:47]
s_add_u32 m0, s28, 21504
ds_read_b128 a[192:195], v12 offset:29696
v_mfma_f32_16x16x32_bf16 v[64:67], a[152:155], a[136:139], v[64:67]
s_add_u32 s79, s69, 65536
ds_read_b128 a[196:199], v12 offset:30720
v_mfma_f32_16x16x32_bf16 v[84:87], a[152:155], a[140:143], v[84:87]
buffer_load_dwordx4 v1, s[44:47], s79 offen sc1 lds
v_mfma_f32_16x16x32_bf16 v[28:31], a[156:159], a[128:131], v[28:31]
s_add_u32 s80, s80, 75497472
v_add_u32 v5, s80, v1
v_lshlrev_b32 v6, 3, v0
v_mfma_f32_16x16x32_bf16 v[48:51], a[156:159], a[132:135], v[48:51]
v_add_u32 v6, s80, v6
v_mfma_f32_16x16x32_bf16 v[68:71], a[156:159], a[136:139], v[68:71]
s_add_u32 m0, s28, 22528
v_mfma_f32_16x16x32_bf16 v[88:91], a[156:159], a[140:143], v[88:91]
s_add_u32 s79, s70, 65536
v_mfma_f32_16x16x32_bf16 v[32:35], a[160:163], a[128:131], v[32:35]
buffer_load_dwordx4 v1, s[44:47], s79 offen sc1 lds
v_mfma_f32_16x16x32_bf16 v[52:55], a[160:163], a[132:135], v[52:55]
v_mfma_f32_16x16x32_bf16 v[72:75], a[160:163], a[136:139], v[72:75]
v_mfma_f32_16x16x32_bf16 v[92:95], a[160:163], a[140:143], v[92:95]
s_waitcnt lgkmcnt(0)
v_mfma_f32_16x16x32_bf16 v[16:19], a[180:183], a[164:167], v[16:19]
s_waitcnt vmcnt(22)
v_mfma_f32_16x16x32_bf16 v[36:39], a[180:183], a[168:171], v[36:39]
s_barrier
v_mfma_f32_16x16x32_bf16 v[56:59], a[180:183], a[172:175], v[56:59]
s_add_u32 m0, s28, 23552
ds_read_b128 a[144:147], v12 offset:36864
v_mfma_f32_16x16x32_bf16 v[76:79], a[180:183], a[176:179], v[76:79]
s_add_u32 s79, s71, 65536
ds_read_b128 a[128:131], v10 offset:0
v_mfma_f32_16x16x32_bf16 v[20:23], a[184:187], a[164:167], v[20:23]
buffer_load_dwordx4 v1, s[44:47], s79 offen sc1 lds
v_mfma_f32_16x16x32_bf16 v[40:43], a[184:187], a[168:171], v[40:43]
s_add_u32 m0, s29, 16384
ds_read_b128 a[132:135], v10 offset:1024
v_mfma_f32_16x16x32_bf16 v[60:63], a[184:187], a[172:175], v[60:63]
s_add_u32 s85, s27, 737280
ds_read_b128 a[136:139], v10 offset:2048
v_mfma_f32_16x16x32_bf16 v[80:83], a[184:187], a[176:179], v[80:83]
buffer_load_dwordx4 v1, s[48:51], s85 offen offset:0 sc1 lds
v_mfma_f32_16x16x32_bf16 v[24:27], a[188:191], a[164:167], v[24:27]
buffer_load_dwordx4 v1, s[48:51], s85 offen offset:1024 sc1 lds
v_mfma_f32_16x16x32_bf16 v[44:47], a[188:191], a[168:171], v[44:47]
s_lshl_b32 s80, s23, 7
ds_read_b128 a[140:143], v10 offset:3072
v_mfma_f32_16x16x32_bf16 v[64:67], a[188:191], a[172:175], v[64:67]
s_lshl_b32 s81, s76, 2
ds_read_b128 a[148:151], v12 offset:37888
v_mfma_f32_16x16x32_bf16 v[84:87], a[188:191], a[176:179], v[84:87]
buffer_load_dwordx4 v1, s[48:51], s85 offen offset:2048 sc1 lds
v_mfma_f32_16x16x32_bf16 v[28:31], a[192:195], a[164:167], v[28:31]
s_add_u32 s80, s80, s81
ds_read_b128 a[152:155], v12 offset:38912
v_mfma_f32_16x16x32_bf16 v[48:51], a[192:195], a[168:171], v[48:51]
s_add_u32 s101, s80, 68239360
ds_read_b128 a[156:159], v12 offset:39936
v_mfma_f32_16x16x32_bf16 v[68:71], a[192:195], a[172:175], v[68:71]
ds_read_b128 a[160:163], v12 offset:40960
v_mfma_f32_16x16x32_bf16 v[88:91], a[192:195], a[176:179], v[88:91]
buffer_load_dwordx4 v1, s[48:51], s85 offen offset:3072 sc1 lds
v_mfma_f32_16x16x32_bf16 v[32:35], a[196:199], a[164:167], v[32:35]
v_mfma_f32_16x16x32_bf16 v[52:55], a[196:199], a[168:171], v[52:55]
v_mfma_f32_16x16x32_bf16 v[72:75], a[196:199], a[172:175], v[72:75]
v_mfma_f32_16x16x32_bf16 v[92:95], a[196:199], a[176:179], v[92:95]
s_waitcnt lgkmcnt(0)
v_mfma_f32_16x16x32_bf16 v[16:19], a[144:147], a[128:131], v[16:19]
s_add_u32 m0, s29, 20480
ds_read_b128 a[180:183], v12 offset:47104
v_mfma_f32_16x16x32_bf16 v[36:39], a[144:147], a[132:135], v[36:39]
s_add_u32 s85, s27, 741376
ds_read_b128 a[164:167], v10 offset:8192
v_mfma_f32_16x16x32_bf16 v[56:59], a[144:147], a[136:139], v[56:59]
buffer_load_dwordx4 v1, s[48:51], s85 offen offset:0 sc1 lds
v_mfma_f32_16x16x32_bf16 v[76:79], a[144:147], a[140:143], v[76:79]
s_lshl_b32 s80, s30, 2
ds_read_b128 a[168:171], v10 offset:9216
v_mfma_f32_16x16x32_bf16 v[20:23], a[148:151], a[128:131], v[20:23]
s_add_u32 m0, s24, 0
ds_read_b128 a[172:175], v10 offset:10240
v_mfma_f32_16x16x32_bf16 v[40:43], a[148:151], a[132:135], v[40:43]
s_add_u32 s79, s68, 73728
ds_read_b128 a[176:179], v10 offset:11264
v_mfma_f32_16x16x32_bf16 v[60:63], a[148:151], a[136:139], v[60:63]
buffer_load_dwordx4 v1, s[44:47], s79 offen sc1 lds
v_mfma_f32_16x16x32_bf16 v[80:83], a[148:151], a[140:143], v[80:83]
s_add_u32 s80, s80, s22
ds_read_b128 a[184:187], v12 offset:48128
v_mfma_f32_16x16x32_bf16 v[24:27], a[152:155], a[128:131], v[24:27]
s_mul_i32 s80, s80, 20480
ds_read_b128 a[188:191], v12 offset:49152
v_mfma_f32_16x16x32_bf16 v[44:47], a[152:155], a[132:135], v[44:47]
s_add_u32 m0, s24, 1024
ds_read_b128 a[192:195], v12 offset:50176
v_mfma_f32_16x16x32_bf16 v[64:67], a[152:155], a[136:139], v[64:67]
s_add_u32 s79, s69, 73728
ds_read_b128 a[196:199], v12 offset:51200
v_mfma_f32_16x16x32_bf16 v[84:87], a[152:155], a[140:143], v[84:87]
buffer_load_dwordx4 v1, s[44:47], s79 offen sc1 lds
v_mfma_f32_16x16x32_bf16 v[28:31], a[156:159], a[128:131], v[28:31]
s_mul_i32 s81, s31, 160
v_mfma_f32_16x16x32_bf16 v[48:51], a[156:159], a[132:135], v[48:51]
s_add_u32 s94, s80, s81
v_mfma_f32_16x16x32_bf16 v[68:71], a[156:159], a[136:139], v[68:71]
s_add_u32 m0, s24, 2048
v_mfma_f32_16x16x32_bf16 v[88:91], a[156:159], a[140:143], v[88:91]
s_add_u32 s79, s70, 73728
v_mfma_f32_16x16x32_bf16 v[32:35], a[160:163], a[128:131], v[32:35]
buffer_load_dwordx4 v1, s[44:47], s79 offen sc1 lds
v_mfma_f32_16x16x32_bf16 v[52:55], a[160:163], a[132:135], v[52:55]
v_mfma_f32_16x16x32_bf16 v[72:75], a[160:163], a[136:139], v[72:75]
v_mfma_f32_16x16x32_bf16 v[92:95], a[160:163], a[140:143], v[92:95]
s_waitcnt lgkmcnt(0)
v_mfma_f32_16x16x32_bf16 v[16:19], a[180:183], a[164:167], v[16:19]
s_waitcnt vmcnt(17)
v_mfma_f32_16x16x32_bf16 v[36:39], a[180:183], a[168:171], v[36:39]
s_barrier
v_mfma_f32_16x16x32_bf16 v[56:59], a[180:183], a[172:175], v[56:59]
s_add_u32 m0, s24, 3072
ds_read_b128 a[144:147], v13 offset:0
v_add_u32 v7, 0, v0
v_mfma_f32_16x16x32_bf16 v[76:79], a[180:183], a[176:179], v[76:79]
s_add_u32 s79, s71, 73728
ds_read_b128 a[128:131], v10 offset:16384
v_mul_u32_u24 v15, 6554, v7
v_mfma_f32_16x16x32_bf16 v[20:23], a[184:187], a[164:167], v[20:23]
buffer_load_dwordx4 v1, s[44:47], s79 offen sc1 lds
v_mfma_f32_16x16x32_bf16 v[40:43], a[184:187], a[168:171], v[40:43]
s_add_u32 m0, s29, 36864
ds_read_b128 a[132:135], v10 offset:17408
v_lshrrev_b32 v15, 16, v15
v_mfma_f32_16x16x32_bf16 v[60:63], a[184:187], a[172:175], v[60:63]
s_add_u32 s85, s27, 819200
ds_read_b128 a[136:139], v10 offset:18432
v_lshlrev_b32 v7, 4, v7
v_mfma_f32_16x16x32_bf16 v[80:83], a[184:187], a[176:179], v[80:83]
buffer_load_dwordx4 v1, s[48:51], s85 offen offset:0 sc1 lds
v_mfma_f32_16x16x32_bf16 v[24:27], a[188:191], a[164:167], v[24:27]
buffer_load_dwordx4 v1, s[48:51], s85 offen offset:1024 sc1 lds
v_mfma_f32_16x16x32_bf16 v[44:47], a[188:191], a[168:171], v[44:47]
s_mul_i32 s80, s76, 2816
ds_read_b128 a[140:143], v10 offset:19456
v_lshl_add_u32 v136, v15, 4, v7
v_mfma_f32_16x16x32_bf16 v[64:67], a[188:191], a[172:175], v[64:67]
ds_read_b128 a[148:151], v13 offset:1024
v_add_u32 v136, s80, v136
v_mfma_f32_16x16x32_bf16 v[84:87], a[188:191], a[176:179], v[84:87]
buffer_load_dwordx4 v1, s[48:51], s85 offen offset:2048 sc1 lds
v_mfma_f32_16x16x32_bf16 v[28:31], a[192:195], a[164:167], v[28:31]
ds_read_b128 a[152:155], v13 offset:2048
v_mul_u32_u24 v15, 1120, v15
v_mfma_f32_16x16x32_bf16 v[48:51], a[192:195], a[168:171], v[48:51]
ds_read_b128 a[156:159], v13 offset:3072
v_add_u32 v139, v15, v7
v_mfma_f32_16x16x32_bf16 v[68:71], a[192:195], a[172:175], v[68:71]
ds_read_b128 a[160:163], v13 offset:4096
v_mfma_f32_16x16x32_bf16 v[88:91], a[192:195], a[176:179], v[88:91]
buffer_load_dwordx4 v1, s[48:51], s85 offen offset:3072 sc1 lds
v_mfma_f32_16x16x32_bf16 v[32:35], a[196:199], a[164:167], v[32:35]
v_mfma_f32_16x16x32_bf16 v[52:55], a[196:199], a[168:171], v[52:55]
v_mfma_f32_16x16x32_bf16 v[72:75], a[196:199], a[172:175], v[72:75]
v_mfma_f32_16x16x32_bf16 v[92:95], a[196:199], a[176:179], v[92:95]
s_waitcnt lgkmcnt(0)
v_mfma_f32_16x16x32_bf16 v[16:19], a[144:147], a[128:131], v[16:19]
s_add_u32 m0, s29, 40960
ds_read_b128 a[180:183], v13 offset:10240
v_mfma_f32_16x16x32_bf16 v[36:39], a[144:147], a[132:135], v[36:39]
s_add_u32 s85, s27, 823296
ds_read_b128 a[164:167], v10 offset:24576
v_mfma_f32_16x16x32_bf16 v[56:59], a[144:147], a[136:139], v[56:59]
buffer_load_dwordx4 v1, s[48:51], s85 offen offset:0 sc1 lds
v_mfma_f32_16x16x32_bf16 v[76:79], a[144:147], a[140:143], v[76:79]
ds_read_b128 a[168:171], v10 offset:25600
v_add_u32 v7, 64, v0
v_mfma_f32_16x16x32_bf16 v[20:23], a[148:151], a[128:131], v[20:23]
s_add_u32 m0, s25, 0
ds_read_b128 a[172:175], v10 offset:26624
v_mul_u32_u24 v15, 6554, v7
v_mfma_f32_16x16x32_bf16 v[40:43], a[148:151], a[132:135], v[40:43]
s_add_u32 s79, s68, 81920
ds_read_b128 a[176:179], v10 offset:27648
v_lshrrev_b32 v15, 16, v15
v_mfma_f32_16x16x32_bf16 v[60:63], a[148:151], a[136:139], v[60:63]
buffer_load_dwordx4 v1, s[44:47], s79 offen sc1 lds
v_mfma_f32_16x16x32_bf16 v[80:83], a[148:151], a[140:143], v[80:83]
ds_read_b128 a[184:187], v13 offset:11264
v_lshlrev_b32 v7, 4, v7
v_mfma_f32_16x16x32_bf16 v[24:27], a[152:155], a[128:131], v[24:27]
s_mul_i32 s80, s76, 2816
ds_read_b128 a[188:191], v13 offset:12288
v_lshl_add_u32 v137, v15, 4, v7
v_mfma_f32_16x16x32_bf16 v[44:47], a[152:155], a[132:135], v[44:47]
s_add_u32 m0, s25, 1024
ds_read_b128 a[192:195], v13 offset:13312
v_add_u32 v137, s80, v137
v_mfma_f32_16x16x32_bf16 v[64:67], a[152:155], a[136:139], v[64:67]
s_add_u32 s79, s69, 81920
ds_read_b128 a[196:199], v13 offset:14336
v_mul_u32_u24 v15, 1120, v15
v_mfma_f32_16x16x32_bf16 v[84:87], a[152:155], a[140:143], v[84:87]
buffer_load_dwordx4 v1, s[44:47], s79 offen sc1 lds
v_mfma_f32_16x16x32_bf16 v[28:31], a[156:159], a[128:131], v[28:31]
v_add_u32 v140, v15, v7
v_mfma_f32_16x16x32_bf16 v[48:51], a[156:159], a[132:135], v[48:51]
v_mfma_f32_16x16x32_bf16 v[68:71], a[156:159], a[136:139], v[68:71]
s_add_u32 m0, s25, 2048
v_mfma_f32_16x16x32_bf16 v[88:91], a[156:159], a[140:143], v[88:91]
s_add_u32 s79, s70, 81920
v_mfma_f32_16x16x32_bf16 v[32:35], a[160:163], a[128:131], v[32:35]
buffer_load_dwordx4 v1, s[44:47], s79 offen sc1 lds
v_mfma_f32_16x16x32_bf16 v[52:55], a[160:163], a[132:135], v[52:55]
v_mfma_f32_16x16x32_bf16 v[72:75], a[160:163], a[136:139], v[72:75]
v_mfma_f32_16x16x32_bf16 v[92:95], a[160:163], a[140:143], v[92:95]
s_waitcnt lgkmcnt(0)
v_mfma_f32_16x16x32_bf16 v[16:19], a[180:183], a[164:167], v[16:19]
s_waitcnt vmcnt(17)
v_mfma_f32_16x16x32_bf16 v[36:39], a[180:183], a[168:171], v[36:39]
s_barrier
v_mfma_f32_16x16x32_bf16 v[56:59], a[180:183], a[172:175], v[56:59]
s_add_u32 m0, s25, 3072
ds_read_b128 a[144:147], v14 offset:0
v_add_u32 v7, 128, v0
v_mfma_f32_16x16x32_bf16 v[76:79], a[180:183], a[176:179], v[76:79]
s_add_u32 s79, s71, 81920
ds_read_b128 a[128:131], v11 offset:20480
v_mul_u32_u24 v15, 6554, v7
v_mfma_f32_16x16x32_bf16 v[20:23], a[184:187], a[164:167], v[20:23]
buffer_load_dwordx4 v1, s[44:47], s79 offen sc1 lds
v_mfma_f32_16x16x32_bf16 v[40:43], a[184:187], a[168:171], v[40:43]
s_add_u32 m0, s32, 0
ds_read_b128 a[132:135], v11 offset:21504
v_lshrrev_b32 v15, 16, v15
v_mfma_f32_16x16x32_bf16 v[60:63], a[184:187], a[172:175], v[60:63]
s_add_u32 s85, s27, 901120
ds_read_b128 a[136:139], v11 offset:22528
v_lshlrev_b32 v7, 4, v7
v_mfma_f32_16x16x32_bf16 v[80:83], a[184:187], a[176:179], v[80:83]
buffer_load_dwordx4 v1, s[48:51], s85 offen offset:0 sc1 lds
v_mfma_f32_16x16x32_bf16 v[24:27], a[188:191], a[164:167], v[24:27]
buffer_load_dwordx4 v1, s[48:51], s85 offen offset:1024 sc1 lds
v_mfma_f32_16x16x32_bf16 v[44:47], a[188:191], a[168:171], v[44:47]
s_mul_i32 s80, s76, 2816
ds_read_b128 a[140:143], v11 offset:23552
v_lshl_add_u32 v138, v15, 4, v7
v_mfma_f32_16x16x32_bf16 v[64:67], a[188:191], a[172:175], v[64:67]
ds_read_b128 a[148:151], v14 offset:1024
v_add_u32 v138, s80, v138
v_mfma_f32_16x16x32_bf16 v[84:87], a[188:191], a[176:179], v[84:87]
buffer_load_dwordx4 v1, s[48:51], s85 offen offset:2048 sc1 lds
v_mfma_f32_16x16x32_bf16 v[28:31], a[192:195], a[164:167], v[28:31]
ds_read_b128 a[152:155], v14 offset:2048
v_mul_u32_u24 v15, 1120, v15
v_mfma_f32_16x16x32_bf16 v[48:51], a[192:195], a[168:171], v[48:51]
ds_read_b128 a[156:159], v14 offset:3072
v_add_u32 v141, v15, v7
v_mfma_f32_16x16x32_bf16 v[68:71], a[192:195], a[172:175], v[68:71]
ds_read_b128 a[160:163], v14 offset:4096
v_sub_u32 v15, 31, v0
v_mfma_f32_16x16x32_bf16 v[88:91], a[192:195], a[176:179], v[88:91]
buffer_load_dwordx4 v1, s[48:51], s85 offen offset:3072 sc1 lds
v_mfma_f32_16x16x32_bf16 v[32:35], a[196:199], a[164:167], v[32:35]
v_and_b32 v15, 1073741824, v15
v_or_b32 v141, v141, v15
v_mfma_f32_16x16x32_bf16 v[52:55], a[196:199], a[168:171], v[52:55]
v_mfma_f32_16x16x32_bf16 v[72:75], a[196:199], a[172:175], v[72:75]
v_mfma_f32_16x16x32_bf16 v[92:95], a[196:199], a[176:179], v[92:95]
s_waitcnt lgkmcnt(0)
v_mfma_f32_16x16x32_bf16 v[16:19], a[144:147], a[128:131], v[16:19]
s_add_u32 m0, s32, 4096
ds_read_b128 a[180:183], v14 offset:10240
v_mfma_f32_16x16x32_bf16 v[36:39], a[144:147], a[132:135], v[36:39]
s_add_u32 s85, s27, 905216
ds_read_b128 a[164:167], v11 offset:28672
v_mfma_f32_16x16x32_bf16 v[56:59], a[144:147], a[136:139], v[56:59]
buffer_load_dwordx4 v1, s[48:51], s85 offen offset:0 sc1 lds
v_mfma_f32_16x16x32_bf16 v[76:79], a[144:147], a[140:143], v[76:79]
s_waitcnt vmcnt(37)
ds_read_b128 a[168:171], v11 offset:29696
v_sub_f32 v97, 1.0, v96
v_mfma_f32_16x16x32_bf16 v[20:23], a[148:151], a[128:131], v[20:23]
s_add_u32 m0, s25, 16384
ds_read_b128 a[172:175], v11 offset:30720
v_sub_f32 v99, 1.0, v98
v_mfma_f32_16x16x32_bf16 v[40:43], a[148:151], a[132:135], v[40:43]
s_add_u32 s79, s68, 90112
ds_read_b128 a[176:179], v11 offset:31744
v_sub_f32 v101, 1.0, v100
v_mfma_f32_16x16x32_bf16 v[60:63], a[148:151], a[136:139], v[60:63]
buffer_load_dwordx4 v1, s[44:47], s79 offen sc1 lds
v_mfma_f32_16x16x32_bf16 v[80:83], a[148:151], a[140:143], v[80:83]
ds_read_b128 a[184:187], v14 offset:11264
v_sub_f32 v103, 1.0, v102
v_mfma_f32_16x16x32_bf16 v[24:27], a[152:155], a[128:131], v[24:27]
ds_read_b128 a[188:191], v14 offset:12288
v_lshlrev_b32 v116, 16, v104
v_mfma_f32_16x16x32_bf16 v[44:47], a[152:155], a[132:135], v[44:47]
s_add_u32 m0, s25, 17408
ds_read_b128 a[192:195], v14 offset:13312
v_and_b32 v117, 0xffff0000, v104
v_mfma_f32_16x16x32_bf16 v[64:67], a[152:155], a[136:139], v[64:67]
s_add_u32 s79, s69, 90112
ds_read_b128 a[196:199], v14 offset:14336
v_lshlrev_b32 v118, 16, v105
v_mfma_f32_16x16x32_bf16 v[84:87], a[152:155], a[140:143], v[84:87]
buffer_load_dwordx4 v1, s[44:47], s79 offen sc1 lds
v_mfma_f32_16x16x32_bf16 v[28:31], a[156:159], a[128:131], v[28:31]
v_and_b32 v119, 0xffff0000, v105
v_lshlrev_b32 v120, 16, v106
v_mfma_f32_16x16x32_bf16 v[48:51], a[156:159], a[132:135], v[48:51]
v_and_b32 v121, 0xffff0000, v106
v_lshlrev_b32 v122, 16, v107
v_mfma_f32_16x16x32_bf16 v[68:71], a[156:159], a[136:139], v[68:71]
s_add_u32 m0, s25, 18432
v_and_b32 v123, 0xffff0000, v107
v_lshlrev_b32 v124, 16, v108
v_mfma_f32_16x16x32_bf16 v[88:91], a[156:159], a[140:143], v[88:91]
s_add_u32 s79, s70, 90112
v_and_b32 v125, 0xffff0000, v108
v_lshlrev_b32 v126, 16, v109
v_mfma_f32_16x16x32_bf16 v[32:35], a[160:163], a[128:131], v[32:35]
buffer_load_dwordx4 v1, s[44:47], s79 offen sc1 lds
v_mfma_f32_16x16x32_bf16 v[52:55], a[160:163], a[132:135], v[52:55]
v_and_b32 v127, 0xffff0000, v109
v_lshlrev_b32 v128, 16, v110
v_mfma_f32_16x16x32_bf16 v[72:75], a[160:163], a[136:139], v[72:75]
v_and_b32 v129, 0xffff0000, v110
v_lshlrev_b32 v130, 16, v111
v_mfma_f32_16x16x32_bf16 v[92:95], a[160:163], a[140:143], v[92:95]
v_and_b32 v131, 0xffff0000, v111
v_lshlrev_b32 v132, 16, v112
v_and_b32 v133, 0xffff0000, v112
v_lshlrev_b32 v134, 16, v113
v_and_b32 v135, 0xffff0000, v113
s_waitcnt lgkmcnt(0)
v_mfma_f32_16x16x32_bf16 v[16:19], a[180:183], a[164:167], v[16:19]
s_waitcnt vmcnt(17)
v_mfma_f32_16x16x32_bf16 v[36:39], a[180:183], a[168:171], v[36:39]
s_barrier
v_mfma_f32_16x16x32_bf16 v[56:59], a[180:183], a[172:175], v[56:59]
s_add_u32 m0, s25, 19456
ds_read_b128 a[144:147], v12 offset:16384
v_add_f32 v144, v144, v116
v_mfma_f32_16x16x32_bf16 v[76:79], a[180:183], a[176:179], v[76:79]
s_add_u32 s79, s71, 90112
ds_read_b128 a[128:131], v9 offset:0
v_add_f32 v145, v145, v117
v_mfma_f32_16x16x32_bf16 v[20:23], a[184:187], a[164:167], v[20:23]
buffer_load_dwordx4 v1, s[44:47], s79 offen sc1 lds
v_mfma_f32_16x16x32_bf16 v[40:43], a[184:187], a[168:171], v[40:43]
s_add_u32 m0, s33, 0
ds_read_b128 a[132:135], v9 offset:1024
v_add_f32 v146, v146, v118
v_mfma_f32_16x16x32_bf16 v[60:63], a[184:187], a[172:175], v[60:63]
s_add_u32 s85, s27, 983040
ds_read_b128 a[136:139], v9 offset:2048
v_add_f32 v147, v147, v119
v_mfma_f32_16x16x32_bf16 v[80:83], a[184:187], a[176:179], v[80:83]
buffer_load_dwordx4 v1, s[48:51], s85 offen offset:0 sc1 lds
v_mfma_f32_16x16x32_bf16 v[24:27], a[188:191], a[164:167], v[24:27]
buffer_load_dwordx4 v1, s[48:51], s85 offen offset:1024 sc1 lds
v_mfma_f32_16x16x32_bf16 v[44:47], a[188:191], a[168:171], v[44:47]
ds_read_b128 a[140:143], v9 offset:3072
v_add_f32 v148, v148, v120
v_mfma_f32_16x16x32_bf16 v[64:67], a[188:191], a[172:175], v[64:67]
ds_read_b128 a[148:151], v12 offset:17408
v_add_f32 v149, v149, v121
v_mfma_f32_16x16x32_bf16 v[84:87], a[188:191], a[176:179], v[84:87]
buffer_load_dwordx4 v1, s[48:51], s85 offen offset:2048 sc1 lds
v_mfma_f32_16x16x32_bf16 v[28:31], a[192:195], a[164:167], v[28:31]
ds_read_b128 a[152:155], v12 offset:18432
v_add_f32 v150, v150, v122
v_mfma_f32_16x16x32_bf16 v[48:51], a[192:195], a[168:171], v[48:51]
ds_read_b128 a[156:159], v12 offset:19456
v_add_f32 v151, v151, v123
v_mfma_f32_16x16x32_bf16 v[68:71], a[192:195], a[172:175], v[68:71]
ds_read_b128 a[160:163], v12 offset:20480
v_add_f32 v152, v152, v124
v_mfma_f32_16x16x32_bf16 v[88:91], a[192:195], a[176:179], v[88:91]
buffer_load_dwordx4 v1, s[48:51], s85 offen offset:3072 sc1 lds
v_mfma_f32_16x16x32_bf16 v[32:35], a[196:199], a[164:167], v[32:35]
v_add_f32 v153, v153, v125
v_add_f32 v154, v154, v126
v_mfma_f32_16x16x32_bf16 v[52:55], a[196:199], a[168:171], v[52:55]
v_add_f32 v155, v155, v127
v_add_f32 v156, v156, v128
v_mfma_f32_16x16x32_bf16 v[72:75], a[196:199], a[172:175], v[72:75]
v_add_f32 v157, v157, v129
v_add_f32 v158, v158, v130
v_mfma_f32_16x16x32_bf16 v[92:95], a[196:199], a[176:179], v[92:95]
v_add_f32 v159, v159, v131
v_add_f32 v160, v160, v132
v_add_f32 v161, v161, v133
v_add_f32 v162, v162, v134
v_add_f32 v163, v163, v135
s_waitcnt lgkmcnt(0)
v_mfma_f32_16x16x32_bf16 v[16:19], a[144:147], a[128:131], v[16:19]
s_add_u32 m0, s33, 4096
ds_read_b128 a[180:183], v12 offset:26624
v_mfma_f32_16x16x32_bf16 v[36:39], a[144:147], a[132:135], v[36:39]
s_add_u32 s85, s27, 987136
ds_read_b128 a[164:167], v9 offset:8192
v_mfma_f32_16x16x32_bf16 v[56:59], a[144:147], a[136:139], v[56:59]
buffer_load_dwordx4 v1, s[48:51], s85 offen offset:0 sc1 lds
v_mfma_f32_16x16x32_bf16 v[76:79], a[144:147], a[140:143], v[76:79]
ds_read_b128 a[168:171], v9 offset:9216
v_mul_f32 v144, v144, v97
v_mfma_f32_16x16x32_bf16 v[20:23], a[148:151], a[128:131], v[20:23]
s_add_u32 m0, s28, 20480
ds_read_b128 a[172:175], v9 offset:10240
v_mul_f32 v145, v145, v97
v_mfma_f32_16x16x32_bf16 v[40:43], a[148:151], a[132:135], v[40:43]
s_add_u32 s79, s68, 98304
ds_read_b128 a[176:179], v9 offset:11264
v_mul_f32 v146, v146, v97
v_mfma_f32_16x16x32_bf16 v[60:63], a[148:151], a[136:139], v[60:63]
buffer_load_dwordx4 v1, s[44:47], s79 offen sc1 lds
v_mfma_f32_16x16x32_bf16 v[80:83], a[148:151], a[140:143], v[80:83]
ds_read_b128 a[184:187], v12 offset:27648
v_mul_f32 v147, v147, v97
v_mfma_f32_16x16x32_bf16 v[24:27], a[152:155], a[128:131], v[24:27]
ds_read_b128 a[188:191], v12 offset:28672
v_mul_f32 v148, v148, v97
v_mfma_f32_16x16x32_bf16 v[44:47], a[152:155], a[132:135], v[44:47]
s_add_u32 m0, s28, 21504
ds_read_b128 a[192:195], v12 offset:29696
v_mul_f32 v149, v149, v97
v_mfma_f32_16x16x32_bf16 v[64:67], a[152:155], a[136:139], v[64:67]
s_add_u32 s79, s69, 98304
ds_read_b128 a[196:199], v12 offset:30720
v_mul_f32 v150, v150, v97
v_mfma_f32_16x16x32_bf16 v[84:87], a[152:155], a[140:143], v[84:87]
buffer_load_dwordx4 v1, s[44:47], s79 offen sc1 lds
v_mfma_f32_16x16x32_bf16 v[28:31], a[156:159], a[128:131], v[28:31]
v_mul_f32 v151, v151, v97
v_mul_f32 v152, v152, v97
v_mfma_f32_16x16x32_bf16 v[48:51], a[156:159], a[132:135], v[48:51]
v_mul_f32 v153, v153, v97
v_mul_f32 v154, v154, v97
v_mfma_f32_16x16x32_bf16 v[68:71], a[156:159], a[136:139], v[68:71]
s_add_u32 m0, s28, 22528
v_mul_f32 v155, v155, v97
v_mul_f32 v156, v156, v97
v_mfma_f32_16x16x32_bf16 v[88:91], a[156:159], a[140:143], v[88:91]
s_add_u32 s79, s70, 98304
v_mul_f32 v157, v157, v97
v_mul_f32 v158, v158, v97
v_mfma_f32_16x16x32_bf16 v[32:35], a[160:163], a[128:131], v[32:35]
buffer_load_dwordx4 v1, s[44:47], s79 offen sc1 lds
v_mfma_f32_16x16x32_bf16 v[52:55], a[160:163], a[132:135], v[52:55]
v_mul_f32 v159, v159, v97
v_mul_f32 v160, v160, v97
v_mfma_f32_16x16x32_bf16 v[72:75], a[160:163], a[136:139], v[72:75]
v_mul_f32 v161, v161, v97
v_mul_f32 v162, v162, v97
v_mfma_f32_16x16x32_bf16 v[92:95], a[160:163], a[140:143], v[92:95]
v_mul_f32 v163, v163, v97
s_waitcnt lgkmcnt(0)
v_mfma_f32_16x16x32_bf16 v[16:19], a[180:183], a[164:167], v[16:19]
s_waitcnt vmcnt(17)
v_mfma_f32_16x16x32_bf16 v[36:39], a[180:183], a[168:171], v[36:39]
s_barrier
v_mfma_f32_16x16x32_bf16 v[56:59], a[180:183], a[172:175], v[56:59]
s_add_u32 m0, s28, 23552
ds_read_b128 a[144:147], v12 offset:36864
v_mul_f32 v164, v164, v99
v_mfma_f32_16x16x32_bf16 v[76:79], a[180:183], a[176:179], v[76:79]
s_add_u32 s79, s71, 98304
ds_read_b128 a[128:131], v10 offset:0
v_mul_f32 v165, v165, v99
v_mfma_f32_16x16x32_bf16 v[20:23], a[184:187], a[164:167], v[20:23]
buffer_load_dwordx4 v1, s[44:47], s79 offen sc1 lds
v_mfma_f32_16x16x32_bf16 v[40:43], a[184:187], a[168:171], v[40:43]
s_add_u32 m0, s29, 16384
ds_read_b128 a[132:135], v10 offset:1024
v_mul_f32 v166, v166, v99
v_mfma_f32_16x16x32_bf16 v[60:63], a[184:187], a[172:175], v[60:63]
s_add_u32 s85, s27, 1064960
ds_read_b128 a[136:139], v10 offset:2048
v_mul_f32 v167, v167, v99
v_mfma_f32_16x16x32_bf16 v[80:83], a[184:187], a[176:179], v[80:83]
buffer_load_dwordx4 v1, s[48:51], s85 offen offset:0 sc1 lds
v_mfma_f32_16x16x32_bf16 v[24:27], a[188:191], a[164:167], v[24:27]
buffer_load_dwordx4 v1, s[48:51], s85 offen offset:1024 sc1 lds
v_mfma_f32_16x16x32_bf16 v[44:47], a[188:191], a[168:171], v[44:47]
ds_read_b128 a[140:143], v10 offset:3072
v_mul_f32 v168, v168, v99
v_mfma_f32_16x16x32_bf16 v[64:67], a[188:191], a[172:175], v[64:67]
ds_read_b128 a[148:151], v12 offset:37888
v_mul_f32 v169, v169, v99
v_mfma_f32_16x16x32_bf16 v[84:87], a[188:191], a[176:179], v[84:87]
buffer_load_dwordx4 v1, s[48:51], s85 offen offset:2048 sc1 lds
v_mfma_f32_16x16x32_bf16 v[28:31], a[192:195], a[164:167], v[28:31]
ds_read_b128 a[152:155], v12 offset:38912
v_mul_f32 v170, v170, v99
v_mfma_f32_16x16x32_bf16 v[48:51], a[192:195], a[168:171], v[48:51]
ds_read_b128 a[156:159], v12 offset:39936
v_mul_f32 v171, v171, v99
v_mfma_f32_16x16x32_bf16 v[68:71], a[192:195], a[172:175], v[68:71]
ds_read_b128 a[160:163], v12 offset:40960
v_mul_f32 v172, v172, v99
v_mfma_f32_16x16x32_bf16 v[88:91], a[192:195], a[176:179], v[88:91]
buffer_load_dwordx4 v1, s[48:51], s85 offen offset:3072 sc1 lds
v_mfma_f32_16x16x32_bf16 v[32:35], a[196:199], a[164:167], v[32:35]
v_mul_f32 v173, v173, v99
v_mul_f32 v174, v174, v99
v_mfma_f32_16x16x32_bf16 v[52:55], a[196:199], a[168:171], v[52:55]
v_mul_f32 v175, v175, v99
v_mul_f32 v176, v176, v99
v_mfma_f32_16x16x32_bf16 v[72:75], a[196:199], a[172:175], v[72:75]
v_mul_f32 v177, v177, v99
v_mul_f32 v178, v178, v99
v_mfma_f32_16x16x32_bf16 v[92:95], a[196:199], a[176:179], v[92:95]
v_mul_f32 v179, v179, v99
v_mul_f32 v180, v180, v99
v_mul_f32 v181, v181, v99
v_mul_f32 v182, v182, v99
v_mul_f32 v183, v183, v99
s_waitcnt lgkmcnt(0)
v_mfma_f32_16x16x32_bf16 v[16:19], a[144:147], a[128:131], v[16:19]
s_add_u32 m0, s29, 20480
ds_read_b128 a[180:183], v12 offset:47104
v_mfma_f32_16x16x32_bf16 v[36:39], a[144:147], a[132:135], v[36:39]
s_add_u32 s85, s27, 1069056
ds_read_b128 a[164:167], v10 offset:8192
v_mfma_f32_16x16x32_bf16 v[56:59], a[144:147], a[136:139], v[56:59]
buffer_load_dwordx4 v1, s[48:51], s85 offen offset:0 sc1 lds
v_mfma_f32_16x16x32_bf16 v[76:79], a[144:147], a[140:143], v[76:79]
ds_read_b128 a[168:171], v10 offset:9216
v_mul_f32 v184, v184, v101
v_mfma_f32_16x16x32_bf16 v[20:23], a[148:151], a[128:131], v[20:23]
s_add_u32 m0, s24, 0
ds_read_b128 a[172:175], v10 offset:10240
v_mul_f32 v185, v185, v101
v_mfma_f32_16x16x32_bf16 v[40:43], a[148:151], a[132:135], v[40:43]
s_add_u32 s79, s68, 106496
ds_read_b128 a[176:179], v10 offset:11264
v_mul_f32 v186, v186, v101
v_mfma_f32_16x16x32_bf16 v[60:63], a[148:151], a[136:139], v[60:63]
buffer_load_dwordx4 v1, s[44:47], s79 offen sc1 lds
v_mfma_f32_16x16x32_bf16 v[80:83], a[148:151], a[140:143], v[80:83]
ds_read_b128 a[184:187], v12 offset:48128
v_mul_f32 v187, v187, v101
v_mfma_f32_16x16x32_bf16 v[24:27], a[152:155], a[128:131], v[24:27]
ds_read_b128 a[188:191], v12 offset:49152
v_mul_f32 v188, v188, v101
v_mfma_f32_16x16x32_bf16 v[44:47], a[152:155], a[132:135], v[44:47]
s_add_u32 m0, s24, 1024
ds_read_b128 a[192:195], v12 offset:50176
v_mul_f32 v189, v189, v101
v_mfma_f32_16x16x32_bf16 v[64:67], a[152:155], a[136:139], v[64:67]
s_add_u32 s79, s69, 106496
ds_read_b128 a[196:199], v12 offset:51200
v_mul_f32 v190, v190, v101
v_mfma_f32_16x16x32_bf16 v[84:87], a[152:155], a[140:143], v[84:87]
buffer_load_dwordx4 v1, s[44:47], s79 offen sc1 lds
v_mfma_f32_16x16x32_bf16 v[28:31], a[156:159], a[128:131], v[28:31]
v_mul_f32 v191, v191, v101
v_mul_f32 v192, v192, v101
v_mfma_f32_16x16x32_bf16 v[48:51], a[156:159], a[132:135], v[48:51]
v_mul_f32 v193, v193, v101
v_mul_f32 v194, v194, v101
v_mfma_f32_16x16x32_bf16 v[68:71], a[156:159], a[136:139], v[68:71]
s_add_u32 m0, s24, 2048
v_mul_f32 v195, v195, v101
v_mul_f32 v196, v196, v101
v_mfma_f32_16x16x32_bf16 v[88:91], a[156:159], a[140:143], v[88:91]
s_add_u32 s79, s70, 106496
v_mul_f32 v197, v197, v101
v_mul_f32 v198, v198, v101
v_mfma_f32_16x16x32_bf16 v[32:35], a[160:163], a[128:131], v[32:35]
buffer_load_dwordx4 v1, s[44:47], s79 offen sc1 lds
v_mfma_f32_16x16x32_bf16 v[52:55], a[160:163], a[132:135], v[52:55]
v_mul_f32 v199, v199, v101
v_mul_f32 v200, v200, v101
v_mfma_f32_16x16x32_bf16 v[72:75], a[160:163], a[136:139], v[72:75]
v_mul_f32 v201, v201, v101
v_mul_f32 v202, v202, v101
v_mfma_f32_16x16x32_bf16 v[92:95], a[160:163], a[140:143], v[92:95]
v_mul_f32 v203, v203, v101
s_waitcnt lgkmcnt(0)
v_mfma_f32_16x16x32_bf16 v[16:19], a[180:183], a[164:167], v[16:19]
s_waitcnt vmcnt(17)
v_mfma_f32_16x16x32_bf16 v[36:39], a[180:183], a[168:171], v[36:39]
s_barrier
v_mfma_f32_16x16x32_bf16 v[56:59], a[180:183], a[172:175], v[56:59]
s_add_u32 m0, s24, 3072
ds_read_b128 a[144:147], v13 offset:0
v_mul_f32 v204, v204, v103
v_mfma_f32_16x16x32_bf16 v[76:79], a[180:183], a[176:179], v[76:79]
s_add_u32 s79, s71, 106496
ds_read_b128 a[128:131], v10 offset:16384
v_mul_f32 v205, v205, v103
v_mfma_f32_16x16x32_bf16 v[20:23], a[184:187], a[164:167], v[20:23]
buffer_load_dwordx4 v1, s[44:47], s79 offen sc1 lds
v_mfma_f32_16x16x32_bf16 v[40:43], a[184:187], a[168:171], v[40:43]
s_add_u32 m0, s29, 36864
ds_read_b128 a[132:135], v10 offset:17408
v_mul_f32 v206, v206, v103
v_mfma_f32_16x16x32_bf16 v[60:63], a[184:187], a[172:175], v[60:63]
s_add_u32 s85, s27, 1146880
ds_read_b128 a[136:139], v10 offset:18432
v_mul_f32 v207, v207, v103
v_mfma_f32_16x16x32_bf16 v[80:83], a[184:187], a[176:179], v[80:83]
buffer_load_dwordx4 v1, s[48:51], s85 offen offset:0 sc1 lds
v_mfma_f32_16x16x32_bf16 v[24:27], a[188:191], a[164:167], v[24:27]
buffer_load_dwordx4 v1, s[48:51], s85 offen offset:1024 sc1 lds
v_mfma_f32_16x16x32_bf16 v[44:47], a[188:191], a[168:171], v[44:47]
ds_read_b128 a[140:143], v10 offset:19456
v_mul_f32 v208, v208, v103
v_mfma_f32_16x16x32_bf16 v[64:67], a[188:191], a[172:175], v[64:67]
ds_read_b128 a[148:151], v13 offset:1024
v_mul_f32 v209, v209, v103
v_mfma_f32_16x16x32_bf16 v[84:87], a[188:191], a[176:179], v[84:87]
buffer_load_dwordx4 v1, s[48:51], s85 offen offset:2048 sc1 lds
v_mfma_f32_16x16x32_bf16 v[28:31], a[192:195], a[164:167], v[28:31]
ds_read_b128 a[152:155], v13 offset:2048
v_mul_f32 v210, v210, v103
v_mfma_f32_16x16x32_bf16 v[48:51], a[192:195], a[168:171], v[48:51]
ds_read_b128 a[156:159], v13 offset:3072
v_mul_f32 v211, v211, v103
v_mfma_f32_16x16x32_bf16 v[68:71], a[192:195], a[172:175], v[68:71]
ds_read_b128 a[160:163], v13 offset:4096
v_mul_f32 v212, v212, v103
v_mfma_f32_16x16x32_bf16 v[88:91], a[192:195], a[176:179], v[88:91]
buffer_load_dwordx4 v1, s[48:51], s85 offen offset:3072 sc1 lds
v_mfma_f32_16x16x32_bf16 v[32:35], a[196:199], a[164:167], v[32:35]
v_mul_f32 v213, v213, v103
v_mul_f32 v214, v214, v103
v_mfma_f32_16x16x32_bf16 v[52:55], a[196:199], a[168:171], v[52:55]
v_mul_f32 v215, v215, v103
v_mul_f32 v216, v216, v103
v_mfma_f32_16x16x32_bf16 v[72:75], a[196:199], a[172:175], v[72:75]
v_mul_f32 v217, v217, v103
v_mul_f32 v218, v218, v103
v_mfma_f32_16x16x32_bf16 v[92:95], a[196:199], a[176:179], v[92:95]
v_mul_f32 v219, v219, v103
v_mul_f32 v220, v220, v103
v_mul_f32 v221, v221, v103
v_mul_f32 v222, v222, v103
v_mul_f32 v223, v223, v103
s_waitcnt lgkmcnt(0)
v_mfma_f32_16x16x32_bf16 v[16:19], a[144:147], a[128:131], v[16:19]
s_add_u32 m0, s29, 40960
ds_read_b128 a[180:183], v13 offset:10240
v_mfma_f32_16x16x32_bf16 v[36:39], a[144:147], a[132:135], v[36:39]
s_add_u32 s85, s27, 1150976
ds_read_b128 a[164:167], v10 offset:24576
v_mfma_f32_16x16x32_bf16 v[56:59], a[144:147], a[136:139], v[56:59]
buffer_load_dwordx4 v1, s[48:51], s85 offen offset:0 sc1 lds
v_mfma_f32_16x16x32_bf16 v[76:79], a[144:147], a[140:143], v[76:79]
ds_read_b128 a[168:171], v10 offset:25600
v_mfma_f32_16x16x32_bf16 v[20:23], a[148:151], a[128:131], v[20:23]
s_add_u32 m0, s25, 0
ds_read_b128 a[172:175], v10 offset:26624
v_mfma_f32_16x16x32_bf16 v[40:43], a[148:151], a[132:135], v[40:43]
s_add_u32 s79, s68, 114688
ds_read_b128 a[176:179], v10 offset:27648
v_mfma_f32_16x16x32_bf16 v[60:63], a[148:151], a[136:139], v[60:63]
buffer_load_dwordx4 v1, s[44:47], s79 offen sc1 lds
v_mfma_f32_16x16x32_bf16 v[80:83], a[148:151], a[140:143], v[80:83]
ds_read_b128 a[184:187], v13 offset:11264
v_mfma_f32_16x16x32_bf16 v[24:27], a[152:155], a[128:131], v[24:27]
ds_read_b128 a[188:191], v13 offset:12288
v_mfma_f32_16x16x32_bf16 v[44:47], a[152:155], a[132:135], v[44:47]
s_add_u32 m0, s25, 1024
ds_read_b128 a[192:195], v13 offset:13312
v_mfma_f32_16x16x32_bf16 v[64:67], a[152:155], a[136:139], v[64:67]
s_add_u32 s79, s69, 114688
ds_read_b128 a[196:199], v13 offset:14336
v_mfma_f32_16x16x32_bf16 v[84:87], a[152:155], a[140:143], v[84:87]
buffer_load_dwordx4 v1, s[44:47], s79 offen sc1 lds
v_mfma_f32_16x16x32_bf16 v[28:31], a[156:159], a[128:131], v[28:31]
v_mfma_f32_16x16x32_bf16 v[48:51], a[156:159], a[132:135], v[48:51]
v_mfma_f32_16x16x32_bf16 v[68:71], a[156:159], a[136:139], v[68:71]
s_add_u32 m0, s25, 2048
v_mfma_f32_16x16x32_bf16 v[88:91], a[156:159], a[140:143], v[88:91]
s_add_u32 s79, s70, 114688
v_mfma_f32_16x16x32_bf16 v[32:35], a[160:163], a[128:131], v[32:35]
buffer_load_dwordx4 v1, s[44:47], s79 offen sc1 lds
v_mfma_f32_16x16x32_bf16 v[52:55], a[160:163], a[132:135], v[52:55]
v_mfma_f32_16x16x32_bf16 v[72:75], a[160:163], a[136:139], v[72:75]
v_mfma_f32_16x16x32_bf16 v[92:95], a[160:163], a[140:143], v[92:95]
s_waitcnt lgkmcnt(0)
v_mfma_f32_16x16x32_bf16 v[16:19], a[180:183], a[164:167], v[16:19]
s_waitcnt vmcnt(17)
v_mfma_f32_16x16x32_bf16 v[36:39], a[180:183], a[168:171], v[36:39]
s_barrier
v_mfma_f32_16x16x32_bf16 v[56:59], a[180:183], a[172:175], v[56:59]
s_add_u32 m0, s25, 3072
ds_read_b128 a[144:147], v14 offset:0
v_mfma_f32_16x16x32_bf16 v[76:79], a[180:183], a[176:179], v[76:79]
s_add_u32 s79, s71, 114688
ds_read_b128 a[128:131], v11 offset:20480
v_mfma_f32_16x16x32_bf16 v[20:23], a[184:187], a[164:167], v[20:23]
buffer_load_dwordx4 v1, s[44:47], s79 offen sc1 lds
v_mfma_f32_16x16x32_bf16 v[40:43], a[184:187], a[168:171], v[40:43]
s_add_u32 m0, s32, 0
ds_read_b128 a[132:135], v11 offset:21504
v_mfma_f32_16x16x32_bf16 v[60:63], a[184:187], a[172:175], v[60:63]
s_add_u32 s85, s27, 1228800
ds_read_b128 a[136:139], v11 offset:22528
v_mfma_f32_16x16x32_bf16 v[80:83], a[184:187], a[176:179], v[80:83]
buffer_load_dwordx4 v1, s[48:51], s85 offen offset:0 sc1 lds
v_mfma_f32_16x16x32_bf16 v[24:27], a[188:191], a[164:167], v[24:27]
buffer_load_dwordx4 v1, s[48:51], s85 offen offset:1024 sc1 lds
v_mfma_f32_16x16x32_bf16 v[44:47], a[188:191], a[168:171], v[44:47]
ds_read_b128 a[140:143], v11 offset:23552
v_mfma_f32_16x16x32_bf16 v[64:67], a[188:191], a[172:175], v[64:67]
ds_read_b128 a[148:151], v14 offset:1024
v_mfma_f32_16x16x32_bf16 v[84:87], a[188:191], a[176:179], v[84:87]
buffer_load_dwordx4 v1, s[48:51], s85 offen offset:2048 sc1 lds
v_mfma_f32_16x16x32_bf16 v[28:31], a[192:195], a[164:167], v[28:31]
ds_read_b128 a[152:155], v14 offset:2048
v_mfma_f32_16x16x32_bf16 v[48:51], a[192:195], a[168:171], v[48:51]
ds_read_b128 a[156:159], v14 offset:3072
v_mfma_f32_16x16x32_bf16 v[68:71], a[192:195], a[172:175], v[68:71]
ds_read_b128 a[160:163], v14 offset:4096
v_mfma_f32_16x16x32_bf16 v[88:91], a[192:195], a[176:179], v[88:91]
buffer_load_dwordx4 v1, s[48:51], s85 offen offset:3072 sc1 lds
v_mfma_f32_16x16x32_bf16 v[32:35], a[196:199], a[164:167], v[32:35]
v_mfma_f32_16x16x32_bf16 v[52:55], a[196:199], a[168:171], v[52:55]
v_mfma_f32_16x16x32_bf16 v[72:75], a[196:199], a[172:175], v[72:75]
v_mfma_f32_16x16x32_bf16 v[92:95], a[196:199], a[176:179], v[92:95]
s_waitcnt lgkmcnt(0)
v_mfma_f32_16x16x32_bf16 v[16:19], a[144:147], a[128:131], v[16:19]
s_add_u32 m0, s32, 4096
ds_read_b128 a[180:183], v14 offset:10240
v_mfma_f32_16x16x32_bf16 v[36:39], a[144:147], a[132:135], v[36:39]
s_add_u32 s85, s27, 1232896
ds_read_b128 a[164:167], v11 offset:28672
v_mfma_f32_16x16x32_bf16 v[56:59], a[144:147], a[136:139], v[56:59]
buffer_load_dwordx4 v1, s[48:51], s85 offen offset:0 sc1 lds
v_mfma_f32_16x16x32_bf16 v[76:79], a[144:147], a[140:143], v[76:79]
ds_read_b128 a[168:171], v11 offset:29696
v_mfma_f32_16x16x32_bf16 v[20:23], a[148:151], a[128:131], v[20:23]
s_add_u32 m0, s25, 16384
ds_read_b128 a[172:175], v11 offset:30720
v_mfma_f32_16x16x32_bf16 v[40:43], a[148:151], a[132:135], v[40:43]
s_add_u32 s79, s68, 122880
ds_read_b128 a[176:179], v11 offset:31744
v_mfma_f32_16x16x32_bf16 v[60:63], a[148:151], a[136:139], v[60:63]
buffer_load_dwordx4 v1, s[44:47], s79 offen sc1 lds
v_mfma_f32_16x16x32_bf16 v[80:83], a[148:151], a[140:143], v[80:83]
ds_read_b128 a[184:187], v14 offset:11264
v_mfma_f32_16x16x32_bf16 v[24:27], a[152:155], a[128:131], v[24:27]
ds_read_b128 a[188:191], v14 offset:12288
v_mfma_f32_16x16x32_bf16 v[44:47], a[152:155], a[132:135], v[44:47]
s_add_u32 m0, s25, 17408
ds_read_b128 a[192:195], v14 offset:13312
v_mfma_f32_16x16x32_bf16 v[64:67], a[152:155], a[136:139], v[64:67]
s_add_u32 s79, s69, 122880
ds_read_b128 a[196:199], v14 offset:14336
v_mfma_f32_16x16x32_bf16 v[84:87], a[152:155], a[140:143], v[84:87]
buffer_load_dwordx4 v1, s[44:47], s79 offen sc1 lds
v_mfma_f32_16x16x32_bf16 v[28:31], a[156:159], a[128:131], v[28:31]
v_mfma_f32_16x16x32_bf16 v[48:51], a[156:159], a[132:135], v[48:51]
v_mfma_f32_16x16x32_bf16 v[68:71], a[156:159], a[136:139], v[68:71]
s_add_u32 m0, s25, 18432
v_mfma_f32_16x16x32_bf16 v[88:91], a[156:159], a[140:143], v[88:91]
s_add_u32 s79, s70, 122880
v_mfma_f32_16x16x32_bf16 v[32:35], a[160:163], a[128:131], v[32:35]
buffer_load_dwordx4 v1, s[44:47], s79 offen sc1 lds
v_mfma_f32_16x16x32_bf16 v[52:55], a[160:163], a[132:135], v[52:55]
v_mfma_f32_16x16x32_bf16 v[72:75], a[160:163], a[136:139], v[72:75]
v_mfma_f32_16x16x32_bf16 v[92:95], a[160:163], a[140:143], v[92:95]
s_waitcnt lgkmcnt(0)
v_mfma_f32_16x16x32_bf16 v[16:19], a[180:183], a[164:167], v[16:19]
s_waitcnt vmcnt(17)
v_mfma_f32_16x16x32_bf16 v[36:39], a[180:183], a[168:171], v[36:39]
s_barrier
v_mfma_f32_16x16x32_bf16 v[56:59], a[180:183], a[172:175], v[56:59]
s_add_u32 m0, s25, 19456
ds_read_b128 a[144:147], v12 offset:16384
v_mfma_f32_16x16x32_bf16 v[76:79], a[180:183], a[176:179], v[76:79]
s_add_u32 s79, s71, 122880
ds_read_b128 a[128:131], v9 offset:0
v_mfma_f32_16x16x32_bf16 v[20:23], a[184:187], a[164:167], v[20:23]
buffer_load_dwordx4 v1, s[44:47], s79 offen sc1 lds
v_mfma_f32_16x16x32_bf16 v[40:43], a[184:187], a[168:171], v[40:43]
ds_read_b128 a[132:135], v9 offset:1024
v_mfma_f32_16x16x32_bf16 v[60:63], a[184:187], a[172:175], v[60:63]
ds_read_b128 a[136:139], v9 offset:2048
v_mfma_f32_16x16x32_bf16 v[80:83], a[184:187], a[176:179], v[80:83]
ds_read_b128 a[140:143], v9 offset:3072
v_mfma_f32_16x16x32_bf16 v[24:27], a[188:191], a[164:167], v[24:27]
ds_read_b128 a[148:151], v12 offset:17408
v_mfma_f32_16x16x32_bf16 v[44:47], a[188:191], a[168:171], v[44:47]
ds_read_b128 a[152:155], v12 offset:18432
v_mfma_f32_16x16x32_bf16 v[64:67], a[188:191], a[172:175], v[64:67]
ds_read_b128 a[156:159], v12 offset:19456
v_mfma_f32_16x16x32_bf16 v[84:87], a[188:191], a[176:179], v[84:87]
ds_read_b128 a[160:163], v12 offset:20480
v_mfma_f32_16x16x32_bf16 v[28:31], a[192:195], a[164:167], v[28:31]
v_mfma_f32_16x16x32_bf16 v[48:51], a[192:195], a[168:171], v[48:51]
v_mfma_f32_16x16x32_bf16 v[68:71], a[192:195], a[172:175], v[68:71]
v_mfma_f32_16x16x32_bf16 v[88:91], a[192:195], a[176:179], v[88:91]
v_mfma_f32_16x16x32_bf16 v[32:35], a[196:199], a[164:167], v[32:35]
v_mfma_f32_16x16x32_bf16 v[52:55], a[196:199], a[168:171], v[52:55]
v_mfma_f32_16x16x32_bf16 v[72:75], a[196:199], a[172:175], v[72:75]
v_mfma_f32_16x16x32_bf16 v[92:95], a[196:199], a[176:179], v[92:95]
s_waitcnt lgkmcnt(0)
v_mfma_f32_16x16x32_bf16 v[16:19], a[144:147], a[128:131], v[16:19]
s_bfe_u32 s68, s68, 0x2000a
ds_read_b128 a[180:183], v12 offset:26624
v_mfma_f32_16x16x32_bf16 v[36:39], a[144:147], a[132:135], v[36:39]
s_mul_i32 s68, s68, 32768
ds_read_b128 a[164:167], v9 offset:8192
v_mfma_f32_16x16x32_bf16 v[56:59], a[144:147], a[136:139], v[56:59]
s_bfe_u32 s69, s69, 0x2000a
ds_read_b128 a[168:171], v9 offset:9216
v_mfma_f32_16x16x32_bf16 v[76:79], a[144:147], a[140:143], v[76:79]
s_mul_i32 s69, s69, 32768
ds_read_b128 a[172:175], v9 offset:10240
v_mfma_f32_16x16x32_bf16 v[20:23], a[148:151], a[128:131], v[20:23]
s_bfe_u32 s70, s70, 0x2000a
ds_read_b128 a[176:179], v9 offset:11264
v_mfma_f32_16x16x32_bf16 v[40:43], a[148:151], a[132:135], v[40:43]
s_mul_i32 s70, s70, 32768
ds_read_b128 a[184:187], v12 offset:27648
v_mfma_f32_16x16x32_bf16 v[60:63], a[148:151], a[136:139], v[60:63]
s_add_u32 s70, s70, 2560
ds_read_b128 a[188:191], v12 offset:28672
v_mfma_f32_16x16x32_bf16 v[80:83], a[148:151], a[140:143], v[80:83]
s_bfe_u32 s71, s71, 0x2000a
ds_read_b128 a[192:195], v12 offset:29696
v_mfma_f32_16x16x32_bf16 v[24:27], a[152:155], a[128:131], v[24:27]
s_mul_i32 s71, s71, 32768
ds_read_b128 a[196:199], v12 offset:30720
v_mfma_f32_16x16x32_bf16 v[44:47], a[152:155], a[132:135], v[44:47]
s_add_u32 s71, s71, 5120
v_mfma_f32_16x16x32_bf16 v[64:67], a[152:155], a[136:139], v[64:67]
s_add_u32 s80, s68, 2560
v_mfma_f32_16x16x32_bf16 v[84:87], a[152:155], a[140:143], v[84:87]
s_add_u32 s81, s68, 5120
v_mfma_f32_16x16x32_bf16 v[28:31], a[156:159], a[128:131], v[28:31]
v_mfma_f32_16x16x32_bf16 v[48:51], a[156:159], a[132:135], v[48:51]
v_mfma_f32_16x16x32_bf16 v[68:71], a[156:159], a[136:139], v[68:71]
v_mfma_f32_16x16x32_bf16 v[88:91], a[156:159], a[140:143], v[88:91]
v_mfma_f32_16x16x32_bf16 v[32:35], a[160:163], a[128:131], v[32:35]
v_mfma_f32_16x16x32_bf16 v[52:55], a[160:163], a[132:135], v[52:55]
v_mfma_f32_16x16x32_bf16 v[72:75], a[160:163], a[136:139], v[72:75]
v_mfma_f32_16x16x32_bf16 v[92:95], a[160:163], a[140:143], v[92:95]
s_waitcnt lgkmcnt(0)
v_mfma_f32_16x16x32_bf16 v[16:19], a[180:183], a[164:167], v[16:19]
s_waitcnt vmcnt(0)
v_mfma_f32_16x16x32_bf16 v[36:39], a[180:183], a[168:171], v[36:39]
s_barrier
v_mfma_f32_16x16x32_bf16 v[56:59], a[180:183], a[172:175], v[56:59]
ds_read_b128 a[96:99], v10 offset:1024
v_mfma_f32_16x16x32_bf16 v[76:79], a[180:183], a[176:179], v[76:79]
ds_read_b128 a[0:3], v12 offset:36864
v_mfma_f32_16x16x32_bf16 v[20:23], a[184:187], a[164:167], v[20:23]
ds_read_b128 a[4:7], v12 offset:37888
v_mfma_f32_16x16x32_bf16 v[40:43], a[184:187], a[168:171], v[40:43]
ds_read_b128 a[8:11], v12 offset:38912
v_mfma_f32_16x16x32_bf16 v[60:63], a[184:187], a[172:175], v[60:63]
ds_read_b128 a[12:15], v12 offset:39936
v_mfma_f32_16x16x32_bf16 v[80:83], a[184:187], a[176:179], v[80:83]
ds_read_b128 a[16:19], v12 offset:40960
v_mfma_f32_16x16x32_bf16 v[24:27], a[188:191], a[164:167], v[24:27]
ds_read_b128 a[100:103], v10 offset:9216
v_mfma_f32_16x16x32_bf16 v[44:47], a[188:191], a[168:171], v[44:47]
ds_read_b128 a[20:23], v12 offset:47104
v_mfma_f32_16x16x32_bf16 v[64:67], a[188:191], a[172:175], v[64:67]
ds_read_b128 a[24:27], v12 offset:48128
v_mfma_f32_16x16x32_bf16 v[84:87], a[188:191], a[176:179], v[84:87]
ds_read_b128 a[28:31], v12 offset:49152
v_mfma_f32_16x16x32_bf16 v[28:31], a[192:195], a[164:167], v[28:31]
ds_read_b128 a[32:35], v12 offset:50176
v_mfma_f32_16x16x32_bf16 v[48:51], a[192:195], a[168:171], v[48:51]
ds_read_b128 a[36:39], v12 offset:51200
v_mfma_f32_16x16x32_bf16 v[68:71], a[192:195], a[172:175], v[68:71]
ds_read_b128 a[104:107], v10 offset:17408
v_mfma_f32_16x16x32_bf16 v[88:91], a[192:195], a[176:179], v[88:91]
ds_read_b128 a[40:43], v13 offset:0
v_mfma_f32_16x16x32_bf16 v[32:35], a[196:199], a[164:167], v[32:35]
ds_read_b128 a[44:47], v13 offset:1024
v_mfma_f32_16x16x32_bf16 v[52:55], a[196:199], a[168:171], v[52:55]
ds_read_b128 a[48:51], v13 offset:2048
v_mfma_f32_16x16x32_bf16 v[72:75], a[196:199], a[172:175], v[72:75]
ds_read_b128 a[52:55], v13 offset:3072
v_mfma_f32_16x16x32_bf16 v[92:95], a[196:199], a[176:179], v[92:95]
ds_read_b128 a[56:59], v13 offset:4096
s_waitcnt lgkmcnt(6)
v_mfma_f32_16x16x32_bf16 v[36:39], a[0:3], a[96:99], v[36:39]
ds_read_b128 a[108:111], v10 offset:25600
v_mfma_f32_16x16x32_bf16 v[40:43], a[4:7], a[96:99], v[40:43]
ds_read_b128 a[60:63], v13 offset:10240
v_mfma_f32_16x16x32_bf16 v[44:47], a[8:11], a[96:99], v[44:47]
ds_read_b128 a[64:67], v13 offset:11264
v_mfma_f32_16x16x32_bf16 v[48:51], a[12:15], a[96:99], v[48:51]
ds_read_b128 a[68:71], v13 offset:12288
v_mfma_f32_16x16x32_bf16 v[52:55], a[16:19], a[96:99], v[52:55]
ds_read_b128 a[72:75], v13 offset:13312
v_mfma_f32_16x16x32_bf16 v[36:39], a[20:23], a[100:103], v[36:39]
ds_read_b128 a[76:79], v13 offset:14336
v_mfma_f32_16x16x32_bf16 v[40:43], a[24:27], a[100:103], v[40:43]
ds_read_b128 a[80:83], v10 offset:2048
v_mfma_f32_16x16x32_bf16 v[44:47], a[28:31], a[100:103], v[44:47]
ds_read_b128 a[84:87], v10 offset:10240
v_mfma_f32_16x16x32_bf16 v[48:51], a[32:35], a[100:103], v[48:51]
ds_read_b128 a[88:91], v10 offset:18432
v_mfma_f32_16x16x32_bf16 v[52:55], a[36:39], a[100:103], v[52:55]
s_waitcnt lgkmcnt(6)
ds_read_b128 a[92:95], v10 offset:26624
v_mfma_f32_16x16x32_bf16 v[36:39], a[40:43], a[104:107], v[36:39]
v_mfma_f32_16x16x32_bf16 v[40:43], a[44:47], a[104:107], v[40:43]
v_mfma_f32_16x16x32_bf16 v[44:47], a[48:51], a[104:107], v[44:47]
v_mfma_f32_16x16x32_bf16 v[48:51], a[52:55], a[104:107], v[48:51]
v_mfma_f32_16x16x32_bf16 v[52:55], a[56:59], a[104:107], v[52:55]
v_mfma_f32_16x16x32_bf16 v[36:39], a[60:63], a[108:111], v[36:39]
v_mfma_f32_16x16x32_bf16 v[40:43], a[64:67], a[108:111], v[40:43]
s_waitcnt lgkmcnt(0)
v_mfma_f32_16x16x32_bf16 v[44:47], a[68:71], a[108:111], v[44:47]
v_mfma_f32_16x16x32_bf16 v[48:51], a[72:75], a[108:111], v[48:51]
v_mfma_f32_16x16x32_bf16 v[52:55], a[76:79], a[108:111], v[52:55]
v_mfma_f32_16x16x32_bf16 v[56:59], a[0:3], a[80:83], v[56:59]
ds_read_b128 a[96:99], v10 offset:3072
v_mfma_f32_16x16x32_bf16 v[60:63], a[4:7], a[80:83], v[60:63]
ds_read_b128 a[100:103], v10 offset:11264
v_fma_f32 v36, v36, v98, v164
v_mfma_f32_16x16x32_bf16 v[64:67], a[8:11], a[80:83], v[64:67]
ds_read_b128 a[104:107], v10 offset:19456
v_fma_f32 v37, v37, v98, v165
v_mfma_f32_16x16x32_bf16 v[68:71], a[12:15], a[80:83], v[68:71]
ds_read_b128 a[108:111], v10 offset:27648
v_fma_f32 v38, v38, v98, v166
v_mfma_f32_16x16x32_bf16 v[72:75], a[16:19], a[80:83], v[72:75]
v_fma_f32 v39, v39, v98, v167
v_cvt_pk_bf16_f32 v36, v36, v37
v_mfma_f32_16x16x32_bf16 v[56:59], a[20:23], a[84:87], v[56:59]
v_cvt_pk_bf16_f32 v37, v38, v39
v_fma_f32 v40, v40, v98, v168
v_mfma_f32_16x16x32_bf16 v[60:63], a[24:27], a[84:87], v[60:63]
v_fma_f32 v41, v41, v98, v169
v_fma_f32 v42, v42, v98, v170
v_mfma_f32_16x16x32_bf16 v[64:67], a[28:31], a[84:87], v[64:67]
v_fma_f32 v43, v43, v98, v171
v_cvt_pk_bf16_f32 v38, v40, v41
v_mfma_f32_16x16x32_bf16 v[68:71], a[32:35], a[84:87], v[68:71]
v_cvt_pk_bf16_f32 v39, v42, v43
v_mfma_f32_16x16x32_bf16 v[72:75], a[36:39], a[84:87], v[72:75]
buffer_store_dwordx4 v[36:39], v5, s[56:59], s69 offen offset:0 sc1
v_mfma_f32_16x16x32_bf16 v[56:59], a[40:43], a[88:91], v[56:59]
v_fma_f32 v44, v44, v98, v172
v_fma_f32 v45, v45, v98, v173
v_mfma_f32_16x16x32_bf16 v[60:63], a[44:47], a[88:91], v[60:63]
v_fma_f32 v46, v46, v98, v174
v_fma_f32 v47, v47, v98, v175
v_mfma_f32_16x16x32_bf16 v[64:67], a[48:51], a[88:91], v[64:67]
v_cvt_pk_bf16_f32 v40, v44, v45
v_cvt_pk_bf16_f32 v41, v46, v47
v_mfma_f32_16x16x32_bf16 v[68:71], a[52:55], a[88:91], v[68:71]
v_fma_f32 v48, v48, v98, v176
v_fma_f32 v49, v49, v98, v177
v_mfma_f32_16x16x32_bf16 v[72:75], a[56:59], a[88:91], v[72:75]
v_fma_f32 v50, v50, v98, v178
v_fma_f32 v51, v51, v98, v179
v_mfma_f32_16x16x32_bf16 v[56:59], a[60:63], a[92:95], v[56:59]
v_cvt_pk_bf16_f32 v42, v48, v49
v_cvt_pk_bf16_f32 v43, v50, v51
v_mfma_f32_16x16x32_bf16 v[60:63], a[64:67], a[92:95], v[60:63]
buffer_store_dwordx4 v[40:43], v5, s[56:59], s69 offen offset:1024 sc1
v_mfma_f32_16x16x32_bf16 v[64:67], a[68:71], a[92:95], v[64:67]
v_fma_f32 v52, v52, v98, v180
v_fma_f32 v53, v53, v98, v181
v_mfma_f32_16x16x32_bf16 v[68:71], a[72:75], a[92:95], v[68:71]
v_fma_f32 v54, v54, v98, v182
v_fma_f32 v55, v55, v98, v183
v_mfma_f32_16x16x32_bf16 v[72:75], a[76:79], a[92:95], v[72:75]
s_waitcnt lgkmcnt(0)
v_cvt_pk_bf16_f32 v44, v52, v53
v_cvt_pk_bf16_f32 v45, v54, v55
v_mfma_f32_16x16x32_bf16 v[76:79], a[0:3], a[96:99], v[76:79]
ds_read_b128 a[80:83], v10 offset:0
v_mfma_f32_16x16x32_bf16 v[80:83], a[4:7], a[96:99], v[80:83]
ds_read_b128 a[84:87], v10 offset:8192
v_fma_f32 v56, v56, v100, v184
v_mfma_f32_16x16x32_bf16 v[84:87], a[8:11], a[96:99], v[84:87]
ds_read_b128 a[88:91], v10 offset:16384
v_fma_f32 v57, v57, v100, v185
v_mfma_f32_16x16x32_bf16 v[88:91], a[12:15], a[96:99], v[88:91]
ds_read_b128 a[92:95], v10 offset:24576
v_fma_f32 v58, v58, v100, v186
v_mfma_f32_16x16x32_bf16 v[92:95], a[16:19], a[96:99], v[92:95]
buffer_store_dwordx2 v[44:45], v6, s[56:59], s69 offen offset:2048 sc1
v_mfma_f32_16x16x32_bf16 v[76:79], a[20:23], a[100:103], v[76:79]
v_fma_f32 v59, v59, v100, v187
v_cvt_pk_bf16_f32 v56, v56, v57
v_mfma_f32_16x16x32_bf16 v[80:83], a[24:27], a[100:103], v[80:83]
v_cvt_pk_bf16_f32 v57, v58, v59
v_fma_f32 v60, v60, v100, v188
v_mfma_f32_16x16x32_bf16 v[84:87], a[28:31], a[100:103], v[84:87]
v_fma_f32 v61, v61, v100, v189
v_fma_f32 v62, v62, v100, v190
v_mfma_f32_16x16x32_bf16 v[88:91], a[32:35], a[100:103], v[88:91]
v_fma_f32 v63, v63, v100, v191
v_cvt_pk_bf16_f32 v58, v60, v61
v_mfma_f32_16x16x32_bf16 v[92:95], a[36:39], a[100:103], v[92:95]
v_cvt_pk_bf16_f32 v59, v62, v63
v_mfma_f32_16x16x32_bf16 v[76:79], a[40:43], a[104:107], v[76:79]
buffer_store_dwordx4 v[56:59], v5, s[56:59], s70 offen offset:0 sc1
v_mfma_f32_16x16x32_bf16 v[80:83], a[44:47], a[104:107], v[80:83]
v_fma_f32 v64, v64, v100, v192
v_fma_f32 v65, v65, v100, v193
v_mfma_f32_16x16x32_bf16 v[84:87], a[48:51], a[104:107], v[84:87]
v_fma_f32 v66, v66, v100, v194
v_fma_f32 v67, v67, v100, v195
v_mfma_f32_16x16x32_bf16 v[88:91], a[52:55], a[104:107], v[88:91]
v_cvt_pk_bf16_f32 v60, v64, v65
v_cvt_pk_bf16_f32 v61, v66, v67
v_mfma_f32_16x16x32_bf16 v[92:95], a[56:59], a[104:107], v[92:95]
v_fma_f32 v68, v68, v100, v196
v_fma_f32 v69, v69, v100, v197
v_mfma_f32_16x16x32_bf16 v[76:79], a[60:63], a[108:111], v[76:79]
v_fma_f32 v70, v70, v100, v198
v_fma_f32 v71, v71, v100, v199
v_mfma_f32_16x16x32_bf16 v[80:83], a[64:67], a[108:111], v[80:83]
v_cvt_pk_bf16_f32 v62, v68, v69
v_cvt_pk_bf16_f32 v63, v70, v71
v_mfma_f32_16x16x32_bf16 v[84:87], a[68:71], a[108:111], v[84:87]
buffer_store_dwordx4 v[60:63], v5, s[56:59], s70 offen offset:1024 sc1
v_mfma_f32_16x16x32_bf16 v[88:91], a[72:75], a[108:111], v[88:91]
v_fma_f32 v72, v72, v100, v200
v_fma_f32 v73, v73, v100, v201
v_mfma_f32_16x16x32_bf16 v[92:95], a[76:79], a[108:111], v[92:95]
s_waitcnt lgkmcnt(0)
v_fma_f32 v74, v74, v100, v202
v_fma_f32 v75, v75, v100, v203
v_mfma_f32_16x16x32_bf16 v[16:19], a[0:3], a[80:83], v[16:19]
v_cvt_pk_bf16_f32 v64, v72, v73
v_cvt_pk_bf16_f32 v65, v74, v75
v_mfma_f32_16x16x32_bf16 v[20:23], a[4:7], a[80:83], v[20:23]
buffer_store_dwordx2 v[64:65], v6, s[56:59], s70 offen offset:2048 sc1
v_mfma_f32_16x16x32_bf16 v[24:27], a[8:11], a[80:83], v[24:27]
v_fma_f32 v76, v76, v102, v204
v_fma_f32 v77, v77, v102, v205
v_mfma_f32_16x16x32_bf16 v[28:31], a[12:15], a[80:83], v[28:31]
v_fma_f32 v78, v78, v102, v206
v_fma_f32 v79, v79, v102, v207
v_mfma_f32_16x16x32_bf16 v[32:35], a[16:19], a[80:83], v[32:35]
v_cvt_pk_bf16_f32 v76, v76, v77
v_cvt_pk_bf16_f32 v77, v78, v79
v_mfma_f32_16x16x32_bf16 v[16:19], a[20:23], a[84:87], v[16:19]
v_fma_f32 v80, v80, v102, v208
v_fma_f32 v81, v81, v102, v209
v_mfma_f32_16x16x32_bf16 v[20:23], a[24:27], a[84:87], v[20:23]
s_barrier
v_fma_f32 v82, v82, v102, v210
v_fma_f32 v83, v83, v102, v211
v_mfma_f32_16x16x32_bf16 v[24:27], a[28:31], a[84:87], v[24:27]
v_cvt_pk_bf16_f32 v78, v80, v81
v_cvt_pk_bf16_f32 v79, v82, v83
v_mfma_f32_16x16x32_bf16 v[28:31], a[32:35], a[84:87], v[28:31]
buffer_store_dwordx4 v[76:79], v5, s[56:59], s71 offen offset:0 sc1
v_mfma_f32_16x16x32_bf16 v[32:35], a[36:39], a[84:87], v[32:35]
v_fma_f32 v84, v84, v102, v212
v_fma_f32 v85, v85, v102, v213
v_mfma_f32_16x16x32_bf16 v[16:19], a[40:43], a[88:91], v[16:19]
v_fma_f32 v86, v86, v102, v214
v_fma_f32 v87, v87, v102, v215
v_mfma_f32_16x16x32_bf16 v[20:23], a[44:47], a[88:91], v[20:23]
v_cvt_pk_bf16_f32 v80, v84, v85
v_cvt_pk_bf16_f32 v81, v86, v87
v_mfma_f32_16x16x32_bf16 v[24:27], a[48:51], a[88:91], v[24:27]
v_fma_f32 v88, v88, v102, v216
v_fma_f32 v89, v89, v102, v217
v_mfma_f32_16x16x32_bf16 v[28:31], a[52:55], a[88:91], v[28:31]
v_fma_f32 v90, v90, v102, v218
v_fma_f32 v91, v91, v102, v219
v_mfma_f32_16x16x32_bf16 v[32:35], a[56:59], a[88:91], v[32:35]
v_cvt_pk_bf16_f32 v82, v88, v89
v_cvt_pk_bf16_f32 v83, v90, v91
v_mfma_f32_16x16x32_bf16 v[16:19], a[60:63], a[92:95], v[16:19]
buffer_store_dwordx4 v[80:83], v5, s[56:59], s71 offen offset:1024 sc1
v_mfma_f32_16x16x32_bf16 v[20:23], a[64:67], a[92:95], v[20:23]
v_fma_f32 v92, v92, v102, v220
v_fma_f32 v93, v93, v102, v221
v_mfma_f32_16x16x32_bf16 v[24:27], a[68:71], a[92:95], v[24:27]
v_fma_f32 v94, v94, v102, v222
v_fma_f32 v95, v95, v102, v223
v_mfma_f32_16x16x32_bf16 v[28:31], a[72:75], a[92:95], v[28:31]
v_cvt_pk_bf16_f32 v84, v92, v93
v_cvt_pk_bf16_f32 v85, v94, v95
v_mfma_f32_16x16x32_bf16 v[32:35], a[76:79], a[92:95], v[32:35]
buffer_store_dwordx2 v[84:85], v6, s[56:59], s71 offen offset:2048 sc1
s_nop 3
v_pk_fma_f32 v[16:17], v[16:17], v[96:97], v[144:145] op_sel_hi:[1,0,1]
v_pk_fma_f32 v[18:19], v[18:19], v[96:97], v[146:147] op_sel_hi:[1,0,1]
v_pk_fma_f32 v[20:21], v[20:21], v[96:97], v[148:149] op_sel_hi:[1,0,1]
v_pk_fma_f32 v[22:23], v[22:23], v[96:97], v[150:151] op_sel_hi:[1,0,1]
v_pk_fma_f32 v[24:25], v[24:25], v[96:97], v[152:153] op_sel_hi:[1,0,1]
v_pk_fma_f32 v[26:27], v[26:27], v[96:97], v[154:155] op_sel_hi:[1,0,1]
v_pk_fma_f32 v[28:29], v[28:29], v[96:97], v[156:157] op_sel_hi:[1,0,1]
v_pk_fma_f32 v[30:31], v[30:31], v[96:97], v[158:159] op_sel_hi:[1,0,1]
v_pk_fma_f32 v[32:33], v[32:33], v[96:97], v[160:161] op_sel_hi:[1,0,1]
v_pk_fma_f32 v[34:35], v[34:35], v[96:97], v[162:163] op_sel_hi:[1,0,1]
v_mov_b32 v4, 1
s_waitcnt vmcnt(0)
buffer_atomic_add v4, v2, s[56:59], s101 offen sc0 sc1
s_waitcnt vmcnt(0)
v_add_u32 v4, 1, v4
s_nop 0
v_readfirstlane_b32 s26, v4
s_cmp_ge_u32 s26, 4
s_cbranch_scc0 L_x_spin0
L_x_ok:
buffer_load_dwordx4 v[224:227], v5, s[56:59], s68 offen offset:0 sc1
buffer_load_dwordx4 v[234:237], v5, s[56:59], s80 offen offset:0 sc1
buffer_load_dwordx4 v[244:247], v5, s[56:59], s81 offen offset:0 sc1
buffer_load_dwordx4 v[228:231], v5, s[56:59], s68 offen offset:1024 sc1
buffer_load_dwordx4 v[238:241], v5, s[56:59], s80 offen offset:1024 sc1
buffer_load_dwordx4 v[248:251], v5, s[56:59], s81 offen offset:1024 sc1
buffer_load_dwordx2 v[232:233], v6, s[56:59], s68 offen offset:2048 sc1
buffer_load_dwordx2 v[242:243], v6, s[56:59], s80 offen offset:2048 sc1
buffer_load_dwordx2 v[252:253], v6, s[56:59], s81 offen offset:2048 sc1
s_waitcnt vmcnt(6)
v_lshlrev_b32 v144, 16, v224
v_and_b32 v145, 0xffff0000, v224
v_lshlrev_b32 v146, 16, v225
v_and_b32 v147, 0xffff0000, v225
v_lshlrev_b32 v164, 16, v234
v_and_b32 v165, 0xffff0000, v234
v_lshlrev_b32 v166, 16, v235
v_and_b32 v167, 0xffff0000, v235
v_lshlrev_b32 v184, 16, v244
v_and_b32 v185, 0xffff0000, v244
v_lshlrev_b32 v186, 16, v245
v_and_b32 v187, 0xffff0000, v245
v_pk_add_f32 v[16:17], v[16:17], v[144:145]
v_pk_add_f32 v[164:165], v[164:165], v[184:185]
v_pk_add_f32 v[18:19], v[18:19], v[146:147]
v_pk_add_f32 v[166:167], v[166:167], v[186:187]
v_pk_add_f32 v[16:17], v[16:17], v[164:165]
v_pk_add_f32 v[18:19], v[18:19], v[166:167]
v_cvt_pk_bf16_f32 v16, v16, v17
v_cvt_pk_bf16_f32 v17, v18, v19
ds_write_b64 v8, v[16:17] offset:0
v_lshlrev_b32 v148, 16, v226
v_and_b32 v149, 0xffff0000, v226
v_lshlrev_b32 v150, 16, v227
v_and_b32 v151, 0xffff0000, v227
v_lshlrev_b32 v168, 16, v236
v_and_b32 v169, 0xffff0000, v236
v_lshlrev_b32 v170, 16, v237
v_and_b32 v171, 0xffff0000, v237
v_lshlrev_b32 v188, 16, v246
v_and_b32 v189, 0xffff0000, v246
v_lshlrev_b32 v190, 16, v247
v_and_b32 v191, 0xffff0000, v247
v_pk_add_f32 v[20:21], v[20:21], v[148:149]
v_pk_add_f32 v[168:169], v[168:169], v[188:189]
v_pk_add_f32 v[22:23], v[22:23], v[150:151]
v_pk_add_f32 v[170:171], v[170:171], v[190:191]
v_pk_add_f32 v[20:21], v[20:21], v[168:169]
v_pk_add_f32 v[22:23], v[22:23], v[170:171]
v_cvt_pk_bf16_f32 v20, v20, v21
v_cvt_pk_bf16_f32 v21, v22, v23
ds_write_b64 v8, v[20:21] offset:32
s_waitcnt vmcnt(3)
v_lshlrev_b32 v152, 16, v228
v_and_b32 v153, 0xffff0000, v228
v_lshlrev_b32 v154, 16, v229
v_and_b32 v155, 0xffff0000, v229
v_lshlrev_b32 v172, 16, v238
v_and_b32 v173, 0xffff0000, v238
v_lshlrev_b32 v174, 16, v239
v_and_b32 v175, 0xffff0000, v239
v_lshlrev_b32 v192, 16, v248
v_and_b32 v193, 0xffff0000, v248
v_lshlrev_b32 v194, 16, v249
v_and_b32 v195, 0xffff0000, v249
v_pk_add_f32 v[24:25], v[24:25], v[152:153]
v_pk_add_f32 v[172:173], v[172:173], v[192:193]
v_pk_add_f32 v[26:27], v[26:27], v[154:155]
v_pk_add_f32 v[174:175], v[174:175], v[194:195]
v_pk_add_f32 v[24:25], v[24:25], v[172:173]
v_pk_add_f32 v[26:27], v[26:27], v[174:175]
v_cvt_pk_bf16_f32 v24, v24, v25
v_cvt_pk_bf16_f32 v25, v26, v27
ds_write_b64 v8, v[24:25] offset:64
v_lshlrev_b32 v156, 16, v230
v_and_b32 v157, 0xffff0000, v230
v_lshlrev_b32 v158, 16, v231
v_and_b32 v159, 0xffff0000, v231
v_lshlrev_b32 v176, 16, v240
v_and_b32 v177, 0xffff0000, v240
v_lshlrev_b32 v178, 16, v241
v_and_b32 v179, 0xffff0000, v241
v_lshlrev_b32 v196, 16, v250
v_and_b32 v197, 0xffff0000, v250
v_lshlrev_b32 v198, 16, v251
v_and_b32 v199, 0xffff0000, v251
v_pk_add_f32 v[28:29], v[28:29], v[156:157]
v_pk_add_f32 v[176:177], v[176:177], v[196:197]
v_pk_add_f32 v[30:31], v[30:31], v[158:159]
v_pk_add_f32 v[178:179], v[178:179], v[198:199]
v_pk_add_f32 v[28:29], v[28:29], v[176:177]
v_pk_add_f32 v[30:31], v[30:31], v[178:179]
v_cvt_pk_bf16_f32 v28, v28, v29
v_cvt_pk_bf16_f32 v29, v30, v31
ds_write_b64 v8, v[28:29] offset:96
s_waitcnt vmcnt(0)
v_lshlrev_b32 v160, 16, v232
v_and_b32 v161, 0xffff0000, v232
v_lshlrev_b32 v162, 16, v233
v_and_b32 v163, 0xffff0000, v233
v_lshlrev_b32 v180, 16, v242
v_and_b32 v181, 0xffff0000, v242
v_lshlrev_b32 v182, 16, v243
v_and_b32 v183, 0xffff0000, v243
v_lshlrev_b32 v200, 16, v252
v_and_b32 v201, 0xffff0000, v252
v_lshlrev_b32 v202, 16, v253
v_and_b32 v203, 0xffff0000, v253
v_pk_add_f32 v[32:33], v[32:33], v[160:161]
v_pk_add_f32 v[180:181], v[180:181], v[200:201]
v_pk_add_f32 v[34:35], v[34:35], v[162:163]
v_pk_add_f32 v[182:183], v[182:183], v[202:203]
v_pk_add_f32 v[32:33], v[32:33], v[180:181]
v_pk_add_f32 v[34:35], v[34:35], v[182:183]
v_cvt_pk_bf16_f32 v32, v32, v33
v_cvt_pk_bf16_f32 v33, v34, v35
ds_write_b64 v8, v[32:33] offset:128
ds_read_b128 v[40:43], v136
ds_read_b128 v[44:47], v137
ds_read_b128 v[48:51], v138
s_waitcnt lgkmcnt(2)
buffer_store_dwordx4 v[40:43], v139, s[52:55], s94 offen
s_waitcnt lgkmcnt(1)
buffer_store_dwordx4 v[44:47], v140, s[52:55], s94 offen
s_waitcnt lgkmcnt(0)
buffer_store_dwordx4 v[48:51], v141, s[52:55], s94 offen
s_endpgm
L_tail_end:
L_clr:
buffer_store_dwordx4 v[24:27], v1, s[56:59], s80 offen offset:0 sc1
buffer_store_dwordx4 v[24:27], v1, s[56:59], s80 offen offset:1024 sc1
buffer_store_dwordx4 v[24:27], v1, s[56:59], s80 offen offset:2048 sc1
buffer_store_dwordx4 v[24:27], v1, s[56:59], s81 offen offset:0 sc1
buffer_store_dwordx4 v[24:27], v1, s[56:59], s81 offen offset:1024 sc1
buffer_store_dwordx4 v[24:27], v1, s[56:59], s81 offen offset:2048 sc1
s_branch L_clr_ret
L_init_spin0:
s_mov_b32 s83, 65536
L_init_spin:
s_sleep 1
buffer_load_dword v28, v21, s[68:71], 0 offen sc1
s_waitcnt vmcnt(0)
v_readfirstlane_b32 s80, v28
s_cmp_eq_u32 s80, 1
s_cbranch_scc1 L_init_ok
s_sub_u32 s83, s83, 1
s_cmp_lg_u32 s83, 0
s_cbranch_scc1 L_init_spin
s_branch L_init_ok
L_kv_spin0:
s_mov_b32 s83, 65536
L_kv_spin:
s_sleep 1
buffer_load_dword v29, v21, s[56:59], s79 offen sc1
s_waitcnt vmcnt(0)
v_readfirstlane_b32 s26, v29
s_waitcnt vmcnt(0)
s_cmp_ge_u32 s26, 8
s_cbranch_scc1 L_kv_ok
s_sub_u32 s83, s83, 1
s_cmp_lg_u32 s83, 0
s_cbranch_scc1 L_kv_spin
s_branch L_kv_ok
L_mid_spin0:
s_mov_b32 s83, 65536
L_mid_spin:
s_sleep 1
buffer_load_dword v4, v8, s[56:59], s3 offen sc1
s_waitcnt vmcnt(0)
v_cmp_eq_u32 vcc, 32, v4
s_add_u32 s80, vcc_lo, s3
s_cmp_ge_u32 s80, 0xff
s_cbranch_scc1 L_mid_ok
s_sub_u32 s83, s83, 1
s_cmp_lg_u32 s83, 0
s_cbranch_scc1 L_mid_spin
s_branch L_mid_ok
L_slow:
v_mov_b32 v16, 0
v_mov_b32 v17, 0
v_mov_b32 v18, 0
v_mov_b32 v19, 0
v_mov_b32 v20, 0
v_mov_b32 v21, 0
v_mov_b32 v22, 0
v_mov_b32 v23, 0
v_mov_b32 v24, 0
v_mov_b32 v25, 0
v_mov_b32 v26, 0
v_mov_b32 v27, 0
v_mov_b32 v28, 0
v_mov_b32 v29, 0
v_mov_b32 v30, 0
v_mov_b32 v31, 0
v_mov_b32 v32, 0
v_mov_b32 v33, 0
v_mov_b32 v34, 0
v_mov_b32 v35, 0
v_mov_b32 v36, 0
v_mov_b32 v37, 0
v_mov_b32 v38, 0
v_mov_b32 v39, 0
v_mov_b32 v40, 0
v_mov_b32 v41, 0
v_mov_b32 v42, 0
v_mov_b32 v43, 0
v_mov_b32 v44, 0
v_mov_b32 v45, 0
v_mov_b32 v46, 0
v_mov_b32 v47, 0
v_mov_b32 v48, 0
v_mov_b32 v49, 0
v_mov_b32 v50, 0
v_mov_b32 v51, 0
v_mov_b32 v52, 0
v_mov_b32 v53, 0
v_mov_b32 v54, 0
v_mov_b32 v55, 0
v_mov_b32 v56, 0
v_mov_b32 v57, 0
v_mov_b32 v58, 0
v_mov_b32 v59, 0
v_mov_b32 v60, 0
v_mov_b32 v61, 0
v_mov_b32 v62, 0
v_mov_b32 v63, 0
v_mov_b32 v64, 0
v_mov_b32 v65, 0
v_mov_b32 v66, 0
v_mov_b32 v67, 0
v_mov_b32 v68, 0
v_mov_b32 v69, 0
v_mov_b32 v70, 0
v_mov_b32 v71, 0
v_mov_b32 v72, 0
v_mov_b32 v73, 0
v_mov_b32 v74, 0
v_mov_b32 v75, 0
v_mov_b32 v76, 0
v_mov_b32 v77, 0
v_mov_b32 v78, 0
v_mov_b32 v79, 0
v_mov_b32 v80, 0
v_mov_b32 v81, 0
v_mov_b32 v82, 0
v_mov_b32 v83, 0
v_mov_b32 v84, 0
v_mov_b32 v85, 0
v_mov_b32 v86, 0
v_mov_b32 v87, 0
v_mov_b32 v88, 0
v_mov_b32 v89, 0
v_mov_b32 v90, 0
v_mov_b32 v91, 0
v_mov_b32 v92, 0
v_mov_b32 v93, 0
v_mov_b32 v94, 0
v_mov_b32 v95, 0
v_mov_b32 v96, 0
v_mov_b32 v97, 0
v_mov_b32 v98, 0
v_mov_b32 v99, 0
v_mov_b32 v100, 0
v_mov_b32 v101, 0
v_mov_b32 v102, 0
v_mov_b32 v103, 0
v_mov_b32 v104, 0
v_mov_b32 v105, 0
v_mov_b32 v106, 0
v_mov_b32 v107, 0
v_mov_b32 v108, 0
v_mov_b32 v109, 0
v_mov_b32 v110, 0
v_mov_b32 v111, 0
v_mov_b32 v112, 0
v_mov_b32 v113, 0
v_mov_b32 v114, 0
v_mov_b32 v115, 0
v_mov_b32 v116, 0
v_mov_b32 v117, 0
v_mov_b32 v118, 0
v_mov_b32 v119, 0
v_mov_b32 v120, 0
v_mov_b32 v121, 0
v_mov_b32 v122, 0
v_mov_b32 v123, 0
v_mov_b32 v124, 0
v_mov_b32 v125, 0
v_mov_b32 v126, 0
v_mov_b32 v127, 0
v_mov_b32 v128, 0
v_mov_b32 v129, 0
v_mov_b32 v130, 0
v_mov_b32 v131, 0
v_mov_b32 v132, 0
v_mov_b32 v133, 0
v_mov_b32 v134, 0
v_mov_b32 v135, 0
v_mov_b32 v136, 0
v_mov_b32 v137, 0
v_mov_b32 v138, 0
v_mov_b32 v139, 0
v_mov_b32 v140, 0
v_mov_b32 v141, 0
v_mov_b32 v142, 0
v_mov_b32 v143, 0
v_lshrrev_b32 v244, 4, v0
v_lshlrev_b32 v244, 2, v244
v_and_b32 v245, 15, v0
v_sub_u32 v244, v245, v244
v_mov_b32 v160, 0xff800000
v_mov_b32 v164, 0
s_lshl_b32 s80, s90, 4
v_add_u32 v168, s80, v244
v_mov_b32 v161, 0xff800000
v_mov_b32 v165, 0
s_lshl_b32 s80, s91, 4
v_add_u32 v169, s80, v244
v_mov_b32 v162, 0xff800000
v_mov_b32 v166, 0
s_lshl_b32 s80, s92, 4
v_add_u32 v170, s80, v244
v_mov_b32 v163, 0xff800000
v_mov_b32 v167, 0
s_lshl_b32 s80, s93, 4
v_add_u32 v171, s80, v244
v_xor_b32 v172, 16, v0
v_lshlrev_b32 v172, 2, v172
v_xor_b32 v173, 32, v0
v_lshlrev_b32 v173, 2, v173
v_mov_b32 v251, 0xff800000
s_mov_b32 s87, 0
L_slow_loop:
s_add_u32 s80, s87, 0
buffer_load_dwordx4 a[0:3], v1, s[60:63], s80 offen offset:0 sc1
buffer_load_dwordx4 a[4:7], v1, s[60:63], s80 offen offset:1024 sc1
buffer_load_dwordx4 a[8:11], v1, s[60:63], s80 offen offset:2048 sc1
buffer_load_dwordx4 a[12:15], v1, s[60:63], s80 offen offset:3072 sc1
s_add_u32 s80, s87, 4096
buffer_load_dwordx4 a[16:19], v1, s[60:63], s80 offen offset:0 sc1
buffer_load_dwordx4 a[20:23], v1, s[60:63], s80 offen offset:1024 sc1
buffer_load_dwordx4 a[24:27], v1, s[60:63], s80 offen offset:2048 sc1
buffer_load_dwordx4 a[28:31], v1, s[60:63], s80 offen offset:3072 sc1
s_add_u32 s80, s87, 8192
buffer_load_dwordx4 a[32:35], v1, s[60:63], s80 offen offset:0 sc1
buffer_load_dwordx4 a[36:39], v1, s[60:63], s80 offen offset:1024 sc1
buffer_load_dwordx4 a[40:43], v1, s[60:63], s80 offen offset:2048 sc1
buffer_load_dwordx4 a[44:47], v1, s[60:63], s80 offen offset:3072 sc1
s_add_u32 s80, s87, 12288
buffer_load_dwordx4 a[48:51], v1, s[60:63], s80 offen offset:0 sc1
buffer_load_dwordx4 a[52:55], v1, s[60:63], s80 offen offset:1024 sc1
buffer_load_dwordx4 a[56:59], v1, s[60:63], s80 offen offset:2048 sc1
buffer_load_dwordx4 a[60:63], v1, s[60:63], s80 offen offset:3072 sc1
s_waitcnt vmcnt(0)
v_mfma_f32_16x16x32_bf16 v[144:147], a[0:3], v[176:179], 0
v_mfma_f32_16x16x32_bf16 v[144:147], a[4:7], v[180:183], v[144:147]
v_mfma_f32_16x16x32_bf16 v[144:147], a[8:11], v[184:187], v[144:147]
v_mfma_f32_16x16x32_bf16 v[144:147], a[12:15], v[188:191], v[144:147]
v_mfma_f32_16x16x32_bf16 v[148:151], a[16:19], v[176:179], 0
v_mfma_f32_16x16x32_bf16 v[148:151], a[20:23], v[180:183], v[148:151]
v_mfma_f32_16x16x32_bf16 v[148:151], a[24:27], v[184:187], v[148:151]
v_mfma_f32_16x16x32_bf16 v[148:151], a[28:31], v[188:191], v[148:151]
s_nop 7
v_cmp_le_i32 vcc, 0, v168
s_nop 1
v_cndmask_b32 v144, v251, v144, vcc
v_cmp_le_i32 vcc, 1, v168
s_nop 1
v_cndmask_b32 v145, v251, v145, vcc
v_cmp_le_i32 vcc, 2, v168
s_nop 1
v_cndmask_b32 v146, v251, v146, vcc
v_cmp_le_i32 vcc, 3, v168
s_nop 1
v_cndmask_b32 v147, v251, v147, vcc
v_cmp_le_i32 vcc, 16, v168
s_nop 1
v_cndmask_b32 v148, v251, v148, vcc
v_cmp_le_i32 vcc, 17, v168
s_nop 1
v_cndmask_b32 v149, v251, v149, vcc
v_cmp_le_i32 vcc, 18, v168
s_nop 1
v_cndmask_b32 v150, v251, v150, vcc
v_cmp_le_i32 vcc, 19, v168
s_nop 1
v_cndmask_b32 v151, v251, v151, vcc
v_subrev_u32 v168, 32, v168
v_max3_f32 v244, v144, v145, v146
v_max3_f32 v244, v244, v147, v148
v_max3_f32 v244, v244, v149, v150
v_max3_f32 v244, v244, v151, v160
ds_bpermute_b32 v245, v172, v244
s_waitcnt lgkmcnt(0)
v_max_f32 v244, v244, v245
ds_bpermute_b32 v245, v173, v244
s_waitcnt lgkmcnt(0)
v_max_f32 v244, v244, v245
v_sub_f32 v245, v160, v244
v_exp_f32 v245, v245
v_mov_b32 v160, v244
v_sub_f32 v144, v144, v244
v_sub_f32 v145, v145, v244
v_sub_f32 v146, v146, v244
v_sub_f32 v147, v147, v244
v_sub_f32 v148, v148, v244
v_sub_f32 v149, v149, v244
v_sub_f32 v150, v150, v244
v_sub_f32 v151, v151, v244
v_exp_f32 v144, v144
v_exp_f32 v145, v145
v_exp_f32 v146, v146
v_exp_f32 v147, v147
v_exp_f32 v148, v148
v_exp_f32 v149, v149
v_exp_f32 v150, v150
v_exp_f32 v151, v151
v_mul_f32 v164, v164, v245
v_add_f32 v164, v164, v144
v_add_f32 v164, v164, v145
v_add_f32 v164, v164, v146
v_add_f32 v164, v164, v147
v_add_f32 v164, v164, v148
v_add_f32 v164, v164, v149
v_add_f32 v164, v164, v150
v_add_f32 v164, v164, v151
v_cvt_pk_bf16_f32 v240, v144, v145
v_cvt_pk_bf16_f32 v241, v146, v147
v_cvt_pk_bf16_f32 v242, v148, v149
v_cvt_pk_bf16_f32 v243, v150, v151
v_mul_f32 v16, v16, v245
v_mul_f32 v17, v17, v245
v_mul_f32 v18, v18, v245
v_mul_f32 v19, v19, v245
v_mul_f32 v20, v20, v245
v_mul_f32 v21, v21, v245
v_mul_f32 v22, v22, v245
v_mul_f32 v23, v23, v245
v_mul_f32 v24, v24, v245
v_mul_f32 v25, v25, v245
v_mul_f32 v26, v26, v245
v_mul_f32 v27, v27, v245
v_mul_f32 v28, v28, v245
v_mul_f32 v29, v29, v245
v_mul_f32 v30, v30, v245
v_mul_f32 v31, v31, v245
v_mul_f32 v32, v32, v245
v_mul_f32 v33, v33, v245
v_mul_f32 v34, v34, v245
v_mul_f32 v35, v35, v245
v_mul_f32 v36, v36, v245
v_mul_f32 v37, v37, v245
v_mul_f32 v38, v38, v245
v_mul_f32 v39, v39, v245
v_mul_f32 v40, v40, v245
v_mul_f32 v41, v41, v245
v_mul_f32 v42, v42, v245
v_mul_f32 v43, v43, v245
v_mul_f32 v44, v44, v245
v_mul_f32 v45, v45, v245
v_mul_f32 v46, v46, v245
v_mul_f32 v47, v47, v245
s_nop 1
v_mfma_f32_16x16x32_bf16 v[16:19], a[32:35], v[240:243], v[16:19]
v_mfma_f32_16x16x32_bf16 v[20:23], a[36:39], v[240:243], v[20:23]
v_mfma_f32_16x16x32_bf16 v[24:27], a[40:43], v[240:243], v[24:27]
v_mfma_f32_16x16x32_bf16 v[28:31], a[44:47], v[240:243], v[28:31]
v_mfma_f32_16x16x32_bf16 v[32:35], a[48:51], v[240:243], v[32:35]
v_mfma_f32_16x16x32_bf16 v[36:39], a[52:55], v[240:243], v[36:39]
v_mfma_f32_16x16x32_bf16 v[40:43], a[56:59], v[240:243], v[40:43]
v_mfma_f32_16x16x32_bf16 v[44:47], a[60:63], v[240:243], v[44:47]
v_mfma_f32_16x16x32_bf16 v[144:147], a[0:3], v[192:195], 0
v_mfma_f32_16x16x32_bf16 v[144:147], a[4:7], v[196:199], v[144:147]
v_mfma_f32_16x16x32_bf16 v[144:147], a[8:11], v[200:203], v[144:147]
v_mfma_f32_16x16x32_bf16 v[144:147], a[12:15], v[204:207], v[144:147]
v_mfma_f32_16x16x32_bf16 v[148:151], a[16:19], v[192:195], 0
v_mfma_f32_16x16x32_bf16 v[148:151], a[20:23], v[196:199], v[148:151]
v_mfma_f32_16x16x32_bf16 v[148:151], a[24:27], v[200:203], v[148:151]
v_mfma_f32_16x16x32_bf16 v[148:151], a[28:31], v[204:207], v[148:151]
s_nop 7
v_cmp_le_i32 vcc, 0, v169
s_nop 1
v_cndmask_b32 v144, v251, v144, vcc
v_cmp_le_i32 vcc, 1, v169
s_nop 1
v_cndmask_b32 v145, v251, v145, vcc
v_cmp_le_i32 vcc, 2, v169
s_nop 1
v_cndmask_b32 v146, v251, v146, vcc
v_cmp_le_i32 vcc, 3, v169
s_nop 1
v_cndmask_b32 v147, v251, v147, vcc
v_cmp_le_i32 vcc, 16, v169
s_nop 1
v_cndmask_b32 v148, v251, v148, vcc
v_cmp_le_i32 vcc, 17, v169
s_nop 1
v_cndmask_b32 v149, v251, v149, vcc
v_cmp_le_i32 vcc, 18, v169
s_nop 1
v_cndmask_b32 v150, v251, v150, vcc
v_cmp_le_i32 vcc, 19, v169
s_nop 1
v_cndmask_b32 v151, v251, v151, vcc
v_subrev_u32 v169, 32, v169
v_max3_f32 v244, v144, v145, v146
v_max3_f32 v244, v244, v147, v148
v_max3_f32 v244, v244, v149, v150
v_max3_f32 v244, v244, v151, v161
ds_bpermute_b32 v245, v172, v244
s_waitcnt lgkmcnt(0)
v_max_f32 v244, v244, v245
ds_bpermute_b32 v245, v173, v244
s_waitcnt lgkmcnt(0)
v_max_f32 v244, v244, v245
v_sub_f32 v245, v161, v244
v_exp_f32 v245, v245
v_mov_b32 v161, v244
v_sub_f32 v144, v144, v244
v_sub_f32 v145, v145, v244
v_sub_f32 v146, v146, v244
v_sub_f32 v147, v147, v244
v_sub_f32 v148, v148, v244
v_sub_f32 v149, v149, v244
v_sub_f32 v150, v150, v244
v_sub_f32 v151, v151, v244
v_exp_f32 v144, v144
v_exp_f32 v145, v145
v_exp_f32 v146, v146
v_exp_f32 v147, v147
v_exp_f32 v148, v148
v_exp_f32 v149, v149
v_exp_f32 v150, v150
v_exp_f32 v151, v151
v_mul_f32 v165, v165, v245
v_add_f32 v165, v165, v144
v_add_f32 v165, v165, v145
v_add_f32 v165, v165, v146
v_add_f32 v165, v165, v147
v_add_f32 v165, v165, v148
v_add_f32 v165, v165, v149
v_add_f32 v165, v165, v150
v_add_f32 v165, v165, v151
v_cvt_pk_bf16_f32 v240, v144, v145
v_cvt_pk_bf16_f32 v241, v146, v147
v_cvt_pk_bf16_f32 v242, v148, v149
v_cvt_pk_bf16_f32 v243, v150, v151
v_mul_f32 v48, v48, v245
v_mul_f32 v49, v49, v245
v_mul_f32 v50, v50, v245
v_mul_f32 v51, v51, v245
v_mul_f32 v52, v52, v245
v_mul_f32 v53, v53, v245
v_mul_f32 v54, v54, v245
v_mul_f32 v55, v55, v245
v_mul_f32 v56, v56, v245
v_mul_f32 v57, v57, v245
v_mul_f32 v58, v58, v245
v_mul_f32 v59, v59, v245
v_mul_f32 v60, v60, v245
v_mul_f32 v61, v61, v245
v_mul_f32 v62, v62, v245
v_mul_f32 v63, v63, v245
v_mul_f32 v64, v64, v245
v_mul_f32 v65, v65, v245
v_mul_f32 v66, v66, v245
v_mul_f32 v67, v67, v245
v_mul_f32 v68, v68, v245
v_mul_f32 v69, v69, v245
v_mul_f32 v70, v70, v245
v_mul_f32 v71, v71, v245
v_mul_f32 v72, v72, v245
v_mul_f32 v73, v73, v245
v_mul_f32 v74, v74, v245
v_mul_f32 v75, v75, v245
v_mul_f32 v76, v76, v245
v_mul_f32 v77, v77, v245
v_mul_f32 v78, v78, v245
v_mul_f32 v79, v79, v245
s_nop 1
v_mfma_f32_16x16x32_bf16 v[48:51], a[32:35], v[240:243], v[48:51]
v_mfma_f32_16x16x32_bf16 v[52:55], a[36:39], v[240:243], v[52:55]
v_mfma_f32_16x16x32_bf16 v[56:59], a[40:43], v[240:243], v[56:59]
v_mfma_f32_16x16x32_bf16 v[60:63], a[44:47], v[240:243], v[60:63]
v_mfma_f32_16x16x32_bf16 v[64:67], a[48:51], v[240:243], v[64:67]
v_mfma_f32_16x16x32_bf16 v[68:71], a[52:55], v[240:243], v[68:71]
v_mfma_f32_16x16x32_bf16 v[72:75], a[56:59], v[240:243], v[72:75]
v_mfma_f32_16x16x32_bf16 v[76:79], a[60:63], v[240:243], v[76:79]
v_mfma_f32_16x16x32_bf16 v[144:147], a[0:3], v[208:211], 0
v_mfma_f32_16x16x32_bf16 v[144:147], a[4:7], v[212:215], v[144:147]
v_mfma_f32_16x16x32_bf16 v[144:147], a[8:11], v[216:219], v[144:147]
v_mfma_f32_16x16x32_bf16 v[144:147], a[12:15], v[220:223], v[144:147]
v_mfma_f32_16x16x32_bf16 v[148:151], a[16:19], v[208:211], 0
v_mfma_f32_16x16x32_bf16 v[148:151], a[20:23], v[212:215], v[148:151]
v_mfma_f32_16x16x32_bf16 v[148:151], a[24:27], v[216:219], v[148:151]
v_mfma_f32_16x16x32_bf16 v[148:151], a[28:31], v[220:223], v[148:151]
s_nop 7
v_cmp_le_i32 vcc, 0, v170
s_nop 1
v_cndmask_b32 v144, v251, v144, vcc
v_cmp_le_i32 vcc, 1, v170
s_nop 1
v_cndmask_b32 v145, v251, v145, vcc
v_cmp_le_i32 vcc, 2, v170
s_nop 1
v_cndmask_b32 v146, v251, v146, vcc
v_cmp_le_i32 vcc, 3, v170
s_nop 1
v_cndmask_b32 v147, v251, v147, vcc
v_cmp_le_i32 vcc, 16, v170
s_nop 1
v_cndmask_b32 v148, v251, v148, vcc
v_cmp_le_i32 vcc, 17, v170
s_nop 1
v_cndmask_b32 v149, v251, v149, vcc
v_cmp_le_i32 vcc, 18, v170
s_nop 1
v_cndmask_b32 v150, v251, v150, vcc
v_cmp_le_i32 vcc, 19, v170
s_nop 1
v_cndmask_b32 v151, v251, v151, vcc
v_subrev_u32 v170, 32, v170
v_max3_f32 v244, v144, v145, v146
v_max3_f32 v244, v244, v147, v148
v_max3_f32 v244, v244, v149, v150
v_max3_f32 v244, v244, v151, v162
ds_bpermute_b32 v245, v172, v244
s_waitcnt lgkmcnt(0)
v_max_f32 v244, v244, v245
ds_bpermute_b32 v245, v173, v244
s_waitcnt lgkmcnt(0)
v_max_f32 v244, v244, v245
v_sub_f32 v245, v162, v244
v_exp_f32 v245, v245
v_mov_b32 v162, v244
v_sub_f32 v144, v144, v244
v_sub_f32 v145, v145, v244
v_sub_f32 v146, v146, v244
v_sub_f32 v147, v147, v244
v_sub_f32 v148, v148, v244
v_sub_f32 v149, v149, v244
v_sub_f32 v150, v150, v244
v_sub_f32 v151, v151, v244
v_exp_f32 v144, v144
v_exp_f32 v145, v145
v_exp_f32 v146, v146
v_exp_f32 v147, v147
v_exp_f32 v148, v148
v_exp_f32 v149, v149
v_exp_f32 v150, v150
v_exp_f32 v151, v151
v_mul_f32 v166, v166, v245
v_add_f32 v166, v166, v144
v_add_f32 v166, v166, v145
v_add_f32 v166, v166, v146
v_add_f32 v166, v166, v147
v_add_f32 v166, v166, v148
v_add_f32 v166, v166, v149
v_add_f32 v166, v166, v150
v_add_f32 v166, v166, v151
v_cvt_pk_bf16_f32 v240, v144, v145
v_cvt_pk_bf16_f32 v241, v146, v147
v_cvt_pk_bf16_f32 v242, v148, v149
v_cvt_pk_bf16_f32 v243, v150, v151
v_mul_f32 v80, v80, v245
v_mul_f32 v81, v81, v245
v_mul_f32 v82, v82, v245
v_mul_f32 v83, v83, v245
v_mul_f32 v84, v84, v245
v_mul_f32 v85, v85, v245
v_mul_f32 v86, v86, v245
v_mul_f32 v87, v87, v245
v_mul_f32 v88, v88, v245
v_mul_f32 v89, v89, v245
v_mul_f32 v90, v90, v245
v_mul_f32 v91, v91, v245
v_mul_f32 v92, v92, v245
v_mul_f32 v93, v93, v245
v_mul_f32 v94, v94, v245
v_mul_f32 v95, v95, v245
v_mul_f32 v96, v96, v245
v_mul_f32 v97, v97, v245
v_mul_f32 v98, v98, v245
v_mul_f32 v99, v99, v245
v_mul_f32 v100, v100, v245
v_mul_f32 v101, v101, v245
v_mul_f32 v102, v102, v245
v_mul_f32 v103, v103, v245
v_mul_f32 v104, v104, v245
v_mul_f32 v105, v105, v245
v_mul_f32 v106, v106, v245
v_mul_f32 v107, v107, v245
v_mul_f32 v108, v108, v245
v_mul_f32 v109, v109, v245
v_mul_f32 v110, v110, v245
v_mul_f32 v111, v111, v245
s_nop 1
v_mfma_f32_16x16x32_bf16 v[80:83], a[32:35], v[240:243], v[80:83]
v_mfma_f32_16x16x32_bf16 v[84:87], a[36:39], v[240:243], v[84:87]
v_mfma_f32_16x16x32_bf16 v[88:91], a[40:43], v[240:243], v[88:91]
v_mfma_f32_16x16x32_bf16 v[92:95], a[44:47], v[240:243], v[92:95]
v_mfma_f32_16x16x32_bf16 v[96:99], a[48:51], v[240:243], v[96:99]
v_mfma_f32_16x16x32_bf16 v[100:103], a[52:55], v[240:243], v[100:103]
v_mfma_f32_16x16x32_bf16 v[104:107], a[56:59], v[240:243], v[104:107]
v_mfma_f32_16x16x32_bf16 v[108:111], a[60:63], v[240:243], v[108:111]
v_mfma_f32_16x16x32_bf16 v[144:147], a[0:3], v[224:227], 0
v_mfma_f32_16x16x32_bf16 v[144:147], a[4:7], v[228:231], v[144:147]
v_mfma_f32_16x16x32_bf16 v[144:147], a[8:11], v[232:235], v[144:147]
v_mfma_f32_16x16x32_bf16 v[144:147], a[12:15], v[236:239], v[144:147]
v_mfma_f32_16x16x32_bf16 v[148:151], a[16:19], v[224:227], 0
v_mfma_f32_16x16x32_bf16 v[148:151], a[20:23], v[228:231], v[148:151]
v_mfma_f32_16x16x32_bf16 v[148:151], a[24:27], v[232:235], v[148:151]
v_mfma_f32_16x16x32_bf16 v[148:151], a[28:31], v[236:239], v[148:151]
s_nop 7
v_cmp_le_i32 vcc, 0, v171
s_nop 1
v_cndmask_b32 v144, v251, v144, vcc
v_cmp_le_i32 vcc, 1, v171
s_nop 1
v_cndmask_b32 v145, v251, v145, vcc
v_cmp_le_i32 vcc, 2, v171
s_nop 1
v_cndmask_b32 v146, v251, v146, vcc
v_cmp_le_i32 vcc, 3, v171
s_nop 1
v_cndmask_b32 v147, v251, v147, vcc
v_cmp_le_i32 vcc, 16, v171
s_nop 1
v_cndmask_b32 v148, v251, v148, vcc
v_cmp_le_i32 vcc, 17, v171
s_nop 1
v_cndmask_b32 v149, v251, v149, vcc
v_cmp_le_i32 vcc, 18, v171
s_nop 1
v_cndmask_b32 v150, v251, v150, vcc
v_cmp_le_i32 vcc, 19, v171
s_nop 1
v_cndmask_b32 v151, v251, v151, vcc
v_subrev_u32 v171, 32, v171
v_max3_f32 v244, v144, v145, v146
v_max3_f32 v244, v244, v147, v148
v_max3_f32 v244, v244, v149, v150
v_max3_f32 v244, v244, v151, v163
ds_bpermute_b32 v245, v172, v244
s_waitcnt lgkmcnt(0)
v_max_f32 v244, v244, v245
ds_bpermute_b32 v245, v173, v244
s_waitcnt lgkmcnt(0)
v_max_f32 v244, v244, v245
v_sub_f32 v245, v163, v244
v_exp_f32 v245, v245
v_mov_b32 v163, v244
v_sub_f32 v144, v144, v244
v_sub_f32 v145, v145, v244
v_sub_f32 v146, v146, v244
v_sub_f32 v147, v147, v244
v_sub_f32 v148, v148, v244
v_sub_f32 v149, v149, v244
v_sub_f32 v150, v150, v244
v_sub_f32 v151, v151, v244
v_exp_f32 v144, v144
v_exp_f32 v145, v145
v_exp_f32 v146, v146
v_exp_f32 v147, v147
v_exp_f32 v148, v148
v_exp_f32 v149, v149
v_exp_f32 v150, v150
v_exp_f32 v151, v151
v_mul_f32 v167, v167, v245
v_add_f32 v167, v167, v144
v_add_f32 v167, v167, v145
v_add_f32 v167, v167, v146
v_add_f32 v167, v167, v147
v_add_f32 v167, v167, v148
v_add_f32 v167, v167, v149
v_add_f32 v167, v167, v150
v_add_f32 v167, v167, v151
v_cvt_pk_bf16_f32 v240, v144, v145
v_cvt_pk_bf16_f32 v241, v146, v147
v_cvt_pk_bf16_f32 v242, v148, v149
v_cvt_pk_bf16_f32 v243, v150, v151
v_mul_f32 v112, v112, v245
v_mul_f32 v113, v113, v245
v_mul_f32 v114, v114, v245
v_mul_f32 v115, v115, v245
v_mul_f32 v116, v116, v245
v_mul_f32 v117, v117, v245
v_mul_f32 v118, v118, v245
v_mul_f32 v119, v119, v245
v_mul_f32 v120, v120, v245
v_mul_f32 v121, v121, v245
v_mul_f32 v122, v122, v245
v_mul_f32 v123, v123, v245
v_mul_f32 v124, v124, v245
v_mul_f32 v125, v125, v245
v_mul_f32 v126, v126, v245
v_mul_f32 v127, v127, v245
v_mul_f32 v128, v128, v245
v_mul_f32 v129, v129, v245
v_mul_f32 v130, v130, v245
v_mul_f32 v131, v131, v245
v_mul_f32 v132, v132, v245
v_mul_f32 v133, v133, v245
v_mul_f32 v134, v134, v245
v_mul_f32 v135, v135, v245
v_mul_f32 v136, v136, v245
v_mul_f32 v137, v137, v245
v_mul_f32 v138, v138, v245
v_mul_f32 v139, v139, v245
v_mul_f32 v140, v140, v245
v_mul_f32 v141, v141, v245
v_mul_f32 v142, v142, v245
v_mul_f32 v143, v143, v245
s_nop 1
v_mfma_f32_16x16x32_bf16 v[112:115], a[32:35], v[240:243], v[112:115]
v_mfma_f32_16x16x32_bf16 v[116:119], a[36:39], v[240:243], v[116:119]
v_mfma_f32_16x16x32_bf16 v[120:123], a[40:43], v[240:243], v[120:123]
v_mfma_f32_16x16x32_bf16 v[124:127], a[44:47], v[240:243], v[124:127]
v_mfma_f32_16x16x32_bf16 v[128:131], a[48:51], v[240:243], v[128:131]
v_mfma_f32_16x16x32_bf16 v[132:135], a[52:55], v[240:243], v[132:135]
v_mfma_f32_16x16x32_bf16 v[136:139], a[56:59], v[240:243], v[136:139]
v_mfma_f32_16x16x32_bf16 v[140:143], a[60:63], v[240:243], v[140:143]
s_add_u32 s87, s87, 16384
s_cmp_lt_u32 s87, s62
s_cbranch_scc1 L_slow_loop
ds_bpermute_b32 v245, v172, v164
s_waitcnt lgkmcnt(0)
v_add_f32 v164, v164, v245
ds_bpermute_b32 v245, v173, v164
s_waitcnt lgkmcnt(0)
v_add_f32 v164, v164, v245
v_mov_b32 v152, v164
ds_bpermute_b32 v245, v172, v165
s_waitcnt lgkmcnt(0)
v_add_f32 v165, v165, v245
ds_bpermute_b32 v245, v173, v165
s_waitcnt lgkmcnt(0)
v_add_f32 v165, v165, v245
v_mov_b32 v154, v165
ds_bpermute_b32 v245, v172, v166
s_waitcnt lgkmcnt(0)
v_add_f32 v166, v166, v245
ds_bpermute_b32 v245, v173, v166
s_waitcnt lgkmcnt(0)
v_add_f32 v166, v166, v245
v_mov_b32 v156, v166
ds_bpermute_b32 v245, v172, v167
s_waitcnt lgkmcnt(0)
v_add_f32 v167, v167, v245
ds_bpermute_b32 v245, v173, v167
s_waitcnt lgkmcnt(0)
v_add_f32 v167, v167, v245
v_mov_b32 v158, v167
v_rcp_f32 v152, v152
v_rcp_f32 v154, v154
s_nop 0
v_pk_mul_f32 v[16:17], v[16:17], v[152:153] op_sel_hi:[1,0]
v_pk_mul_f32 v[18:19], v[18:19], v[152:153] op_sel_hi:[1,0]
v_pk_mul_f32 v[20:21], v[20:21], v[152:153] op_sel_hi:[1,0]
v_pk_mul_f32 v[22:23], v[22:23], v[152:153] op_sel_hi:[1,0]
s_add_u32 s84, s94, 0
v_cvt_pk_bf16_f32 v16, v16, v17
v_cvt_pk_bf16_f32 v17, v18, v19
v_cvt_pk_bf16_f32 v18, v20, v21
v_cvt_pk_bf16_f32 v19, v22, v23
buffer_store_dwordx4 v[16:19], v1, s[56:59], s84 offen sc1
v_pk_mul_f32 v[24:25], v[24:25], v[152:153] op_sel_hi:[1,0]
v_pk_mul_f32 v[26:27], v[26:27], v[152:153] op_sel_hi:[1,0]
v_pk_mul_f32 v[28:29], v[28:29], v[152:153] op_sel_hi:[1,0]
v_pk_mul_f32 v[30:31], v[30:31], v[152:153] op_sel_hi:[1,0]
s_add_u32 s84, s94, 4096
v_cvt_pk_bf16_f32 v24, v24, v25
v_cvt_pk_bf16_f32 v25, v26, v27
v_cvt_pk_bf16_f32 v26, v28, v29
v_cvt_pk_bf16_f32 v27, v30, v31
buffer_store_dwordx4 v[24:27], v1, s[56:59], s84 offen sc1
v_pk_mul_f32 v[32:33], v[32:33], v[152:153] op_sel_hi:[1,0]
v_pk_mul_f32 v[34:35], v[34:35], v[152:153] op_sel_hi:[1,0]
v_pk_mul_f32 v[36:37], v[36:37], v[152:153] op_sel_hi:[1,0]
v_pk_mul_f32 v[38:39], v[38:39], v[152:153] op_sel_hi:[1,0]
s_add_u32 s84, s94, 8192
v_cvt_pk_bf16_f32 v32, v32, v33
v_cvt_pk_bf16_f32 v33, v34, v35
v_cvt_pk_bf16_f32 v34, v36, v37
v_cvt_pk_bf16_f32 v35, v38, v39
buffer_store_dwordx4 v[32:35], v1, s[56:59], s84 offen sc1
v_pk_mul_f32 v[40:41], v[40:41], v[152:153] op_sel_hi:[1,0]
v_pk_mul_f32 v[42:43], v[42:43], v[152:153] op_sel_hi:[1,0]
v_pk_mul_f32 v[44:45], v[44:45], v[152:153] op_sel_hi:[1,0]
v_pk_mul_f32 v[46:47], v[46:47], v[152:153] op_sel_hi:[1,0]
s_add_u32 s84, s94, 12288
v_cvt_pk_bf16_f32 v40, v40, v41
v_cvt_pk_bf16_f32 v41, v42, v43
v_cvt_pk_bf16_f32 v42, v44, v45
v_cvt_pk_bf16_f32 v43, v46, v47
buffer_store_dwordx4 v[40:43], v1, s[56:59], s84 offen sc1
v_pk_mul_f32 v[48:49], v[48:49], v[154:155] op_sel_hi:[1,0]
v_pk_mul_f32 v[50:51], v[50:51], v[154:155] op_sel_hi:[1,0]
v_pk_mul_f32 v[52:53], v[52:53], v[154:155] op_sel_hi:[1,0]
v_pk_mul_f32 v[54:55], v[54:55], v[154:155] op_sel_hi:[1,0]
s_add_u32 s84, s95, 0
v_cvt_pk_bf16_f32 v48, v48, v49
v_cvt_pk_bf16_f32 v49, v50, v51
v_cvt_pk_bf16_f32 v50, v52, v53
v_cvt_pk_bf16_f32 v51, v54, v55
buffer_store_dwordx4 v[48:51], v1, s[56:59], s84 offen sc1
v_pk_mul_f32 v[56:57], v[56:57], v[154:155] op_sel_hi:[1,0]
v_pk_mul_f32 v[58:59], v[58:59], v[154:155] op_sel_hi:[1,0]
v_pk_mul_f32 v[60:61], v[60:61], v[154:155] op_sel_hi:[1,0]
v_pk_mul_f32 v[62:63], v[62:63], v[154:155] op_sel_hi:[1,0]
s_add_u32 s84, s95, 4096
v_cvt_pk_bf16_f32 v56, v56, v57
v_cvt_pk_bf16_f32 v57, v58, v59
v_cvt_pk_bf16_f32 v58, v60, v61
v_cvt_pk_bf16_f32 v59, v62, v63
buffer_store_dwordx4 v[56:59], v1, s[56:59], s84 offen sc1
v_pk_mul_f32 v[64:65], v[64:65], v[154:155] op_sel_hi:[1,0]
v_pk_mul_f32 v[66:67], v[66:67], v[154:155] op_sel_hi:[1,0]
v_pk_mul_f32 v[68:69], v[68:69], v[154:155] op_sel_hi:[1,0]
v_pk_mul_f32 v[70:71], v[70:71], v[154:155] op_sel_hi:[1,0]
s_add_u32 s84, s95, 8192
v_cvt_pk_bf16_f32 v64, v64, v65
v_cvt_pk_bf16_f32 v65, v66, v67
v_cvt_pk_bf16_f32 v66, v68, v69
v_cvt_pk_bf16_f32 v67, v70, v71
buffer_store_dwordx4 v[64:67], v1, s[56:59], s84 offen sc1
v_pk_mul_f32 v[72:73], v[72:73], v[154:155] op_sel_hi:[1,0]
v_pk_mul_f32 v[74:75], v[74:75], v[154:155] op_sel_hi:[1,0]
v_pk_mul_f32 v[76:77], v[76:77], v[154:155] op_sel_hi:[1,0]
v_pk_mul_f32 v[78:79], v[78:79], v[154:155] op_sel_hi:[1,0]
s_add_u32 s84, s95, 12288
v_cvt_pk_bf16_f32 v72, v72, v73
v_cvt_pk_bf16_f32 v73, v74, v75
v_cvt_pk_bf16_f32 v74, v76, v77
v_cvt_pk_bf16_f32 v75, v78, v79
buffer_store_dwordx4 v[72:75], v1, s[56:59], s84 offen sc1
s_waitcnt vmcnt(0)
s_branch L_slow_ret
L_ctx_spin0:
s_mov_b32 s83, 65536
L_ctx_spin:
s_sleep 1
buffer_load_dword v4, v2, s[56:59], s101 offen sc1
s_waitcnt vmcnt(0)
v_readfirstlane_b32 s26, v4
s_add_u32 s26, s26, s3
s_cmp_ge_u32 s26, 8
s_cbranch_scc1 L_ctx_ok
s_sub_u32 s83, s83, 1
s_cmp_lg_u32 s83, 0
s_cbranch_scc1 L_ctx_spin
s_branch L_ctx_ok
L_x_spin0:
s_mov_b32 s83, 65536
L_x_spin:
buffer_load_dword v4, v2, s[56:59], s101 offen sc1
s_waitcnt vmcnt(0)
s_nop 0
v_readfirstlane_b32 s26, v4
s_cmp_ge_u32 s26, 4
s_cbranch_scc1 L_x_ok
s_sub_u32 s83, s83, 1
s_cmp_lg_u32 s83, 0
s_cbranch_scc1 L_x_spin
s_branch L_x_ok
L_exit:
s_endpgm
.section .rodata,"a"
.p2align 6
.amdhsa_kernel gated_mix__compressed_kv_cla__dense_activation_gelu__prompt_kernel
  .amdhsa_next_free_vgpr 512
  .amdhsa_next_free_sgpr 102
  .amdhsa_accum_offset 256
  .amdhsa_group_segment_fixed_size 0
  .amdhsa_kernarg_size 120
  .amdhsa_user_sgpr_count 2
  .amdhsa_user_sgpr_kernarg_segment_ptr 1
  .amdhsa_system_sgpr_workgroup_id_x 1
  .amdhsa_float_denorm_mode_32 3
  .amdhsa_float_denorm_mode_16_64 3
.end_amdhsa_kernel
```
